```python
import torch

def _softmax(x, axis=-1):
    return torch.softmax(x, dim=axis)
def _gelu(x):
    return torch.nn.functional.gelu(x, approximate="tanh")
def _silu(x):
    return torch.nn.functional.silu(x)
def _sigmoid(x):
    return torch.sigmoid(x)
def _layernorm(x, axis=-1, eps=1e-5):
    m = x.mean(dim=axis, keepdim=True)
    v = x.var(dim=axis, keepdim=True, unbiased=False)
    return (x - m) / torch.sqrt(v + eps)
def _scatter_add(tgt, idx, src, axis=0):
    return tgt.clone().index_add_(axis, idx, src)
def _segment_sum(src, seg, n):
    out = torch.zeros((n,) + src.shape[1:], dtype=src.dtype)
    return out.index_add_(0, seg, src)
def _pad(x, pw):
    flat = tuple(v for pair in reversed(pw) for v in pair)
    return torch.nn.functional.pad(x, flat)

kernel_name = 'gated_mix__spectral_gfnet__mixer_token_mlp__prompt'

def setup_inputs():

    _w = (lambda a: (lambda t: t.to(torch.bfloat16) if t.is_floating_point() else t)(torch.as_tensor(a)))
    def _A_setup():
        B, S, D = 1, 2048, 512
        Df = D // 2 + 1
        return {
            "x": _w((lambda *s: torch.randn(*s, dtype=torch.bfloat16) * 0.05)(B, S, D)),
            "w_r": _w((lambda *s: torch.randn(*s, dtype=torch.bfloat16) * 0.8)(S, Df) * 0.02),
            "w_i": _w((lambda *s: torch.randn(*s, dtype=torch.bfloat16) * 1.6)(S, Df) * 0.02),
        }
    _A_in = _A_setup()

    def _B_setup():
        B, S, D, F = 1, 2048, 512, 1792
        return {
            "x": _w((lambda *s: torch.randn(*s, dtype=torch.bfloat16) * 0.05)(B, S, D)),
            "w1": _w((lambda *s: torch.randn(*s, dtype=torch.bfloat16) * 0.2)(S, F) * (S ** -0.5)),
            "b1": _w((lambda *s: torch.randn(*s, dtype=torch.bfloat16) * 3.2)(F) * 0.02),
            "w2": _w((lambda *s: torch.randn(*s, dtype=torch.bfloat16) * 0.05)(F, S) * (F ** -0.5)),
            "b2": _w((lambda *s: torch.randn(*s, dtype=torch.bfloat16) * 0.1)(S) * 0.02),
        }
    _B_in = _B_setup()

    return {
        "A_x": _A_in["x"],
        "A_w_r": _A_in["w_r"],
        "A_w_i": _A_in["w_i"],
        "B_x": _B_in["x"],
        "B_w1": _B_in["w1"],
        "B_b1": _B_in["b1"],
        "B_w2": _B_in["w2"],
        "B_b2": _B_in["b2"],
        "gate_w": _w((lambda *s: torch.randn(*s, dtype=torch.bfloat16) * 0.05)(512) * 16.0),
    }

def reference(A_x, A_w_r, A_w_i, B_x, B_w1, B_b1, B_w2, B_b2, gate_w):
    def _A_ref(x, w_r, w_i):
        B, S, D = x.shape
        X = (lambda x, axes=(-2,-1): torch.fft.rfft2(x.float(), dim=axes))(x, axes=(-2, -1))
        W = w_r + 1j * w_i
        X = X * W
        y = (lambda x, s, axes=(-2,-1): torch.fft.irfft2(x, s=s, dim=axes).to(torch.bfloat16))(X, (S, D), axes=(-2, -1))
        return y

    def _B_ref(x, w1, b1, w2, b2):
        B, S, D = x.shape
        h = _layernorm(x, axis=-1)
        u = torch.einsum("bsd,sf->bdf", h, w1) + b1
        u = _gelu(u)
        y = torch.einsum("bdf,fs->bds", u, w2) + b2
        return (lambda x, *d: x.permute(*d))(y, 0, 2, 1)

    x = A_x
    g = _sigmoid((x * gate_w).sum(-1, keepdims=True))
    a = _A_ref(x, A_w_r, A_w_i)
    b = _B_ref(x, B_w1, B_b1, B_w2, B_b2)
    return g * a + (1 - g) * b
```

```asm
; @launch grid=(256,1,1) block=(512,1,1) lds=163840
.amdgcn_target "amdgcn-amd-amdhsa--gfx950"
.text
.globl gated_mix__spectral_gfnet__mixer_token_mlp__prompt_kernel
.p2align 8
.type gated_mix__spectral_gfnet__mixer_token_mlp__prompt_kernel,@function
gated_mix__spectral_gfnet__mixer_token_mlp__prompt_kernel:
    s_cmp_ge_u32 s2, 256
    s_cbranch_scc1 L_end
    s_load_dwordx16 s[64:79], s[0:1], 0
    s_load_dwordx4 s[4:7], s[0:1], 64
    s_load_dwordx2 s[60:61], s[0:1], 88
    s_getpc_b64 s[28:29]
Lpc0:
    s_sub_u32 s28, s28, Lpc0-gated_mix__spectral_gfnet__mixer_token_mlp__prompt_kernel
    s_subb_u32 s29, s29, 0
    s_and_b32 s29, s29, 0xffff
    s_mov_b32 s30, TABLES-gated_mix__spectral_gfnet__mixer_token_mlp__prompt_kernel+69632
    s_mov_b32 s31, 0x00020000
    v_lshrrev_b32 v1, 6, v0
    v_and_b32 v2, 63, v0
    v_readfirstlane_b32 s48, v1
    v_lshlrev_b32 v3, 4, v2
    v_mov_b32 v4, 0
    v_mov_b32 v5, 0
    v_mov_b32 v6, 0
    v_mov_b32 v7, 0
    v_mov_b32 v8, 0
    v_mov_b32 v9, 0
    v_mov_b32 v10, 0
    v_mov_b32 v11, 0
    v_mov_b32 v12, 0
    v_mov_b32 v13, 0
    v_mov_b32 v14, 0
    v_mov_b32 v15, 0
    s_and_b32 s49, s2, 7
    s_lshr_b32 s50, s2, 3
    s_lshl_b32 s52, s49, 3
    s_bfe_u32 s3, s2, 0x30004
    s_lshr_b32 s53, s2, 7
    s_add_u32 s52, s52, s3
    s_sub_u32 s3, s50, 4
    s_lshr_b32 s59, s50, 1
    s_cmp_lt_u32 s50, 8
    s_cselect_b32 s3, s59, s3
    s_and_b32 s59, s49, 1
    s_lshl_b32 s59, s59, 2
    s_lshr_b32 s58, s3, 3
    s_add_u32 s55, s58, s59
    s_and_b32 s54, s3, 7
    s_add_u32 s59, s59, s54
    s_cmp_ge_u32 s3, 24
    s_cselect_b32 s55, 3, s55
    s_cselect_b32 s54, s59, s54
    s_lshl_b32 s58, s58, 1
    s_add_u32 s58, s58, s54
    s_mul_i32 s58, s58, 0
    s_lshr_b32 s3, s49, 1
    s_mul_i32 s3, s3, 7
    s_add_u32 s55, s55, s3
    s_and_b32 s56, s50, 7
    s_lshl_b32 s57, s49, 2
    s_lshr_b32 s3, s50, 3
    s_add_u32 s57, s57, s3
    s_and_b32 s3, s50, 0x19
    s_lshl_b32 s62, s53, 10
    s_add_u32 s62, s62, s52
    s_and_b32 s59, s48, 3
    s_lshl_b32 s63, s59, 8
    s_add_u32 s62, s62, s63
    s_lshl_b32 s62, s62, 10
    s_lshl_b32 s59, s59, 12
    s_add_u32 s59, s59, 131072
    s_waitcnt lgkmcnt(0)
    s_mov_b32 s8, s64
    s_and_b32 s9, s65, 0xffff
    s_mov_b32 s10, 2097152
    s_mov_b32 s11, 0x00020000
    s_cmp_lt_u32 s48, 4
    s_cbranch_scc1 L_xdone
    s_setprio 3
    s_bitcmp1_b32 s50, 0
    s_cbranch_scc1 L_xdma
    s_add_u32 s63, s62, 0
    buffer_load_dwordx4 v[16:19], v3, s[8:11], s63 offen
    s_add_u32 s63, s62, 65536
    buffer_load_dwordx4 v[20:23], v3, s[8:11], s63 offen
    s_add_u32 s63, s62, 131072
    buffer_load_dwordx4 v[24:27], v3, s[8:11], s63 offen
    s_add_u32 s63, s62, 196608
    buffer_load_dwordx4 v[28:31], v3, s[8:11], s63 offen
    s_branch L_xdone
L_xdma:
    s_add_u32 s63, s62, 0
    s_add_u32 m0, s59, 0
    s_nop 0
    buffer_load_dwordx4 v3, s[8:11], s63 offen  lds
    s_add_u32 s63, s62, 65536
    s_add_u32 m0, s59, 1024
    s_nop 0
    buffer_load_dwordx4 v3, s[8:11], s63 offen  lds
    s_add_u32 s63, s62, 131072
    s_add_u32 m0, s59, 2048
    s_nop 0
    buffer_load_dwordx4 v3, s[8:11], s63 offen  lds
    s_add_u32 s63, s62, 196608
    s_add_u32 m0, s59, 3072
    s_nop 0
    buffer_load_dwordx4 v3, s[8:11], s63 offen  lds
L_xdone:
    s_mov_b32 s20, s4
    s_and_b32 s21, s5, 0xffff
    s_mov_b32 s22, 1024
    s_mov_b32 s23, 0x00020000
    s_mov_b32 s12, s66
    s_and_b32 s13, s67, 0xffff
    s_mov_b32 s14, 1052672
    s_mov_b32 s15, 0x00020000
    s_mov_b32 s16, s68
    s_and_b32 s17, s69, 0xffff
    s_mov_b32 s18, 1052672
    s_mov_b32 s19, 0x00020000
    s_mov_b32 s32, s72
    s_and_b32 s33, s73, 0xffff
    s_mov_b32 s34, 7340032
    s_mov_b32 s35, 0x00020000
    s_mov_b32 s36, s76
    s_and_b32 s37, s77, 0xffff
    s_mov_b32 s38, 7340032
    s_mov_b32 s39, 0x00020000
    s_mov_b32 s44, s78
    s_and_b32 s45, s79, 0xffff
    s_mov_b32 s46, 4096
    s_mov_b32 s47, 0x00020000
    s_mov_b32 s40, s6
    s_and_b32 s41, s7, 0xffff
    s_mov_b32 s42, 2097152
    s_mov_b32 s43, 0x00020000
    s_mov_b32 s24, s60
    s_and_b32 s25, s61, 0xffff
    s_mov_b32 s26, 268435456
    s_mov_b32 s27, 0x00020000
    s_mov_b64 s[4:5], s[74:75]
    s_add_u32 s6, s60, 12623872
    s_addc_u32 s7, s61, 0
    v_mov_b32 v100, 163776
    ds_write_b128 v100, v[4:7] offset:0
    ds_write_b128 v100, v[4:7] offset:16
    ds_write_b128 v100, v[4:7] offset:32
    ds_write_b128 v100, v[4:7] offset:48
    s_and_b32 s74, s58, 15
    s_mov_b32 s64, s59
    s_lshl_b32 s58, s55, 7
    s_lshl_b32 s63, s48, 4
    s_add_u32 s63, s63, s58
    s_add_u32 s4, s4, s63
    s_addc_u32 s5, s5, 0
    s_waitcnt lgkmcnt(0)
    s_load_dword s51, s[6:7], 0
    s_and_b32 s58, s2, 7
    s_nop 0
    s_lshl_b32 s6, s58, 17
    s_cmp_lt_u32 s48, 4
    s_nop 0
    s_cbranch_scc1 L_gwave
    s_bitcmp1_b32 s50, 0
    s_cbranch_scc1 L_p1fft
    buffer_load_dwordx4 v[96:99], v3, s[20:23], 0 offen
    s_barrier
    v_mov_b32 v108, 0x3b000000
    v_lshlrev_b32 v11, 5, v2
    v_add_u32 v11, s64, v11
    v_and_b32 v4, 255, v0
    v_lshlrev_b32 v4, 2, v4
    v_add_u32 v4, 131072, v4
    s_lshl_b32 s72, s53, 6
    s_add_u32 s72, s72, s52
    s_lshl_b32 s72, s72, 6
    s_lshl_b32 s70, s72, 4
    s_lshl_b32 s71, s53, 16
    s_add_u32 s70, s70, s71
    s_and_b32 s71, s48, 3
    s_lshl_b32 s71, s71, 18
    s_add_u32 s70, s70, s71
    s_waitcnt vmcnt(4)
    v_lshlrev_b32 v32, 16, v16
    v_and_b32 v33, 0xffff0000, v16
    v_lshlrev_b32 v34, 16, v17
    v_and_b32 v35, 0xffff0000, v17
    v_lshlrev_b32 v36, 16, v18
    v_and_b32 v37, 0xffff0000, v18
    v_lshlrev_b32 v38, 16, v19
    v_and_b32 v39, 0xffff0000, v19
    v_pk_add_f32 v[168:169], v[32:33], v[34:35]
    v_pk_add_f32 v[170:171], v[36:37], v[38:39]
    v_pk_add_f32 v[168:169], v[168:169], v[170:171]
    v_add_f32 v100, v168, v169
    s_waitcnt vmcnt(3)
    v_lshlrev_b32 v40, 16, v20
    v_and_b32 v41, 0xffff0000, v20
    v_lshlrev_b32 v42, 16, v21
    v_and_b32 v43, 0xffff0000, v21
    v_lshlrev_b32 v44, 16, v22
    v_and_b32 v45, 0xffff0000, v22
    v_lshlrev_b32 v46, 16, v23
    v_and_b32 v47, 0xffff0000, v23
    v_pk_add_f32 v[172:173], v[40:41], v[42:43]
    v_pk_add_f32 v[174:175], v[44:45], v[46:47]
    v_pk_add_f32 v[172:173], v[172:173], v[174:175]
    v_add_f32 v101, v172, v173
    s_waitcnt vmcnt(2)
    v_lshlrev_b32 v48, 16, v24
    v_and_b32 v49, 0xffff0000, v24
    v_lshlrev_b32 v50, 16, v25
    v_and_b32 v51, 0xffff0000, v25
    v_lshlrev_b32 v52, 16, v26
    v_and_b32 v53, 0xffff0000, v26
    v_lshlrev_b32 v54, 16, v27
    v_and_b32 v55, 0xffff0000, v27
    v_pk_add_f32 v[176:177], v[48:49], v[50:51]
    v_pk_add_f32 v[178:179], v[52:53], v[54:55]
    v_pk_add_f32 v[176:177], v[176:177], v[178:179]
    v_add_f32 v102, v176, v177
    s_waitcnt vmcnt(1)
    v_lshlrev_b32 v56, 16, v28
    v_and_b32 v57, 0xffff0000, v28
    v_lshlrev_b32 v58, 16, v29
    v_and_b32 v59, 0xffff0000, v29
    v_lshlrev_b32 v60, 16, v30
    v_and_b32 v61, 0xffff0000, v30
    v_lshlrev_b32 v62, 16, v31
    v_and_b32 v63, 0xffff0000, v31
    v_pk_add_f32 v[180:181], v[56:57], v[58:59]
    v_pk_add_f32 v[182:183], v[60:61], v[62:63]
    v_pk_add_f32 v[180:181], v[180:181], v[182:183]
    v_add_f32 v103, v180, v181
    v_add_f32_dpp v100, v100, v100 quad_perm:[1,0,3,2] row_mask:0xf bank_mask:0xf
    v_add_f32_dpp v101, v101, v101 quad_perm:[1,0,3,2] row_mask:0xf bank_mask:0xf
    v_add_f32_dpp v102, v102, v102 quad_perm:[1,0,3,2] row_mask:0xf bank_mask:0xf
    v_add_f32_dpp v103, v103, v103 quad_perm:[1,0,3,2] row_mask:0xf bank_mask:0xf
    v_add_f32_dpp v100, v100, v100 quad_perm:[2,3,0,1] row_mask:0xf bank_mask:0xf
    v_add_f32_dpp v101, v101, v101 quad_perm:[2,3,0,1] row_mask:0xf bank_mask:0xf
    v_add_f32_dpp v102, v102, v102 quad_perm:[2,3,0,1] row_mask:0xf bank_mask:0xf
    v_add_f32_dpp v103, v103, v103 quad_perm:[2,3,0,1] row_mask:0xf bank_mask:0xf
    v_add_f32_dpp v100, v100, v100 row_half_mirror row_mask:0xf bank_mask:0xf
    v_add_f32_dpp v101, v101, v101 row_half_mirror row_mask:0xf bank_mask:0xf
    v_add_f32_dpp v102, v102, v102 row_half_mirror row_mask:0xf bank_mask:0xf
    v_add_f32_dpp v103, v103, v103 row_half_mirror row_mask:0xf bank_mask:0xf
    v_add_f32_dpp v100, v100, v100 row_mirror row_mask:0xf bank_mask:0xf
    v_add_f32_dpp v101, v101, v101 row_mirror row_mask:0xf bank_mask:0xf
    v_add_f32_dpp v102, v102, v102 row_mirror row_mask:0xf bank_mask:0xf
    v_add_f32_dpp v103, v103, v103 row_mirror row_mask:0xf bank_mask:0xf
    v_add_f32_dpp v100, v100, v100 row_bcast:15 row_mask:0xa bank_mask:0xf
    v_add_f32_dpp v101, v101, v101 row_bcast:15 row_mask:0xa bank_mask:0xf
    v_add_f32_dpp v102, v102, v102 row_bcast:15 row_mask:0xa bank_mask:0xf
    v_add_f32_dpp v103, v103, v103 row_bcast:15 row_mask:0xa bank_mask:0xf
    v_add_f32_dpp v100, v100, v100 row_bcast:31 row_mask:0xc bank_mask:0xf
    v_add_f32_dpp v101, v101, v101 row_bcast:31 row_mask:0xc bank_mask:0xf
    v_add_f32_dpp v102, v102, v102 row_bcast:31 row_mask:0xc bank_mask:0xf
    v_add_f32_dpp v103, v103, v103 row_bcast:31 row_mask:0xc bank_mask:0xf
    v_readlane_b32 s64, v100, 63
    v_readlane_b32 s65, v101, 63
    v_readlane_b32 s66, v102, 63
    v_readlane_b32 s67, v103, 63
    v_mul_f32 v152, s64, v108
    v_mul_f32 v153, s64, v108
    v_mul_f32 v154, s65, v108
    v_mul_f32 v155, s65, v108
    v_mul_f32 v156, s66, v108
    v_mul_f32 v157, s66, v108
    v_mul_f32 v158, s67, v108
    v_mul_f32 v159, s67, v108
    v_pk_add_f32 v[64:65], v[32:33], v[152:153] neg_lo:[0,1] neg_hi:[0,1]
    v_pk_add_f32 v[72:73], v[40:41], v[154:155] neg_lo:[0,1] neg_hi:[0,1]
    v_pk_add_f32 v[80:81], v[48:49], v[156:157] neg_lo:[0,1] neg_hi:[0,1]
    v_pk_add_f32 v[88:89], v[56:57], v[158:159] neg_lo:[0,1] neg_hi:[0,1]
    v_pk_mul_f32 v[168:169], v[64:65], v[64:65]
    v_pk_mul_f32 v[170:171], v[72:73], v[72:73]
    v_pk_mul_f32 v[172:173], v[80:81], v[80:81]
    v_pk_mul_f32 v[174:175], v[88:89], v[88:89]
    v_pk_add_f32 v[66:67], v[34:35], v[152:153] neg_lo:[0,1] neg_hi:[0,1]
    v_pk_add_f32 v[74:75], v[42:43], v[154:155] neg_lo:[0,1] neg_hi:[0,1]
    v_pk_add_f32 v[82:83], v[50:51], v[156:157] neg_lo:[0,1] neg_hi:[0,1]
    v_pk_add_f32 v[90:91], v[58:59], v[158:159] neg_lo:[0,1] neg_hi:[0,1]
    v_pk_fma_f32 v[168:169], v[66:67], v[66:67], v[168:169]
    v_pk_fma_f32 v[170:171], v[74:75], v[74:75], v[170:171]
    v_pk_fma_f32 v[172:173], v[82:83], v[82:83], v[172:173]
    v_pk_fma_f32 v[174:175], v[90:91], v[90:91], v[174:175]
    v_pk_add_f32 v[68:69], v[36:37], v[152:153] neg_lo:[0,1] neg_hi:[0,1]
    v_pk_add_f32 v[76:77], v[44:45], v[154:155] neg_lo:[0,1] neg_hi:[0,1]
    v_pk_add_f32 v[84:85], v[52:53], v[156:157] neg_lo:[0,1] neg_hi:[0,1]
    v_pk_add_f32 v[92:93], v[60:61], v[158:159] neg_lo:[0,1] neg_hi:[0,1]
    v_pk_fma_f32 v[168:169], v[68:69], v[68:69], v[168:169]
    v_pk_fma_f32 v[170:171], v[76:77], v[76:77], v[170:171]
    v_pk_fma_f32 v[172:173], v[84:85], v[84:85], v[172:173]
    v_pk_fma_f32 v[174:175], v[92:93], v[92:93], v[174:175]
    v_pk_add_f32 v[70:71], v[38:39], v[152:153] neg_lo:[0,1] neg_hi:[0,1]
    v_pk_add_f32 v[78:79], v[46:47], v[154:155] neg_lo:[0,1] neg_hi:[0,1]
    v_pk_add_f32 v[86:87], v[54:55], v[156:157] neg_lo:[0,1] neg_hi:[0,1]
    v_pk_add_f32 v[94:95], v[62:63], v[158:159] neg_lo:[0,1] neg_hi:[0,1]
    v_pk_fma_f32 v[168:169], v[70:71], v[70:71], v[168:169]
    v_pk_fma_f32 v[170:171], v[78:79], v[78:79], v[170:171]
    v_pk_fma_f32 v[172:173], v[86:87], v[86:87], v[172:173]
    v_pk_fma_f32 v[174:175], v[94:95], v[94:95], v[174:175]
    v_add_f32 v100, v168, v169
    v_add_f32 v101, v170, v171
    v_add_f32 v102, v172, v173
    v_add_f32 v103, v174, v175
    v_cvt_pk_bf16_f32 v104, v152, v152
    v_cvt_pk_bf16_f32 v105, v154, v154
    v_cvt_pk_bf16_f32 v106, v156, v156
    v_cvt_pk_bf16_f32 v107, v158, v158
    v_lshlrev_b32 v152, 16, v104
    v_and_b32 v153, 0xffff0000, v104
    v_lshlrev_b32 v154, 16, v105
    v_and_b32 v155, 0xffff0000, v105
    v_lshlrev_b32 v156, 16, v106
    v_and_b32 v157, 0xffff0000, v106
    v_lshlrev_b32 v158, 16, v107
    v_and_b32 v159, 0xffff0000, v107
    v_add_f32_dpp v100, v100, v100 quad_perm:[1,0,3,2] row_mask:0xf bank_mask:0xf
    v_add_f32_dpp v101, v101, v101 quad_perm:[1,0,3,2] row_mask:0xf bank_mask:0xf
    v_add_f32_dpp v102, v102, v102 quad_perm:[1,0,3,2] row_mask:0xf bank_mask:0xf
    v_add_f32_dpp v103, v103, v103 quad_perm:[1,0,3,2] row_mask:0xf bank_mask:0xf
    v_add_f32_dpp v100, v100, v100 quad_perm:[2,3,0,1] row_mask:0xf bank_mask:0xf
    v_add_f32_dpp v101, v101, v101 quad_perm:[2,3,0,1] row_mask:0xf bank_mask:0xf
    v_add_f32_dpp v102, v102, v102 quad_perm:[2,3,0,1] row_mask:0xf bank_mask:0xf
    v_add_f32_dpp v103, v103, v103 quad_perm:[2,3,0,1] row_mask:0xf bank_mask:0xf
    v_add_f32_dpp v100, v100, v100 row_half_mirror row_mask:0xf bank_mask:0xf
    v_add_f32_dpp v101, v101, v101 row_half_mirror row_mask:0xf bank_mask:0xf
    v_add_f32_dpp v102, v102, v102 row_half_mirror row_mask:0xf bank_mask:0xf
    v_add_f32_dpp v103, v103, v103 row_half_mirror row_mask:0xf bank_mask:0xf
    v_add_f32_dpp v100, v100, v100 row_mirror row_mask:0xf bank_mask:0xf
    v_add_f32_dpp v101, v101, v101 row_mirror row_mask:0xf bank_mask:0xf
    v_add_f32_dpp v102, v102, v102 row_mirror row_mask:0xf bank_mask:0xf
    v_add_f32_dpp v103, v103, v103 row_mirror row_mask:0xf bank_mask:0xf
    v_add_f32_dpp v100, v100, v100 row_bcast:15 row_mask:0xa bank_mask:0xf
    v_add_f32_dpp v101, v101, v101 row_bcast:15 row_mask:0xa bank_mask:0xf
    v_add_f32_dpp v102, v102, v102 row_bcast:15 row_mask:0xa bank_mask:0xf
    v_add_f32_dpp v103, v103, v103 row_bcast:15 row_mask:0xa bank_mask:0xf
    v_add_f32_dpp v100, v100, v100 row_bcast:31 row_mask:0xc bank_mask:0xf
    v_add_f32_dpp v101, v101, v101 row_bcast:31 row_mask:0xc bank_mask:0xf
    v_add_f32_dpp v102, v102, v102 row_bcast:31 row_mask:0xc bank_mask:0xf
    v_add_f32_dpp v103, v103, v103 row_bcast:31 row_mask:0xc bank_mask:0xf
    v_readlane_b32 s64, v100, 63
    v_readlane_b32 s65, v101, 63
    v_readlane_b32 s66, v102, 63
    v_readlane_b32 s67, v103, 63
    v_pk_add_f32 v[64:65], v[32:33], v[152:153] neg_lo:[0,1] neg_hi:[0,1]
    v_pk_add_f32 v[72:73], v[40:41], v[154:155] neg_lo:[0,1] neg_hi:[0,1]
    v_pk_add_f32 v[80:81], v[48:49], v[156:157] neg_lo:[0,1] neg_hi:[0,1]
    v_pk_add_f32 v[88:89], v[56:57], v[158:159] neg_lo:[0,1] neg_hi:[0,1]
    v_mul_f32 v116, s64, v108
    v_mul_f32 v117, s65, v108
    v_mul_f32 v118, s66, v108
    v_mul_f32 v119, s67, v108
    v_cvt_pk_bf16_f32 v104, v116, v117
    v_cvt_pk_bf16_f32 v105, v118, v119
    v_lshlrev_b32 v116, 16, v104
    v_and_b32 v117, 0xffff0000, v104
    v_lshlrev_b32 v118, 16, v105
    v_and_b32 v119, 0xffff0000, v105
    v_add_f32 v116, 0x3727c5ac, v116
    v_add_f32 v117, 0x3727c5ac, v117
    v_add_f32 v118, 0x3727c5ac, v118
    v_add_f32 v119, 0x3727c5ac, v119
    v_cvt_pk_bf16_f32 v104, v116, v117
    v_cvt_pk_bf16_f32 v105, v118, v119
    v_lshlrev_b32 v116, 16, v104
    v_and_b32 v117, 0xffff0000, v104
    v_lshlrev_b32 v118, 16, v105
    v_and_b32 v119, 0xffff0000, v105
    v_sqrt_f32 v116, v116
    v_sqrt_f32 v117, v117
    v_sqrt_f32 v118, v118
    v_sqrt_f32 v119, v119
    v_pk_add_f32 v[66:67], v[34:35], v[152:153] neg_lo:[0,1] neg_hi:[0,1]
    v_pk_add_f32 v[74:75], v[42:43], v[154:155] neg_lo:[0,1] neg_hi:[0,1]
    v_pk_add_f32 v[82:83], v[50:51], v[156:157] neg_lo:[0,1] neg_hi:[0,1]
    v_pk_add_f32 v[90:91], v[58:59], v[158:159] neg_lo:[0,1] neg_hi:[0,1]
    v_cvt_pk_bf16_f32 v104, v116, v117
    v_cvt_pk_bf16_f32 v105, v118, v119
    v_lshlrev_b32 v116, 16, v104
    v_and_b32 v117, 0xffff0000, v104
    v_lshlrev_b32 v118, 16, v105
    v_and_b32 v119, 0xffff0000, v105
    v_rcp_f32 v160, v116
    v_rcp_f32 v161, v116
    v_rcp_f32 v162, v117
    v_rcp_f32 v163, v117
    v_rcp_f32 v164, v118
    v_rcp_f32 v165, v118
    v_rcp_f32 v166, v119
    v_rcp_f32 v167, v119
    v_pk_add_f32 v[68:69], v[36:37], v[152:153] neg_lo:[0,1] neg_hi:[0,1]
    v_pk_add_f32 v[76:77], v[44:45], v[154:155] neg_lo:[0,1] neg_hi:[0,1]
    v_pk_add_f32 v[84:85], v[52:53], v[156:157] neg_lo:[0,1] neg_hi:[0,1]
    v_pk_add_f32 v[92:93], v[60:61], v[158:159] neg_lo:[0,1] neg_hi:[0,1]
    v_pk_add_f32 v[70:71], v[38:39], v[152:153] neg_lo:[0,1] neg_hi:[0,1]
    v_pk_add_f32 v[78:79], v[46:47], v[154:155] neg_lo:[0,1] neg_hi:[0,1]
    v_pk_add_f32 v[86:87], v[54:55], v[156:157] neg_lo:[0,1] neg_hi:[0,1]
    v_pk_add_f32 v[94:95], v[62:63], v[158:159] neg_lo:[0,1] neg_hi:[0,1]
    v_cvt_pk_bf16_f32 v120, v64, v65
    v_cvt_pk_bf16_f32 v124, v72, v73
    v_cvt_pk_bf16_f32 v128, v80, v81
    v_cvt_pk_bf16_f32 v132, v88, v89
    v_cvt_pk_bf16_f32 v121, v66, v67
    v_cvt_pk_bf16_f32 v125, v74, v75
    v_cvt_pk_bf16_f32 v129, v82, v83
    v_cvt_pk_bf16_f32 v133, v90, v91
    v_cvt_pk_bf16_f32 v122, v68, v69
    v_cvt_pk_bf16_f32 v126, v76, v77
    v_cvt_pk_bf16_f32 v130, v84, v85
    v_cvt_pk_bf16_f32 v134, v92, v93
    v_cvt_pk_bf16_f32 v123, v70, v71
    v_cvt_pk_bf16_f32 v127, v78, v79
    v_cvt_pk_bf16_f32 v131, v86, v87
    v_cvt_pk_bf16_f32 v135, v94, v95
    v_lshlrev_b32 v64, 16, v120
    v_and_b32 v65, 0xffff0000, v120
    v_lshlrev_b32 v66, 16, v121
    v_and_b32 v67, 0xffff0000, v121
    v_lshlrev_b32 v68, 16, v122
    v_and_b32 v69, 0xffff0000, v122
    v_lshlrev_b32 v70, 16, v123
    v_and_b32 v71, 0xffff0000, v123
    v_pk_mul_f32 v[64:65], v[64:65], v[160:161]
    v_pk_mul_f32 v[66:67], v[66:67], v[160:161]
    v_pk_mul_f32 v[68:69], v[68:69], v[160:161]
    v_pk_mul_f32 v[70:71], v[70:71], v[160:161]
    v_lshlrev_b32 v72, 16, v124
    v_and_b32 v73, 0xffff0000, v124
    v_lshlrev_b32 v74, 16, v125
    v_and_b32 v75, 0xffff0000, v125
    v_lshlrev_b32 v76, 16, v126
    v_and_b32 v77, 0xffff0000, v126
    v_lshlrev_b32 v78, 16, v127
    v_and_b32 v79, 0xffff0000, v127
    v_pk_mul_f32 v[72:73], v[72:73], v[162:163]
    v_pk_mul_f32 v[74:75], v[74:75], v[162:163]
    v_pk_mul_f32 v[76:77], v[76:77], v[162:163]
    v_pk_mul_f32 v[78:79], v[78:79], v[162:163]
    v_cvt_pk_bf16_f32 v176, v64, v72
    v_cvt_pk_bf16_f32 v177, v65, v73
    v_cvt_pk_bf16_f32 v178, v66, v74
    v_cvt_pk_bf16_f32 v179, v67, v75
    v_cvt_pk_bf16_f32 v180, v68, v76
    v_cvt_pk_bf16_f32 v181, v69, v77
    v_cvt_pk_bf16_f32 v182, v70, v78
    v_cvt_pk_bf16_f32 v183, v71, v79
    ds_write_b128 v11, v[176:179] offset:0
    ds_write_b128 v11, v[180:183] offset:16
    v_lshlrev_b32 v80, 16, v128
    v_and_b32 v81, 0xffff0000, v128
    v_lshlrev_b32 v82, 16, v129
    v_and_b32 v83, 0xffff0000, v129
    v_lshlrev_b32 v84, 16, v130
    v_and_b32 v85, 0xffff0000, v130
    v_lshlrev_b32 v86, 16, v131
    v_and_b32 v87, 0xffff0000, v131
    v_pk_mul_f32 v[80:81], v[80:81], v[164:165]
    v_pk_mul_f32 v[82:83], v[82:83], v[164:165]
    v_pk_mul_f32 v[84:85], v[84:85], v[164:165]
    v_pk_mul_f32 v[86:87], v[86:87], v[164:165]
    v_lshlrev_b32 v88, 16, v132
    v_and_b32 v89, 0xffff0000, v132
    v_lshlrev_b32 v90, 16, v133
    v_and_b32 v91, 0xffff0000, v133
    v_lshlrev_b32 v92, 16, v134
    v_and_b32 v93, 0xffff0000, v134
    v_lshlrev_b32 v94, 16, v135
    v_and_b32 v95, 0xffff0000, v135
    v_pk_mul_f32 v[88:89], v[88:89], v[166:167]
    v_pk_mul_f32 v[90:91], v[90:91], v[166:167]
    v_pk_mul_f32 v[92:93], v[92:93], v[166:167]
    v_pk_mul_f32 v[94:95], v[94:95], v[166:167]
    v_cvt_pk_bf16_f32 v184, v80, v88
    v_cvt_pk_bf16_f32 v185, v81, v89
    v_cvt_pk_bf16_f32 v186, v82, v90
    v_cvt_pk_bf16_f32 v187, v83, v91
    v_cvt_pk_bf16_f32 v188, v84, v92
    v_cvt_pk_bf16_f32 v189, v85, v93
    v_cvt_pk_bf16_f32 v190, v86, v94
    v_cvt_pk_bf16_f32 v191, v87, v95
    ds_write_b128 v11, v[184:187] offset:2048
    ds_write_b128 v11, v[188:191] offset:2064
    s_waitcnt lgkmcnt(0)
    v_mov_b32 v12, 163808
    v_mov_b32 v13, 1
    s_mov_b64 exec, 1
    ds_add_u32 v12, v13
    s_mov_b64 exec, -1
    s_mov_b32 s79, 200000
    s_waitcnt lgkmcnt(0)
L_wc_1:
    ds_read_b32 v13, v12
    s_waitcnt lgkmcnt(0)
    v_readfirstlane_b32 s78, v13
    s_nop 0
    s_cmp_ge_u32 s78, 4
    s_cbranch_scc1 L_wcd_2
    s_sub_u32 s79, s79, 1
    s_cbranch_scc1 L_wcd_2
    s_branch L_wc_1
L_wcd_2:
    ds_read2st64_b32 v[136:137], v4 offset0:0 offset1:8
    ds_read2st64_b32 v[138:139], v4 offset0:16 offset1:24
    ds_read2st64_b32 v[140:141], v4 offset0:32 offset1:40
    ds_read2st64_b32 v[142:143], v4 offset0:48 offset1:56
    ds_read2st64_b32 v[144:145], v4 offset0:4 offset1:12
    ds_read2st64_b32 v[146:147], v4 offset0:20 offset1:28
    ds_read2st64_b32 v[148:149], v4 offset0:36 offset1:44
    ds_read2st64_b32 v[150:151], v4 offset0:52 offset1:60
    s_add_u32 s71, s70, 0
    s_waitcnt lgkmcnt(6)
    buffer_store_dwordx4 v[136:139], v3, s[24:27], s71 offen sc1
    s_add_u32 s71, s70, 65536
    s_waitcnt lgkmcnt(4)
    buffer_store_dwordx4 v[140:143], v3, s[24:27], s71 offen sc1
    s_add_u32 s71, s70, 1048576
    s_waitcnt lgkmcnt(2)
    buffer_store_dwordx4 v[144:147], v3, s[24:27], s71 offen sc1
    s_add_u32 s71, s70, 1114112
    s_waitcnt lgkmcnt(0)
    buffer_store_dwordx4 v[148:151], v3, s[24:27], s71 offen sc1
    v_mov_b32 v12, 163820
    v_mov_b32 v13, 1
    s_mov_b64 exec, 1
    ds_add_u32 v12, v13
    s_mov_b64 exec, -1
    s_waitcnt lgkmcnt(0)
    s_add_u32 s51, s51, 0x9e3779b9
    s_waitcnt vmcnt(0)
    v_mov_b32 v12, 163776
    v_mov_b32 v13, 1
    s_mov_b64 exec, 1
    ds_add_rtn_u32 v13, v12, v13
    s_mov_b64 exec, -1
    s_waitcnt lgkmcnt(0)
    v_readfirstlane_b32 s78, v13
    s_nop 0
    s_cmp_lg_u32 s78, 3
    s_cbranch_scc1 L_arr_3
    v_mov_b32 v13, s51
    v_lshlrev_b32 v12, 17, v2
    v_add_u32 v12, 12582912, v12
    s_mov_b64 exec, 255
    buffer_store_dword v13, v12, s[24:27], s72 offen sc1
    s_mov_b64 exec, -1
    s_nop 1
L_arr_3:
    s_nop 1
    s_branch L_p1done
L_p1fft:
    s_and_b32 s65, s48, 3
    s_lshl_b32 s66, s65, 10
    s_add_u32 s67, s66, 0
    s_add_u32 m0, s67, 152576
    s_add_u32 s67, s67, TABLES-gated_mix__spectral_gfnet__mixer_token_mlp__prompt_kernel
    buffer_load_dwordx4 v3, s[28:31], s67 offen lds
    s_add_u32 s67, s66, 4096
    s_add_u32 m0, s67, 152576
    s_add_u32 s67, s67, TABLES-gated_mix__spectral_gfnet__mixer_token_mlp__prompt_kernel
    buffer_load_dwordx4 v3, s[28:31], s67 offen lds
    s_add_u32 s67, s66, 8192
    s_min_u32 s67, s67, 9216
    s_add_u32 m0, s67, 152576
    s_add_u32 s67, s67, TABLES-gated_mix__spectral_gfnet__mixer_token_mlp__prompt_kernel
    buffer_load_dwordx4 v3, s[28:31], s67 offen lds
    v_and_b32 v9, 15, v2
    s_barrier
    v_lshrrev_b32 v4, 4, v2
    v_lshlrev_b32 v5, 9, v4
    v_lshlrev_b32 v4, 8, v4
    v_lshl_add_u32 v4, v9, 3, v4
    v_add_u32 v4, s64, v4
    v_lshl_add_u32 v5, v9, 2, v5
    v_add_u32 v5, s64, v5
    v_add_u32 v14, 152576, v3
    v_bfe_u32 v7, v0, 2, 6
    v_and_b32 v6, 3, v2
    v_and_b32 v15, 1, v2
    v_cmp_eq_u32 vcc, 1, v15
    v_bfe_u32 v10, v2, 1, 1
    v_lshlrev_b32 v10, 13, v10
    v_add_u32 v10, 131072, v10
    v_add_u32 v11, 0, v7
    v_sub_u32 v12, 512, v7
    v_mov_b32 v13, 256
    v_cmp_eq_u32 s[76:77], 0, v7
    s_nop 1
    v_cndmask_b32 v12, v12, v13, s[76:77]
    v_cndmask_b32 v11, v11, v12, vcc
    v_lshl_add_u32 v136, v11, 2, v10
    v_add_u32 v11, 64, v7
    v_sub_u32 v12, 448, v7
    v_cndmask_b32 v11, v11, v12, vcc
    v_lshl_add_u32 v137, v11, 2, v10
    v_add_u32 v11, 128, v7
    v_sub_u32 v12, 384, v7
    v_cndmask_b32 v11, v11, v12, vcc
    v_lshl_add_u32 v138, v11, 2, v10
    v_add_u32 v11, 192, v7
    v_sub_u32 v12, 320, v7
    v_cndmask_b32 v11, v11, v12, vcc
    v_lshl_add_u32 v139, v11, 2, v10
    v_lshlrev_b32 v8, 13, v7
    v_lshl_add_u32 v8, v6, 4, v8
    s_lshl_b32 s72, s53, 6
    s_add_u32 s72, s72, s52
    s_lshl_b32 s72, s72, 6
    s_add_u32 s70, s72, 2097152
    s_add_u32 s72, s72, 8192
    s_waitcnt vmcnt(0)
    s_waitcnt lgkmcnt(0)
    v_mov_b32 v12, 163812
    v_mov_b32 v13, 1
    s_mov_b64 exec, 1
    ds_add_u32 v12, v13
    s_mov_b64 exec, -1
    s_mov_b32 s79, 200000
    s_waitcnt lgkmcnt(0)
L_wc_4:
    ds_read_b32 v13, v12
    s_waitcnt lgkmcnt(0)
    v_readfirstlane_b32 s78, v13
    s_nop 0
    s_cmp_ge_u32 s78, 4
    s_cbranch_scc1 L_wcd_5
    s_sub_u32 s79, s79, 1
    s_cbranch_scc1 L_wcd_5
    s_branch L_wc_4
L_wcd_5:
    ds_read_b64_tr_b16 v[56:57], v4 offset:0
    ds_read_b64_tr_b16 v[58:59], v4 offset:128
    ds_read_b64_tr_b16 v[60:61], v4 offset:1024
    ds_read_b64_tr_b16 v[62:63], v4 offset:1152
    ds_read_b128 v[16:19], v14 offset:0
    ds_read_b128 v[32:35], v14 offset:4096
    ds_read_b128 v[24:27], v14 offset:2048
    ds_read_b128 v[20:23], v14 offset:1024
    ds_read_b128 v[36:39], v14 offset:5120
    ds_read_b128 v[28:31], v14 offset:3072
    ds_read_b64_tr_b16 v[64:65], v4 offset:2048
    ds_read_b64_tr_b16 v[66:67], v4 offset:2176
    ds_read_b64_tr_b16 v[68:69], v4 offset:3072
    ds_read_b64_tr_b16 v[70:71], v4 offset:3200
    ds_read_b128 v[48:51], v14 offset:8192
    ds_read_b128 v[52:55], v14 offset:9216
    ds_read_b128 v[40:43], v14 offset:6144
    ds_read_b128 v[44:47], v14 offset:7168
    s_waitcnt lgkmcnt(13)
    v_mfma_f32_16x16x32_bf16 v[72:75], v[56:59], v[16:19], 0
    s_waitcnt lgkmcnt(12)
    v_mfma_f32_16x16x32_bf16 v[76:79], v[56:59], v[32:35], 0
    s_waitcnt lgkmcnt(11)
    v_mfma_f32_16x16x32_bf16 v[72:75], v[60:63], v[24:27], v[72:75]
    v_mfma_f32_16x16x32_bf16 v[76:79], v[60:63], v[16:19], v[76:79]
    s_waitcnt lgkmcnt(10)
    v_mfma_f32_16x16x32_bf16 v[80:83], v[56:59], v[20:23], 0
    s_waitcnt lgkmcnt(9)
    v_mfma_f32_16x16x32_bf16 v[84:87], v[56:59], v[36:39], 0
    s_waitcnt lgkmcnt(8)
    v_mfma_f32_16x16x32_bf16 v[80:83], v[60:63], v[28:31], v[80:83]
    v_mfma_f32_16x16x32_bf16 v[84:87], v[60:63], v[20:23], v[84:87]
    s_waitcnt lgkmcnt(6)
    v_mfma_f32_16x16x32_bf16 v[88:91], v[64:67], v[16:19], 0
    v_mfma_f32_16x16x32_bf16 v[92:95], v[64:67], v[32:35], 0
    s_waitcnt lgkmcnt(4)
    v_mfma_f32_16x16x32_bf16 v[88:91], v[68:71], v[24:27], v[88:91]
    v_mfma_f32_16x16x32_bf16 v[92:95], v[68:71], v[16:19], v[92:95]
    v_mfma_f32_16x16x32_bf16 v[96:99], v[64:67], v[20:23], 0
    v_mfma_f32_16x16x32_bf16 v[100:103], v[64:67], v[36:39], 0
    v_mfma_f32_16x16x32_bf16 v[96:99], v[68:71], v[28:31], v[96:99]
    v_mfma_f32_16x16x32_bf16 v[100:103], v[68:71], v[20:23], v[100:103]
    s_waitcnt lgkmcnt(3)
    v_fma_mix_f32 v120, v72, v48, 0 op_sel_hi:[0,1,0]
    v_fma_mix_f32 v124, v76, v48, 0 op_sel_hi:[0,1,0]
    v_fma_mix_f32 v120, v76, v48, v120 op_sel:[0,1,0] op_sel_hi:[0,1,0]
    v_fma_mix_f32 v124, -v72, v48, v124 op_sel:[0,1,0] op_sel_hi:[0,1,0]
    v_fma_mix_f32 v121, v73, v49, 0 op_sel_hi:[0,1,0]
    v_fma_mix_f32 v125, v77, v49, 0 op_sel_hi:[0,1,0]
    v_fma_mix_f32 v121, v77, v49, v121 op_sel:[0,1,0] op_sel_hi:[0,1,0]
    v_fma_mix_f32 v125, -v73, v49, v125 op_sel:[0,1,0] op_sel_hi:[0,1,0]
    v_fma_mix_f32 v122, v74, v50, 0 op_sel_hi:[0,1,0]
    v_fma_mix_f32 v126, v78, v50, 0 op_sel_hi:[0,1,0]
    v_fma_mix_f32 v122, v78, v50, v122 op_sel:[0,1,0] op_sel_hi:[0,1,0]
    v_fma_mix_f32 v126, -v74, v50, v126 op_sel:[0,1,0] op_sel_hi:[0,1,0]
    v_fma_mix_f32 v123, v75, v51, 0 op_sel_hi:[0,1,0]
    v_fma_mix_f32 v127, v79, v51, 0 op_sel_hi:[0,1,0]
    v_fma_mix_f32 v123, v79, v51, v123 op_sel:[0,1,0] op_sel_hi:[0,1,0]
    v_fma_mix_f32 v127, -v75, v51, v127 op_sel:[0,1,0] op_sel_hi:[0,1,0]
    v_cvt_pk_bf16_f32 v104, v120, v121
    v_cvt_pk_bf16_f32 v105, v122, v123
    v_cvt_pk_bf16_f32 v106, v124, v125
    v_cvt_pk_bf16_f32 v107, v126, v127
    s_waitcnt lgkmcnt(1)
    s_nop 0
    v_mfma_f32_16x16x32_bf16 v[72:75], v[40:43], v[104:107], 0
    s_waitcnt lgkmcnt(0)
    v_mfma_f32_16x16x32_bf16 v[76:79], v[44:47], v[104:107], 0
    v_fma_mix_f32 v128, v80, v52, 0 op_sel_hi:[0,1,0]
    v_fma_mix_f32 v132, v84, v52, 0 op_sel_hi:[0,1,0]
    v_fma_mix_f32 v128, v84, v52, v128 op_sel:[0,1,0] op_sel_hi:[0,1,0]
    v_fma_mix_f32 v132, -v80, v52, v132 op_sel:[0,1,0] op_sel_hi:[0,1,0]
    v_fma_mix_f32 v129, v81, v53, 0 op_sel_hi:[0,1,0]
    v_fma_mix_f32 v133, v85, v53, 0 op_sel_hi:[0,1,0]
    v_fma_mix_f32 v129, v85, v53, v129 op_sel:[0,1,0] op_sel_hi:[0,1,0]
    v_fma_mix_f32 v133, -v81, v53, v133 op_sel:[0,1,0] op_sel_hi:[0,1,0]
    v_fma_mix_f32 v130, v82, v54, 0 op_sel_hi:[0,1,0]
    v_fma_mix_f32 v134, v86, v54, 0 op_sel_hi:[0,1,0]
    v_fma_mix_f32 v130, v86, v54, v130 op_sel:[0,1,0] op_sel_hi:[0,1,0]
    v_fma_mix_f32 v134, -v82, v54, v134 op_sel:[0,1,0] op_sel_hi:[0,1,0]
    v_fma_mix_f32 v131, v83, v55, 0 op_sel_hi:[0,1,0]
    v_fma_mix_f32 v135, v87, v55, 0 op_sel_hi:[0,1,0]
    v_fma_mix_f32 v131, v87, v55, v131 op_sel:[0,1,0] op_sel_hi:[0,1,0]
    v_fma_mix_f32 v135, -v83, v55, v135 op_sel:[0,1,0] op_sel_hi:[0,1,0]
    v_cvt_pk_bf16_f32 v108, v128, v129
    v_cvt_pk_bf16_f32 v109, v130, v131
    v_cvt_pk_bf16_f32 v110, v132, v133
    v_cvt_pk_bf16_f32 v111, v134, v135
    s_nop 1
    v_mfma_f32_16x16x32_bf16 v[80:83], v[40:43], v[108:111], 0
    v_mfma_f32_16x16x32_bf16 v[84:87], v[44:47], v[108:111], 0
    v_fma_mix_f32 v120, v88, v48, 0 op_sel_hi:[0,1,0]
    v_fma_mix_f32 v124, v92, v48, 0 op_sel_hi:[0,1,0]
    v_fma_mix_f32 v120, v92, v48, v120 op_sel:[0,1,0] op_sel_hi:[0,1,0]
    v_fma_mix_f32 v124, -v88, v48, v124 op_sel:[0,1,0] op_sel_hi:[0,1,0]
    v_fma_mix_f32 v121, v89, v49, 0 op_sel_hi:[0,1,0]
    v_fma_mix_f32 v125, v93, v49, 0 op_sel_hi:[0,1,0]
    v_fma_mix_f32 v121, v93, v49, v121 op_sel:[0,1,0] op_sel_hi:[0,1,0]
    v_fma_mix_f32 v125, -v89, v49, v125 op_sel:[0,1,0] op_sel_hi:[0,1,0]
    v_fma_mix_f32 v122, v90, v50, 0 op_sel_hi:[0,1,0]
    v_fma_mix_f32 v126, v94, v50, 0 op_sel_hi:[0,1,0]
    v_fma_mix_f32 v122, v94, v50, v122 op_sel:[0,1,0] op_sel_hi:[0,1,0]
    v_fma_mix_f32 v126, -v90, v50, v126 op_sel:[0,1,0] op_sel_hi:[0,1,0]
    v_fma_mix_f32 v123, v91, v51, 0 op_sel_hi:[0,1,0]
    v_fma_mix_f32 v127, v95, v51, 0 op_sel_hi:[0,1,0]
    v_fma_mix_f32 v123, v95, v51, v123 op_sel:[0,1,0] op_sel_hi:[0,1,0]
    v_fma_mix_f32 v127, -v91, v51, v127 op_sel:[0,1,0] op_sel_hi:[0,1,0]
    v_cvt_pk_bf16_f32 v112, v120, v121
    v_cvt_pk_bf16_f32 v113, v122, v123
    v_cvt_pk_bf16_f32 v114, v124, v125
    v_cvt_pk_bf16_f32 v115, v126, v127
    s_nop 1
    v_mfma_f32_16x16x32_bf16 v[88:91], v[40:43], v[112:115], 0
    v_mfma_f32_16x16x32_bf16 v[92:95], v[44:47], v[112:115], 0
    v_fma_mix_f32 v128, v96, v52, 0 op_sel_hi:[0,1,0]
    v_fma_mix_f32 v132, v100, v52, 0 op_sel_hi:[0,1,0]
    v_fma_mix_f32 v128, v100, v52, v128 op_sel:[0,1,0] op_sel_hi:[0,1,0]
    v_fma_mix_f32 v132, -v96, v52, v132 op_sel:[0,1,0] op_sel_hi:[0,1,0]
    v_fma_mix_f32 v129, v97, v53, 0 op_sel_hi:[0,1,0]
    v_fma_mix_f32 v133, v101, v53, 0 op_sel_hi:[0,1,0]
    v_fma_mix_f32 v129, v101, v53, v129 op_sel:[0,1,0] op_sel_hi:[0,1,0]
    v_fma_mix_f32 v133, -v97, v53, v133 op_sel:[0,1,0] op_sel_hi:[0,1,0]
    v_fma_mix_f32 v130, v98, v54, 0 op_sel_hi:[0,1,0]
    v_fma_mix_f32 v134, v102, v54, 0 op_sel_hi:[0,1,0]
    v_fma_mix_f32 v130, v102, v54, v130 op_sel:[0,1,0] op_sel_hi:[0,1,0]
    v_fma_mix_f32 v134, -v98, v54, v134 op_sel:[0,1,0] op_sel_hi:[0,1,0]
    v_fma_mix_f32 v131, v99, v55, 0 op_sel_hi:[0,1,0]
    v_fma_mix_f32 v135, v103, v55, 0 op_sel_hi:[0,1,0]
    v_fma_mix_f32 v131, v103, v55, v131 op_sel:[0,1,0] op_sel_hi:[0,1,0]
    v_fma_mix_f32 v135, -v99, v55, v135 op_sel:[0,1,0] op_sel_hi:[0,1,0]
    v_cvt_pk_bf16_f32 v116, v128, v129
    v_cvt_pk_bf16_f32 v117, v130, v131
    v_cvt_pk_bf16_f32 v118, v132, v133
    v_cvt_pk_bf16_f32 v119, v134, v135
    s_nop 1
    v_mfma_f32_16x16x32_bf16 v[96:99], v[40:43], v[116:119], 0
    v_mfma_f32_16x16x32_bf16 v[100:103], v[44:47], v[116:119], 0
    v_cvt_pk_bf16_f32 v56, v72, v76
    ds_write_b32 v5, v56 offset:0
    v_cvt_pk_bf16_f32 v57, v73, v77
    ds_write_b32 v5, v57 offset:128
    v_cvt_pk_bf16_f32 v58, v74, v78
    ds_write_b32 v5, v58 offset:256
    v_cvt_pk_bf16_f32 v59, v75, v79
    ds_write_b32 v5, v59 offset:384
    v_cvt_pk_bf16_f32 v60, v80, v84
    ds_write_b32 v5, v60 offset:64
    v_cvt_pk_bf16_f32 v61, v81, v85
    ds_write_b32 v5, v61 offset:192
    v_cvt_pk_bf16_f32 v62, v82, v86
    ds_write_b32 v5, v62 offset:320
    v_cvt_pk_bf16_f32 v63, v83, v87
    ds_write_b32 v5, v63 offset:448
    v_cvt_pk_bf16_f32 v64, v88, v92
    ds_write_b32 v5, v64 offset:2048
    v_cvt_pk_bf16_f32 v65, v89, v93
    ds_write_b32 v5, v65 offset:2176
    v_cvt_pk_bf16_f32 v66, v90, v94
    ds_write_b32 v5, v66 offset:2304
    v_cvt_pk_bf16_f32 v67, v91, v95
    ds_write_b32 v5, v67 offset:2432
    v_cvt_pk_bf16_f32 v68, v96, v100
    ds_write_b32 v5, v68 offset:2112
    v_cvt_pk_bf16_f32 v69, v97, v101
    ds_write_b32 v5, v69 offset:2240
    v_cvt_pk_bf16_f32 v70, v98, v102
    ds_write_b32 v5, v70 offset:2368
    v_cvt_pk_bf16_f32 v71, v99, v103
    ds_write_b32 v5, v71 offset:2496
    s_waitcnt lgkmcnt(0)
    v_mov_b32 v12, 163808
    v_mov_b32 v13, 1
    s_mov_b64 exec, 1
    ds_add_u32 v12, v13
    s_mov_b64 exec, -1
    s_mov_b32 s79, 200000
    s_waitcnt lgkmcnt(0)
L_wc_6:
    ds_read_b32 v13, v12
    s_waitcnt lgkmcnt(0)
    v_readfirstlane_b32 s78, v13
    s_nop 0
    s_cmp_ge_u32 s78, 4
    s_cbranch_scc1 L_wcd_7
    s_sub_u32 s79, s79, 1
    s_cbranch_scc1 L_wcd_7
    s_branch L_wc_6
L_wcd_7:
    ds_read2st64_b32 v[96:97], v136 offset0:0 offset1:8
    ds_read2st64_b32 v[98:99], v136 offset0:16 offset1:24
    ds_read2st64_b32 v[100:101], v137 offset0:0 offset1:8
    ds_read2st64_b32 v[102:103], v137 offset0:16 offset1:24
    ds_read2st64_b32 v[104:105], v138 offset0:0 offset1:8
    ds_read2st64_b32 v[106:107], v138 offset0:16 offset1:24
    ds_read2st64_b32 v[108:109], v139 offset0:0 offset1:8
    ds_read2st64_b32 v[110:111], v139 offset0:16 offset1:24
    s_waitcnt lgkmcnt(6)
    buffer_store_dwordx4 v[96:99], v8, s[24:27], s70 offen sc1
    s_add_u32 s70, s70, 524288
    s_waitcnt lgkmcnt(4)
    buffer_store_dwordx4 v[100:103], v8, s[24:27], s70 offen sc1
    s_add_u32 s70, s70, 524288
    s_waitcnt lgkmcnt(2)
    buffer_store_dwordx4 v[104:107], v8, s[24:27], s70 offen sc1
    s_add_u32 s70, s70, 524288
    s_waitcnt lgkmcnt(0)
    buffer_store_dwordx4 v[108:111], v8, s[24:27], s70 offen sc1
    v_mov_b32 v12, 163820
    v_mov_b32 v13, 1
    s_mov_b64 exec, 1
    ds_add_u32 v12, v13
    s_mov_b64 exec, -1
    s_waitcnt lgkmcnt(0)
    s_add_u32 s51, s51, 0x9e3779b9
    s_waitcnt vmcnt(0)
    v_mov_b32 v12, 163776
    v_mov_b32 v13, 1
    s_mov_b64 exec, 1
    ds_add_rtn_u32 v13, v12, v13
    s_mov_b64 exec, -1
    s_waitcnt lgkmcnt(0)
    v_readfirstlane_b32 s78, v13
    s_nop 0
    s_cmp_lg_u32 s78, 3
    s_cbranch_scc1 L_arr_8
    v_mov_b32 v13, s51
    v_lshlrev_b32 v12, 17, v2
    v_add_u32 v12, 12582912, v12
    s_mov_b64 exec, 255
    buffer_store_dword v13, v12, s[24:27], s72 offen sc1
    s_mov_b64 exec, -1
    s_nop 1
L_arr_8:
    s_nop 1
L_p1done:
    s_cmp_eq_u32 s3, 1
    s_cbranch_scc1 L_fft
    s_branch L_g1help
L_gwave:
    v_lshrrev_b32 v150, 2, v2
    v_and_b32 v151, 3, v2
    v_mul_u32_u24 v150, 3584, v150
    v_lshl_add_u32 v150, v151, 7, v150
    s_lshl_b32 s70, s50, 2
    s_add_u32 s70, s70, s48
    s_mul_i32 s70, s70, 57344
    s_lshr_b32 s71, s49, 1
    s_mul_i32 s71, s71, 896
    s_add_u32 s70, s70, s71
    s_and_b32 s71, s49, 1
    s_mul_i32 s71, s71, 384
    s_add_u32 s70, s70, s71
    s_barrier
    s_cmp_lg_u32 s3, 1
    s_cbranch_scc1 L_g1
    buffer_load_dword v250, v150, s[32:35], s70 offen
    s_mov_b32 exec_hi, -1
    v_mov_b32 v12, 163776
    s_mov_b32 s79, 200000
    s_nop 3
L_wc_9:
    ds_read_b32 v13, v12
    s_waitcnt lgkmcnt(0)
    v_readfirstlane_b32 s78, v13
    s_nop 0
    s_cmp_ge_u32 s78, 4
    s_cbranch_scc1 L_wcd_10
    s_sub_u32 s79, s79, 1
    s_cbranch_scc1 L_wcd_10
    s_sleep 2
    s_branch L_wc_9
L_wcd_10:
    s_lshl_b32 s72, s48, 10
    s_add_u32 m0, s72, 65536
    s_add_u32 s73, s72, TABLES-gated_mix__spectral_gfnet__mixer_token_mlp__prompt_kernel+10240
    buffer_load_dwordx4 v3, s[28:31], s73 offen lds
    s_add_u32 m0, s72, 69632
    s_add_u32 s73, s72, TABLES-gated_mix__spectral_gfnet__mixer_token_mlp__prompt_kernel+14336
    buffer_load_dwordx4 v3, s[28:31], s73 offen lds
    s_add_u32 m0, s72, 73728
    s_add_u32 s73, s72, TABLES-gated_mix__spectral_gfnet__mixer_token_mlp__prompt_kernel+18432
    buffer_load_dwordx4 v3, s[28:31], s73 offen lds
    s_add_u32 m0, s72, 77824
    s_add_u32 s73, s72, TABLES-gated_mix__spectral_gfnet__mixer_token_mlp__prompt_kernel+22528
    buffer_load_dwordx4 v3, s[28:31], s73 offen lds
    s_add_u32 m0, s72, 81920
    s_add_u32 s73, s72, TABLES-gated_mix__spectral_gfnet__mixer_token_mlp__prompt_kernel+26624
    buffer_load_dwordx4 v3, s[28:31], s73 offen lds
    s_add_u32 m0, s72, 86016
    s_add_u32 s73, s72, TABLES-gated_mix__spectral_gfnet__mixer_token_mlp__prompt_kernel+30720
    buffer_load_dwordx4 v3, s[28:31], s73 offen lds
    s_add_u32 m0, s72, 90112
    s_add_u32 s73, s72, TABLES-gated_mix__spectral_gfnet__mixer_token_mlp__prompt_kernel+34816
    buffer_load_dwordx4 v3, s[28:31], s73 offen lds
    s_add_u32 m0, s72, 94208
    s_add_u32 s73, s72, TABLES-gated_mix__spectral_gfnet__mixer_token_mlp__prompt_kernel+38912
    buffer_load_dwordx4 v3, s[28:31], s73 offen lds
    s_add_u32 m0, s72, 98304
    s_add_u32 s73, s72, TABLES-gated_mix__spectral_gfnet__mixer_token_mlp__prompt_kernel+43008
    buffer_load_dwordx4 v3, s[28:31], s73 offen lds
    s_add_u32 m0, s72, 102400
    s_add_u32 s73, s72, TABLES-gated_mix__spectral_gfnet__mixer_token_mlp__prompt_kernel+47104
    buffer_load_dwordx4 v3, s[28:31], s73 offen lds
    s_add_u32 m0, s72, 106496
    s_add_u32 s73, s72, TABLES-gated_mix__spectral_gfnet__mixer_token_mlp__prompt_kernel+51200
    buffer_load_dwordx4 v3, s[28:31], s73 offen lds
    s_add_u32 m0, s72, 110592
    s_add_u32 s73, s72, TABLES-gated_mix__spectral_gfnet__mixer_token_mlp__prompt_kernel+55296
    buffer_load_dwordx4 v3, s[28:31], s73 offen lds
    s_add_u32 m0, s72, 114688
    s_add_u32 s73, s72, TABLES-gated_mix__spectral_gfnet__mixer_token_mlp__prompt_kernel+59392
    buffer_load_dwordx4 v3, s[28:31], s73 offen lds
    s_add_u32 m0, s72, 118784
    s_add_u32 s73, s72, TABLES-gated_mix__spectral_gfnet__mixer_token_mlp__prompt_kernel+63488
    buffer_load_dwordx4 v3, s[28:31], s73 offen lds
    s_min_u32 s72, s72, 1024
    s_add_u32 m0, s72, 122880
    s_add_u32 s73, s72, TABLES-gated_mix__spectral_gfnet__mixer_token_mlp__prompt_kernel+67584
    buffer_load_dwordx4 v3, s[28:31], s73 offen lds
    v_lshlrev_b32 v152, 7, v2
    s_lshl_b32 s73, s48, 13
    s_add_u32 s73, s73, L_fft2-gated_mix__spectral_gfnet__mixer_token_mlp__prompt_kernel
    buffer_load_dword v153, v152, s[28:31], s73 offen
    s_waitcnt lgkmcnt(0)
    s_add_u32 s51, s51, 0x9e3779b9
    s_nop 0
    s_branch L_fft2
L_g1:
    s_bitcmp1_b32 s50, 0
    s_nop 0
    s_cbranch_scc1 L_gw_11
    s_lshr_b32 s66, s62, 10
    s_mul_i32 s67, s66, 514
    s_and_b32 s67, s67, 0xfffffff0
    s_mul_i32 s69, s48, 2112
    s_mov_b32 exec_hi, 1
    s_add_u32 m0, s69, 0
    s_nop 0
    buffer_load_dwordx4 v3, s[12:15], s67 offen  lds
    s_add_u32 m0, s69, 32768
    s_nop 0
    buffer_load_dwordx4 v3, s[16:19], s67 offen  lds
    s_add_u32 s67, s67, 32896
    s_add_u32 m0, s69, 528
    s_nop 0
    buffer_load_dwordx4 v3, s[12:15], s67 offen  lds
    s_add_u32 m0, s69, 33296
    s_nop 0
    buffer_load_dwordx4 v3, s[16:19], s67 offen  lds
    s_add_u32 s67, s67, 32896
    s_add_u32 m0, s69, 1056
    s_nop 0
    buffer_load_dwordx4 v3, s[12:15], s67 offen  lds
    s_add_u32 m0, s69, 33824
    s_nop 0
    buffer_load_dwordx4 v3, s[16:19], s67 offen  lds
    s_add_u32 s67, s67, 32896
    s_add_u32 m0, s69, 1584
    s_nop 0
    buffer_load_dwordx4 v3, s[12:15], s67 offen  lds
    s_add_u32 m0, s69, 34352
    s_nop 0
    buffer_load_dwordx4 v3, s[16:19], s67 offen  lds
    s_mov_b32 exec_hi, -1
    v_and_b32 v9, 15, v2
    s_lshl_b32 s66, s53, 10
    s_add_u32 s66, s66, s52
    v_lshlrev_b32 v10, 6, v9
    v_add_u32 v10, s66, v10
    v_sub_u32 v11, 2048, v10
    v_and_b32 v11, 2047, v11
    v_bfe_u32 v212, v2, 4, 1
    v_lshlrev_b32 v213, 9, v212
    s_movk_i32 s68, 514
    v_mad_u32_u24 v11, v11, s68, v213
    v_mov_b32 v208, 0
    v_mov_b32 v209, 0
    v_mov_b32 v210, 0
    v_mov_b32 v211, 0
    s_cmp_eq_u32 s48, 0
    s_cselect_b32 s68, 0, 0x7fffffff
    s_mov_b32 exec_hi, 0
    buffer_load_short_d16_hi v210, v11, s[12:15], s68 offen
    buffer_load_short_d16_hi v211, v11, s[16:19], s68 offen
    s_mov_b32 exec_hi, -1
    v_bfe_u32 v7, v0, 2, 6
    v_and_b32 v6, 3, v2
    v_lshlrev_b32 v8, 13, v7
    v_lshl_add_u32 v8, v6, 4, v8
    s_lshl_b32 s72, s53, 6
    s_add_u32 s72, s72, s52
    s_lshl_b32 s72, s72, 6
    s_add_u32 s72, s72, 8192
    s_mov_b64 s[64:65], s[70:71]
    buffer_load_dword v250, v150, s[32:35], s70 offen
    s_mov_b32 exec_hi, -1
    s_waitcnt vmcnt(1)
    v_mov_b32 v12, 163816
    v_mov_b32 v13, 1
    s_mov_b64 exec, 1
    ds_add_u32 v12, v13
    s_mov_b64 exec, -1
    s_mov_b32 s79, 200000
    s_waitcnt lgkmcnt(0)
L_wc_13:
    ds_read_b32 v13, v12
    s_waitcnt lgkmcnt(0)
    v_readfirstlane_b32 s78, v13
    s_nop 0
    s_cmp_ge_u32 s78, 4
    s_cbranch_scc1 L_wcd_14
    s_sub_u32 s79, s79, 1
    s_cbranch_scc1 L_wcd_14
    s_branch L_wc_13
L_wcd_14:
    s_lshl_b32 s67, s52, 1
    s_and_b32 s67, s67, 15
    v_mul_u32_u24 v14, 2112, v6
    v_lshl_add_u32 v14, v7, 1, v14
    v_add_u32 v14, s67, v14
    v_mul_u32_u24 v10, 528, v9
    v_add_u32 v10, v10, v213
    v_add_u32 v10, s67, v10
    v_mov_b32 v32, 0
    v_mov_b32 v33, 0
    v_mov_b32 v34, 0
    v_mov_b32 v35, 0
    v_mov_b32 v36, 0
    v_mov_b32 v37, 0
    v_mov_b32 v38, 0
    v_mov_b32 v39, 0
    v_mov_b32 v40, 0
    v_mov_b32 v41, 0
    v_mov_b32 v42, 0
    v_mov_b32 v43, 0
    v_mov_b32 v44, 0
    v_mov_b32 v45, 0
    v_mov_b32 v46, 0
    v_mov_b32 v47, 0
    ds_read_u16 v16, v14 offset:0
    ds_read_u16_d16_hi v32, v14 offset:32768
    ds_read_u16 v17, v14 offset:528
    ds_read_u16_d16_hi v33, v14 offset:33296
    ds_read_u16 v18, v14 offset:1056
    ds_read_u16_d16_hi v34, v14 offset:33824
    ds_read_u16 v19, v14 offset:1584
    ds_read_u16_d16_hi v35, v14 offset:34352
    ds_read_u16 v20, v14 offset:128
    ds_read_u16_d16_hi v36, v14 offset:32896
    ds_read_u16 v21, v14 offset:656
    ds_read_u16_d16_hi v37, v14 offset:33424
    ds_read_u16 v22, v14 offset:1184
    ds_read_u16_d16_hi v38, v14 offset:33952
    ds_read_u16 v23, v14 offset:1712
    ds_read_u16_d16_hi v39, v14 offset:34480
    ds_read_u16 v24, v14 offset:256
    ds_read_u16_d16_hi v40, v14 offset:33024
    ds_read_u16 v25, v14 offset:784
    ds_read_u16_d16_hi v41, v14 offset:33552
    ds_read_u16 v26, v14 offset:1312
    ds_read_u16_d16_hi v42, v14 offset:34080
    ds_read_u16 v27, v14 offset:1840
    ds_read_u16_d16_hi v43, v14 offset:34608
    ds_read_u16 v28, v14 offset:384
    ds_read_u16_d16_hi v44, v14 offset:33152
    ds_read_u16 v29, v14 offset:912
    ds_read_u16_d16_hi v45, v14 offset:33680
    ds_read_u16 v30, v14 offset:1440
    ds_read_u16_d16_hi v46, v14 offset:34208
    ds_read_u16 v31, v14 offset:1968
    ds_read_u16_d16_hi v47, v14 offset:34736
    ds_read_u16_d16_hi v208, v10 offset:0
    ds_read_u16_d16_hi v209, v10 offset:32768
    s_sub_u32 s69, s72, 8192
    s_add_u32 s70, s69, 4194304
    s_add_u32 s69, s69, 49152
    s_waitcnt lgkmcnt(15)
    v_or_b32 v16, v16, v32
    v_or_b32 v17, v17, v33
    v_or_b32 v18, v18, v34
    v_or_b32 v19, v19, v35
    v_or_b32 v20, v20, v36
    v_or_b32 v21, v21, v37
    v_or_b32 v22, v22, v38
    v_or_b32 v23, v23, v39
    v_or_b32 v24, v24, v40
    s_waitcnt lgkmcnt(14)
    v_or_b32 v25, v25, v41
    s_waitcnt lgkmcnt(12)
    v_or_b32 v26, v26, v42
    s_waitcnt lgkmcnt(10)
    v_or_b32 v27, v27, v43
    s_waitcnt lgkmcnt(8)
    v_or_b32 v28, v28, v44
    s_waitcnt lgkmcnt(6)
    v_or_b32 v29, v29, v45
    s_waitcnt lgkmcnt(4)
    v_or_b32 v30, v30, v46
    s_waitcnt lgkmcnt(2)
    v_or_b32 v31, v31, v47
    s_add_u32 s71, s70, 524288
    buffer_store_dwordx4 v[20:23], v8, s[24:27], s71 offen sc1
    s_add_u32 s71, s70, 1048576
    buffer_store_dwordx4 v[24:27], v8, s[24:27], s71 offen sc1
    s_add_u32 s71, s70, 1572864
    buffer_store_dwordx4 v[28:31], v8, s[24:27], s71 offen sc1
    v_cmp_ne_u32 vcc, 0, v7
    s_nop 0
    s_and_saveexec_b64 s[76:77], vcc
    buffer_store_dwordx4 v[16:19], v8, s[24:27], s70 offen sc1
    s_mov_b64 exec, s[76:77]
    s_waitcnt lgkmcnt(1)
    v_add_f32 v208, v208, v210
    s_waitcnt lgkmcnt(0)
    v_sub_f32 v209, v209, v211
    ds_swizzle_b32 v210, v208 offset:0x401F
    ds_swizzle_b32 v211, v209 offset:0x401F
    v_lshlrev_b32 v15, 31, v212
    v_xor_b32 v208, v15, v208
    v_xor_b32 v209, v15, v209
    s_waitcnt lgkmcnt(1)
    v_add_f32 v208, v208, v210
    s_waitcnt lgkmcnt(0)
    v_add_f32 v209, v209, v211
    v_mul_f32 v208, 0x3e800000, v208
    v_mul_f32 v209, 0x3e800000, v209
    v_cvt_pk_bf16_f32 v210, v208, v209
    v_lshlrev_b32 v14, 21, v212
    v_lshl_add_u32 v14, v9, 2, v14
    s_add_u32 s68, s68, s70
    s_mov_b32 exec_hi, 0
    buffer_store_dword v210, v14, s[24:27], s68 offen sc1
    s_mov_b32 exec_hi, -1
    s_waitcnt lgkmcnt(0)
    s_add_u32 s51, s51, 0x9e3779b9
    v_mov_b32 v12, 163816
    v_mov_b32 v13, 1
    s_mov_b64 exec, 1
    ds_add_u32 v12, v13
    s_mov_b64 exec, -1
    s_mov_b32 s79, 200000
    s_waitcnt lgkmcnt(0)
L_wc_15:
    ds_read_b32 v13, v12
    s_waitcnt lgkmcnt(0)
    v_readfirstlane_b32 s78, v13
    s_nop 0
    s_cmp_ge_u32 s78, 8
    s_cbranch_scc1 L_wcd_16
    s_sub_u32 s79, s79, 1
    s_cbranch_scc1 L_wcd_16
    s_branch L_wc_15
L_wcd_16:
    s_branch L_gw_12
L_gw_11:
    buffer_load_dword v250, v150, s[32:35], s70 offen
    s_mov_b32 exec_hi, -1
    s_waitcnt lgkmcnt(0)
    s_add_u32 s51, s51, 0x9e3779b9
    s_waitcnt vmcnt(0)
L_gw_12:
    v_mov_b32 v12, 163820
    s_mov_b32 s79, 200000
    s_nop 3
L_wc_17:
    ds_read_b32 v13, v12
    s_waitcnt lgkmcnt(0)
    v_readfirstlane_b32 s78, v13
    s_nop 0
    s_cmp_ge_u32 s78, 4
    s_cbranch_scc1 L_wcd_18
    s_sub_u32 s79, s79, 1
    s_cbranch_scc1 L_wcd_18
    s_sleep 2
    s_branch L_wc_17
L_wcd_18:
    s_load_dwordx4 s[64:67], s[4:5], 0
    s_lshl_b32 s58, s48, 15
    v_lshrrev_b32 v12, 3, v2
    s_mov_b32 s79, 229376
    v_mul_lo_u32 v4, v12, s79
    v_bfe_u32 v12, v2, 1, 2
    v_bfe_u32 v13, v2, 4, 1
    v_xor_b32 v12, v12, v13
    v_lshl_add_u32 v4, v12, 5, v4
    v_and_b32 v12, 1, v2
    v_lshl_add_u32 v4, v12, 4, v4
    v_xor_b32 v5, 64, v4
    v_lshrrev_b32 v13, 4, v2
    v_lshlrev_b32 v6, 10, v13
    v_and_b32 v12, 15, v2
    v_lshl_add_u32 v6, v12, 4, v6
    v_lshlrev_b32 v8, 10, v13
    v_bfe_u32 v12, v2, 2, 2
    v_lshl_add_u32 v8, v12, 7, v8
    v_bfe_u32 v12, v2, 3, 2
    v_lshl_add_u32 v8, v12, 5, v8
    v_and_b32 v12, 3, v2
    v_lshl_add_u32 v8, v12, 3, v8
    v_add_u32 v8, s58, v8
    v_xor_b32 v9, 32, v8
    v_xor_b32 v10, 64, v8
    v_xor_b32 v11, 96, v8
    v_add_u32 v7, s58, v3
    s_mul_i32 s62, s48, 1835008
    s_lshl_b32 s63, s55, 7
    s_add_u32 s62, s62, s63
    s_lshl_b32 s60, s54, 18
    s_lshl_b32 s63, s48, 16
    s_add_u32 s60, s60, s63
    s_add_u32 s75, s74, 0
    s_and_b32 s75, s75, 15
    s_mul_i32 s75, s75, 14336
    s_add_u32 s75, s75, s62
    s_add_u32 s59, s75, 0
    s_add_u32 m0, s58, 16384
    s_nop 0
    buffer_load_dwordx4 v4, s[32:35], s59 offen lds
    s_add_u32 s59, s75, 3584
    s_add_u32 m0, s58, 17408
    s_nop 0
    buffer_load_dwordx4 v5, s[32:35], s59 offen lds
    s_add_u32 s59, s75, 7168
    s_add_u32 m0, s58, 18432
    s_nop 0
    buffer_load_dwordx4 v4, s[32:35], s59 offen lds
    s_add_u32 s59, s75, 10752
    s_add_u32 m0, s58, 19456
    s_nop 0
    buffer_load_dwordx4 v5, s[32:35], s59 offen lds
    s_add_u32 s75, s74, 1
    s_and_b32 s75, s75, 15
    s_mul_i32 s75, s75, 14336
    s_add_u32 s75, s75, s62
    s_add_u32 s59, s75, 0
    s_add_u32 m0, s58, 20480
    s_nop 0
    buffer_load_dwordx4 v4, s[32:35], s59 offen lds
    s_add_u32 s59, s75, 3584
    s_add_u32 m0, s58, 21504
    s_nop 0
    buffer_load_dwordx4 v5, s[32:35], s59 offen lds
    s_add_u32 s59, s75, 7168
    s_add_u32 m0, s58, 22528
    s_nop 0
    buffer_load_dwordx4 v4, s[32:35], s59 offen lds
    s_add_u32 s59, s75, 10752
    s_add_u32 m0, s58, 23552
    s_nop 0
    buffer_load_dwordx4 v5, s[32:35], s59 offen lds
    s_bitcmp1_b32 s50, 0
    s_nop 0
    s_cbranch_scc1 L_nowa_19
    s_waitcnt vmcnt(8)
    v_mov_b32 v12, 163788
    v_mov_b32 v13, 1
    s_mov_b64 exec, 1
    ds_add_rtn_u32 v13, v12, v13
    s_mov_b64 exec, -1
    s_waitcnt lgkmcnt(0)
    v_readfirstlane_b32 s78, v13
    s_nop 0
    s_cmp_lg_u32 s78, 3
    s_cbranch_scc1 L_arr_20
    v_mov_b32 v13, s51
    v_lshlrev_b32 v12, 17, v2
    v_add_u32 v12, 12582912, v12
    s_mov_b64 exec, 255
    buffer_store_dword v13, v12, s[24:27], s69 offen sc1
    s_mov_b64 exec, -1
    s_nop 1
L_arr_20:
    s_nop 1
L_nowa_19:
    s_add_u32 s75, s74, 2
    s_and_b32 s75, s75, 15
    s_mul_i32 s75, s75, 14336
    s_add_u32 s75, s75, s62
    s_add_u32 s59, s75, 0
    s_add_u32 m0, s58, 24576
    s_nop 0
    buffer_load_dwordx4 v4, s[32:35], s59 offen lds
    s_add_u32 s59, s75, 3584
    s_add_u32 m0, s58, 25600
    s_nop 0
    buffer_load_dwordx4 v5, s[32:35], s59 offen lds
    s_add_u32 s59, s75, 7168
    s_add_u32 m0, s58, 26624
    s_nop 0
    buffer_load_dwordx4 v4, s[32:35], s59 offen lds
    s_add_u32 s59, s75, 10752
    s_add_u32 m0, s58, 27648
    s_nop 0
    buffer_load_dwordx4 v5, s[32:35], s59 offen lds
    s_add_u32 s75, s74, 3
    s_and_b32 s75, s75, 15
    s_mul_i32 s75, s75, 14336
    s_add_u32 s75, s75, s62
    s_add_u32 s59, s75, 0
    s_add_u32 m0, s58, 28672
    s_nop 0
    buffer_load_dwordx4 v4, s[32:35], s59 offen lds
    s_add_u32 s59, s75, 3584
    s_add_u32 m0, s58, 29696
    s_nop 0
    buffer_load_dwordx4 v5, s[32:35], s59 offen lds
    s_add_u32 s59, s75, 7168
    s_add_u32 m0, s58, 30720
    s_nop 0
    buffer_load_dwordx4 v4, s[32:35], s59 offen lds
    s_add_u32 s59, s75, 10752
    s_add_u32 m0, s58, 31744
    s_nop 0
    buffer_load_dwordx4 v5, s[32:35], s59 offen lds
    s_add_u32 s75, s74, 4
    s_and_b32 s75, s75, 15
    s_mul_i32 s75, s75, 14336
    s_add_u32 s75, s75, s62
    s_add_u32 s59, s75, 0
    s_add_u32 m0, s58, 0
    s_nop 0
    buffer_load_dwordx4 v4, s[32:35], s59 offen lds
    s_add_u32 s59, s75, 3584
    s_add_u32 m0, s58, 1024
    s_nop 0
    buffer_load_dwordx4 v5, s[32:35], s59 offen lds
    s_add_u32 s59, s75, 7168
    s_add_u32 m0, s58, 2048
    s_nop 0
    buffer_load_dwordx4 v4, s[32:35], s59 offen lds
    s_add_u32 s59, s75, 10752
    s_add_u32 m0, s58, 3072
    s_nop 0
    buffer_load_dwordx4 v5, s[32:35], s59 offen lds
    s_add_u32 s75, s74, 5
    s_and_b32 s75, s75, 15
    s_mul_i32 s75, s75, 14336
    s_add_u32 s75, s75, s62
    s_add_u32 s59, s75, 0
    s_add_u32 m0, s58, 4096
    s_nop 0
    buffer_load_dwordx4 v4, s[32:35], s59 offen lds
    s_add_u32 s59, s75, 3584
    s_add_u32 m0, s58, 5120
    s_nop 0
    buffer_load_dwordx4 v5, s[32:35], s59 offen lds
    s_add_u32 s59, s75, 7168
    s_add_u32 m0, s58, 6144
    s_nop 0
    buffer_load_dwordx4 v4, s[32:35], s59 offen lds
    s_add_u32 s59, s75, 10752
    s_add_u32 m0, s58, 7168
    s_nop 0
    buffer_load_dwordx4 v5, s[32:35], s59 offen lds
    s_add_u32 s75, s74, 6
    s_and_b32 s75, s75, 15
    s_mul_i32 s75, s75, 14336
    s_add_u32 s75, s75, s62
    s_add_u32 s59, s75, 0
    s_add_u32 m0, s58, 8192
    s_nop 0
    buffer_load_dwordx4 v4, s[32:35], s59 offen lds
    s_add_u32 s59, s75, 3584
    s_add_u32 m0, s58, 9216
    s_nop 0
    buffer_load_dwordx4 v5, s[32:35], s59 offen lds
    s_add_u32 s59, s75, 7168
    s_add_u32 m0, s58, 10240
    s_nop 0
    buffer_load_dwordx4 v4, s[32:35], s59 offen lds
    s_add_u32 s59, s75, 10752
    s_add_u32 m0, s58, 11264
    s_nop 0
    buffer_load_dwordx4 v5, s[32:35], s59 offen lds
    s_add_u32 s75, s74, 7
    s_and_b32 s75, s75, 15
    s_mul_i32 s75, s75, 14336
    s_add_u32 s75, s75, s62
    s_add_u32 s59, s75, 0
    s_add_u32 m0, s58, 12288
    s_nop 0
    buffer_load_dwordx4 v4, s[32:35], s59 offen lds
    s_add_u32 s59, s75, 3584
    s_add_u32 m0, s58, 13312
    s_nop 0
    buffer_load_dwordx4 v5, s[32:35], s59 offen lds
    s_add_u32 s59, s75, 7168
    s_add_u32 m0, s58, 14336
    s_nop 0
    buffer_load_dwordx4 v4, s[32:35], s59 offen lds
    s_add_u32 s59, s75, 10752
    s_add_u32 m0, s58, 15360
    s_nop 0
    buffer_load_dwordx4 v5, s[32:35], s59 offen lds
    s_add_u32 s75, s74, 8
    s_and_b32 s75, s75, 15
    s_mul_i32 s75, s75, 14336
    s_add_u32 s75, s75, s62
    s_add_u32 s59, s75, 0
    buffer_load_dwordx4 v[160:163], v4, s[32:35], s59 offen
    s_add_u32 s59, s75, 3584
    buffer_load_dwordx4 v[164:167], v5, s[32:35], s59 offen
    s_add_u32 s59, s75, 7168
    buffer_load_dwordx4 v[168:171], v4, s[32:35], s59 offen
    s_add_u32 s59, s75, 10752
    buffer_load_dwordx4 v[172:175], v5, s[32:35], s59 offen
    s_add_u32 s75, s74, 9
    s_and_b32 s75, s75, 15
    s_mul_i32 s75, s75, 14336
    s_add_u32 s75, s75, s62
    s_add_u32 s59, s75, 0
    buffer_load_dwordx4 v[176:179], v4, s[32:35], s59 offen
    s_add_u32 s59, s75, 3584
    buffer_load_dwordx4 v[180:183], v5, s[32:35], s59 offen
    s_add_u32 s59, s75, 7168
    buffer_load_dwordx4 v[184:187], v4, s[32:35], s59 offen
    s_add_u32 s59, s75, 10752
    buffer_load_dwordx4 v[188:191], v5, s[32:35], s59 offen
    s_add_u32 s75, s74, 10
    s_and_b32 s75, s75, 15
    s_mul_i32 s75, s75, 14336
    s_add_u32 s75, s75, s62
    s_add_u32 s59, s75, 0
    buffer_load_dwordx4 v[192:195], v4, s[32:35], s59 offen
    s_add_u32 s59, s75, 3584
    buffer_load_dwordx4 v[196:199], v5, s[32:35], s59 offen
    s_add_u32 s59, s75, 7168
    buffer_load_dwordx4 v[200:203], v4, s[32:35], s59 offen
    s_add_u32 s59, s75, 10752
    buffer_load_dwordx4 v[204:207], v5, s[32:35], s59 offen
    s_add_u32 s75, s74, 11
    s_and_b32 s75, s75, 15
    s_mul_i32 s75, s75, 14336
    s_add_u32 s75, s75, s62
    s_add_u32 s59, s75, 0
    buffer_load_dwordx4 v[208:211], v4, s[32:35], s59 offen
    s_add_u32 s59, s75, 3584
    buffer_load_dwordx4 v[212:215], v5, s[32:35], s59 offen
    s_add_u32 s59, s75, 7168
    buffer_load_dwordx4 v[216:219], v4, s[32:35], s59 offen
    s_add_u32 s59, s75, 10752
    buffer_load_dwordx4 v[220:223], v5, s[32:35], s59 offen
    s_add_u32 s75, s74, 12
    s_and_b32 s75, s75, 15
    s_mul_i32 s75, s75, 14336
    s_add_u32 s75, s75, s62
    s_add_u32 s59, s75, 0
    buffer_load_dwordx4 v[224:227], v4, s[32:35], s59 offen
    s_add_u32 s59, s75, 3584
    buffer_load_dwordx4 v[228:231], v5, s[32:35], s59 offen
    s_add_u32 s59, s75, 7168
    buffer_load_dwordx4 v[232:235], v4, s[32:35], s59 offen
    s_add_u32 s59, s75, 10752
    buffer_load_dwordx4 v[236:239], v5, s[32:35], s59 offen
    s_add_u32 s75, s74, 13
    s_and_b32 s75, s75, 15
    s_mul_i32 s75, s75, 14336
    s_add_u32 s75, s75, s62
    s_add_u32 s59, s75, 0
    buffer_load_dwordx4 v[240:243], v4, s[32:35], s59 offen
    s_add_u32 s59, s75, 3584
    buffer_load_dwordx4 v[244:247], v5, s[32:35], s59 offen
    s_add_u32 s59, s75, 7168
    buffer_load_dwordx4 v[248:251], v4, s[32:35], s59 offen
    s_add_u32 s59, s75, 10752
    buffer_load_dwordx4 v[252:255], v5, s[32:35], s59 offen
    s_lshr_b32 s72, s48, 1
    s_lshl_b32 s72, s72, 12
    s_add_u32 s72, s72, 12582912
    s_bitcmp1_b32 s48, 0
    s_nop 0
    s_cbranch_scc1 L_g1odd
    v_min_u32 v12, 63, v2
    v_lshlrev_b32 v12, 6, v12
    v_add_u32 v12, s6, v12
    s_mov_b32 s79, 50000
    s_waitcnt lgkmcnt(0)
    s_nop 2
L_gp_21:
    buffer_load_dword v16, v12, s[24:27], s72 offen sc1
    s_sub_u32 s79, s79, 1
    s_waitcnt vmcnt(0)
L_gpc_23:
    v_cmp_ne_u32 vcc, s51, v16
    s_nop 1
    s_cmp_eq_u64 vcc, 0
    s_cbranch_scc1 L_gpd_22
    s_cmp_eq_u32 s79, 0
    s_cbranch_scc1 L_gpd_22
    s_mov_b64 exec, vcc
    s_sleep 2
    s_branch L_gp_21
L_gpd_22:
    s_mov_b64 exec, -1
    s_lshl_b32 s72, s48, 1
    s_add_u32 s72, s72, 163824
    v_mov_b32 v12, s72
    ds_write_b32 v12, v12
    s_waitcnt lgkmcnt(0)
    s_nop 2
    s_branch L_g1go
L_g1odd:
    s_lshl_b32 s72, s48, 1
    s_add_u32 s72, s72, 163822
    v_mov_b32 v12, s72
    s_mov_b32 s79, 200000
    s_waitcnt lgkmcnt(0)
    s_nop 2
L_wc_24:
    ds_read_b32 v13, v12
    s_waitcnt lgkmcnt(0)
    v_readfirstlane_b32 s78, v13
    s_nop 0
    s_cmp_ge_u32 s78, 1
    s_cbranch_scc1 L_wcd_25
    s_sub_u32 s79, s79, 1
    s_cbranch_scc1 L_wcd_25
    s_sleep 1
    s_branch L_wc_24
L_wcd_25:
L_g1go:
    v_lshrrev_b32 v12, 3, v2
    s_mov_b32 s79, 4096
    v_mul_lo_u32 v14, v12, s79
    v_bfe_u32 v12, v2, 1, 2
    v_bfe_u32 v13, v2, 4, 1
    v_xor_b32 v12, v12, v13
    v_lshl_add_u32 v14, v12, 5, v14
    v_and_b32 v12, 1, v2
    v_lshl_add_u32 v14, v12, 4, v14
    v_xor_b32 v15, 64, v14
    s_and_b32 s76, s48, 3
    s_lshl_b32 s58, s76, 15
    s_mul_i32 s63, s76, 1835008
    s_lshl_b32 s76, s57, 7
    s_add_u32 s63, s63, s76
    s_and_b32 s77, s57, 3
    s_lshl_b32 s77, s77, 1
    s_and_b32 s76, s56, 7
    s_mul_i32 s76, s76, 0
    s_add_u32 s77, s77, s76
    s_mul_i32 s77, s77, 0
    s_lshr_b32 s77, s77, 2
    s_sub_u32 s76, s77, 14
    s_min_u32 s77, s77, s76
    s_lshl_b32 s76, s48, 2
    s_add_u32 s76, s76, 163792
    v_mov_b32 v12, s76
    s_add_u32 s61, s74, 0
    s_and_b32 s61, s61, 15
    s_lshl_b32 s61, s61, 12
    s_add_u32 s61, s61, s60
    buffer_load_dwordx4 v[112:115], v6, s[24:27], s61 offen offset:0 sc1
    buffer_load_dwordx4 v[116:119], v6, s[24:27], s61 offen offset:256 sc1
    buffer_load_dwordx4 v[120:123], v6, s[24:27], s61 offen offset:512 sc1
    buffer_load_dwordx4 v[124:127], v6, s[24:27], s61 offen offset:768 sc1
    s_add_u32 s61, s74, 1
    s_and_b32 s61, s61, 15
    s_lshl_b32 s61, s61, 12
    s_add_u32 s61, s61, s60
    buffer_load_dwordx4 v[128:131], v6, s[24:27], s61 offen offset:0 sc1
    buffer_load_dwordx4 v[132:135], v6, s[24:27], s61 offen offset:256 sc1
    buffer_load_dwordx4 v[136:139], v6, s[24:27], s61 offen offset:512 sc1
    buffer_load_dwordx4 v[140:143], v6, s[24:27], s61 offen offset:768 sc1
    s_add_u32 s61, s74, 2
    s_and_b32 s61, s61, 15
    s_lshl_b32 s61, s61, 12
    s_add_u32 s61, s61, s60
    buffer_load_dwordx4 v[144:147], v6, s[24:27], s61 offen offset:0 sc1
    buffer_load_dwordx4 v[148:151], v6, s[24:27], s61 offen offset:256 sc1
    buffer_load_dwordx4 v[152:155], v6, s[24:27], s61 offen offset:512 sc1
    buffer_load_dwordx4 v[156:159], v6, s[24:27], s61 offen offset:768 sc1
    ds_read_b64_tr_b16 v[80:81], v8 offset:16384
    ds_read_b64_tr_b16 v[82:83], v8 offset:16896
    ds_read_b64_tr_b16 v[84:85], v9 offset:16384
    ds_read_b64_tr_b16 v[86:87], v9 offset:16896
    ds_read_b64_tr_b16 v[88:89], v10 offset:16384
    ds_read_b64_tr_b16 v[90:91], v10 offset:16896
    ds_read_b64_tr_b16 v[92:93], v11 offset:16384
    ds_read_b64_tr_b16 v[94:95], v11 offset:16896
    s_waitcnt lgkmcnt(0)
    s_waitcnt vmcnt(11)
    v_mfma_f32_16x16x32_bf16 v[16:19], v[80:83], v[112:115], 0
    ds_write_b128 v7, v[160:163] offset:16384
    s_waitcnt vmcnt(10)
    v_mfma_f32_16x16x32_bf16 v[20:23], v[80:83], v[116:119], 0
    ds_write_b128 v7, v[164:167] offset:17408
    s_waitcnt vmcnt(9)
    v_mfma_f32_16x16x32_bf16 v[24:27], v[80:83], v[120:123], 0
    ds_write_b128 v7, v[168:171] offset:18432
    s_waitcnt vmcnt(8)
    v_mfma_f32_16x16x32_bf16 v[28:31], v[80:83], v[124:127], 0
    ds_write_b128 v7, v[172:175] offset:19456
    v_mfma_f32_16x16x32_bf16 v[32:35], v[84:87], v[112:115], 0
    v_mfma_f32_16x16x32_bf16 v[36:39], v[84:87], v[116:119], 0
    v_mfma_f32_16x16x32_bf16 v[40:43], v[84:87], v[120:123], 0
    ds_read_b64_tr_b16 v[96:97], v8 offset:20480
    v_mfma_f32_16x16x32_bf16 v[44:47], v[84:87], v[124:127], 0
    ds_read_b64_tr_b16 v[98:99], v8 offset:20992
    v_mfma_f32_16x16x32_bf16 v[48:51], v[88:91], v[112:115], 0
    ds_read_b64_tr_b16 v[100:101], v9 offset:20480
    v_mfma_f32_16x16x32_bf16 v[52:55], v[88:91], v[116:119], 0
    ds_read_b64_tr_b16 v[102:103], v9 offset:20992
    v_mfma_f32_16x16x32_bf16 v[56:59], v[88:91], v[120:123], 0
    ds_read_b64_tr_b16 v[104:105], v10 offset:20480
    v_mfma_f32_16x16x32_bf16 v[60:63], v[88:91], v[124:127], 0
    ds_read_b64_tr_b16 v[106:107], v10 offset:20992
    v_mfma_f32_16x16x32_bf16 v[64:67], v[92:95], v[112:115], 0
    ds_read_b64_tr_b16 v[108:109], v11 offset:20480
    s_add_u32 s61, s74, 3
    s_and_b32 s61, s61, 15
    s_lshl_b32 s61, s61, 12
    s_add_u32 s61, s61, s60
    buffer_load_dwordx4 v[112:115], v6, s[24:27], s61 offen offset:0 sc1
    v_mfma_f32_16x16x32_bf16 v[68:71], v[92:95], v[116:119], 0
    ds_read_b64_tr_b16 v[110:111], v11 offset:20992
    buffer_load_dwordx4 v[116:119], v6, s[24:27], s61 offen offset:256 sc1
    v_mfma_f32_16x16x32_bf16 v[72:75], v[92:95], v[120:123], 0
    buffer_load_dwordx4 v[120:123], v6, s[24:27], s61 offen offset:512 sc1
    v_mfma_f32_16x16x32_bf16 v[76:79], v[92:95], v[124:127], 0
    buffer_load_dwordx4 v[124:127], v6, s[24:27], s61 offen offset:768 sc1
    s_waitcnt lgkmcnt(0)
    s_waitcnt vmcnt(11)
    v_mfma_f32_16x16x32_bf16 v[16:19], v[96:99], v[128:131], v[16:19]
    ds_write_b128 v7, v[176:179] offset:20480
    s_waitcnt vmcnt(10)
    v_mfma_f32_16x16x32_bf16 v[20:23], v[96:99], v[132:135], v[20:23]
    ds_write_b128 v7, v[180:183] offset:21504
    s_waitcnt vmcnt(9)
    v_mfma_f32_16x16x32_bf16 v[24:27], v[96:99], v[136:139], v[24:27]
    ds_write_b128 v7, v[184:187] offset:22528
    s_waitcnt vmcnt(8)
    v_mfma_f32_16x16x32_bf16 v[28:31], v[96:99], v[140:143], v[28:31]
    ds_write_b128 v7, v[188:191] offset:23552
    v_mfma_f32_16x16x32_bf16 v[32:35], v[100:103], v[128:131], v[32:35]
    v_mfma_f32_16x16x32_bf16 v[36:39], v[100:103], v[132:135], v[36:39]
    v_mfma_f32_16x16x32_bf16 v[40:43], v[100:103], v[136:139], v[40:43]
    ds_read_b64_tr_b16 v[80:81], v8 offset:24576
    v_mfma_f32_16x16x32_bf16 v[44:47], v[100:103], v[140:143], v[44:47]
    ds_read_b64_tr_b16 v[82:83], v8 offset:25088
    v_mfma_f32_16x16x32_bf16 v[48:51], v[104:107], v[128:131], v[48:51]
    ds_read_b64_tr_b16 v[84:85], v9 offset:24576
    v_mfma_f32_16x16x32_bf16 v[52:55], v[104:107], v[132:135], v[52:55]
    ds_read_b64_tr_b16 v[86:87], v9 offset:25088
    v_mfma_f32_16x16x32_bf16 v[56:59], v[104:107], v[136:139], v[56:59]
    ds_read_b64_tr_b16 v[88:89], v10 offset:24576
    v_mfma_f32_16x16x32_bf16 v[60:63], v[104:107], v[140:143], v[60:63]
    ds_read_b64_tr_b16 v[90:91], v10 offset:25088
    v_mfma_f32_16x16x32_bf16 v[64:67], v[108:111], v[128:131], v[64:67]
    ds_read_b64_tr_b16 v[92:93], v11 offset:24576
    s_add_u32 s61, s74, 4
    s_and_b32 s61, s61, 15
    s_lshl_b32 s61, s61, 12
    s_add_u32 s61, s61, s60
    buffer_load_dwordx4 v[128:131], v6, s[24:27], s61 offen offset:0 sc1
    v_mfma_f32_16x16x32_bf16 v[68:71], v[108:111], v[132:135], v[68:71]
    ds_read_b64_tr_b16 v[94:95], v11 offset:25088
    buffer_load_dwordx4 v[132:135], v6, s[24:27], s61 offen offset:256 sc1
    v_mfma_f32_16x16x32_bf16 v[72:75], v[108:111], v[136:139], v[72:75]
    buffer_load_dwordx4 v[136:139], v6, s[24:27], s61 offen offset:512 sc1
    v_mfma_f32_16x16x32_bf16 v[76:79], v[108:111], v[140:143], v[76:79]
    buffer_load_dwordx4 v[140:143], v6, s[24:27], s61 offen offset:768 sc1
    s_waitcnt lgkmcnt(0)
    s_waitcnt vmcnt(11)
    v_mfma_f32_16x16x32_bf16 v[16:19], v[80:83], v[144:147], v[16:19]
    ds_write_b128 v7, v[192:195] offset:24576
    s_waitcnt vmcnt(10)
    v_mfma_f32_16x16x32_bf16 v[20:23], v[80:83], v[148:151], v[20:23]
    ds_write_b128 v7, v[196:199] offset:25600
    s_waitcnt vmcnt(9)
    v_mfma_f32_16x16x32_bf16 v[24:27], v[80:83], v[152:155], v[24:27]
    ds_write_b128 v7, v[200:203] offset:26624
    s_waitcnt vmcnt(8)
    v_mfma_f32_16x16x32_bf16 v[28:31], v[80:83], v[156:159], v[28:31]
    ds_write_b128 v7, v[204:207] offset:27648
    v_mfma_f32_16x16x32_bf16 v[32:35], v[84:87], v[144:147], v[32:35]
    v_mfma_f32_16x16x32_bf16 v[36:39], v[84:87], v[148:151], v[36:39]
    v_mfma_f32_16x16x32_bf16 v[40:43], v[84:87], v[152:155], v[40:43]
    ds_read_b64_tr_b16 v[96:97], v8 offset:28672
    v_mfma_f32_16x16x32_bf16 v[44:47], v[84:87], v[156:159], v[44:47]
    ds_read_b64_tr_b16 v[98:99], v8 offset:29184
    v_mfma_f32_16x16x32_bf16 v[48:51], v[88:91], v[144:147], v[48:51]
    ds_read_b64_tr_b16 v[100:101], v9 offset:28672
    v_mfma_f32_16x16x32_bf16 v[52:55], v[88:91], v[148:151], v[52:55]
    ds_read_b64_tr_b16 v[102:103], v9 offset:29184
    v_mfma_f32_16x16x32_bf16 v[56:59], v[88:91], v[152:155], v[56:59]
    ds_read_b64_tr_b16 v[104:105], v10 offset:28672
    v_mfma_f32_16x16x32_bf16 v[60:63], v[88:91], v[156:159], v[60:63]
    ds_read_b64_tr_b16 v[106:107], v10 offset:29184
    v_mfma_f32_16x16x32_bf16 v[64:67], v[92:95], v[144:147], v[64:67]
    ds_read_b64_tr_b16 v[108:109], v11 offset:28672
    s_add_u32 s61, s74, 5
    s_and_b32 s61, s61, 15
    s_lshl_b32 s61, s61, 12
    s_add_u32 s61, s61, s60
    buffer_load_dwordx4 v[144:147], v6, s[24:27], s61 offen offset:0 sc1
    v_mfma_f32_16x16x32_bf16 v[68:71], v[92:95], v[148:151], v[68:71]
    ds_read_b64_tr_b16 v[110:111], v11 offset:29184
    buffer_load_dwordx4 v[148:151], v6, s[24:27], s61 offen offset:256 sc1
    v_mfma_f32_16x16x32_bf16 v[72:75], v[92:95], v[152:155], v[72:75]
    buffer_load_dwordx4 v[152:155], v6, s[24:27], s61 offen offset:512 sc1
    v_mfma_f32_16x16x32_bf16 v[76:79], v[92:95], v[156:159], v[76:79]
    buffer_load_dwordx4 v[156:159], v6, s[24:27], s61 offen offset:768 sc1
    s_waitcnt lgkmcnt(0)
    s_waitcnt vmcnt(11)
    v_mfma_f32_16x16x32_bf16 v[16:19], v[96:99], v[112:115], v[16:19]
    ds_write_b128 v7, v[208:211] offset:28672
    s_waitcnt vmcnt(10)
    v_mfma_f32_16x16x32_bf16 v[20:23], v[96:99], v[116:119], v[20:23]
    ds_write_b128 v7, v[212:215] offset:29696
    s_waitcnt vmcnt(9)
    v_mfma_f32_16x16x32_bf16 v[24:27], v[96:99], v[120:123], v[24:27]
    ds_write_b128 v7, v[216:219] offset:30720
    s_waitcnt vmcnt(8)
    v_mfma_f32_16x16x32_bf16 v[28:31], v[96:99], v[124:127], v[28:31]
    ds_write_b128 v7, v[220:223] offset:31744
    v_mfma_f32_16x16x32_bf16 v[32:35], v[100:103], v[112:115], v[32:35]
    v_mfma_f32_16x16x32_bf16 v[36:39], v[100:103], v[116:119], v[36:39]
    v_mfma_f32_16x16x32_bf16 v[40:43], v[100:103], v[120:123], v[40:43]
    ds_read_b64_tr_b16 v[80:81], v8 offset:0
    v_mfma_f32_16x16x32_bf16 v[44:47], v[100:103], v[124:127], v[44:47]
    ds_read_b64_tr_b16 v[82:83], v8 offset:512
    v_mfma_f32_16x16x32_bf16 v[48:51], v[104:107], v[112:115], v[48:51]
    ds_read_b64_tr_b16 v[84:85], v9 offset:0
    v_mfma_f32_16x16x32_bf16 v[52:55], v[104:107], v[116:119], v[52:55]
    ds_read_b64_tr_b16 v[86:87], v9 offset:512
    v_mfma_f32_16x16x32_bf16 v[56:59], v[104:107], v[120:123], v[56:59]
    ds_read_b64_tr_b16 v[88:89], v10 offset:0
    v_mfma_f32_16x16x32_bf16 v[60:63], v[104:107], v[124:127], v[60:63]
    ds_read_b64_tr_b16 v[90:91], v10 offset:512
    v_mfma_f32_16x16x32_bf16 v[64:67], v[108:111], v[112:115], v[64:67]
    ds_read_b64_tr_b16 v[92:93], v11 offset:0
    s_add_u32 s61, s74, 6
    s_and_b32 s61, s61, 15
    s_lshl_b32 s61, s61, 12
    s_add_u32 s61, s61, s60
    buffer_load_dwordx4 v[112:115], v6, s[24:27], s61 offen offset:0 sc1
    v_mfma_f32_16x16x32_bf16 v[68:71], v[108:111], v[116:119], v[68:71]
    ds_read_b64_tr_b16 v[94:95], v11 offset:512
    buffer_load_dwordx4 v[116:119], v6, s[24:27], s61 offen offset:256 sc1
    v_mfma_f32_16x16x32_bf16 v[72:75], v[108:111], v[120:123], v[72:75]
    buffer_load_dwordx4 v[120:123], v6, s[24:27], s61 offen offset:512 sc1
    v_mfma_f32_16x16x32_bf16 v[76:79], v[108:111], v[124:127], v[76:79]
    buffer_load_dwordx4 v[124:127], v6, s[24:27], s61 offen offset:768 sc1
    s_waitcnt lgkmcnt(0)
    s_waitcnt vmcnt(11)
    v_mfma_f32_16x16x32_bf16 v[16:19], v[80:83], v[128:131], v[16:19]
    ds_write_b128 v7, v[224:227] offset:0
    s_waitcnt vmcnt(10)
    v_mfma_f32_16x16x32_bf16 v[20:23], v[80:83], v[132:135], v[20:23]
    ds_write_b128 v7, v[228:231] offset:1024
    s_waitcnt vmcnt(9)
    v_mfma_f32_16x16x32_bf16 v[24:27], v[80:83], v[136:139], v[24:27]
    ds_write_b128 v7, v[232:235] offset:2048
    s_waitcnt vmcnt(8)
    v_mfma_f32_16x16x32_bf16 v[28:31], v[80:83], v[140:143], v[28:31]
    ds_write_b128 v7, v[236:239] offset:3072
    v_mfma_f32_16x16x32_bf16 v[32:35], v[84:87], v[128:131], v[32:35]
    v_mfma_f32_16x16x32_bf16 v[36:39], v[84:87], v[132:135], v[36:39]
    v_mfma_f32_16x16x32_bf16 v[40:43], v[84:87], v[136:139], v[40:43]
    ds_read_b64_tr_b16 v[96:97], v8 offset:4096
    v_mfma_f32_16x16x32_bf16 v[44:47], v[84:87], v[140:143], v[44:47]
    ds_read_b64_tr_b16 v[98:99], v8 offset:4608
    v_mfma_f32_16x16x32_bf16 v[48:51], v[88:91], v[128:131], v[48:51]
    ds_read_b64_tr_b16 v[100:101], v9 offset:4096
    v_mfma_f32_16x16x32_bf16 v[52:55], v[88:91], v[132:135], v[52:55]
    ds_read_b64_tr_b16 v[102:103], v9 offset:4608
    v_mfma_f32_16x16x32_bf16 v[56:59], v[88:91], v[136:139], v[56:59]
    ds_read_b64_tr_b16 v[104:105], v10 offset:4096
    v_mfma_f32_16x16x32_bf16 v[60:63], v[88:91], v[140:143], v[60:63]
    ds_read_b64_tr_b16 v[106:107], v10 offset:4608
    v_mfma_f32_16x16x32_bf16 v[64:67], v[92:95], v[128:131], v[64:67]
    ds_read_b64_tr_b16 v[108:109], v11 offset:4096
    s_add_u32 s61, s74, 7
    s_and_b32 s61, s61, 15
    s_lshl_b32 s61, s61, 12
    s_add_u32 s61, s61, s60
    buffer_load_dwordx4 v[128:131], v6, s[24:27], s61 offen offset:0 sc1
    v_mfma_f32_16x16x32_bf16 v[68:71], v[92:95], v[132:135], v[68:71]
    ds_read_b64_tr_b16 v[110:111], v11 offset:4608
    buffer_load_dwordx4 v[132:135], v6, s[24:27], s61 offen offset:256 sc1
    v_mfma_f32_16x16x32_bf16 v[72:75], v[92:95], v[136:139], v[72:75]
    buffer_load_dwordx4 v[136:139], v6, s[24:27], s61 offen offset:512 sc1
    v_mfma_f32_16x16x32_bf16 v[76:79], v[92:95], v[140:143], v[76:79]
    buffer_load_dwordx4 v[140:143], v6, s[24:27], s61 offen offset:768 sc1
    s_waitcnt lgkmcnt(0)
    s_waitcnt vmcnt(11)
    v_mfma_f32_16x16x32_bf16 v[16:19], v[96:99], v[144:147], v[16:19]
    ds_write_b128 v7, v[240:243] offset:4096
    s_waitcnt vmcnt(10)
    v_mfma_f32_16x16x32_bf16 v[20:23], v[96:99], v[148:151], v[20:23]
    ds_write_b128 v7, v[244:247] offset:5120
    s_waitcnt vmcnt(9)
    v_mfma_f32_16x16x32_bf16 v[24:27], v[96:99], v[152:155], v[24:27]
    ds_write_b128 v7, v[248:251] offset:6144
    s_waitcnt vmcnt(8)
    v_mfma_f32_16x16x32_bf16 v[28:31], v[96:99], v[156:159], v[28:31]
    ds_write_b128 v7, v[252:255] offset:7168
    v_mfma_f32_16x16x32_bf16 v[32:35], v[100:103], v[144:147], v[32:35]
    v_mfma_f32_16x16x32_bf16 v[36:39], v[100:103], v[148:151], v[36:39]
    v_mfma_f32_16x16x32_bf16 v[40:43], v[100:103], v[152:155], v[40:43]
    ds_read_b64_tr_b16 v[80:81], v8 offset:8192
    v_mfma_f32_16x16x32_bf16 v[44:47], v[100:103], v[156:159], v[44:47]
    ds_read_b64_tr_b16 v[82:83], v8 offset:8704
    v_mfma_f32_16x16x32_bf16 v[48:51], v[104:107], v[144:147], v[48:51]
    ds_read_b64_tr_b16 v[84:85], v9 offset:8192
    v_mfma_f32_16x16x32_bf16 v[52:55], v[104:107], v[148:151], v[52:55]
    ds_read_b64_tr_b16 v[86:87], v9 offset:8704
    v_mfma_f32_16x16x32_bf16 v[56:59], v[104:107], v[152:155], v[56:59]
    ds_read_b64_tr_b16 v[88:89], v10 offset:8192
    v_mfma_f32_16x16x32_bf16 v[60:63], v[104:107], v[156:159], v[60:63]
    ds_read_b64_tr_b16 v[90:91], v10 offset:8704
    v_mfma_f32_16x16x32_bf16 v[64:67], v[108:111], v[144:147], v[64:67]
    ds_read_b64_tr_b16 v[92:93], v11 offset:8192
    s_add_u32 s61, s74, 8
    s_and_b32 s61, s61, 15
    s_lshl_b32 s61, s61, 12
    s_add_u32 s61, s61, s60
    buffer_load_dwordx4 v[144:147], v6, s[24:27], s61 offen offset:0 sc1
    v_mfma_f32_16x16x32_bf16 v[68:71], v[108:111], v[148:151], v[68:71]
    ds_read_b64_tr_b16 v[94:95], v11 offset:8704
    buffer_load_dwordx4 v[148:151], v6, s[24:27], s61 offen offset:256 sc1
    v_mfma_f32_16x16x32_bf16 v[72:75], v[108:111], v[152:155], v[72:75]
    buffer_load_dwordx4 v[152:155], v6, s[24:27], s61 offen offset:512 sc1
    v_mfma_f32_16x16x32_bf16 v[76:79], v[108:111], v[156:159], v[76:79]
    buffer_load_dwordx4 v[156:159], v6, s[24:27], s61 offen offset:768 sc1
    s_waitcnt lgkmcnt(0)
    s_waitcnt vmcnt(11)
    v_mfma_f32_16x16x32_bf16 v[16:19], v[80:83], v[112:115], v[16:19]
    s_add_u32 s75, s74, 14
    s_and_b32 s75, s75, 15
    s_mul_i32 s75, s75, 14336
    s_add_u32 s75, s75, s62
    s_add_u32 s59, s75, 0
    s_add_u32 m0, s58, 8192
    s_nop 0
    buffer_load_dwordx4 v4, s[32:35], s59 offen lds
    s_waitcnt vmcnt(11)
    v_mfma_f32_16x16x32_bf16 v[20:23], v[80:83], v[116:119], v[20:23]
    s_add_u32 s59, s75, 3584
    s_add_u32 m0, s58, 9216
    s_nop 0
    buffer_load_dwordx4 v5, s[32:35], s59 offen lds
    s_waitcnt vmcnt(11)
    v_mfma_f32_16x16x32_bf16 v[24:27], v[80:83], v[120:123], v[24:27]
    s_add_u32 s59, s75, 7168
    s_add_u32 m0, s58, 10240
    s_nop 0
    buffer_load_dwordx4 v4, s[32:35], s59 offen lds
    s_waitcnt vmcnt(11)
    v_mfma_f32_16x16x32_bf16 v[28:31], v[80:83], v[124:127], v[28:31]
    s_add_u32 s59, s75, 10752
    s_add_u32 m0, s58, 11264
    s_nop 0
    buffer_load_dwordx4 v5, s[32:35], s59 offen lds
    v_mfma_f32_16x16x32_bf16 v[32:35], v[84:87], v[112:115], v[32:35]
    v_mfma_f32_16x16x32_bf16 v[36:39], v[84:87], v[116:119], v[36:39]
    v_mfma_f32_16x16x32_bf16 v[40:43], v[84:87], v[120:123], v[40:43]
    ds_read_b64_tr_b16 v[96:97], v8 offset:12288
    v_mfma_f32_16x16x32_bf16 v[44:47], v[84:87], v[124:127], v[44:47]
    ds_read_b64_tr_b16 v[98:99], v8 offset:12800
    v_mfma_f32_16x16x32_bf16 v[48:51], v[88:91], v[112:115], v[48:51]
    ds_read_b64_tr_b16 v[100:101], v9 offset:12288
    v_mfma_f32_16x16x32_bf16 v[52:55], v[88:91], v[116:119], v[52:55]
    ds_read_b64_tr_b16 v[102:103], v9 offset:12800
    v_mfma_f32_16x16x32_bf16 v[56:59], v[88:91], v[120:123], v[56:59]
    ds_read_b64_tr_b16 v[104:105], v10 offset:12288
    v_mfma_f32_16x16x32_bf16 v[60:63], v[88:91], v[124:127], v[60:63]
    ds_read_b64_tr_b16 v[106:107], v10 offset:12800
    v_mfma_f32_16x16x32_bf16 v[64:67], v[92:95], v[112:115], v[64:67]
    ds_read_b64_tr_b16 v[108:109], v11 offset:12288
    s_add_u32 s61, s74, 9
    s_and_b32 s61, s61, 15
    s_lshl_b32 s61, s61, 12
    s_add_u32 s61, s61, s60
    buffer_load_dwordx4 v[112:115], v6, s[24:27], s61 offen offset:0 sc1
    v_mfma_f32_16x16x32_bf16 v[68:71], v[92:95], v[116:119], v[68:71]
    ds_read_b64_tr_b16 v[110:111], v11 offset:12800
    buffer_load_dwordx4 v[116:119], v6, s[24:27], s61 offen offset:256 sc1
    v_mfma_f32_16x16x32_bf16 v[72:75], v[92:95], v[120:123], v[72:75]
    buffer_load_dwordx4 v[120:123], v6, s[24:27], s61 offen offset:512 sc1
    v_mfma_f32_16x16x32_bf16 v[76:79], v[92:95], v[124:127], v[76:79]
    buffer_load_dwordx4 v[124:127], v6, s[24:27], s61 offen offset:768 sc1
    s_waitcnt lgkmcnt(0)
    s_waitcnt vmcnt(15)
    v_mfma_f32_16x16x32_bf16 v[16:19], v[96:99], v[128:131], v[16:19]
    s_add_u32 s75, s74, 15
    s_and_b32 s75, s75, 15
    s_mul_i32 s75, s75, 14336
    s_add_u32 s75, s75, s62
    s_add_u32 s59, s75, 0
    s_add_u32 m0, s58, 12288
    s_nop 0
    buffer_load_dwordx4 v4, s[32:35], s59 offen lds
    s_waitcnt vmcnt(15)
    v_mfma_f32_16x16x32_bf16 v[20:23], v[96:99], v[132:135], v[20:23]
    s_add_u32 s59, s75, 3584
    s_add_u32 m0, s58, 13312
    s_nop 0
    buffer_load_dwordx4 v5, s[32:35], s59 offen lds
    s_waitcnt vmcnt(15)
    v_mfma_f32_16x16x32_bf16 v[24:27], v[96:99], v[136:139], v[24:27]
    s_add_u32 s59, s75, 7168
    s_add_u32 m0, s58, 14336
    s_nop 0
    buffer_load_dwordx4 v4, s[32:35], s59 offen lds
    s_waitcnt vmcnt(15)
    v_mfma_f32_16x16x32_bf16 v[28:31], v[96:99], v[140:143], v[28:31]
    s_add_u32 s59, s75, 10752
    s_add_u32 m0, s58, 15360
    s_nop 0
    buffer_load_dwordx4 v5, s[32:35], s59 offen lds
    v_mfma_f32_16x16x32_bf16 v[32:35], v[100:103], v[128:131], v[32:35]
    v_mfma_f32_16x16x32_bf16 v[36:39], v[100:103], v[132:135], v[36:39]
    v_mfma_f32_16x16x32_bf16 v[40:43], v[100:103], v[136:139], v[40:43]
    ds_read_b64_tr_b16 v[80:81], v8 offset:16384
    v_mfma_f32_16x16x32_bf16 v[44:47], v[100:103], v[140:143], v[44:47]
    ds_read_b64_tr_b16 v[82:83], v8 offset:16896
    v_mfma_f32_16x16x32_bf16 v[48:51], v[104:107], v[128:131], v[48:51]
    ds_read_b64_tr_b16 v[84:85], v9 offset:16384
    v_mfma_f32_16x16x32_bf16 v[52:55], v[104:107], v[132:135], v[52:55]
    ds_read_b64_tr_b16 v[86:87], v9 offset:16896
    v_mfma_f32_16x16x32_bf16 v[56:59], v[104:107], v[136:139], v[56:59]
    ds_read_b64_tr_b16 v[88:89], v10 offset:16384
    v_mfma_f32_16x16x32_bf16 v[60:63], v[104:107], v[140:143], v[60:63]
    ds_read_b64_tr_b16 v[90:91], v10 offset:16896
    v_mfma_f32_16x16x32_bf16 v[64:67], v[108:111], v[128:131], v[64:67]
    ds_read_b64_tr_b16 v[92:93], v11 offset:16384
    s_add_u32 s61, s74, 10
    s_and_b32 s61, s61, 15
    s_lshl_b32 s61, s61, 12
    s_add_u32 s61, s61, s60
    buffer_load_dwordx4 v[128:131], v6, s[24:27], s61 offen offset:0 sc1
    v_mfma_f32_16x16x32_bf16 v[68:71], v[108:111], v[132:135], v[68:71]
    ds_read_b64_tr_b16 v[94:95], v11 offset:16896
    buffer_load_dwordx4 v[132:135], v6, s[24:27], s61 offen offset:256 sc1
    v_mfma_f32_16x16x32_bf16 v[72:75], v[108:111], v[136:139], v[72:75]
    buffer_load_dwordx4 v[136:139], v6, s[24:27], s61 offen offset:512 sc1
    v_mfma_f32_16x16x32_bf16 v[76:79], v[108:111], v[140:143], v[76:79]
    buffer_load_dwordx4 v[140:143], v6, s[24:27], s61 offen offset:768 sc1
    s_waitcnt vmcnt(19) lgkmcnt(6)
    v_mfma_f32_16x16x32_bf16 v[16:19], v[80:83], v[144:147], v[16:19]
    s_waitcnt vmcnt(18)
    v_mfma_f32_16x16x32_bf16 v[20:23], v[80:83], v[148:151], v[20:23]
    s_waitcnt vmcnt(17)
    v_mfma_f32_16x16x32_bf16 v[24:27], v[80:83], v[152:155], v[24:27]
    s_waitcnt vmcnt(16)
    v_mfma_f32_16x16x32_bf16 v[28:31], v[80:83], v[156:159], v[28:31]
    s_waitcnt lgkmcnt(4)
    v_mfma_f32_16x16x32_bf16 v[32:35], v[84:87], v[144:147], v[32:35]
    v_mfma_f32_16x16x32_bf16 v[36:39], v[84:87], v[148:151], v[36:39]
    v_mfma_f32_16x16x32_bf16 v[40:43], v[84:87], v[152:155], v[40:43]
    ds_read_b64_tr_b16 v[96:97], v8 offset:20480
    v_mfma_f32_16x16x32_bf16 v[44:47], v[84:87], v[156:159], v[44:47]
    ds_read_b64_tr_b16 v[98:99], v8 offset:20992
    s_waitcnt lgkmcnt(4)
    v_mfma_f32_16x16x32_bf16 v[48:51], v[88:91], v[144:147], v[48:51]
    ds_read_b64_tr_b16 v[100:101], v9 offset:20480
    v_mfma_f32_16x16x32_bf16 v[52:55], v[88:91], v[148:151], v[52:55]
    ds_read_b64_tr_b16 v[102:103], v9 offset:20992
    v_mfma_f32_16x16x32_bf16 v[56:59], v[88:91], v[152:155], v[56:59]
    ds_read_b64_tr_b16 v[104:105], v10 offset:20480
    v_mfma_f32_16x16x32_bf16 v[60:63], v[88:91], v[156:159], v[60:63]
    ds_read_b64_tr_b16 v[106:107], v10 offset:20992
    s_waitcnt lgkmcnt(6)
    v_mfma_f32_16x16x32_bf16 v[64:67], v[92:95], v[144:147], v[64:67]
    ds_read_b64_tr_b16 v[108:109], v11 offset:20480
    s_add_u32 s61, s74, 11
    s_and_b32 s61, s61, 15
    s_lshl_b32 s61, s61, 12
    s_add_u32 s61, s61, s60
    buffer_load_dwordx4 v[144:147], v6, s[24:27], s61 offen offset:0 sc1
    v_mfma_f32_16x16x32_bf16 v[68:71], v[92:95], v[148:151], v[68:71]
    ds_read_b64_tr_b16 v[110:111], v11 offset:20992
    buffer_load_dwordx4 v[148:151], v6, s[24:27], s61 offen offset:256 sc1
    v_mfma_f32_16x16x32_bf16 v[72:75], v[92:95], v[152:155], v[72:75]
    buffer_load_dwordx4 v[152:155], v6, s[24:27], s61 offen offset:512 sc1
    v_mfma_f32_16x16x32_bf16 v[76:79], v[92:95], v[156:159], v[76:79]
    buffer_load_dwordx4 v[156:159], v6, s[24:27], s61 offen offset:768 sc1
    s_waitcnt vmcnt(15) lgkmcnt(6)
    v_mfma_f32_16x16x32_bf16 v[16:19], v[96:99], v[112:115], v[16:19]
    s_waitcnt vmcnt(14)
    v_mfma_f32_16x16x32_bf16 v[20:23], v[96:99], v[116:119], v[20:23]
    s_waitcnt vmcnt(13)
    v_mfma_f32_16x16x32_bf16 v[24:27], v[96:99], v[120:123], v[24:27]
    s_waitcnt vmcnt(12)
    v_mfma_f32_16x16x32_bf16 v[28:31], v[96:99], v[124:127], v[28:31]
    s_waitcnt lgkmcnt(4)
    v_mfma_f32_16x16x32_bf16 v[32:35], v[100:103], v[112:115], v[32:35]
    v_mfma_f32_16x16x32_bf16 v[36:39], v[100:103], v[116:119], v[36:39]
    v_mfma_f32_16x16x32_bf16 v[40:43], v[100:103], v[120:123], v[40:43]
    ds_read_b64_tr_b16 v[80:81], v8 offset:24576
    v_mfma_f32_16x16x32_bf16 v[44:47], v[100:103], v[124:127], v[44:47]
    ds_read_b64_tr_b16 v[82:83], v8 offset:25088
    s_waitcnt lgkmcnt(4)
    v_mfma_f32_16x16x32_bf16 v[48:51], v[104:107], v[112:115], v[48:51]
    ds_read_b64_tr_b16 v[84:85], v9 offset:24576
    v_mfma_f32_16x16x32_bf16 v[52:55], v[104:107], v[116:119], v[52:55]
    ds_read_b64_tr_b16 v[86:87], v9 offset:25088
    v_mfma_f32_16x16x32_bf16 v[56:59], v[104:107], v[120:123], v[56:59]
    ds_read_b64_tr_b16 v[88:89], v10 offset:24576
    v_mfma_f32_16x16x32_bf16 v[60:63], v[104:107], v[124:127], v[60:63]
    ds_read_b64_tr_b16 v[90:91], v10 offset:25088
    s_waitcnt lgkmcnt(6)
    v_mfma_f32_16x16x32_bf16 v[64:67], v[108:111], v[112:115], v[64:67]
    ds_read_b64_tr_b16 v[92:93], v11 offset:24576
    s_add_u32 s61, s74, 12
    s_and_b32 s61, s61, 15
    s_lshl_b32 s61, s61, 12
    s_add_u32 s61, s61, s60
    buffer_load_dwordx4 v[112:115], v6, s[24:27], s61 offen offset:0 sc1
    v_mfma_f32_16x16x32_bf16 v[68:71], v[108:111], v[116:119], v[68:71]
    ds_read_b64_tr_b16 v[94:95], v11 offset:25088
    buffer_load_dwordx4 v[116:119], v6, s[24:27], s61 offen offset:256 sc1
    v_mfma_f32_16x16x32_bf16 v[72:75], v[108:111], v[120:123], v[72:75]
    buffer_load_dwordx4 v[120:123], v6, s[24:27], s61 offen offset:512 sc1
    v_mfma_f32_16x16x32_bf16 v[76:79], v[108:111], v[124:127], v[76:79]
    buffer_load_dwordx4 v[124:127], v6, s[24:27], s61 offen offset:768 sc1
    s_waitcnt vmcnt(11) lgkmcnt(6)
    v_mfma_f32_16x16x32_bf16 v[16:19], v[80:83], v[128:131], v[16:19]
    s_waitcnt vmcnt(10)
    v_mfma_f32_16x16x32_bf16 v[20:23], v[80:83], v[132:135], v[20:23]
    s_waitcnt vmcnt(9)
    v_mfma_f32_16x16x32_bf16 v[24:27], v[80:83], v[136:139], v[24:27]
    s_waitcnt vmcnt(8)
    v_mfma_f32_16x16x32_bf16 v[28:31], v[80:83], v[140:143], v[28:31]
    s_waitcnt lgkmcnt(4)
    v_mfma_f32_16x16x32_bf16 v[32:35], v[84:87], v[128:131], v[32:35]
    v_mfma_f32_16x16x32_bf16 v[36:39], v[84:87], v[132:135], v[36:39]
    v_mfma_f32_16x16x32_bf16 v[40:43], v[84:87], v[136:139], v[40:43]
    ds_read_b64_tr_b16 v[96:97], v8 offset:28672
    v_mfma_f32_16x16x32_bf16 v[44:47], v[84:87], v[140:143], v[44:47]
    ds_read_b64_tr_b16 v[98:99], v8 offset:29184
    s_waitcnt lgkmcnt(4)
    v_mfma_f32_16x16x32_bf16 v[48:51], v[88:91], v[128:131], v[48:51]
    ds_read_b64_tr_b16 v[100:101], v9 offset:28672
    v_mfma_f32_16x16x32_bf16 v[52:55], v[88:91], v[132:135], v[52:55]
    ds_read_b64_tr_b16 v[102:103], v9 offset:29184
    v_mfma_f32_16x16x32_bf16 v[56:59], v[88:91], v[136:139], v[56:59]
    ds_read_b64_tr_b16 v[104:105], v10 offset:28672
    v_mfma_f32_16x16x32_bf16 v[60:63], v[88:91], v[140:143], v[60:63]
    ds_read_b64_tr_b16 v[106:107], v10 offset:29184
    s_waitcnt lgkmcnt(6)
    v_mfma_f32_16x16x32_bf16 v[64:67], v[92:95], v[128:131], v[64:67]
    ds_read_b64_tr_b16 v[108:109], v11 offset:28672
    s_add_u32 s61, s74, 13
    s_and_b32 s61, s61, 15
    s_lshl_b32 s61, s61, 12
    s_add_u32 s61, s61, s60
    buffer_load_dwordx4 v[128:131], v6, s[24:27], s61 offen offset:0 sc1
    v_mfma_f32_16x16x32_bf16 v[68:71], v[92:95], v[132:135], v[68:71]
    ds_read_b64_tr_b16 v[110:111], v11 offset:29184
    buffer_load_dwordx4 v[132:135], v6, s[24:27], s61 offen offset:256 sc1
    v_mfma_f32_16x16x32_bf16 v[72:75], v[92:95], v[136:139], v[72:75]
    buffer_load_dwordx4 v[136:139], v6, s[24:27], s61 offen offset:512 sc1
    v_mfma_f32_16x16x32_bf16 v[76:79], v[92:95], v[140:143], v[76:79]
    buffer_load_dwordx4 v[140:143], v6, s[24:27], s61 offen offset:768 sc1
    s_waitcnt vmcnt(11) lgkmcnt(6)
    v_mfma_f32_16x16x32_bf16 v[16:19], v[96:99], v[144:147], v[16:19]
    s_waitcnt vmcnt(10)
    v_mfma_f32_16x16x32_bf16 v[20:23], v[96:99], v[148:151], v[20:23]
    s_waitcnt vmcnt(9)
    v_mfma_f32_16x16x32_bf16 v[24:27], v[96:99], v[152:155], v[24:27]
    s_waitcnt vmcnt(8)
    v_mfma_f32_16x16x32_bf16 v[28:31], v[96:99], v[156:159], v[28:31]
    s_waitcnt lgkmcnt(4)
    v_mfma_f32_16x16x32_bf16 v[32:35], v[100:103], v[144:147], v[32:35]
    v_mfma_f32_16x16x32_bf16 v[36:39], v[100:103], v[148:151], v[36:39]
    v_mfma_f32_16x16x32_bf16 v[40:43], v[100:103], v[152:155], v[40:43]
    ds_read_b64_tr_b16 v[80:81], v8 offset:0
    v_mfma_f32_16x16x32_bf16 v[44:47], v[100:103], v[156:159], v[44:47]
    ds_read_b64_tr_b16 v[82:83], v8 offset:512
    s_waitcnt lgkmcnt(4)
    v_mfma_f32_16x16x32_bf16 v[48:51], v[104:107], v[144:147], v[48:51]
    ds_read_b64_tr_b16 v[84:85], v9 offset:0
    v_mfma_f32_16x16x32_bf16 v[52:55], v[104:107], v[148:151], v[52:55]
    ds_read_b64_tr_b16 v[86:87], v9 offset:512
    v_mfma_f32_16x16x32_bf16 v[56:59], v[104:107], v[152:155], v[56:59]
    ds_read_b64_tr_b16 v[88:89], v10 offset:0
    v_mfma_f32_16x16x32_bf16 v[60:63], v[104:107], v[156:159], v[60:63]
    ds_read_b64_tr_b16 v[90:91], v10 offset:512
    s_waitcnt lgkmcnt(6)
    v_mfma_f32_16x16x32_bf16 v[64:67], v[108:111], v[144:147], v[64:67]
    ds_read_b64_tr_b16 v[92:93], v11 offset:0
    s_add_u32 s61, s74, 14
    s_and_b32 s61, s61, 15
    s_lshl_b32 s61, s61, 12
    s_add_u32 s61, s61, s60
    buffer_load_dwordx4 v[144:147], v6, s[24:27], s61 offen offset:0 sc1
    v_mfma_f32_16x16x32_bf16 v[68:71], v[108:111], v[148:151], v[68:71]
    ds_read_b64_tr_b16 v[94:95], v11 offset:512
    buffer_load_dwordx4 v[148:151], v6, s[24:27], s61 offen offset:256 sc1
    v_mfma_f32_16x16x32_bf16 v[72:75], v[108:111], v[152:155], v[72:75]
    buffer_load_dwordx4 v[152:155], v6, s[24:27], s61 offen offset:512 sc1
    v_mfma_f32_16x16x32_bf16 v[76:79], v[108:111], v[156:159], v[76:79]
    buffer_load_dwordx4 v[156:159], v6, s[24:27], s61 offen offset:768 sc1
    s_waitcnt vmcnt(11) lgkmcnt(6)
    v_mfma_f32_16x16x32_bf16 v[16:19], v[80:83], v[112:115], v[16:19]
    s_waitcnt vmcnt(10)
    v_mfma_f32_16x16x32_bf16 v[20:23], v[80:83], v[116:119], v[20:23]
    s_waitcnt vmcnt(9)
    v_mfma_f32_16x16x32_bf16 v[24:27], v[80:83], v[120:123], v[24:27]
    s_waitcnt vmcnt(8)
    v_mfma_f32_16x16x32_bf16 v[28:31], v[80:83], v[124:127], v[28:31]
    s_waitcnt lgkmcnt(4)
    v_mfma_f32_16x16x32_bf16 v[32:35], v[84:87], v[112:115], v[32:35]
    v_mfma_f32_16x16x32_bf16 v[36:39], v[84:87], v[116:119], v[36:39]
    v_mfma_f32_16x16x32_bf16 v[40:43], v[84:87], v[120:123], v[40:43]
    ds_read_b64_tr_b16 v[96:97], v8 offset:4096
    v_mfma_f32_16x16x32_bf16 v[44:47], v[84:87], v[124:127], v[44:47]
    ds_read_b64_tr_b16 v[98:99], v8 offset:4608
    s_waitcnt lgkmcnt(4)
    v_mfma_f32_16x16x32_bf16 v[48:51], v[88:91], v[112:115], v[48:51]
    ds_read_b64_tr_b16 v[100:101], v9 offset:4096
    v_mfma_f32_16x16x32_bf16 v[52:55], v[88:91], v[116:119], v[52:55]
    ds_read_b64_tr_b16 v[102:103], v9 offset:4608
    v_mfma_f32_16x16x32_bf16 v[56:59], v[88:91], v[120:123], v[56:59]
    ds_read_b64_tr_b16 v[104:105], v10 offset:4096
    v_mfma_f32_16x16x32_bf16 v[60:63], v[88:91], v[124:127], v[60:63]
    ds_read_b64_tr_b16 v[106:107], v10 offset:4608
    s_waitcnt lgkmcnt(6)
    v_mfma_f32_16x16x32_bf16 v[64:67], v[92:95], v[112:115], v[64:67]
    ds_read_b64_tr_b16 v[108:109], v11 offset:4096
    s_add_u32 s61, s74, 15
    s_and_b32 s61, s61, 15
    s_lshl_b32 s61, s61, 12
    s_add_u32 s61, s61, s60
    buffer_load_dwordx4 v[112:115], v6, s[24:27], s61 offen offset:0 sc1
    v_mfma_f32_16x16x32_bf16 v[68:71], v[92:95], v[116:119], v[68:71]
    ds_read_b64_tr_b16 v[110:111], v11 offset:4608
    buffer_load_dwordx4 v[116:119], v6, s[24:27], s61 offen offset:256 sc1
    v_mfma_f32_16x16x32_bf16 v[72:75], v[92:95], v[120:123], v[72:75]
    buffer_load_dwordx4 v[120:123], v6, s[24:27], s61 offen offset:512 sc1
    v_mfma_f32_16x16x32_bf16 v[76:79], v[92:95], v[124:127], v[76:79]
    buffer_load_dwordx4 v[124:127], v6, s[24:27], s61 offen offset:768 sc1
    s_waitcnt lgkmcnt(0)
    s_waitcnt vmcnt(11)
    v_mfma_f32_16x16x32_bf16 v[16:19], v[96:99], v[128:131], v[16:19]
    s_waitcnt vmcnt(10)
    v_mfma_f32_16x16x32_bf16 v[20:23], v[96:99], v[132:135], v[20:23]
    ds_write_b32 v12, v12
    s_waitcnt vmcnt(9)
    v_mfma_f32_16x16x32_bf16 v[24:27], v[96:99], v[136:139], v[24:27]
    s_waitcnt vmcnt(8)
    v_mfma_f32_16x16x32_bf16 v[28:31], v[96:99], v[140:143], v[28:31]
    v_mfma_f32_16x16x32_bf16 v[32:35], v[100:103], v[128:131], v[32:35]
    v_mfma_f32_16x16x32_bf16 v[36:39], v[100:103], v[132:135], v[36:39]
    v_mfma_f32_16x16x32_bf16 v[40:43], v[100:103], v[136:139], v[40:43]
    ds_read_b64_tr_b16 v[80:81], v8 offset:8192
    v_mfma_f32_16x16x32_bf16 v[44:47], v[100:103], v[140:143], v[44:47]
    ds_read_b64_tr_b16 v[82:83], v8 offset:8704
    v_mfma_f32_16x16x32_bf16 v[48:51], v[104:107], v[128:131], v[48:51]
    ds_read_b64_tr_b16 v[84:85], v9 offset:8192
    v_mfma_f32_16x16x32_bf16 v[52:55], v[104:107], v[132:135], v[52:55]
    ds_read_b64_tr_b16 v[86:87], v9 offset:8704
    v_mfma_f32_16x16x32_bf16 v[56:59], v[104:107], v[136:139], v[56:59]
    ds_read_b64_tr_b16 v[88:89], v10 offset:8192
    v_mfma_f32_16x16x32_bf16 v[60:63], v[104:107], v[140:143], v[60:63]
    ds_read_b64_tr_b16 v[90:91], v10 offset:8704
    v_mfma_f32_16x16x32_bf16 v[64:67], v[108:111], v[128:131], v[64:67]
    ds_read_b64_tr_b16 v[92:93], v11 offset:8192
    v_mfma_f32_16x16x32_bf16 v[68:71], v[108:111], v[132:135], v[68:71]
    ds_read_b64_tr_b16 v[94:95], v11 offset:8704
    v_mfma_f32_16x16x32_bf16 v[72:75], v[108:111], v[136:139], v[72:75]
    v_mfma_f32_16x16x32_bf16 v[76:79], v[108:111], v[140:143], v[76:79]
    s_waitcnt vmcnt(7) lgkmcnt(6)
    v_mfma_f32_16x16x32_bf16 v[16:19], v[80:83], v[144:147], v[16:19]
    s_waitcnt vmcnt(6)
    v_mfma_f32_16x16x32_bf16 v[20:23], v[80:83], v[148:151], v[20:23]
    s_waitcnt vmcnt(5)
    v_mfma_f32_16x16x32_bf16 v[24:27], v[80:83], v[152:155], v[24:27]
    s_waitcnt vmcnt(4)
    v_mfma_f32_16x16x32_bf16 v[28:31], v[80:83], v[156:159], v[28:31]
    s_waitcnt lgkmcnt(4)
    v_mfma_f32_16x16x32_bf16 v[32:35], v[84:87], v[144:147], v[32:35]
    v_mfma_f32_16x16x32_bf16 v[36:39], v[84:87], v[148:151], v[36:39]
    v_mfma_f32_16x16x32_bf16 v[40:43], v[84:87], v[152:155], v[40:43]
    ds_read_b64_tr_b16 v[96:97], v8 offset:12288
    v_mfma_f32_16x16x32_bf16 v[44:47], v[84:87], v[156:159], v[44:47]
    ds_read_b64_tr_b16 v[98:99], v8 offset:12800
    s_waitcnt lgkmcnt(4)
    v_mfma_f32_16x16x32_bf16 v[48:51], v[88:91], v[144:147], v[48:51]
    ds_read_b64_tr_b16 v[100:101], v9 offset:12288
    v_mfma_f32_16x16x32_bf16 v[52:55], v[88:91], v[148:151], v[52:55]
    ds_read_b64_tr_b16 v[102:103], v9 offset:12800
    v_mfma_f32_16x16x32_bf16 v[56:59], v[88:91], v[152:155], v[56:59]
    ds_read_b64_tr_b16 v[104:105], v10 offset:12288
    v_mfma_f32_16x16x32_bf16 v[60:63], v[88:91], v[156:159], v[60:63]
    ds_read_b64_tr_b16 v[106:107], v10 offset:12800
    s_waitcnt lgkmcnt(6)
    v_mfma_f32_16x16x32_bf16 v[64:67], v[92:95], v[144:147], v[64:67]
    ds_read_b64_tr_b16 v[108:109], v11 offset:12288
    v_mfma_f32_16x16x32_bf16 v[68:71], v[92:95], v[148:151], v[68:71]
    ds_read_b64_tr_b16 v[110:111], v11 offset:12800
    v_mfma_f32_16x16x32_bf16 v[72:75], v[92:95], v[152:155], v[72:75]
    v_mfma_f32_16x16x32_bf16 v[76:79], v[92:95], v[156:159], v[76:79]
    s_waitcnt vmcnt(3) lgkmcnt(6)
    v_mfma_f32_16x16x32_bf16 v[16:19], v[96:99], v[112:115], v[16:19]
    s_waitcnt vmcnt(2)
    v_mfma_f32_16x16x32_bf16 v[20:23], v[96:99], v[116:119], v[20:23]
    s_waitcnt vmcnt(1)
    v_mfma_f32_16x16x32_bf16 v[24:27], v[96:99], v[120:123], v[24:27]
    s_waitcnt vmcnt(0)
    v_mfma_f32_16x16x32_bf16 v[28:31], v[96:99], v[124:127], v[28:31]
    s_waitcnt lgkmcnt(4)
    v_mfma_f32_16x16x32_bf16 v[32:35], v[100:103], v[112:115], v[32:35]
    v_mfma_f32_16x16x32_bf16 v[36:39], v[100:103], v[116:119], v[36:39]
    v_mfma_f32_16x16x32_bf16 v[40:43], v[100:103], v[120:123], v[40:43]
    v_mfma_f32_16x16x32_bf16 v[44:47], v[100:103], v[124:127], v[44:47]
    s_waitcnt lgkmcnt(2)
    v_mfma_f32_16x16x32_bf16 v[48:51], v[104:107], v[112:115], v[48:51]
    ds_write_b128 v7, v[16:19] offset:16384
    v_mfma_f32_16x16x32_bf16 v[52:55], v[104:107], v[116:119], v[52:55]
    ds_write_b128 v7, v[20:23] offset:17408
    v_mfma_f32_16x16x32_bf16 v[56:59], v[104:107], v[120:123], v[56:59]
    ds_write_b128 v7, v[24:27] offset:18432
    v_mfma_f32_16x16x32_bf16 v[60:63], v[104:107], v[124:127], v[60:63]
    ds_write_b128 v7, v[28:31] offset:19456
    s_waitcnt lgkmcnt(4)
    v_mfma_f32_16x16x32_bf16 v[64:67], v[108:111], v[112:115], v[64:67]
    ds_write_b128 v7, v[32:35] offset:20480
    v_mfma_f32_16x16x32_bf16 v[68:71], v[108:111], v[116:119], v[68:71]
    ds_write_b128 v7, v[36:39] offset:21504
    v_mfma_f32_16x16x32_bf16 v[72:75], v[108:111], v[120:123], v[72:75]
    ds_write_b128 v7, v[40:43] offset:22528
    v_mfma_f32_16x16x32_bf16 v[76:79], v[108:111], v[124:127], v[76:79]
    ds_write_b128 v7, v[44:47] offset:23552
    ds_write_b128 v7, v[48:51] offset:24576
    ds_write_b128 v7, v[52:55] offset:25600
    ds_write_b128 v7, v[56:59] offset:26624
    ds_write_b128 v7, v[60:63] offset:27648
    ds_write_b128 v7, v[64:67] offset:28672
    ds_write_b128 v7, v[68:71] offset:29696
    ds_write_b128 v7, v[72:75] offset:30720
    ds_write_b128 v7, v[76:79] offset:31744
    s_waitcnt lgkmcnt(0)
    s_branch L_g1red
L_g1help:
    s_load_dwordx4 s[64:67], s[4:5], 0
    s_setprio 0
    s_bitcmp1_b32 s50, 0
    s_nop 0
    s_cbranch_scc1 L_nogate_26
    v_lshlrev_b32 v16, 16, v96
    v_and_b32 v17, 0xffff0000, v96
    v_lshlrev_b32 v18, 16, v97
    v_and_b32 v19, 0xffff0000, v97
    v_lshlrev_b32 v20, 16, v98
    v_and_b32 v21, 0xffff0000, v98
    v_lshlrev_b32 v22, 16, v99
    v_and_b32 v23, 0xffff0000, v99
    v_mul_f32 v64, v32, v16
    v_mul_f32 v72, v40, v16
    v_mul_f32 v80, v48, v16
    v_mul_f32 v88, v56, v16
    v_mul_f32 v65, v33, v17
    v_mul_f32 v73, v41, v17
    v_mul_f32 v81, v49, v17
    v_mul_f32 v89, v57, v17
    v_mul_f32 v66, v34, v18
    v_mul_f32 v74, v42, v18
    v_mul_f32 v82, v50, v18
    v_mul_f32 v90, v58, v18
    v_mul_f32 v67, v35, v19
    v_mul_f32 v75, v43, v19
    v_mul_f32 v83, v51, v19
    v_mul_f32 v91, v59, v19
    v_mul_f32 v68, v36, v20
    v_mul_f32 v76, v44, v20
    v_mul_f32 v84, v52, v20
    v_mul_f32 v92, v60, v20
    v_mul_f32 v69, v37, v21
    v_mul_f32 v77, v45, v21
    v_mul_f32 v85, v53, v21
    v_mul_f32 v93, v61, v21
    v_mul_f32 v70, v38, v22
    v_mul_f32 v78, v46, v22
    v_mul_f32 v86, v54, v22
    v_mul_f32 v94, v62, v22
    v_mul_f32 v71, v39, v23
    v_mul_f32 v79, v47, v23
    v_mul_f32 v87, v55, v23
    v_mul_f32 v95, v63, v23
    v_cvt_pk_bf16_f32 v24, v64, v72
    v_lshlrev_b32 v64, 16, v24
    v_and_b32 v72, 0xffff0000, v24
    v_cvt_pk_bf16_f32 v25, v65, v73
    v_lshlrev_b32 v65, 16, v25
    v_and_b32 v73, 0xffff0000, v25
    v_cvt_pk_bf16_f32 v26, v66, v74
    v_lshlrev_b32 v66, 16, v26
    v_and_b32 v74, 0xffff0000, v26
    v_cvt_pk_bf16_f32 v27, v67, v75
    v_lshlrev_b32 v67, 16, v27
    v_and_b32 v75, 0xffff0000, v27
    v_cvt_pk_bf16_f32 v24, v68, v76
    v_lshlrev_b32 v68, 16, v24
    v_and_b32 v76, 0xffff0000, v24
    v_cvt_pk_bf16_f32 v25, v69, v77
    v_lshlrev_b32 v69, 16, v25
    v_and_b32 v77, 0xffff0000, v25
    v_cvt_pk_bf16_f32 v26, v70, v78
    v_lshlrev_b32 v70, 16, v26
    v_and_b32 v78, 0xffff0000, v26
    v_cvt_pk_bf16_f32 v27, v71, v79
    v_lshlrev_b32 v71, 16, v27
    v_and_b32 v79, 0xffff0000, v27
    v_cvt_pk_bf16_f32 v24, v80, v88
    v_lshlrev_b32 v80, 16, v24
    v_and_b32 v88, 0xffff0000, v24
    v_cvt_pk_bf16_f32 v25, v81, v89
    v_lshlrev_b32 v81, 16, v25
    v_and_b32 v89, 0xffff0000, v25
    v_cvt_pk_bf16_f32 v26, v82, v90
    v_lshlrev_b32 v82, 16, v26
    v_and_b32 v90, 0xffff0000, v26
    v_cvt_pk_bf16_f32 v27, v83, v91
    v_lshlrev_b32 v83, 16, v27
    v_and_b32 v91, 0xffff0000, v27
    v_cvt_pk_bf16_f32 v24, v84, v92
    v_lshlrev_b32 v84, 16, v24
    v_and_b32 v92, 0xffff0000, v24
    v_cvt_pk_bf16_f32 v25, v85, v93
    v_lshlrev_b32 v85, 16, v25
    v_and_b32 v93, 0xffff0000, v25
    v_cvt_pk_bf16_f32 v26, v86, v94
    v_lshlrev_b32 v86, 16, v26
    v_and_b32 v94, 0xffff0000, v26
    v_cvt_pk_bf16_f32 v27, v87, v95
    v_lshlrev_b32 v87, 16, v27
    v_and_b32 v95, 0xffff0000, v27
    v_add_f32 v100, v64, v65
    v_add_f32 v101, v72, v73
    v_add_f32 v102, v80, v81
    v_add_f32 v103, v88, v89
    v_add_f32 v100, v100, v66
    v_add_f32 v101, v101, v74
    v_add_f32 v102, v102, v82
    v_add_f32 v103, v103, v90
    v_add_f32 v100, v100, v67
    v_add_f32 v101, v101, v75
    v_add_f32 v102, v102, v83
    v_add_f32 v103, v103, v91
    v_add_f32 v100, v100, v68
    v_add_f32 v101, v101, v76
    v_add_f32 v102, v102, v84
    v_add_f32 v103, v103, v92
    v_add_f32 v100, v100, v69
    v_add_f32 v101, v101, v77
    v_add_f32 v102, v102, v85
    v_add_f32 v103, v103, v93
    v_add_f32 v100, v100, v70
    v_add_f32 v101, v101, v78
    v_add_f32 v102, v102, v86
    v_add_f32 v103, v103, v94
    v_add_f32 v100, v100, v71
    v_add_f32 v101, v101, v79
    v_add_f32 v102, v102, v87
    v_add_f32 v103, v103, v95
    v_add_f32_dpp v100, v100, v100 quad_perm:[1,0,3,2] row_mask:0xf bank_mask:0xf
    v_add_f32_dpp v101, v101, v101 quad_perm:[1,0,3,2] row_mask:0xf bank_mask:0xf
    v_add_f32_dpp v102, v102, v102 quad_perm:[1,0,3,2] row_mask:0xf bank_mask:0xf
    v_add_f32_dpp v103, v103, v103 quad_perm:[1,0,3,2] row_mask:0xf bank_mask:0xf
    v_add_f32_dpp v100, v100, v100 quad_perm:[2,3,0,1] row_mask:0xf bank_mask:0xf
    v_add_f32_dpp v101, v101, v101 quad_perm:[2,3,0,1] row_mask:0xf bank_mask:0xf
    v_add_f32_dpp v102, v102, v102 quad_perm:[2,3,0,1] row_mask:0xf bank_mask:0xf
    v_add_f32_dpp v103, v103, v103 quad_perm:[2,3,0,1] row_mask:0xf bank_mask:0xf
    v_add_f32_dpp v100, v100, v100 row_half_mirror row_mask:0xf bank_mask:0xf
    v_add_f32_dpp v101, v101, v101 row_half_mirror row_mask:0xf bank_mask:0xf
    v_add_f32_dpp v102, v102, v102 row_half_mirror row_mask:0xf bank_mask:0xf
    v_add_f32_dpp v103, v103, v103 row_half_mirror row_mask:0xf bank_mask:0xf
    v_add_f32_dpp v100, v100, v100 row_mirror row_mask:0xf bank_mask:0xf
    v_add_f32_dpp v101, v101, v101 row_mirror row_mask:0xf bank_mask:0xf
    v_add_f32_dpp v102, v102, v102 row_mirror row_mask:0xf bank_mask:0xf
    v_add_f32_dpp v103, v103, v103 row_mirror row_mask:0xf bank_mask:0xf
    v_add_f32_dpp v100, v100, v100 row_bcast:15 row_mask:0xa bank_mask:0xf
    v_add_f32_dpp v101, v101, v101 row_bcast:15 row_mask:0xa bank_mask:0xf
    v_add_f32_dpp v102, v102, v102 row_bcast:15 row_mask:0xa bank_mask:0xf
    v_add_f32_dpp v103, v103, v103 row_bcast:15 row_mask:0xa bank_mask:0xf
    v_add_f32_dpp v100, v100, v100 row_bcast:31 row_mask:0xc bank_mask:0xf
    v_add_f32_dpp v101, v101, v101 row_bcast:31 row_mask:0xc bank_mask:0xf
    v_add_f32_dpp v102, v102, v102 row_bcast:31 row_mask:0xc bank_mask:0xf
    v_add_f32_dpp v103, v103, v103 row_bcast:31 row_mask:0xc bank_mask:0xf
    v_cvt_pk_bf16_f32 v104, v100, v101
    v_cvt_pk_bf16_f32 v105, v102, v103
    v_lshlrev_b32 v100, 16, v104
    v_and_b32 v101, 0xffff0000, v104
    v_lshlrev_b32 v102, 16, v105
    v_and_b32 v103, 0xffff0000, v105
    v_mul_f32 v100, 0xbfb8aa3b, v100
    v_mul_f32 v101, 0xbfb8aa3b, v101
    v_mul_f32 v102, 0xbfb8aa3b, v102
    v_mul_f32 v103, 0xbfb8aa3b, v103
    v_exp_f32 v100, v100
    v_exp_f32 v101, v101
    v_exp_f32 v102, v102
    v_exp_f32 v103, v103
    v_add_f32 v100, 1.0, v100
    v_add_f32 v101, 1.0, v101
    v_add_f32 v102, 1.0, v102
    v_add_f32 v103, 1.0, v103
    v_rcp_f32 v100, v100
    v_rcp_f32 v101, v101
    v_rcp_f32 v102, v102
    v_rcp_f32 v103, v103
    v_cvt_pk_bf16_f32 v104, v100, v101
    v_cvt_pk_bf16_f32 v105, v102, v103
    v_lshlrev_b32 v100, 16, v104
    v_and_b32 v101, 0xffff0000, v104
    v_lshlrev_b32 v102, 16, v105
    v_and_b32 v103, 0xffff0000, v105
    s_lshl_b32 s73, s53, 6
    s_add_u32 s73, s73, s52
    s_lshl_b32 s73, s73, 6
    s_and_b32 s79, s48, 3
    s_lshl_b32 s79, s79, 4
    s_add_u32 s78, s73, s79
    s_add_u32 s78, s78, 11534336
    s_add_u32 s73, s73, 57344
    v_mov_b32 v104, 0
    s_mov_b32 exec_lo, 0
    s_mov_b32 exec_hi, 0x80000000
    buffer_store_dwordx4 v[100:103], v104, s[24:27], s78 offen sc1
    s_mov_b64 exec, -1
    s_waitcnt vmcnt(0)
    v_mov_b32 v12, 163784
    v_mov_b32 v13, 1
    s_mov_b64 exec, 1
    ds_add_rtn_u32 v13, v12, v13
    s_mov_b64 exec, -1
    s_waitcnt lgkmcnt(0)
    v_readfirstlane_b32 s78, v13
    s_nop 0
    s_cmp_lg_u32 s78, 3
    s_cbranch_scc1 L_arr_27
    s_setprio 3
    v_mov_b32 v13, s51
    v_lshlrev_b32 v12, 17, v2
    v_add_u32 v12, 12582912, v12
    s_mov_b64 exec, 255
    buffer_store_dword v13, v12, s[24:27], s73 offen sc1
    s_mov_b64 exec, -1
    s_setprio 0
    s_nop 0
L_arr_27:
    s_nop 1
L_nogate_26:
    s_bfe_u32 s70, s48, 0x10001
    s_and_b32 s71, s48, 1
    v_and_b32 v4, 15, v2
    v_lshrrev_b32 v5, 4, v2
    s_lshl_b32 s62, s56, 6
    v_add_u32 v7, s62, v4
    v_cvt_f32_u32 v8, v7
    v_mul_f32 v8, 0x3b000000, v8
    v_add_f32 v9, 0x3d000000, v8
    v_add_f32 v10, 0x3d000000, v9
    v_add_f32 v11, 0x3d000000, v10
    s_lshl_b32 s62, s70, 7
    v_lshlrev_b32 v12, 2, v5
    v_add_u32 v12, s62, v12
    v_cvt_f32_u32 v12, v12
    v_mul_f32 v240, v8, v12
    v_mul_f32 v244, 0x41500000, v8
    v_mul_f32 v241, v9, v12
    v_mul_f32 v245, 0x41500000, v9
    v_mul_f32 v242, v10, v12
    v_mul_f32 v246, 0x41500000, v10
    v_mul_f32 v243, v11, v12
    v_mul_f32 v247, 0x41500000, v11
    v_cos_f32 v248, v240
    v_sin_f32 v249, v240
    v_add_f32 v240, v240, v8
    v_cos_f32 v250, v241
    v_sin_f32 v251, v241
    v_add_f32 v241, v241, v9
    v_cos_f32 v252, v242
    v_sin_f32 v253, v242
    v_add_f32 v242, v242, v10
    v_cos_f32 v254, v243
    v_sin_f32 v255, v243
    v_add_f32 v243, v243, v11
    v_cvt_pk_bf16_f32 v112, v248, -v249
    v_cvt_pk_bf16_f32 v116, v250, -v251
    v_cvt_pk_bf16_f32 v120, v252, -v253
    v_cvt_pk_bf16_f32 v124, v254, -v255
    v_cos_f32 v248, v240
    v_sin_f32 v249, v240
    v_add_f32 v240, v240, v8
    v_cos_f32 v250, v241
    v_sin_f32 v251, v241
    v_add_f32 v241, v241, v9
    v_cos_f32 v252, v242
    v_sin_f32 v253, v242
    v_add_f32 v242, v242, v10
    v_cos_f32 v254, v243
    v_sin_f32 v255, v243
    v_add_f32 v243, v243, v11
    v_cvt_pk_bf16_f32 v113, v248, -v249
    v_cvt_pk_bf16_f32 v117, v250, -v251
    v_cvt_pk_bf16_f32 v121, v252, -v253
    v_cvt_pk_bf16_f32 v125, v254, -v255
    v_cos_f32 v248, v240
    v_sin_f32 v249, v240
    v_add_f32 v240, v240, v8
    v_cos_f32 v250, v241
    v_sin_f32 v251, v241
    v_add_f32 v241, v241, v9
    v_cos_f32 v252, v242
    v_sin_f32 v253, v242
    v_add_f32 v242, v242, v10
    v_cos_f32 v254, v243
    v_sin_f32 v255, v243
    v_add_f32 v243, v243, v11
    v_cvt_pk_bf16_f32 v114, v248, -v249
    v_cvt_pk_bf16_f32 v118, v250, -v251
    v_cvt_pk_bf16_f32 v122, v252, -v253
    v_cvt_pk_bf16_f32 v126, v254, -v255
    v_cos_f32 v248, v240
    v_sin_f32 v249, v240
    v_add_f32 v240, v240, v244
    v_cos_f32 v250, v241
    v_sin_f32 v251, v241
    v_add_f32 v241, v241, v245
    v_cos_f32 v252, v242
    v_sin_f32 v253, v242
    v_add_f32 v242, v242, v246
    v_cos_f32 v254, v243
    v_sin_f32 v255, v243
    v_add_f32 v243, v243, v247
    v_cvt_pk_bf16_f32 v115, v248, -v249
    v_cvt_pk_bf16_f32 v119, v250, -v251
    v_cvt_pk_bf16_f32 v123, v252, -v253
    v_cvt_pk_bf16_f32 v127, v254, -v255
    v_and_b32 v13, 1, v2
    v_lshlrev_b32 v13, 31, v13
    v_or_b32 v13, 0x3f003f00, v13
    s_cmp_eq_u32 s70, 0
    s_cselect_b32 s76, 0xffff, 0
    s_mov_b32 s77, 0
    v_cndmask_b32 v112, v112, v13, s[76:77]
    v_cndmask_b32 v116, v116, v13, s[76:77]
    v_cndmask_b32 v120, v120, v13, s[76:77]
    v_cndmask_b32 v124, v124, v13, s[76:77]
    v_cos_f32 v248, v240
    v_sin_f32 v249, v240
    v_add_f32 v240, v240, v8
    v_cos_f32 v250, v241
    v_sin_f32 v251, v241
    v_add_f32 v241, v241, v9
    v_cos_f32 v252, v242
    v_sin_f32 v253, v242
    v_add_f32 v242, v242, v10
    v_cos_f32 v254, v243
    v_sin_f32 v255, v243
    v_add_f32 v243, v243, v11
    v_cvt_pk_bf16_f32 v128, v248, -v249
    v_cvt_pk_bf16_f32 v132, v250, -v251
    v_cvt_pk_bf16_f32 v136, v252, -v253
    v_cvt_pk_bf16_f32 v140, v254, -v255
    v_cos_f32 v248, v240
    v_sin_f32 v249, v240
    v_add_f32 v240, v240, v8
    v_cos_f32 v250, v241
    v_sin_f32 v251, v241
    v_add_f32 v241, v241, v9
    v_cos_f32 v252, v242
    v_sin_f32 v253, v242
    v_add_f32 v242, v242, v10
    v_cos_f32 v254, v243
    v_sin_f32 v255, v243
    v_add_f32 v243, v243, v11
    v_cvt_pk_bf16_f32 v129, v248, -v249
    v_cvt_pk_bf16_f32 v133, v250, -v251
    v_cvt_pk_bf16_f32 v137, v252, -v253
    v_cvt_pk_bf16_f32 v141, v254, -v255
    v_cos_f32 v248, v240
    v_sin_f32 v249, v240
    v_add_f32 v240, v240, v8
    v_cos_f32 v250, v241
    v_sin_f32 v251, v241
    v_add_f32 v241, v241, v9
    v_cos_f32 v252, v242
    v_sin_f32 v253, v242
    v_add_f32 v242, v242, v10
    v_cos_f32 v254, v243
    v_sin_f32 v255, v243
    v_add_f32 v243, v243, v11
    v_cvt_pk_bf16_f32 v130, v248, -v249
    v_cvt_pk_bf16_f32 v134, v250, -v251
    v_cvt_pk_bf16_f32 v138, v252, -v253
    v_cvt_pk_bf16_f32 v142, v254, -v255
    v_cos_f32 v248, v240
    v_sin_f32 v249, v240
    v_add_f32 v240, v240, v244
    v_cos_f32 v250, v241
    v_sin_f32 v251, v241
    v_add_f32 v241, v241, v245
    v_cos_f32 v252, v242
    v_sin_f32 v253, v242
    v_add_f32 v242, v242, v246
    v_cos_f32 v254, v243
    v_sin_f32 v255, v243
    v_add_f32 v243, v243, v247
    v_cvt_pk_bf16_f32 v131, v248, -v249
    v_cvt_pk_bf16_f32 v135, v250, -v251
    v_cvt_pk_bf16_f32 v139, v252, -v253
    v_cvt_pk_bf16_f32 v143, v254, -v255
    v_cos_f32 v248, v240
    v_sin_f32 v249, v240
    v_add_f32 v240, v240, v8
    v_cos_f32 v250, v241
    v_sin_f32 v251, v241
    v_add_f32 v241, v241, v9
    v_cos_f32 v252, v242
    v_sin_f32 v253, v242
    v_add_f32 v242, v242, v10
    v_cos_f32 v254, v243
    v_sin_f32 v255, v243
    v_add_f32 v243, v243, v11
    v_cvt_pk_bf16_f32 v144, v248, -v249
    v_cvt_pk_bf16_f32 v148, v250, -v251
    v_cvt_pk_bf16_f32 v152, v252, -v253
    v_cvt_pk_bf16_f32 v156, v254, -v255
    v_cos_f32 v248, v240
    v_sin_f32 v249, v240
    v_add_f32 v240, v240, v8
    v_cos_f32 v250, v241
    v_sin_f32 v251, v241
    v_add_f32 v241, v241, v9
    v_cos_f32 v252, v242
    v_sin_f32 v253, v242
    v_add_f32 v242, v242, v10
    v_cos_f32 v254, v243
    v_sin_f32 v255, v243
    v_add_f32 v243, v243, v11
    v_cvt_pk_bf16_f32 v145, v248, -v249
    v_cvt_pk_bf16_f32 v149, v250, -v251
    v_cvt_pk_bf16_f32 v153, v252, -v253
    v_cvt_pk_bf16_f32 v157, v254, -v255
    v_cos_f32 v248, v240
    v_sin_f32 v249, v240
    v_add_f32 v240, v240, v8
    v_cos_f32 v250, v241
    v_sin_f32 v251, v241
    v_add_f32 v241, v241, v9
    v_cos_f32 v252, v242
    v_sin_f32 v253, v242
    v_add_f32 v242, v242, v10
    v_cos_f32 v254, v243
    v_sin_f32 v255, v243
    v_add_f32 v243, v243, v11
    v_cvt_pk_bf16_f32 v146, v248, -v249
    v_cvt_pk_bf16_f32 v150, v250, -v251
    v_cvt_pk_bf16_f32 v154, v252, -v253
    v_cvt_pk_bf16_f32 v158, v254, -v255
    v_cos_f32 v248, v240
    v_sin_f32 v249, v240
    v_add_f32 v240, v240, v244
    v_cos_f32 v250, v241
    v_sin_f32 v251, v241
    v_add_f32 v241, v241, v245
    v_cos_f32 v252, v242
    v_sin_f32 v253, v242
    v_add_f32 v242, v242, v246
    v_cos_f32 v254, v243
    v_sin_f32 v255, v243
    v_add_f32 v243, v243, v247
    v_cvt_pk_bf16_f32 v147, v248, -v249
    v_cvt_pk_bf16_f32 v151, v250, -v251
    v_cvt_pk_bf16_f32 v155, v252, -v253
    v_cvt_pk_bf16_f32 v159, v254, -v255
    v_cos_f32 v248, v240
    v_sin_f32 v249, v240
    v_add_f32 v240, v240, v8
    v_cos_f32 v250, v241
    v_sin_f32 v251, v241
    v_add_f32 v241, v241, v9
    v_cos_f32 v252, v242
    v_sin_f32 v253, v242
    v_add_f32 v242, v242, v10
    v_cos_f32 v254, v243
    v_sin_f32 v255, v243
    v_add_f32 v243, v243, v11
    v_cvt_pk_bf16_f32 v160, v248, -v249
    v_cvt_pk_bf16_f32 v164, v250, -v251
    v_cvt_pk_bf16_f32 v168, v252, -v253
    v_cvt_pk_bf16_f32 v172, v254, -v255
    v_cos_f32 v248, v240
    v_sin_f32 v249, v240
    v_add_f32 v240, v240, v8
    v_cos_f32 v250, v241
    v_sin_f32 v251, v241
    v_add_f32 v241, v241, v9
    v_cos_f32 v252, v242
    v_sin_f32 v253, v242
    v_add_f32 v242, v242, v10
    v_cos_f32 v254, v243
    v_sin_f32 v255, v243
    v_add_f32 v243, v243, v11
    v_cvt_pk_bf16_f32 v161, v248, -v249
    v_cvt_pk_bf16_f32 v165, v250, -v251
    v_cvt_pk_bf16_f32 v169, v252, -v253
    v_cvt_pk_bf16_f32 v173, v254, -v255
    v_cos_f32 v248, v240
    v_sin_f32 v249, v240
    v_add_f32 v240, v240, v8
    v_cos_f32 v250, v241
    v_sin_f32 v251, v241
    v_add_f32 v241, v241, v9
    v_cos_f32 v252, v242
    v_sin_f32 v253, v242
    v_add_f32 v242, v242, v10
    v_cos_f32 v254, v243
    v_sin_f32 v255, v243
    v_add_f32 v243, v243, v11
    v_cvt_pk_bf16_f32 v162, v248, -v249
    v_cvt_pk_bf16_f32 v166, v250, -v251
    v_cvt_pk_bf16_f32 v170, v252, -v253
    v_cvt_pk_bf16_f32 v174, v254, -v255
    v_cos_f32 v248, v240
    v_sin_f32 v249, v240
    v_add_f32 v240, v240, v244
    v_cos_f32 v250, v241
    v_sin_f32 v251, v241
    v_add_f32 v241, v241, v245
    v_cos_f32 v252, v242
    v_sin_f32 v253, v242
    v_add_f32 v242, v242, v246
    v_cos_f32 v254, v243
    v_sin_f32 v255, v243
    v_add_f32 v243, v243, v247
    v_cvt_pk_bf16_f32 v163, v248, -v249
    v_cvt_pk_bf16_f32 v167, v250, -v251
    v_cvt_pk_bf16_f32 v171, v252, -v253
    v_cvt_pk_bf16_f32 v175, v254, -v255
    v_cos_f32 v248, v240
    v_sin_f32 v249, v240
    v_add_f32 v240, v240, v8
    v_cos_f32 v250, v241
    v_sin_f32 v251, v241
    v_add_f32 v241, v241, v9
    v_cos_f32 v252, v242
    v_sin_f32 v253, v242
    v_add_f32 v242, v242, v10
    v_cos_f32 v254, v243
    v_sin_f32 v255, v243
    v_add_f32 v243, v243, v11
    v_cvt_pk_bf16_f32 v176, v248, -v249
    v_cvt_pk_bf16_f32 v180, v250, -v251
    v_cvt_pk_bf16_f32 v184, v252, -v253
    v_cvt_pk_bf16_f32 v188, v254, -v255
    v_cos_f32 v248, v240
    v_sin_f32 v249, v240
    v_add_f32 v240, v240, v8
    v_cos_f32 v250, v241
    v_sin_f32 v251, v241
    v_add_f32 v241, v241, v9
    v_cos_f32 v252, v242
    v_sin_f32 v253, v242
    v_add_f32 v242, v242, v10
    v_cos_f32 v254, v243
    v_sin_f32 v255, v243
    v_add_f32 v243, v243, v11
    v_cvt_pk_bf16_f32 v177, v248, -v249
    v_cvt_pk_bf16_f32 v181, v250, -v251
    v_cvt_pk_bf16_f32 v185, v252, -v253
    v_cvt_pk_bf16_f32 v189, v254, -v255
    v_cos_f32 v248, v240
    v_sin_f32 v249, v240
    v_add_f32 v240, v240, v8
    v_cos_f32 v250, v241
    v_sin_f32 v251, v241
    v_add_f32 v241, v241, v9
    v_cos_f32 v252, v242
    v_sin_f32 v253, v242
    v_add_f32 v242, v242, v10
    v_cos_f32 v254, v243
    v_sin_f32 v255, v243
    v_add_f32 v243, v243, v11
    v_cvt_pk_bf16_f32 v178, v248, -v249
    v_cvt_pk_bf16_f32 v182, v250, -v251
    v_cvt_pk_bf16_f32 v186, v252, -v253
    v_cvt_pk_bf16_f32 v190, v254, -v255
    v_cos_f32 v248, v240
    v_sin_f32 v249, v240
    v_add_f32 v240, v240, v244
    v_cos_f32 v250, v241
    v_sin_f32 v251, v241
    v_add_f32 v241, v241, v245
    v_cos_f32 v252, v242
    v_sin_f32 v253, v242
    v_add_f32 v242, v242, v246
    v_cos_f32 v254, v243
    v_sin_f32 v255, v243
    v_add_f32 v243, v243, v247
    v_cvt_pk_bf16_f32 v179, v248, -v249
    v_cvt_pk_bf16_f32 v183, v250, -v251
    v_cvt_pk_bf16_f32 v187, v252, -v253
    v_cvt_pk_bf16_f32 v191, v254, -v255
    v_cos_f32 v248, v240
    v_sin_f32 v249, v240
    v_add_f32 v240, v240, v8
    v_cos_f32 v250, v241
    v_sin_f32 v251, v241
    v_add_f32 v241, v241, v9
    v_cos_f32 v252, v242
    v_sin_f32 v253, v242
    v_add_f32 v242, v242, v10
    v_cos_f32 v254, v243
    v_sin_f32 v255, v243
    v_add_f32 v243, v243, v11
    v_cvt_pk_bf16_f32 v192, v248, -v249
    v_cvt_pk_bf16_f32 v196, v250, -v251
    v_cvt_pk_bf16_f32 v200, v252, -v253
    v_cvt_pk_bf16_f32 v204, v254, -v255
    v_cos_f32 v248, v240
    v_sin_f32 v249, v240
    v_add_f32 v240, v240, v8
    v_cos_f32 v250, v241
    v_sin_f32 v251, v241
    v_add_f32 v241, v241, v9
    v_cos_f32 v252, v242
    v_sin_f32 v253, v242
    v_add_f32 v242, v242, v10
    v_cos_f32 v254, v243
    v_sin_f32 v255, v243
    v_add_f32 v243, v243, v11
    v_cvt_pk_bf16_f32 v193, v248, -v249
    v_cvt_pk_bf16_f32 v197, v250, -v251
    v_cvt_pk_bf16_f32 v201, v252, -v253
    v_cvt_pk_bf16_f32 v205, v254, -v255
    v_cos_f32 v248, v240
    v_sin_f32 v249, v240
    v_add_f32 v240, v240, v8
    v_cos_f32 v250, v241
    v_sin_f32 v251, v241
    v_add_f32 v241, v241, v9
    v_cos_f32 v252, v242
    v_sin_f32 v253, v242
    v_add_f32 v242, v242, v10
    v_cos_f32 v254, v243
    v_sin_f32 v255, v243
    v_add_f32 v243, v243, v11
    v_cvt_pk_bf16_f32 v194, v248, -v249
    v_cvt_pk_bf16_f32 v198, v250, -v251
    v_cvt_pk_bf16_f32 v202, v252, -v253
    v_cvt_pk_bf16_f32 v206, v254, -v255
    v_cos_f32 v248, v240
    v_sin_f32 v249, v240
    v_add_f32 v240, v240, v244
    v_cos_f32 v250, v241
    v_sin_f32 v251, v241
    v_add_f32 v241, v241, v245
    v_cos_f32 v252, v242
    v_sin_f32 v253, v242
    v_add_f32 v242, v242, v246
    v_cos_f32 v254, v243
    v_sin_f32 v255, v243
    v_add_f32 v243, v243, v247
    v_cvt_pk_bf16_f32 v195, v248, -v249
    v_cvt_pk_bf16_f32 v199, v250, -v251
    v_cvt_pk_bf16_f32 v203, v252, -v253
    v_cvt_pk_bf16_f32 v207, v254, -v255
    v_cos_f32 v248, v240
    v_sin_f32 v249, v240
    v_add_f32 v240, v240, v8
    v_cos_f32 v250, v241
    v_sin_f32 v251, v241
    v_add_f32 v241, v241, v9
    v_cos_f32 v252, v242
    v_sin_f32 v253, v242
    v_add_f32 v242, v242, v10
    v_cos_f32 v254, v243
    v_sin_f32 v255, v243
    v_add_f32 v243, v243, v11
    v_cvt_pk_bf16_f32 v208, v248, -v249
    v_cvt_pk_bf16_f32 v212, v250, -v251
    v_cvt_pk_bf16_f32 v216, v252, -v253
    v_cvt_pk_bf16_f32 v220, v254, -v255
    v_cos_f32 v248, v240
    v_sin_f32 v249, v240
    v_add_f32 v240, v240, v8
    v_cos_f32 v250, v241
    v_sin_f32 v251, v241
    v_add_f32 v241, v241, v9
    v_cos_f32 v252, v242
    v_sin_f32 v253, v242
    v_add_f32 v242, v242, v10
    v_cos_f32 v254, v243
    v_sin_f32 v255, v243
    v_add_f32 v243, v243, v11
    v_cvt_pk_bf16_f32 v209, v248, -v249
    v_cvt_pk_bf16_f32 v213, v250, -v251
    v_cvt_pk_bf16_f32 v217, v252, -v253
    v_cvt_pk_bf16_f32 v221, v254, -v255
    v_cos_f32 v248, v240
    v_sin_f32 v249, v240
    v_add_f32 v240, v240, v8
    v_cos_f32 v250, v241
    v_sin_f32 v251, v241
    v_add_f32 v241, v241, v9
    v_cos_f32 v252, v242
    v_sin_f32 v253, v242
    v_add_f32 v242, v242, v10
    v_cos_f32 v254, v243
    v_sin_f32 v255, v243
    v_add_f32 v243, v243, v11
    v_cvt_pk_bf16_f32 v210, v248, -v249
    v_cvt_pk_bf16_f32 v214, v250, -v251
    v_cvt_pk_bf16_f32 v218, v252, -v253
    v_cvt_pk_bf16_f32 v222, v254, -v255
    v_cos_f32 v248, v240
    v_sin_f32 v249, v240
    v_add_f32 v240, v240, v244
    v_cos_f32 v250, v241
    v_sin_f32 v251, v241
    v_add_f32 v241, v241, v245
    v_cos_f32 v252, v242
    v_sin_f32 v253, v242
    v_add_f32 v242, v242, v246
    v_cos_f32 v254, v243
    v_sin_f32 v255, v243
    v_add_f32 v243, v243, v247
    v_cvt_pk_bf16_f32 v211, v248, -v249
    v_cvt_pk_bf16_f32 v215, v250, -v251
    v_cvt_pk_bf16_f32 v219, v252, -v253
    v_cvt_pk_bf16_f32 v223, v254, -v255
    v_cos_f32 v248, v240
    v_sin_f32 v249, v240
    v_add_f32 v240, v240, v8
    v_cos_f32 v250, v241
    v_sin_f32 v251, v241
    v_add_f32 v241, v241, v9
    v_cos_f32 v252, v242
    v_sin_f32 v253, v242
    v_add_f32 v242, v242, v10
    v_cos_f32 v254, v243
    v_sin_f32 v255, v243
    v_add_f32 v243, v243, v11
    v_cvt_pk_bf16_f32 v224, v248, -v249
    v_cvt_pk_bf16_f32 v228, v250, -v251
    v_cvt_pk_bf16_f32 v232, v252, -v253
    v_cvt_pk_bf16_f32 v236, v254, -v255
    v_cos_f32 v248, v240
    v_sin_f32 v249, v240
    v_add_f32 v240, v240, v8
    v_cos_f32 v250, v241
    v_sin_f32 v251, v241
    v_add_f32 v241, v241, v9
    v_cos_f32 v252, v242
    v_sin_f32 v253, v242
    v_add_f32 v242, v242, v10
    v_cos_f32 v254, v243
    v_sin_f32 v255, v243
    v_add_f32 v243, v243, v11
    v_cvt_pk_bf16_f32 v225, v248, -v249
    v_cvt_pk_bf16_f32 v229, v250, -v251
    v_cvt_pk_bf16_f32 v233, v252, -v253
    v_cvt_pk_bf16_f32 v237, v254, -v255
    v_cos_f32 v248, v240
    v_sin_f32 v249, v240
    v_add_f32 v240, v240, v8
    v_cos_f32 v250, v241
    v_sin_f32 v251, v241
    v_add_f32 v241, v241, v9
    v_cos_f32 v252, v242
    v_sin_f32 v253, v242
    v_add_f32 v242, v242, v10
    v_cos_f32 v254, v243
    v_sin_f32 v255, v243
    v_add_f32 v243, v243, v11
    v_cvt_pk_bf16_f32 v226, v248, -v249
    v_cvt_pk_bf16_f32 v230, v250, -v251
    v_cvt_pk_bf16_f32 v234, v252, -v253
    v_cvt_pk_bf16_f32 v238, v254, -v255
    v_cos_f32 v248, v240
    v_sin_f32 v249, v240
    v_cos_f32 v250, v241
    v_sin_f32 v251, v241
    v_cos_f32 v252, v242
    v_sin_f32 v253, v242
    v_cos_f32 v254, v243
    v_sin_f32 v255, v243
    v_cvt_pk_bf16_f32 v227, v248, -v249
    v_cvt_pk_bf16_f32 v231, v250, -v251
    v_cvt_pk_bf16_f32 v235, v252, -v253
    v_cvt_pk_bf16_f32 v239, v254, -v255
    s_lshl_b32 s76, s48, 2
    s_add_u32 s76, s76, 163776
    v_mov_b32 v12, s76
    s_mov_b32 s79, 200000
    s_waitcnt lgkmcnt(0)
    s_nop 2
L_wc_28:
    ds_read_b32 v13, v12
    s_waitcnt lgkmcnt(0)
    v_readfirstlane_b32 s78, v13
    s_nop 0
    s_cmp_ge_u32 s78, 1
    s_cbranch_scc1 L_wcd_29
    s_sub_u32 s79, s79, 1
    s_cbranch_scc1 L_wcd_29
    s_sleep 2
    s_branch L_wc_28
L_wcd_29:
    v_lshrrev_b32 v12, 2, v2
    v_lshlrev_b32 v12, 12, v12
    v_and_b32 v13, 3, v2
    v_lshl_add_u32 v12, v13, 7, v12
    s_lshl_b32 s70, s50, 2
    s_and_b32 s71, s48, 3
    s_add_u32 s70, s70, s71
    s_mul_i32 s70, s70, 57344
    s_lshl_b32 s71, s49, 9
    s_add_u32 s70, s70, s71
    s_mov_b32 exec_hi, 0x00ffffff
    buffer_load_dword v250, v12, s[36:39], s70 offen
    s_mov_b32 exec_hi, -1
    s_nop 0
L_g1red:
    s_waitcnt lgkmcnt(0)
    s_barrier
    s_lshr_b32 s68, s48, 1
    s_lshl_b32 s68, s68, 12
    s_and_b32 s69, s48, 1
    s_lshl_b32 s69, s69, 9
    s_add_u32 s68, s68, s69
    v_lshrrev_b32 v12, 4, v2
    v_lshlrev_b32 v12, 10, v12
    v_and_b32 v13, 15, v2
    v_lshl_add_u32 v12, v13, 4, v12
    v_add_u32 v12, s68, v12
    v_add_u32 v13, 65536, v12
    ds_read_b128 v[16:19], v12 offset:16384
    ds_read_b128 v[20:23], v12 offset:16640
    ds_read_b128 v[24:27], v12 offset:49152
    ds_read_b128 v[28:31], v12 offset:49408
    ds_read_b128 v[32:35], v13 offset:16384
    ds_read_b128 v[36:39], v13 offset:16640
    ds_read_b128 v[40:43], v13 offset:49152
    ds_read_b128 v[44:47], v13 offset:49408
    s_lshl_b32 s68, s64, 16
    s_and_b32 s69, s64, 0xffff0000
    s_lshl_b32 s70, s65, 16
    s_and_b32 s71, s65, 0xffff0000
    s_lshl_b32 s72, s66, 16
    s_and_b32 s73, s66, 0xffff0000
    s_lshl_b32 s74, s67, 16
    s_and_b32 s75, s67, 0xffff0000
    s_waitcnt lgkmcnt(5)
    v_pk_add_f32 v[16:17], v[16:17], v[24:25]
    v_pk_add_f32 v[18:19], v[18:19], v[26:27]
    s_waitcnt lgkmcnt(4)
    v_pk_add_f32 v[20:21], v[20:21], v[28:29]
    v_pk_add_f32 v[22:23], v[22:23], v[30:31]
    s_waitcnt lgkmcnt(1)
    v_pk_add_f32 v[32:33], v[32:33], v[40:41]
    v_pk_add_f32 v[34:35], v[34:35], v[42:43]
    s_waitcnt lgkmcnt(0)
    v_pk_add_f32 v[36:37], v[36:37], v[44:45]
    v_pk_add_f32 v[38:39], v[38:39], v[46:47]
    v_pk_add_f32 v[16:17], v[16:17], v[32:33]
    v_pk_add_f32 v[18:19], v[18:19], v[34:35]
    v_pk_add_f32 v[20:21], v[20:21], v[36:37]
    v_pk_add_f32 v[22:23], v[22:23], v[38:39]
    v_cvt_pk_bf16_f32 v24, v16, v17
    v_cvt_pk_bf16_f32 v25, v18, v19
    v_cvt_pk_bf16_f32 v26, v20, v21
    v_cvt_pk_bf16_f32 v27, v22, v23
    v_lshlrev_b32 v16, 16, v24
    v_and_b32 v17, 0xffff0000, v24
    v_lshlrev_b32 v18, 16, v25
    v_and_b32 v19, 0xffff0000, v25
    v_lshlrev_b32 v20, 16, v26
    v_and_b32 v21, 0xffff0000, v26
    v_lshlrev_b32 v22, 16, v27
    v_and_b32 v23, 0xffff0000, v27
    v_pk_add_f32 v[16:17], v[16:17], s[68:69]
    v_pk_add_f32 v[18:19], v[18:19], s[70:71]
    v_pk_add_f32 v[20:21], v[20:21], s[72:73]
    v_pk_add_f32 v[22:23], v[22:23], s[74:75]
    v_mov_b32 v40, 0xc0135761
    v_mov_b32 v41, 0xc0135761
    v_mov_b32 v42, 0xbdd2d3e8
    v_mov_b32 v43, 0xbdd2d3e8
    v_mov_b32 v44, 0x3f800000
    v_mov_b32 v45, 0x3f800000
    v_cvt_pk_bf16_f32 v24, v16, v17
    v_cvt_pk_bf16_f32 v25, v18, v19
    v_cvt_pk_bf16_f32 v26, v20, v21
    v_cvt_pk_bf16_f32 v27, v22, v23
    v_lshlrev_b32 v16, 16, v24
    v_and_b32 v17, 0xffff0000, v24
    v_lshlrev_b32 v18, 16, v25
    v_and_b32 v19, 0xffff0000, v25
    v_lshlrev_b32 v20, 16, v26
    v_and_b32 v21, 0xffff0000, v26
    v_lshlrev_b32 v22, 16, v27
    v_and_b32 v23, 0xffff0000, v27
    v_pk_mul_f32 v[24:25], v[16:17], v[16:17]
    v_pk_mul_f32 v[26:27], v[18:19], v[18:19]
    v_pk_mul_f32 v[28:29], v[20:21], v[20:21]
    v_pk_mul_f32 v[30:31], v[22:23], v[22:23]
    v_pk_fma_f32 v[24:25], v[24:25], v[42:43], v[40:41]
    v_pk_fma_f32 v[26:27], v[26:27], v[42:43], v[40:41]
    v_pk_fma_f32 v[28:29], v[28:29], v[42:43], v[40:41]
    v_pk_fma_f32 v[30:31], v[30:31], v[42:43], v[40:41]
    v_pk_mul_f32 v[24:25], v[24:25], v[16:17]
    v_pk_mul_f32 v[26:27], v[26:27], v[18:19]
    v_pk_mul_f32 v[28:29], v[28:29], v[20:21]
    v_pk_mul_f32 v[30:31], v[30:31], v[22:23]
    v_exp_f32 v24, v24
    v_exp_f32 v25, v25
    v_exp_f32 v26, v26
    v_exp_f32 v27, v27
    v_exp_f32 v28, v28
    v_exp_f32 v29, v29
    v_exp_f32 v30, v30
    v_exp_f32 v31, v31
    v_pk_add_f32 v[24:25], v[24:25], v[44:45]
    v_pk_add_f32 v[26:27], v[26:27], v[44:45]
    v_pk_add_f32 v[28:29], v[28:29], v[44:45]
    v_pk_add_f32 v[30:31], v[30:31], v[44:45]
    v_rcp_f32 v24, v24
    v_rcp_f32 v25, v25
    v_rcp_f32 v26, v26
    v_rcp_f32 v27, v27
    v_rcp_f32 v28, v28
    v_rcp_f32 v29, v29
    v_rcp_f32 v30, v30
    v_rcp_f32 v31, v31
    v_pk_mul_f32 v[16:17], v[16:17], v[24:25]
    v_pk_mul_f32 v[18:19], v[18:19], v[26:27]
    v_pk_mul_f32 v[20:21], v[20:21], v[28:29]
    v_pk_mul_f32 v[22:23], v[22:23], v[30:31]
    v_cvt_pk_bf16_f32 v24, v16, v17
    v_cvt_pk_bf16_f32 v25, v18, v19
    v_cvt_pk_bf16_f32 v26, v20, v21
    v_cvt_pk_bf16_f32 v27, v22, v23
    s_mul_i32 s68, s54, 229376
    s_lshl_b32 s69, s55, 3
    s_add_u32 s69, s69, s48
    s_lshl_b32 s69, s69, 10
    s_add_u32 s68, s68, s69
    s_add_u32 s68, s68, 7340032
    buffer_store_dwordx4 v[24:27], v3, s[24:27], s68 offen sc1
    s_lshl_b32 s72, s54, 5
    s_add_u32 s72, s72, s55
    s_lshl_b32 s72, s72, 6
    s_add_u32 s72, s72, 16384
    s_barrier
    s_branch L_pub2
L_fft:
    s_setprio 0
L_fft2:
    s_lshl_b32 s62, s49, 2
    s_lshr_b32 s63, s50, 1
    s_add_u32 s62, s62, s63
    s_lshl_b32 s63, s62, 3
    s_add_u32 s63, s63, s48
    v_and_b32 v4, 31, v2
    v_lshrrev_b32 v5, 5, v2
    s_lshl_b32 s66, s48, 13
    v_lshrrev_b32 v6, 4, v2
    v_xor_b32 v6, v6, v2
    v_and_b32 v6, 3, v6
    v_lshlrev_b32 v6, 4, v6
    v_lshrrev_b32 v7, 2, v2
    v_lshl_add_u32 v6, v7, 6, v6
    v_bfe_u32 v7, v2, 2, 2
    v_xor_b32 v8, v7, v5
    v_lshlrev_b32 v8, 4, v8
    v_lshl_add_u32 v8, v4, 6, v8
    v_add_u32 v8, s66, v8
    v_xor_b32 v9, 32, v8
    v_add_u32 v10, 65536, v3
    s_cmp_eq_u32 s63, 0
    s_cselect_b32 s67, 51200, 0
    v_add_u32 v14, s67, v10
    v_lshlrev_b32 v11, 10, v5
    v_lshl_add_u32 v11, v4, 2, v11
    v_add_u32 v11, s66, v11
    s_cmp_lt_u32 s48, 4
    s_cselect_b32 s68, 124928, 0
    v_add_u32 v12, s68, v8
    v_add_u32 v13, s68, v9
    s_cmp_eq_u32 s48, 4
    s_nop 3
    s_cbranch_scc1 L_fpollz
    s_cmp_eq_u32 s48, 5
    s_cbranch_scc1 L_fpollw
    s_cmp_ge_u32 s48, 4
    s_cbranch_scc1 L_fgo
    s_waitcnt vmcnt(0)
    v_mov_b32 v20, 163836
    v_mov_b32 v21, 1
    s_mov_b64 exec, 1
    ds_add_u32 v20, v21
    s_mov_b64 exec, -1
    s_nop 1
    s_branch L_fgo
L_fpollw:
    s_mov_b32 s68, 49152
    s_add_u32 s68, s68, 12582912
    v_min_u32 v20, 63, v2
    v_lshlrev_b32 v20, 6, v20
    v_add_u32 v20, s6, v20
    s_mov_b32 s79, 50000
    s_add_u32 s78, s68, 4096
    s_nop 2
L_poll_30:
    buffer_load_dword v21, v20, s[24:27], s68 offen sc1
    buffer_load_dword v22, v20, s[24:27], s78 offen sc1
    s_sub_u32 s79, s79, 1
    s_waitcnt vmcnt(0)
    v_cmp_ne_u32 vcc, s51, v21
    v_cmp_ne_u32 s[76:77], s51, v22
    s_nop 1
    s_or_b64 vcc, vcc, s[76:77]
    s_cmp_eq_u64 vcc, 0
    s_cbranch_scc1 L_polld_31
    s_cmp_eq_u32 s79, 0
    s_cbranch_scc1 L_polld_31
    s_sleep 2
    s_branch L_poll_30
L_polld_31:
    v_mov_b32 v20, 163776
    s_mov_b32 s79, 200000
    s_nop 3
L_wc_32:
    ds_read_b32 v21, v20
    s_waitcnt lgkmcnt(0)
    v_readfirstlane_b32 s78, v21
    s_nop 0
    s_cmp_ge_u32 s78, 4
    s_cbranch_scc1 L_wcd_33
    s_sub_u32 s79, s79, 1
    s_cbranch_scc1 L_wcd_33
    s_sleep 2
    s_branch L_wc_32
L_wcd_33:
    v_mov_b32 v20, 163828
    v_mov_b32 v21, 1
    s_mov_b64 exec, 1
    ds_add_u32 v20, v21
    s_mov_b64 exec, -1
    s_sub_u32 s69, s63, 5
    s_mov_b32 s70, 124928
    s_lshl_b32 s68, s69, 13
    s_add_u32 s68, s68, 4194304
    s_add_u32 m0, s70, 0
    s_nop 0
    buffer_load_dwordx4 v6, s[24:27], s68 offen sc1 lds
    s_add_u32 s68, s68, 1024
    s_add_u32 m0, s70, 1024
    s_nop 0
    buffer_load_dwordx4 v6, s[24:27], s68 offen sc1 lds
    s_add_u32 s68, s68, 1024
    s_add_u32 m0, s70, 2048
    s_nop 0
    buffer_load_dwordx4 v6, s[24:27], s68 offen sc1 lds
    s_add_u32 s68, s68, 1024
    s_add_u32 m0, s70, 3072
    s_nop 0
    buffer_load_dwordx4 v6, s[24:27], s68 offen sc1 lds
    s_add_u32 s68, s68, 1024
    s_add_u32 m0, s70, 4096
    s_nop 0
    buffer_load_dwordx4 v6, s[24:27], s68 offen sc1 lds
    s_add_u32 s68, s68, 1024
    s_add_u32 m0, s70, 5120
    s_nop 0
    buffer_load_dwordx4 v6, s[24:27], s68 offen sc1 lds
    s_add_u32 s68, s68, 1024
    s_add_u32 m0, s70, 6144
    s_nop 0
    buffer_load_dwordx4 v6, s[24:27], s68 offen sc1 lds
    s_add_u32 s68, s68, 1024
    s_add_u32 m0, s70, 7168
    s_nop 0
    buffer_load_dwordx4 v6, s[24:27], s68 offen sc1 lds
    s_sub_u32 s69, s63, 4
    s_mov_b32 s70, 133120
    s_lshl_b32 s68, s69, 13
    s_add_u32 s68, s68, 4194304
    s_add_u32 m0, s70, 0
    s_nop 0
    buffer_load_dwordx4 v6, s[24:27], s68 offen sc1 lds
    s_add_u32 s68, s68, 1024
    s_add_u32 m0, s70, 1024
    s_nop 0
    buffer_load_dwordx4 v6, s[24:27], s68 offen sc1 lds
    s_add_u32 s68, s68, 1024
    s_add_u32 m0, s70, 2048
    s_nop 0
    buffer_load_dwordx4 v6, s[24:27], s68 offen sc1 lds
    s_add_u32 s68, s68, 1024
    s_add_u32 m0, s70, 3072
    s_nop 0
    buffer_load_dwordx4 v6, s[24:27], s68 offen sc1 lds
    s_add_u32 s68, s68, 1024
    s_add_u32 m0, s70, 4096
    s_nop 0
    buffer_load_dwordx4 v6, s[24:27], s68 offen sc1 lds
    s_add_u32 s68, s68, 1024
    s_add_u32 m0, s70, 5120
    s_nop 0
    buffer_load_dwordx4 v6, s[24:27], s68 offen sc1 lds
    s_add_u32 s68, s68, 1024
    s_add_u32 m0, s70, 6144
    s_nop 0
    buffer_load_dwordx4 v6, s[24:27], s68 offen sc1 lds
    s_add_u32 s68, s68, 1024
    s_add_u32 m0, s70, 7168
    s_nop 0
    buffer_load_dwordx4 v6, s[24:27], s68 offen sc1 lds
    s_sub_u32 s69, s63, 3
    s_mov_b32 s70, 141312
    s_lshl_b32 s68, s69, 13
    s_add_u32 s68, s68, 4194304
    s_add_u32 m0, s70, 0
    s_nop 0
    buffer_load_dwordx4 v6, s[24:27], s68 offen sc1 lds
    s_add_u32 s68, s68, 1024
    s_add_u32 m0, s70, 1024
    s_nop 0
    buffer_load_dwordx4 v6, s[24:27], s68 offen sc1 lds
    s_add_u32 s68, s68, 1024
    s_add_u32 m0, s70, 2048
    s_nop 0
    buffer_load_dwordx4 v6, s[24:27], s68 offen sc1 lds
    s_add_u32 s68, s68, 1024
    s_add_u32 m0, s70, 3072
    s_nop 0
    buffer_load_dwordx4 v6, s[24:27], s68 offen sc1 lds
    s_add_u32 s68, s68, 1024
    s_add_u32 m0, s70, 4096
    s_nop 0
    buffer_load_dwordx4 v6, s[24:27], s68 offen sc1 lds
    s_add_u32 s68, s68, 1024
    s_add_u32 m0, s70, 5120
    s_nop 0
    buffer_load_dwordx4 v6, s[24:27], s68 offen sc1 lds
    s_add_u32 s68, s68, 1024
    s_add_u32 m0, s70, 6144
    s_nop 0
    buffer_load_dwordx4 v6, s[24:27], s68 offen sc1 lds
    s_add_u32 s68, s68, 1024
    s_add_u32 m0, s70, 7168
    s_nop 0
    buffer_load_dwordx4 v6, s[24:27], s68 offen sc1 lds
    s_sub_u32 s69, s63, 2
    s_mov_b32 s70, 149504
    s_lshl_b32 s68, s69, 13
    s_add_u32 s68, s68, 4194304
    s_add_u32 m0, s70, 0
    s_nop 0
    buffer_load_dwordx4 v6, s[24:27], s68 offen sc1 lds
    s_add_u32 s68, s68, 1024
    s_add_u32 m0, s70, 1024
    s_nop 0
    buffer_load_dwordx4 v6, s[24:27], s68 offen sc1 lds
    s_add_u32 s68, s68, 1024
    s_add_u32 m0, s70, 2048
    s_nop 0
    buffer_load_dwordx4 v6, s[24:27], s68 offen sc1 lds
    s_add_u32 s68, s68, 1024
    s_add_u32 m0, s70, 3072
    s_nop 0
    buffer_load_dwordx4 v6, s[24:27], s68 offen sc1 lds
    s_add_u32 s68, s68, 1024
    s_add_u32 m0, s70, 4096
    s_nop 0
    buffer_load_dwordx4 v6, s[24:27], s68 offen sc1 lds
    s_add_u32 s68, s68, 1024
    s_add_u32 m0, s70, 5120
    s_nop 0
    buffer_load_dwordx4 v6, s[24:27], s68 offen sc1 lds
    s_add_u32 s68, s68, 1024
    s_add_u32 m0, s70, 6144
    s_nop 0
    buffer_load_dwordx4 v6, s[24:27], s68 offen sc1 lds
    s_add_u32 s68, s68, 1024
    s_add_u32 m0, s70, 7168
    s_nop 0
    buffer_load_dwordx4 v6, s[24:27], s68 offen sc1 lds
    s_branch L_fgo
L_fpollz:
    s_mov_b32 s68, 8192
    s_add_u32 s68, s68, 12582912
    v_min_u32 v20, 63, v2
    v_lshlrev_b32 v20, 6, v20
    v_add_u32 v20, s6, v20
    s_mov_b32 s79, 50000
    s_add_u32 s78, s68, 4096
    s_nop 2
L_poll_34:
    buffer_load_dword v21, v20, s[24:27], s68 offen sc1
    buffer_load_dword v22, v20, s[24:27], s78 offen sc1
    s_sub_u32 s79, s79, 1
    s_waitcnt vmcnt(0)
    v_cmp_ne_u32 vcc, s51, v21
    v_cmp_ne_u32 s[76:77], s51, v22
    s_nop 1
    s_or_b64 vcc, vcc, s[76:77]
    s_cmp_eq_u64 vcc, 0
    s_cbranch_scc1 L_polld_35
    s_cmp_eq_u32 s79, 0
    s_cbranch_scc1 L_polld_35
    s_sleep 2
    s_branch L_poll_34
L_polld_35:
    v_mov_b32 v20, 163832
    v_mov_b32 v21, 1
    s_mov_b64 exec, 1
    ds_add_u32 v20, v21
    s_mov_b64 exec, -1
    s_nop 1
L_fgo:
    v_mov_b32 v20, 163836
    s_mov_b32 s79, 200000
    s_nop 3
L_wc_36:
    ds_read_b32 v21, v20
    s_waitcnt lgkmcnt(0)
    v_readfirstlane_b32 s78, v21
    s_nop 0
    s_cmp_ge_u32 s78, 4
    s_cbranch_scc1 L_wcd_37
    s_sub_u32 s79, s79, 1
    s_cbranch_scc1 L_wcd_37
    s_sleep 1
    s_branch L_wc_36
L_wcd_37:
    v_mov_b32 v20, 163832
    s_mov_b32 s79, 200000
    s_nop 3
L_wc_38:
    ds_read_b32 v21, v20
    s_waitcnt lgkmcnt(0)
    v_readfirstlane_b32 s78, v21
    s_nop 0
    s_cmp_ge_u32 s78, 1
    s_cbranch_scc1 L_wcd_39
    s_sub_u32 s79, s79, 1
    s_cbranch_scc1 L_wcd_39
    s_sleep 1
    s_branch L_wc_38
L_wcd_39:
    s_lshl_b32 s68, s63, 13
    s_add_u32 s68, s68, 2097152
    s_add_u32 m0, s66, 0
    s_nop 0
    buffer_load_dwordx4 v6, s[24:27], s68 offen sc1 lds
    s_add_u32 s68, s68, 1024
    s_add_u32 m0, s66, 1024
    s_nop 0
    buffer_load_dwordx4 v6, s[24:27], s68 offen sc1 lds
    s_add_u32 s68, s68, 1024
    s_add_u32 m0, s66, 2048
    s_nop 0
    buffer_load_dwordx4 v6, s[24:27], s68 offen sc1 lds
    s_add_u32 s68, s68, 1024
    s_add_u32 m0, s66, 3072
    s_nop 0
    buffer_load_dwordx4 v6, s[24:27], s68 offen sc1 lds
    s_add_u32 s68, s68, 1024
    s_add_u32 m0, s66, 4096
    s_nop 0
    buffer_load_dwordx4 v6, s[24:27], s68 offen sc1 lds
    s_add_u32 s68, s68, 1024
    s_add_u32 m0, s66, 5120
    s_nop 0
    buffer_load_dwordx4 v6, s[24:27], s68 offen sc1 lds
    s_add_u32 s68, s68, 1024
    s_add_u32 m0, s66, 6144
    s_nop 0
    buffer_load_dwordx4 v6, s[24:27], s68 offen sc1 lds
    s_add_u32 s68, s68, 1024
    s_add_u32 m0, s66, 7168
    s_nop 0
    buffer_load_dwordx4 v6, s[24:27], s68 offen sc1 lds
    ds_read_b128 v[208:211], v14 offset:0
    ds_read_b128 v[224:227], v14 offset:4096
    ds_read_b128 v[212:215], v14 offset:1024
    ds_read_b128 v[228:231], v14 offset:5120
    ds_read_b128 v[216:219], v14 offset:2048
    ds_read_b128 v[232:235], v14 offset:6144
    ds_read_b128 v[220:223], v14 offset:3072
    ds_read_b128 v[236:239], v14 offset:7168
    ds_read_b128 v[176:179], v10 offset:26624
    ds_read_b128 v[180:183], v10 offset:27648
    ds_read_b128 v[184:187], v10 offset:28672
    ds_read_b128 v[188:191], v10 offset:29696
    ds_read_b128 v[192:195], v10 offset:34816
    ds_read_b128 v[196:199], v10 offset:35840
    ds_read_b128 v[200:203], v10 offset:36864
    ds_read_b128 v[204:207], v10 offset:37888
    s_waitcnt vmcnt(4)
    ds_read_b128 v[16:19], v8 offset:0
    ds_read_b128 v[32:35], v8 offset:2048
    ds_read_b128 v[20:23], v9 offset:0
    ds_read_b128 v[36:39], v9 offset:2048
    s_waitcnt vmcnt(0)
    ds_read_b128 v[24:27], v8 offset:4096
    ds_read_b128 v[40:43], v8 offset:6144
    ds_read_b128 v[28:31], v9 offset:4096
    ds_read_b128 v[44:47], v9 offset:6144
    s_cmp_eq_u32 s48, 5
    s_waitcnt lgkmcnt(0)
    s_cbranch_scc0 L_fnot5
    v_mov_b32 v240, 163804
    v_mov_b32 v241, 1
    s_mov_b64 exec, 1
    ds_add_u32 v240, v241
    s_mov_b64 exec, -1
    s_nop 1
L_fnot5:
    s_cmp_lt_u32 s48, 4
    s_cbranch_scc1 L_fcomp
    v_mov_b32 v240, 163828
    s_mov_b32 s79, 200000
    s_waitcnt lgkmcnt(0)
    s_nop 2
L_wc_40:
    ds_read_b32 v241, v240
    s_waitcnt lgkmcnt(0)
    v_readfirstlane_b32 s78, v241
    s_nop 0
    s_cmp_ge_u32 s78, 1
    s_cbranch_scc1 L_wcd_41
    s_sub_u32 s79, s79, 1
    s_cbranch_scc1 L_wcd_41
    s_branch L_wc_40
L_wcd_41:
    s_lshl_b32 s68, s63, 13
    s_add_u32 s68, s68, 4194304
    s_add_u32 m0, s66, 0
    s_nop 0
    buffer_load_dwordx4 v6, s[24:27], s68 offen sc1 lds
    s_add_u32 s68, s68, 1024
    s_add_u32 m0, s66, 1024
    s_nop 0
    buffer_load_dwordx4 v6, s[24:27], s68 offen sc1 lds
    s_add_u32 s68, s68, 1024
    s_add_u32 m0, s66, 2048
    s_nop 0
    buffer_load_dwordx4 v6, s[24:27], s68 offen sc1 lds
    s_add_u32 s68, s68, 1024
    s_add_u32 m0, s66, 3072
    s_nop 0
    buffer_load_dwordx4 v6, s[24:27], s68 offen sc1 lds
    s_add_u32 s68, s68, 1024
    s_add_u32 m0, s66, 4096
    s_nop 0
    buffer_load_dwordx4 v6, s[24:27], s68 offen sc1 lds
    s_add_u32 s68, s68, 1024
    s_add_u32 m0, s66, 5120
    s_nop 0
    buffer_load_dwordx4 v6, s[24:27], s68 offen sc1 lds
    s_add_u32 s68, s68, 1024
    s_add_u32 m0, s66, 6144
    s_nop 0
    buffer_load_dwordx4 v6, s[24:27], s68 offen sc1 lds
    s_add_u32 s68, s68, 1024
    s_add_u32 m0, s66, 7168
    s_nop 0
    buffer_load_dwordx4 v6, s[24:27], s68 offen sc1 lds
L_fcomp:
    v_mfma_f32_32x32x16_bf16 v[48:63], v[16:19], v[208:211], 0
    v_mfma_f32_32x32x16_bf16 v[64:79], v[16:19], v[224:227], 0
    v_mfma_f32_32x32x16_bf16 v[80:95], v[32:35], v[208:211], 0
    v_mfma_f32_32x32x16_bf16 v[96:111], v[32:35], v[224:227], 0
    v_mfma_f32_32x32x16_bf16 v[48:63], v[20:23], v[212:215], v[48:63]
    v_mfma_f32_32x32x16_bf16 v[64:79], v[20:23], v[228:231], v[64:79]
    v_mfma_f32_32x32x16_bf16 v[80:95], v[36:39], v[212:215], v[80:95]
    v_mfma_f32_32x32x16_bf16 v[96:111], v[36:39], v[228:231], v[96:111]
    v_mfma_f32_32x32x16_bf16 v[48:63], v[24:27], v[216:219], v[48:63]
    v_mfma_f32_32x32x16_bf16 v[64:79], v[24:27], v[232:235], v[64:79]
    v_mfma_f32_32x32x16_bf16 v[80:95], v[40:43], v[216:219], v[80:95]
    v_mfma_f32_32x32x16_bf16 v[96:111], v[40:43], v[232:235], v[96:111]
    v_mfma_f32_32x32x16_bf16 v[48:63], v[28:31], v[220:223], v[48:63]
    v_mfma_f32_32x32x16_bf16 v[64:79], v[28:31], v[236:239], v[64:79]
    v_mfma_f32_32x32x16_bf16 v[80:95], v[44:47], v[220:223], v[80:95]
    v_mfma_f32_32x32x16_bf16 v[96:111], v[44:47], v[236:239], v[96:111]
    v_mov_b32 v254, 2.0
    v_mov_b32 v255, 2.0
    ds_read_b128 v[208:211], v10 offset:8192
    ds_read_b128 v[212:215], v10 offset:10240
    ds_read_b128 v[216:219], v10 offset:12288
    ds_read_b128 v[220:223], v10 offset:14336
    ds_read_b128 v[224:227], v10 offset:16384
    ds_read_b128 v[228:231], v10 offset:18432
    s_nop 0
    v_pk_mul_f32 v[240:241], v[48:49], v[176:177]
    v_pk_mul_f32 v[242:243], v[64:65], v[176:177]
    v_pk_fma_f32 v[240:241], v[64:65], v[178:179], v[240:241]
    v_pk_fma_f32 v[242:243], v[48:49], v[178:179], v[242:243] neg_lo:[1,0,0] neg_hi:[1,0,0]
    v_pk_fma_f32 v[48:49], v[80:81], v[192:193], v[240:241]
    v_pk_fma_f32 v[64:65], v[96:97], v[192:193], v[242:243]
    v_pk_fma_f32 v[48:49], v[96:97], v[194:195], v[48:49]
    v_pk_fma_f32 v[64:65], v[80:81], v[194:195], v[64:65] neg_lo:[1,0,0] neg_hi:[1,0,0]
    v_pk_fma_f32 v[80:81], v[240:241], v[254:255], v[48:49] neg_lo:[0,0,1] neg_hi:[0,0,1]
    v_pk_fma_f32 v[96:97], v[242:243], v[254:255], v[64:65] neg_lo:[0,0,1] neg_hi:[0,0,1]
    ds_read_b128 v[176:179], v10 offset:30720
    ds_read_b128 v[192:195], v10 offset:38912
    v_cvt_pk_bf16_f32 v16, v48, v49
    v_cvt_pk_bf16_f32 v24, v64, v65
    v_cvt_pk_bf16_f32 v32, v80, v81
    v_cvt_pk_bf16_f32 v40, v96, v97
    v_pk_mul_f32 v[244:245], v[50:51], v[180:181]
    v_pk_mul_f32 v[246:247], v[66:67], v[180:181]
    v_pk_fma_f32 v[244:245], v[66:67], v[182:183], v[244:245]
    v_pk_fma_f32 v[246:247], v[50:51], v[182:183], v[246:247] neg_lo:[1,0,0] neg_hi:[1,0,0]
    v_pk_fma_f32 v[50:51], v[82:83], v[196:197], v[244:245]
    v_pk_fma_f32 v[66:67], v[98:99], v[196:197], v[246:247]
    v_pk_fma_f32 v[50:51], v[98:99], v[198:199], v[50:51]
    v_pk_fma_f32 v[66:67], v[82:83], v[198:199], v[66:67] neg_lo:[1,0,0] neg_hi:[1,0,0]
    v_pk_fma_f32 v[82:83], v[244:245], v[254:255], v[50:51] neg_lo:[0,0,1] neg_hi:[0,0,1]
    v_pk_fma_f32 v[98:99], v[246:247], v[254:255], v[66:67] neg_lo:[0,0,1] neg_hi:[0,0,1]
    ds_read_b128 v[180:183], v10 offset:31744
    ds_read_b128 v[196:199], v10 offset:39936
    v_cvt_pk_bf16_f32 v17, v50, v51
    v_cvt_pk_bf16_f32 v25, v66, v67
    v_cvt_pk_bf16_f32 v33, v82, v83
    v_cvt_pk_bf16_f32 v41, v98, v99
    v_pk_mul_f32 v[240:241], v[52:53], v[184:185]
    v_pk_mul_f32 v[242:243], v[68:69], v[184:185]
    v_pk_fma_f32 v[240:241], v[68:69], v[186:187], v[240:241]
    v_pk_fma_f32 v[242:243], v[52:53], v[186:187], v[242:243] neg_lo:[1,0,0] neg_hi:[1,0,0]
    v_pk_fma_f32 v[52:53], v[84:85], v[200:201], v[240:241]
    v_pk_fma_f32 v[68:69], v[100:101], v[200:201], v[242:243]
    v_pk_fma_f32 v[52:53], v[100:101], v[202:203], v[52:53]
    v_pk_fma_f32 v[68:69], v[84:85], v[202:203], v[68:69] neg_lo:[1,0,0] neg_hi:[1,0,0]
    v_pk_fma_f32 v[84:85], v[240:241], v[254:255], v[52:53] neg_lo:[0,0,1] neg_hi:[0,0,1]
    v_pk_fma_f32 v[100:101], v[242:243], v[254:255], v[68:69] neg_lo:[0,0,1] neg_hi:[0,0,1]
    ds_read_b128 v[184:187], v10 offset:32768
    ds_read_b128 v[200:203], v10 offset:40960
    v_cvt_pk_bf16_f32 v18, v52, v53
    v_cvt_pk_bf16_f32 v26, v68, v69
    v_cvt_pk_bf16_f32 v34, v84, v85
    v_cvt_pk_bf16_f32 v42, v100, v101
    v_pk_mul_f32 v[244:245], v[54:55], v[188:189]
    v_pk_mul_f32 v[246:247], v[70:71], v[188:189]
    v_pk_fma_f32 v[244:245], v[70:71], v[190:191], v[244:245]
    v_pk_fma_f32 v[246:247], v[54:55], v[190:191], v[246:247] neg_lo:[1,0,0] neg_hi:[1,0,0]
    v_pk_fma_f32 v[54:55], v[86:87], v[204:205], v[244:245]
    v_pk_fma_f32 v[70:71], v[102:103], v[204:205], v[246:247]
    v_pk_fma_f32 v[54:55], v[102:103], v[206:207], v[54:55]
    v_pk_fma_f32 v[70:71], v[86:87], v[206:207], v[70:71] neg_lo:[1,0,0] neg_hi:[1,0,0]
    v_pk_fma_f32 v[86:87], v[244:245], v[254:255], v[54:55] neg_lo:[0,0,1] neg_hi:[0,0,1]
    v_pk_fma_f32 v[102:103], v[246:247], v[254:255], v[70:71] neg_lo:[0,0,1] neg_hi:[0,0,1]
    ds_read_b128 v[188:191], v10 offset:33792
    ds_read_b128 v[204:207], v10 offset:41984
    v_cvt_pk_bf16_f32 v19, v54, v55
    v_cvt_pk_bf16_f32 v27, v70, v71
    v_cvt_pk_bf16_f32 v35, v86, v87
    v_cvt_pk_bf16_f32 v43, v102, v103
    s_waitcnt lgkmcnt(13)
    v_mfma_f32_32x32x16_bf16 v[112:127], v[208:211], v[16:19], 0
    s_waitcnt lgkmcnt(7)
    v_pk_mul_f32 v[240:241], v[56:57], v[176:177]
    v_pk_mul_f32 v[242:243], v[72:73], v[176:177]
    v_pk_fma_f32 v[240:241], v[72:73], v[178:179], v[240:241]
    v_pk_fma_f32 v[242:243], v[56:57], v[178:179], v[242:243] neg_lo:[1,0,0] neg_hi:[1,0,0]
    s_waitcnt lgkmcnt(6)
    v_pk_fma_f32 v[56:57], v[88:89], v[192:193], v[240:241]
    v_pk_fma_f32 v[72:73], v[104:105], v[192:193], v[242:243]
    v_pk_fma_f32 v[56:57], v[104:105], v[194:195], v[56:57]
    v_mfma_f32_32x32x16_bf16 v[128:143], v[216:219], v[16:19], 0
    v_pk_fma_f32 v[72:73], v[88:89], v[194:195], v[72:73] neg_lo:[1,0,0] neg_hi:[1,0,0]
    v_pk_fma_f32 v[88:89], v[240:241], v[254:255], v[56:57] neg_lo:[0,0,1] neg_hi:[0,0,1]
    v_pk_fma_f32 v[104:105], v[242:243], v[254:255], v[72:73] neg_lo:[0,0,1] neg_hi:[0,0,1]
    v_cvt_pk_bf16_f32 v20, v56, v57
    v_cvt_pk_bf16_f32 v28, v72, v73
    v_cvt_pk_bf16_f32 v36, v88, v89
    v_cvt_pk_bf16_f32 v44, v104, v105
    v_mfma_f32_32x32x16_bf16 v[112:127], v[212:215], v[24:27], v[112:127]
    s_waitcnt lgkmcnt(5)
    v_pk_mul_f32 v[244:245], v[58:59], v[180:181]
    v_pk_mul_f32 v[246:247], v[74:75], v[180:181]
    v_pk_fma_f32 v[244:245], v[74:75], v[182:183], v[244:245]
    v_pk_fma_f32 v[246:247], v[58:59], v[182:183], v[246:247] neg_lo:[1,0,0] neg_hi:[1,0,0]
    s_waitcnt lgkmcnt(4)
    v_pk_fma_f32 v[58:59], v[90:91], v[196:197], v[244:245]
    v_pk_fma_f32 v[74:75], v[106:107], v[196:197], v[246:247]
    v_pk_fma_f32 v[58:59], v[106:107], v[198:199], v[58:59]
    v_mfma_f32_32x32x16_bf16 v[128:143], v[208:211], v[24:27], v[128:143]
    ds_read_b128 v[208:211], v10 offset:9216
    ds_read_b128 v[212:215], v10 offset:11264
    ds_read_b128 v[216:219], v10 offset:13312
    v_pk_fma_f32 v[74:75], v[90:91], v[198:199], v[74:75] neg_lo:[1,0,0] neg_hi:[1,0,0]
    v_pk_fma_f32 v[90:91], v[244:245], v[254:255], v[58:59] neg_lo:[0,0,1] neg_hi:[0,0,1]
    v_pk_fma_f32 v[106:107], v[246:247], v[254:255], v[74:75] neg_lo:[0,0,1] neg_hi:[0,0,1]
    v_cvt_pk_bf16_f32 v21, v58, v59
    v_cvt_pk_bf16_f32 v29, v74, v75
    v_cvt_pk_bf16_f32 v37, v90, v91
    v_cvt_pk_bf16_f32 v45, v106, v107
    v_mfma_f32_32x32x16_bf16 v[144:159], v[220:223], v[32:35], 0
    s_waitcnt lgkmcnt(6)
    v_pk_mul_f32 v[240:241], v[60:61], v[184:185]
    v_pk_mul_f32 v[242:243], v[76:77], v[184:185]
    v_pk_fma_f32 v[240:241], v[76:77], v[186:187], v[240:241]
    v_pk_fma_f32 v[242:243], v[60:61], v[186:187], v[242:243] neg_lo:[1,0,0] neg_hi:[1,0,0]
    s_waitcnt lgkmcnt(5)
    v_pk_fma_f32 v[60:61], v[92:93], v[200:201], v[240:241]
    v_pk_fma_f32 v[76:77], v[108:109], v[200:201], v[242:243]
    v_pk_fma_f32 v[60:61], v[108:109], v[202:203], v[60:61]
    v_mfma_f32_32x32x16_bf16 v[160:175], v[228:231], v[32:35], 0
    v_pk_fma_f32 v[76:77], v[92:93], v[202:203], v[76:77] neg_lo:[1,0,0] neg_hi:[1,0,0]
    v_pk_fma_f32 v[92:93], v[240:241], v[254:255], v[60:61] neg_lo:[0,0,1] neg_hi:[0,0,1]
    v_pk_fma_f32 v[108:109], v[242:243], v[254:255], v[76:77] neg_lo:[0,0,1] neg_hi:[0,0,1]
    v_cvt_pk_bf16_f32 v22, v60, v61
    v_cvt_pk_bf16_f32 v30, v76, v77
    v_cvt_pk_bf16_f32 v38, v92, v93
    v_cvt_pk_bf16_f32 v46, v108, v109
    v_mfma_f32_32x32x16_bf16 v[144:159], v[224:227], v[40:43], v[144:159]
    s_waitcnt lgkmcnt(4)
    v_pk_mul_f32 v[244:245], v[62:63], v[188:189]
    v_pk_mul_f32 v[246:247], v[78:79], v[188:189]
    v_pk_fma_f32 v[244:245], v[78:79], v[190:191], v[244:245]
    v_pk_fma_f32 v[246:247], v[62:63], v[190:191], v[246:247] neg_lo:[1,0,0] neg_hi:[1,0,0]
    s_waitcnt lgkmcnt(3)
    v_pk_fma_f32 v[62:63], v[94:95], v[204:205], v[244:245]
    v_pk_fma_f32 v[78:79], v[110:111], v[204:205], v[246:247]
    v_pk_fma_f32 v[62:63], v[110:111], v[206:207], v[62:63]
    v_mfma_f32_32x32x16_bf16 v[160:175], v[220:223], v[40:43], v[160:175]
    ds_read_b128 v[220:223], v10 offset:15360
    ds_read_b128 v[224:227], v10 offset:17408
    ds_read_b128 v[228:231], v10 offset:19456
    v_pk_fma_f32 v[78:79], v[94:95], v[206:207], v[78:79] neg_lo:[1,0,0] neg_hi:[1,0,0]
    v_pk_fma_f32 v[94:95], v[244:245], v[254:255], v[62:63] neg_lo:[0,0,1] neg_hi:[0,0,1]
    v_pk_fma_f32 v[110:111], v[246:247], v[254:255], v[78:79] neg_lo:[0,0,1] neg_hi:[0,0,1]
    v_cvt_pk_bf16_f32 v23, v62, v63
    v_cvt_pk_bf16_f32 v31, v78, v79
    v_cvt_pk_bf16_f32 v39, v94, v95
    v_cvt_pk_bf16_f32 v47, v110, v111
    s_waitcnt vmcnt(0)
    v_mov_b32 v15, 163804
    s_mov_b32 s79, 200000
    s_waitcnt lgkmcnt(0)
    s_nop 2
L_wc_42:
    ds_read_b32 v7, v15
    s_waitcnt lgkmcnt(0)
    v_readfirstlane_b32 s78, v7
    s_nop 0
    s_cmp_ge_u32 s78, 1
    s_cbranch_scc1 L_wcd_43
    s_sub_u32 s79, s79, 1
    s_cbranch_scc1 L_wcd_43
    s_branch L_wc_42
L_wcd_43:
    ds_read_b128 v[176:179], v12 offset:0
    ds_read_b128 v[192:195], v13 offset:0
    ds_read_b128 v[180:183], v12 offset:4096
    ds_read_b128 v[196:199], v13 offset:4096
    ds_read_b128 v[184:187], v12 offset:2048
    ds_read_b128 v[200:203], v13 offset:2048
    ds_read_b128 v[188:191], v12 offset:6144
    ds_read_b128 v[204:207], v13 offset:6144
    v_lshrrev_b32 v15, 2, v2
    v_lshlrev_b32 v15, 12, v15
    v_and_b32 v7, 3, v2
    v_lshl_add_u32 v15, v7, 7, v15
    s_lshl_b32 s70, s50, 3
    s_add_u32 s70, s70, s48
    s_mul_i32 s70, s70, 28672
    s_lshl_b32 s71, s49, 9
    s_add_u32 s70, s70, s71
    s_mov_b64 exec, 0x0fffffff
    buffer_load_dword v1, v15, s[36:39], s70 offen
    s_mov_b64 exec, -1
    s_cmp_lg_u32 s67, 0
    s_waitcnt lgkmcnt(0)
    s_cbranch_scc1 L_fspecial
    v_mfma_f32_32x32x16_bf16 v[112:127], v[208:211], v[20:23], v[112:127]
    v_mfma_f32_32x32x16_bf16 v[128:143], v[216:219], v[20:23], v[128:143]
    v_mfma_f32_32x32x16_bf16 v[112:127], v[212:215], v[28:31], v[112:127]
    v_mfma_f32_32x32x16_bf16 v[128:143], v[208:211], v[28:31], v[128:143]
    ds_read_b128 v[208:211], v10 offset:8192
    ds_read_b128 v[212:215], v10 offset:10240
    ds_read_b128 v[216:219], v10 offset:12288
    v_mfma_f32_32x32x16_bf16 v[144:159], v[220:223], v[36:39], v[144:159]
    v_lshlrev_b32 v240, 16, v176
    v_lshlrev_b32 v241, 16, v177
    v_and_b32 v242, 0xffff0000, v176
    v_and_b32 v243, 0xffff0000, v177
    s_nop 2
    v_pk_mul_f32 v[244:245], v[112:113], v[242:243]
    v_pk_mul_f32 v[112:113], v[112:113], v[240:241]
    v_mfma_f32_32x32x16_bf16 v[160:175], v[228:231], v[36:39], v[160:175]
    v_pk_fma_f32 v[112:113], v[128:129], v[242:243], v[112:113] neg_lo:[1,0,0] neg_hi:[1,0,0]
    v_pk_fma_f32 v[128:129], v[128:129], v[240:241], v[244:245]
    v_cvt_pk_bf16_f32 v16, v112, v113
    v_cvt_pk_bf16_f32 v24, v128, v129
    v_lshlrev_b32 v246, 16, v178
    v_lshlrev_b32 v247, 16, v179
    v_mfma_f32_32x32x16_bf16 v[144:159], v[224:227], v[44:47], v[144:159]
    v_and_b32 v248, 0xffff0000, v178
    v_and_b32 v249, 0xffff0000, v179
    v_pk_mul_f32 v[250:251], v[114:115], v[248:249]
    v_pk_mul_f32 v[114:115], v[114:115], v[246:247]
    v_pk_fma_f32 v[114:115], v[130:131], v[248:249], v[114:115] neg_lo:[1,0,0] neg_hi:[1,0,0]
    v_pk_fma_f32 v[130:131], v[130:131], v[246:247], v[250:251]
    v_mfma_f32_32x32x16_bf16 v[160:175], v[220:223], v[44:47], v[160:175]
    ds_read_b128 v[220:223], v10 offset:9216
    ds_read_b128 v[224:227], v10 offset:11264
    ds_read_b128 v[228:231], v10 offset:13312
    ds_read_b128 v[176:179], v10 offset:43008
    v_cvt_pk_bf16_f32 v17, v114, v115
    v_cvt_pk_bf16_f32 v25, v130, v131
    v_lshlrev_b32 v240, 16, v192
    v_lshlrev_b32 v241, 16, v193
    v_and_b32 v242, 0xffff0000, v192
    v_and_b32 v243, 0xffff0000, v193
    v_pk_mul_f32 v[244:245], v[116:117], v[242:243]
    v_pk_mul_f32 v[116:117], v[116:117], v[240:241]
    v_pk_fma_f32 v[116:117], v[132:133], v[242:243], v[116:117] neg_lo:[1,0,0] neg_hi:[1,0,0]
    v_pk_fma_f32 v[132:133], v[132:133], v[240:241], v[244:245]
    v_cvt_pk_bf16_f32 v18, v116, v117
    v_cvt_pk_bf16_f32 v26, v132, v133
    v_lshlrev_b32 v246, 16, v194
    v_lshlrev_b32 v247, 16, v195
    v_and_b32 v248, 0xffff0000, v194
    v_and_b32 v249, 0xffff0000, v195
    v_pk_mul_f32 v[250:251], v[118:119], v[248:249]
    v_pk_mul_f32 v[118:119], v[118:119], v[246:247]
    v_pk_fma_f32 v[118:119], v[134:135], v[248:249], v[118:119] neg_lo:[1,0,0] neg_hi:[1,0,0]
    v_pk_fma_f32 v[134:135], v[134:135], v[246:247], v[250:251]
    ds_read_b128 v[192:195], v10 offset:44032
    v_cvt_pk_bf16_f32 v19, v118, v119
    v_cvt_pk_bf16_f32 v27, v134, v135
    v_lshlrev_b32 v240, 16, v180
    v_lshlrev_b32 v241, 16, v181
    v_and_b32 v242, 0xffff0000, v180
    v_and_b32 v243, 0xffff0000, v181
    v_pk_mul_f32 v[244:245], v[120:121], v[242:243]
    v_pk_mul_f32 v[120:121], v[120:121], v[240:241]
    v_pk_fma_f32 v[120:121], v[136:137], v[242:243], v[120:121] neg_lo:[1,0,0] neg_hi:[1,0,0]
    v_pk_fma_f32 v[136:137], v[136:137], v[240:241], v[244:245]
    v_cvt_pk_bf16_f32 v20, v120, v121
    v_cvt_pk_bf16_f32 v28, v136, v137
    v_lshlrev_b32 v246, 16, v182
    v_lshlrev_b32 v247, 16, v183
    v_and_b32 v248, 0xffff0000, v182
    v_and_b32 v249, 0xffff0000, v183
    v_pk_mul_f32 v[250:251], v[122:123], v[248:249]
    v_pk_mul_f32 v[122:123], v[122:123], v[246:247]
    v_pk_fma_f32 v[122:123], v[138:139], v[248:249], v[122:123] neg_lo:[1,0,0] neg_hi:[1,0,0]
    v_pk_fma_f32 v[138:139], v[138:139], v[246:247], v[250:251]
    ds_read_b128 v[180:183], v10 offset:45056
    v_cvt_pk_bf16_f32 v21, v122, v123
    v_cvt_pk_bf16_f32 v29, v138, v139
    v_lshlrev_b32 v240, 16, v196
    v_lshlrev_b32 v241, 16, v197
    v_and_b32 v242, 0xffff0000, v196
    v_and_b32 v243, 0xffff0000, v197
    v_pk_mul_f32 v[244:245], v[124:125], v[242:243]
    v_pk_mul_f32 v[124:125], v[124:125], v[240:241]
    v_pk_fma_f32 v[124:125], v[140:141], v[242:243], v[124:125] neg_lo:[1,0,0] neg_hi:[1,0,0]
    v_pk_fma_f32 v[140:141], v[140:141], v[240:241], v[244:245]
    v_cvt_pk_bf16_f32 v22, v124, v125
    v_cvt_pk_bf16_f32 v30, v140, v141
    v_lshlrev_b32 v246, 16, v198
    v_lshlrev_b32 v247, 16, v199
    v_and_b32 v248, 0xffff0000, v198
    v_and_b32 v249, 0xffff0000, v199
    v_pk_mul_f32 v[250:251], v[126:127], v[248:249]
    v_pk_mul_f32 v[126:127], v[126:127], v[246:247]
    v_pk_fma_f32 v[126:127], v[142:143], v[248:249], v[126:127] neg_lo:[1,0,0] neg_hi:[1,0,0]
    v_pk_fma_f32 v[142:143], v[142:143], v[246:247], v[250:251]
    ds_read_b128 v[196:199], v10 offset:46080
    v_cvt_pk_bf16_f32 v23, v126, v127
    v_cvt_pk_bf16_f32 v31, v142, v143
    s_waitcnt lgkmcnt(9)
    v_mfma_f32_32x32x16_bf16 v[48:63], v[16:19], v[208:211], 0
    v_lshlrev_b32 v240, 16, v184
    v_lshlrev_b32 v241, 16, v185
    v_and_b32 v242, 0xffff0000, v184
    v_and_b32 v243, 0xffff0000, v185
    v_pk_mul_f32 v[244:245], v[144:145], v[242:243]
    v_pk_mul_f32 v[144:145], v[144:145], v[240:241]
    v_pk_fma_f32 v[144:145], v[160:161], v[242:243], v[144:145] neg_lo:[1,0,0] neg_hi:[1,0,0]
    v_pk_fma_f32 v[160:161], v[160:161], v[240:241], v[244:245]
    v_cvt_pk_bf16_f32 v32, v144, v145
    v_cvt_pk_bf16_f32 v40, v160, v161
    v_lshlrev_b32 v246, 16, v186
    s_waitcnt lgkmcnt(8)
    v_mfma_f32_32x32x16_bf16 v[64:79], v[16:19], v[212:215], 0
    v_lshlrev_b32 v247, 16, v187
    v_and_b32 v248, 0xffff0000, v186
    v_and_b32 v249, 0xffff0000, v187
    v_pk_mul_f32 v[250:251], v[146:147], v[248:249]
    v_pk_mul_f32 v[146:147], v[146:147], v[246:247]
    v_pk_fma_f32 v[146:147], v[162:163], v[248:249], v[146:147] neg_lo:[1,0,0] neg_hi:[1,0,0]
    v_pk_fma_f32 v[162:163], v[162:163], v[246:247], v[250:251]
    ds_read_b128 v[184:187], v10 offset:47104
    v_cvt_pk_bf16_f32 v33, v146, v147
    v_cvt_pk_bf16_f32 v41, v162, v163
    v_lshlrev_b32 v240, 16, v200
    s_waitcnt lgkmcnt(8)
    v_mfma_f32_32x32x16_bf16 v[48:63], v[24:27], v[216:219], v[48:63]
    v_lshlrev_b32 v241, 16, v201
    v_and_b32 v242, 0xffff0000, v200
    v_and_b32 v243, 0xffff0000, v201
    v_pk_mul_f32 v[244:245], v[148:149], v[242:243]
    v_pk_mul_f32 v[148:149], v[148:149], v[240:241]
    v_pk_fma_f32 v[148:149], v[164:165], v[242:243], v[148:149] neg_lo:[1,0,0] neg_hi:[1,0,0]
    v_pk_fma_f32 v[164:165], v[164:165], v[240:241], v[244:245]
    v_cvt_pk_bf16_f32 v34, v148, v149
    v_cvt_pk_bf16_f32 v42, v164, v165
    v_lshlrev_b32 v246, 16, v202
    v_lshlrev_b32 v247, 16, v203
    v_mfma_f32_32x32x16_bf16 v[64:79], v[24:27], v[208:211], v[64:79]
    ds_read_b128 v[208:211], v10 offset:20480
    ds_read_b128 v[212:215], v10 offset:22528
    ds_read_b128 v[216:219], v10 offset:24576
    v_and_b32 v248, 0xffff0000, v202
    v_and_b32 v249, 0xffff0000, v203
    v_pk_mul_f32 v[250:251], v[150:151], v[248:249]
    v_pk_mul_f32 v[150:151], v[150:151], v[246:247]
    v_pk_fma_f32 v[150:151], v[166:167], v[248:249], v[150:151] neg_lo:[1,0,0] neg_hi:[1,0,0]
    v_pk_fma_f32 v[166:167], v[166:167], v[246:247], v[250:251]
    ds_read_b128 v[200:203], v10 offset:48128
    v_cvt_pk_bf16_f32 v35, v150, v151
    v_cvt_pk_bf16_f32 v43, v166, v167
    v_lshlrev_b32 v240, 16, v188
    v_lshlrev_b32 v241, 16, v189
    s_waitcnt lgkmcnt(11)
    v_mfma_f32_32x32x16_bf16 v[48:63], v[20:23], v[220:223], v[48:63]
    v_and_b32 v242, 0xffff0000, v188
    v_and_b32 v243, 0xffff0000, v189
    v_pk_mul_f32 v[244:245], v[152:153], v[242:243]
    v_pk_mul_f32 v[152:153], v[152:153], v[240:241]
    v_pk_fma_f32 v[152:153], v[168:169], v[242:243], v[152:153] neg_lo:[1,0,0] neg_hi:[1,0,0]
    v_pk_fma_f32 v[168:169], v[168:169], v[240:241], v[244:245]
    v_cvt_pk_bf16_f32 v36, v152, v153
    v_cvt_pk_bf16_f32 v44, v168, v169
    v_lshlrev_b32 v246, 16, v190
    v_lshlrev_b32 v247, 16, v191
    v_and_b32 v248, 0xffff0000, v190
    s_waitcnt lgkmcnt(10)
    v_mfma_f32_32x32x16_bf16 v[64:79], v[20:23], v[224:227], v[64:79]
    v_and_b32 v249, 0xffff0000, v191
    v_pk_mul_f32 v[250:251], v[154:155], v[248:249]
    v_pk_mul_f32 v[154:155], v[154:155], v[246:247]
    v_pk_fma_f32 v[154:155], v[170:171], v[248:249], v[154:155] neg_lo:[1,0,0] neg_hi:[1,0,0]
    v_pk_fma_f32 v[170:171], v[170:171], v[246:247], v[250:251]
    ds_read_b128 v[188:191], v10 offset:49152
    v_cvt_pk_bf16_f32 v37, v154, v155
    v_cvt_pk_bf16_f32 v45, v170, v171
    v_lshlrev_b32 v240, 16, v204
    v_lshlrev_b32 v241, 16, v205
    v_and_b32 v242, 0xffff0000, v204
    s_waitcnt lgkmcnt(10)
    v_mfma_f32_32x32x16_bf16 v[48:63], v[28:31], v[228:231], v[48:63]
    v_and_b32 v243, 0xffff0000, v205
    v_pk_mul_f32 v[244:245], v[156:157], v[242:243]
    v_pk_mul_f32 v[156:157], v[156:157], v[240:241]
    v_pk_fma_f32 v[156:157], v[172:173], v[242:243], v[156:157] neg_lo:[1,0,0] neg_hi:[1,0,0]
    v_pk_fma_f32 v[172:173], v[172:173], v[240:241], v[244:245]
    v_cvt_pk_bf16_f32 v38, v156, v157
    v_cvt_pk_bf16_f32 v46, v172, v173
    v_lshlrev_b32 v246, 16, v206
    v_lshlrev_b32 v247, 16, v207
    v_and_b32 v248, 0xffff0000, v206
    v_and_b32 v249, 0xffff0000, v207
    v_mfma_f32_32x32x16_bf16 v[64:79], v[28:31], v[220:223], v[64:79]
    ds_read_b128 v[220:223], v10 offset:21504
    ds_read_b128 v[224:227], v10 offset:23552
    ds_read_b128 v[228:231], v10 offset:25600
    v_pk_mul_f32 v[250:251], v[158:159], v[248:249]
    v_pk_mul_f32 v[158:159], v[158:159], v[246:247]
    v_pk_fma_f32 v[158:159], v[174:175], v[248:249], v[158:159] neg_lo:[1,0,0] neg_hi:[1,0,0]
    v_pk_fma_f32 v[174:175], v[174:175], v[246:247], v[250:251]
    ds_read_b128 v[204:207], v10 offset:50176
    v_cvt_pk_bf16_f32 v39, v158, v159
    v_cvt_pk_bf16_f32 v47, v174, v175
    s_waitcnt lgkmcnt(8)
    v_mfma_f32_32x32x16_bf16 v[80:95], v[32:35], v[208:211], 0
    s_waitcnt lgkmcnt(7)
    v_mfma_f32_32x32x16_bf16 v[96:111], v[32:35], v[212:215], 0
    s_waitcnt lgkmcnt(6)
    v_mfma_f32_32x32x16_bf16 v[80:95], v[40:43], v[216:219], v[80:95]
    v_mfma_f32_32x32x16_bf16 v[96:111], v[40:43], v[208:211], v[96:111]
    ds_read_b128 v[208:211], v10 offset:8192
    ds_read_b128 v[212:215], v10 offset:10240
    ds_read_b128 v[216:219], v10 offset:12288
    s_waitcnt lgkmcnt(6)
    v_mfma_f32_32x32x16_bf16 v[80:95], v[36:39], v[220:223], v[80:95]
    s_waitcnt lgkmcnt(5)
    v_mfma_f32_32x32x16_bf16 v[96:111], v[36:39], v[224:227], v[96:111]
    s_waitcnt lgkmcnt(4)
    v_mfma_f32_32x32x16_bf16 v[80:95], v[44:47], v[228:231], v[80:95]
    v_mfma_f32_32x32x16_bf16 v[96:111], v[44:47], v[220:223], v[96:111]
    ds_read_b128 v[220:223], v10 offset:14336
    ds_read_b128 v[224:227], v10 offset:16384
    ds_read_b128 v[228:231], v10 offset:18432
    s_waitcnt lgkmcnt(0)
    s_nop 7
    s_branch L_fjoin
L_fspecial:
    s_movk_i32 s71, 256
    s_mov_b32 s72, 124928
    s_lshl_b32 s68, s71, 13
    s_add_u32 s68, s68, 4194304
    s_add_u32 m0, s72, 0
    s_nop 0
    buffer_load_dwordx4 v6, s[24:27], s68 offen sc1 lds
    s_add_u32 s68, s68, 1024
    s_add_u32 m0, s72, 1024
    s_nop 0
    buffer_load_dwordx4 v6, s[24:27], s68 offen sc1 lds
    s_add_u32 s68, s68, 1024
    s_add_u32 m0, s72, 2048
    s_nop 0
    buffer_load_dwordx4 v6, s[24:27], s68 offen sc1 lds
    s_add_u32 s68, s68, 1024
    s_add_u32 m0, s72, 3072
    s_nop 0
    buffer_load_dwordx4 v6, s[24:27], s68 offen sc1 lds
    s_add_u32 s68, s68, 1024
    s_add_u32 m0, s72, 4096
    s_nop 0
    buffer_load_dwordx4 v6, s[24:27], s68 offen sc1 lds
    s_add_u32 s68, s68, 1024
    s_add_u32 m0, s72, 5120
    s_nop 0
    buffer_load_dwordx4 v6, s[24:27], s68 offen sc1 lds
    s_add_u32 s68, s68, 1024
    s_add_u32 m0, s72, 6144
    s_nop 0
    buffer_load_dwordx4 v6, s[24:27], s68 offen sc1 lds
    s_add_u32 s68, s68, 1024
    s_add_u32 m0, s72, 7168
    s_nop 0
    buffer_load_dwordx4 v6, s[24:27], s68 offen sc1 lds
    v_mfma_f32_32x32x16_bf16 v[112:127], v[208:211], v[20:23], v[112:127]
    v_mfma_f32_32x32x16_bf16 v[128:143], v[216:219], v[20:23], v[128:143]
    v_mfma_f32_32x32x16_bf16 v[112:127], v[212:215], v[28:31], v[112:127]
    v_mfma_f32_32x32x16_bf16 v[128:143], v[208:211], v[28:31], v[128:143]
    ds_read_b128 v[208:211], v10 offset:8192
    ds_read_b128 v[212:215], v10 offset:10240
    ds_read_b128 v[216:219], v10 offset:12288
    v_mfma_f32_32x32x16_bf16 v[144:159], v[220:223], v[36:39], v[144:159]
    v_mfma_f32_32x32x16_bf16 v[160:175], v[228:231], v[36:39], v[160:175]
    v_mfma_f32_32x32x16_bf16 v[144:159], v[224:227], v[44:47], v[144:159]
    v_mfma_f32_32x32x16_bf16 v[160:175], v[220:223], v[44:47], v[160:175]
    ds_read_b128 v[220:223], v10 offset:9216
    ds_read_b128 v[224:227], v10 offset:11264
    ds_read_b128 v[228:231], v10 offset:13312
    v_lshlrev_b32 v15, 8, v5
    v_add_u32 v15, v15, v4
    v_lshlrev_b32 v15, 2, v15
    v_sub_u32 v7, 1152, v15
    v_cmp_eq_u32 vcc, 0, v2
    ds_write_b32 v15, v112 offset:0
    ds_write_b32 v15, v113 offset:256
    ds_write_b32 v15, v114 offset:512
    ds_write_b32 v15, v115 offset:768
    ds_write_b32 v15, v116 offset:2048
    ds_write_b32 v15, v117 offset:2304
    ds_write_b32 v15, v118 offset:2560
    ds_write_b32 v15, v119 offset:2816
    ds_write_b32 v15, v120 offset:4096
    ds_write_b32 v15, v121 offset:4352
    ds_write_b32 v15, v122 offset:4608
    ds_write_b32 v15, v123 offset:4864
    ds_write_b32 v15, v124 offset:6144
    ds_write_b32 v15, v125 offset:6400
    ds_write_b32 v15, v126 offset:6656
    ds_write_b32 v15, v127 offset:6912
    ds_write_b32 v15, v144 offset:128
    ds_write_b32 v15, v145 offset:384
    ds_write_b32 v15, v146 offset:640
    ds_write_b32 v15, v147 offset:896
    ds_write_b32 v15, v148 offset:2176
    ds_write_b32 v15, v149 offset:2432
    ds_write_b32 v15, v150 offset:2688
    ds_write_b32 v15, v151 offset:2944
    ds_write_b32 v15, v152 offset:4224
    ds_write_b32 v15, v153 offset:4480
    ds_write_b32 v15, v154 offset:4736
    ds_write_b32 v15, v155 offset:4992
    ds_write_b32 v15, v156 offset:6272
    ds_write_b32 v15, v157 offset:6528
    ds_write_b32 v15, v158 offset:6784
    ds_write_b32 v15, v159 offset:7040
    s_waitcnt lgkmcnt(0)
    ds_read_b32 v48, v7 offset:7040
    ds_read_b32 v49, v7 offset:6784
    ds_read_b32 v50, v7 offset:6528
    ds_read_b32 v51, v7 offset:6272
    ds_read_b32 v52, v7 offset:4992
    ds_read_b32 v53, v7 offset:4736
    ds_read_b32 v54, v7 offset:4480
    ds_read_b32 v55, v7 offset:4224
    ds_read_b32 v56, v7 offset:2944
    ds_read_b32 v57, v7 offset:2688
    ds_read_b32 v58, v7 offset:2432
    ds_read_b32 v59, v7 offset:2176
    ds_read_b32 v60, v7 offset:896
    ds_read_b32 v61, v7 offset:640
    ds_read_b32 v62, v7 offset:384
    ds_read_b32 v63, v7 offset:128
    ds_read_b32 v80, v7 offset:6912
    ds_read_b32 v81, v7 offset:6656
    ds_read_b32 v82, v7 offset:6400
    ds_read_b32 v83, v7 offset:6144
    ds_read_b32 v84, v7 offset:4864
    ds_read_b32 v85, v7 offset:4608
    ds_read_b32 v86, v7 offset:4352
    ds_read_b32 v87, v7 offset:4096
    ds_read_b32 v88, v7 offset:2816
    ds_read_b32 v89, v7 offset:2560
    ds_read_b32 v90, v7 offset:2304
    ds_read_b32 v91, v7 offset:2048
    ds_read_b32 v92, v7 offset:768
    ds_read_b32 v93, v7 offset:512
    ds_read_b32 v94, v7 offset:256
    ds_read_b32 v95, v7 offset:0
    s_waitcnt lgkmcnt(0)
    v_cndmask_b32 v48, v48, v112, vcc
    ds_write_b32 v15, v128 offset:0
    ds_write_b32 v15, v129 offset:256
    ds_write_b32 v15, v130 offset:512
    ds_write_b32 v15, v131 offset:768
    ds_write_b32 v15, v132 offset:2048
    ds_write_b32 v15, v133 offset:2304
    ds_write_b32 v15, v134 offset:2560
    ds_write_b32 v15, v135 offset:2816
    ds_write_b32 v15, v136 offset:4096
    ds_write_b32 v15, v137 offset:4352
    ds_write_b32 v15, v138 offset:4608
    ds_write_b32 v15, v139 offset:4864
    ds_write_b32 v15, v140 offset:6144
    ds_write_b32 v15, v141 offset:6400
    ds_write_b32 v15, v142 offset:6656
    ds_write_b32 v15, v143 offset:6912
    ds_write_b32 v15, v160 offset:128
    ds_write_b32 v15, v161 offset:384
    ds_write_b32 v15, v162 offset:640
    ds_write_b32 v15, v163 offset:896
    ds_write_b32 v15, v164 offset:2176
    ds_write_b32 v15, v165 offset:2432
    ds_write_b32 v15, v166 offset:2688
    ds_write_b32 v15, v167 offset:2944
    ds_write_b32 v15, v168 offset:4224
    ds_write_b32 v15, v169 offset:4480
    ds_write_b32 v15, v170 offset:4736
    ds_write_b32 v15, v171 offset:4992
    ds_write_b32 v15, v172 offset:6272
    ds_write_b32 v15, v173 offset:6528
    ds_write_b32 v15, v174 offset:6784
    ds_write_b32 v15, v175 offset:7040
    s_waitcnt lgkmcnt(0)
    ds_read_b32 v64, v7 offset:7040
    ds_read_b32 v65, v7 offset:6784
    ds_read_b32 v66, v7 offset:6528
    ds_read_b32 v67, v7 offset:6272
    ds_read_b32 v68, v7 offset:4992
    ds_read_b32 v69, v7 offset:4736
    ds_read_b32 v70, v7 offset:4480
    ds_read_b32 v71, v7 offset:4224
    ds_read_b32 v72, v7 offset:2944
    ds_read_b32 v73, v7 offset:2688
    ds_read_b32 v74, v7 offset:2432
    ds_read_b32 v75, v7 offset:2176
    ds_read_b32 v76, v7 offset:896
    ds_read_b32 v77, v7 offset:640
    ds_read_b32 v78, v7 offset:384
    ds_read_b32 v79, v7 offset:128
    ds_read_b32 v96, v7 offset:6912
    ds_read_b32 v97, v7 offset:6656
    ds_read_b32 v98, v7 offset:6400
    ds_read_b32 v99, v7 offset:6144
    ds_read_b32 v100, v7 offset:4864
    ds_read_b32 v101, v7 offset:4608
    ds_read_b32 v102, v7 offset:4352
    ds_read_b32 v103, v7 offset:4096
    ds_read_b32 v104, v7 offset:2816
    ds_read_b32 v105, v7 offset:2560
    ds_read_b32 v106, v7 offset:2304
    ds_read_b32 v107, v7 offset:2048
    ds_read_b32 v108, v7 offset:768
    ds_read_b32 v109, v7 offset:512
    ds_read_b32 v110, v7 offset:256
    ds_read_b32 v111, v7 offset:0
    s_waitcnt lgkmcnt(0)
    v_cndmask_b32 v64, v64, v128, vcc
    v_lshlrev_b32 v240, 16, v176
    v_lshlrev_b32 v241, 16, v177
    v_and_b32 v242, 0xffff0000, v176
    v_and_b32 v243, 0xffff0000, v177
    v_pk_mul_f32 v[244:245], v[112:113], v[242:243]
    v_pk_mul_f32 v[112:113], v[112:113], v[240:241]
    v_pk_fma_f32 v[112:113], v[128:129], v[242:243], v[112:113] neg_lo:[1,0,0] neg_hi:[1,0,0]
    v_pk_fma_f32 v[128:129], v[128:129], v[240:241], v[244:245]
    v_lshlrev_b32 v246, 16, v178
    v_lshlrev_b32 v247, 16, v179
    v_and_b32 v248, 0xffff0000, v178
    v_and_b32 v249, 0xffff0000, v179
    v_pk_mul_f32 v[250:251], v[114:115], v[248:249]
    v_pk_mul_f32 v[114:115], v[114:115], v[246:247]
    v_pk_fma_f32 v[114:115], v[130:131], v[248:249], v[114:115] neg_lo:[1,0,0] neg_hi:[1,0,0]
    v_pk_fma_f32 v[130:131], v[130:131], v[246:247], v[250:251]
    v_lshlrev_b32 v240, 16, v192
    v_lshlrev_b32 v241, 16, v193
    v_and_b32 v242, 0xffff0000, v192
    v_and_b32 v243, 0xffff0000, v193
    v_pk_mul_f32 v[244:245], v[116:117], v[242:243]
    v_pk_mul_f32 v[116:117], v[116:117], v[240:241]
    v_pk_fma_f32 v[116:117], v[132:133], v[242:243], v[116:117] neg_lo:[1,0,0] neg_hi:[1,0,0]
    v_pk_fma_f32 v[132:133], v[132:133], v[240:241], v[244:245]
    v_lshlrev_b32 v246, 16, v194
    v_lshlrev_b32 v247, 16, v195
    v_and_b32 v248, 0xffff0000, v194
    v_and_b32 v249, 0xffff0000, v195
    v_pk_mul_f32 v[250:251], v[118:119], v[248:249]
    v_pk_mul_f32 v[118:119], v[118:119], v[246:247]
    v_pk_fma_f32 v[118:119], v[134:135], v[248:249], v[118:119] neg_lo:[1,0,0] neg_hi:[1,0,0]
    v_pk_fma_f32 v[134:135], v[134:135], v[246:247], v[250:251]
    v_lshlrev_b32 v240, 16, v180
    v_lshlrev_b32 v241, 16, v181
    v_and_b32 v242, 0xffff0000, v180
    v_and_b32 v243, 0xffff0000, v181
    v_pk_mul_f32 v[244:245], v[120:121], v[242:243]
    v_pk_mul_f32 v[120:121], v[120:121], v[240:241]
    v_pk_fma_f32 v[120:121], v[136:137], v[242:243], v[120:121] neg_lo:[1,0,0] neg_hi:[1,0,0]
    v_pk_fma_f32 v[136:137], v[136:137], v[240:241], v[244:245]
    v_lshlrev_b32 v246, 16, v182
    v_lshlrev_b32 v247, 16, v183
    v_and_b32 v248, 0xffff0000, v182
    v_and_b32 v249, 0xffff0000, v183
    v_pk_mul_f32 v[250:251], v[122:123], v[248:249]
    v_pk_mul_f32 v[122:123], v[122:123], v[246:247]
    v_pk_fma_f32 v[122:123], v[138:139], v[248:249], v[122:123] neg_lo:[1,0,0] neg_hi:[1,0,0]
    v_pk_fma_f32 v[138:139], v[138:139], v[246:247], v[250:251]
    v_lshlrev_b32 v240, 16, v196
    v_lshlrev_b32 v241, 16, v197
    v_and_b32 v242, 0xffff0000, v196
    v_and_b32 v243, 0xffff0000, v197
    v_pk_mul_f32 v[244:245], v[124:125], v[242:243]
    v_pk_mul_f32 v[124:125], v[124:125], v[240:241]
    v_pk_fma_f32 v[124:125], v[140:141], v[242:243], v[124:125] neg_lo:[1,0,0] neg_hi:[1,0,0]
    v_pk_fma_f32 v[140:141], v[140:141], v[240:241], v[244:245]
    v_lshlrev_b32 v246, 16, v198
    v_lshlrev_b32 v247, 16, v199
    v_and_b32 v248, 0xffff0000, v198
    v_and_b32 v249, 0xffff0000, v199
    v_pk_mul_f32 v[250:251], v[126:127], v[248:249]
    v_pk_mul_f32 v[126:127], v[126:127], v[246:247]
    v_pk_fma_f32 v[126:127], v[142:143], v[248:249], v[126:127] neg_lo:[1,0,0] neg_hi:[1,0,0]
    v_pk_fma_f32 v[142:143], v[142:143], v[246:247], v[250:251]
    v_lshlrev_b32 v240, 16, v184
    v_lshlrev_b32 v241, 16, v185
    v_and_b32 v242, 0xffff0000, v184
    v_and_b32 v243, 0xffff0000, v185
    v_pk_mul_f32 v[244:245], v[144:145], v[242:243]
    v_pk_mul_f32 v[144:145], v[144:145], v[240:241]
    v_pk_fma_f32 v[144:145], v[160:161], v[242:243], v[144:145] neg_lo:[1,0,0] neg_hi:[1,0,0]
    v_pk_fma_f32 v[160:161], v[160:161], v[240:241], v[244:245]
    v_lshlrev_b32 v246, 16, v186
    v_lshlrev_b32 v247, 16, v187
    v_and_b32 v248, 0xffff0000, v186
    v_and_b32 v249, 0xffff0000, v187
    v_pk_mul_f32 v[250:251], v[146:147], v[248:249]
    v_pk_mul_f32 v[146:147], v[146:147], v[246:247]
    v_pk_fma_f32 v[146:147], v[162:163], v[248:249], v[146:147] neg_lo:[1,0,0] neg_hi:[1,0,0]
    v_pk_fma_f32 v[162:163], v[162:163], v[246:247], v[250:251]
    v_lshlrev_b32 v240, 16, v200
    v_lshlrev_b32 v241, 16, v201
    v_and_b32 v242, 0xffff0000, v200
    v_and_b32 v243, 0xffff0000, v201
    v_pk_mul_f32 v[244:245], v[148:149], v[242:243]
    v_pk_mul_f32 v[148:149], v[148:149], v[240:241]
    v_pk_fma_f32 v[148:149], v[164:165], v[242:243], v[148:149] neg_lo:[1,0,0] neg_hi:[1,0,0]
    v_pk_fma_f32 v[164:165], v[164:165], v[240:241], v[244:245]
    v_lshlrev_b32 v246, 16, v202
    v_lshlrev_b32 v247, 16, v203
    v_and_b32 v248, 0xffff0000, v202
    v_and_b32 v249, 0xffff0000, v203
    v_pk_mul_f32 v[250:251], v[150:151], v[248:249]
    v_pk_mul_f32 v[150:151], v[150:151], v[246:247]
    v_pk_fma_f32 v[150:151], v[166:167], v[248:249], v[150:151] neg_lo:[1,0,0] neg_hi:[1,0,0]
    v_pk_fma_f32 v[166:167], v[166:167], v[246:247], v[250:251]
    v_lshlrev_b32 v240, 16, v188
    v_lshlrev_b32 v241, 16, v189
    v_and_b32 v242, 0xffff0000, v188
    v_and_b32 v243, 0xffff0000, v189
    v_pk_mul_f32 v[244:245], v[152:153], v[242:243]
    v_pk_mul_f32 v[152:153], v[152:153], v[240:241]
    v_pk_fma_f32 v[152:153], v[168:169], v[242:243], v[152:153] neg_lo:[1,0,0] neg_hi:[1,0,0]
    v_pk_fma_f32 v[168:169], v[168:169], v[240:241], v[244:245]
    v_lshlrev_b32 v246, 16, v190
    v_lshlrev_b32 v247, 16, v191
    v_and_b32 v248, 0xffff0000, v190
    v_and_b32 v249, 0xffff0000, v191
    v_pk_mul_f32 v[250:251], v[154:155], v[248:249]
    v_pk_mul_f32 v[154:155], v[154:155], v[246:247]
    v_pk_fma_f32 v[154:155], v[170:171], v[248:249], v[154:155] neg_lo:[1,0,0] neg_hi:[1,0,0]
    v_pk_fma_f32 v[170:171], v[170:171], v[246:247], v[250:251]
    v_lshlrev_b32 v240, 16, v204
    v_lshlrev_b32 v241, 16, v205
    v_and_b32 v242, 0xffff0000, v204
    v_and_b32 v243, 0xffff0000, v205
    v_pk_mul_f32 v[244:245], v[156:157], v[242:243]
    v_pk_mul_f32 v[156:157], v[156:157], v[240:241]
    v_pk_fma_f32 v[156:157], v[172:173], v[242:243], v[156:157] neg_lo:[1,0,0] neg_hi:[1,0,0]
    v_pk_fma_f32 v[172:173], v[172:173], v[240:241], v[244:245]
    v_lshlrev_b32 v246, 16, v206
    v_lshlrev_b32 v247, 16, v207
    v_and_b32 v248, 0xffff0000, v206
    v_and_b32 v249, 0xffff0000, v207
    v_pk_mul_f32 v[250:251], v[158:159], v[248:249]
    v_pk_mul_f32 v[158:159], v[158:159], v[246:247]
    v_pk_fma_f32 v[158:159], v[174:175], v[248:249], v[158:159] neg_lo:[1,0,0] neg_hi:[1,0,0]
    v_pk_fma_f32 v[174:175], v[174:175], v[246:247], v[250:251]
    s_waitcnt vmcnt(0)
    ds_read_b128 v[176:179], v12 offset:0
    ds_read_b128 v[192:195], v13 offset:0
    ds_read_b128 v[180:183], v12 offset:4096
    ds_read_b128 v[196:199], v13 offset:4096
    ds_read_b128 v[184:187], v12 offset:2048
    ds_read_b128 v[200:203], v13 offset:2048
    ds_read_b128 v[188:191], v12 offset:6144
    ds_read_b128 v[204:207], v13 offset:6144
    s_waitcnt lgkmcnt(7)
    v_lshlrev_b32 v240, 16, v176
    v_lshlrev_b32 v241, 16, v177
    v_and_b32 v242, 0xffff0000, v176
    v_and_b32 v243, 0xffff0000, v177
    v_pk_fma_f32 v[112:113], v[48:49], v[240:241], v[112:113]
    v_pk_fma_f32 v[128:129], v[48:49], v[242:243], v[128:129]
    v_pk_fma_f32 v[112:113], v[64:65], v[242:243], v[112:113]
    v_pk_fma_f32 v[128:129], v[64:65], v[240:241], v[128:129] neg_lo:[1,0,0] neg_hi:[1,0,0]
    v_lshlrev_b32 v244, 16, v178
    v_lshlrev_b32 v245, 16, v179
    v_and_b32 v246, 0xffff0000, v178
    v_and_b32 v247, 0xffff0000, v179
    v_pk_fma_f32 v[114:115], v[50:51], v[244:245], v[114:115]
    v_pk_fma_f32 v[130:131], v[50:51], v[246:247], v[130:131]
    v_pk_fma_f32 v[114:115], v[66:67], v[246:247], v[114:115]
    v_pk_fma_f32 v[130:131], v[66:67], v[244:245], v[130:131] neg_lo:[1,0,0] neg_hi:[1,0,0]
    ds_read_b128 v[176:179], v10 offset:43008
    s_waitcnt lgkmcnt(7)
    v_lshlrev_b32 v240, 16, v192
    v_lshlrev_b32 v241, 16, v193
    v_and_b32 v242, 0xffff0000, v192
    v_and_b32 v243, 0xffff0000, v193
    v_pk_fma_f32 v[116:117], v[52:53], v[240:241], v[116:117]
    v_pk_fma_f32 v[132:133], v[52:53], v[242:243], v[132:133]
    v_pk_fma_f32 v[116:117], v[68:69], v[242:243], v[116:117]
    v_pk_fma_f32 v[132:133], v[68:69], v[240:241], v[132:133] neg_lo:[1,0,0] neg_hi:[1,0,0]
    v_lshlrev_b32 v244, 16, v194
    v_lshlrev_b32 v245, 16, v195
    v_and_b32 v246, 0xffff0000, v194
    v_and_b32 v247, 0xffff0000, v195
    v_pk_fma_f32 v[118:119], v[54:55], v[244:245], v[118:119]
    v_pk_fma_f32 v[134:135], v[54:55], v[246:247], v[134:135]
    v_pk_fma_f32 v[118:119], v[70:71], v[246:247], v[118:119]
    v_pk_fma_f32 v[134:135], v[70:71], v[244:245], v[134:135] neg_lo:[1,0,0] neg_hi:[1,0,0]
    ds_read_b128 v[192:195], v10 offset:44032
    s_waitcnt lgkmcnt(7)
    v_lshlrev_b32 v240, 16, v180
    v_lshlrev_b32 v241, 16, v181
    v_and_b32 v242, 0xffff0000, v180
    v_and_b32 v243, 0xffff0000, v181
    v_pk_fma_f32 v[120:121], v[56:57], v[240:241], v[120:121]
    v_pk_fma_f32 v[136:137], v[56:57], v[242:243], v[136:137]
    v_pk_fma_f32 v[120:121], v[72:73], v[242:243], v[120:121]
    v_pk_fma_f32 v[136:137], v[72:73], v[240:241], v[136:137] neg_lo:[1,0,0] neg_hi:[1,0,0]
    v_lshlrev_b32 v244, 16, v182
    v_lshlrev_b32 v245, 16, v183
    v_and_b32 v246, 0xffff0000, v182
    v_and_b32 v247, 0xffff0000, v183
    v_pk_fma_f32 v[122:123], v[58:59], v[244:245], v[122:123]
    v_pk_fma_f32 v[138:139], v[58:59], v[246:247], v[138:139]
    v_pk_fma_f32 v[122:123], v[74:75], v[246:247], v[122:123]
    v_pk_fma_f32 v[138:139], v[74:75], v[244:245], v[138:139] neg_lo:[1,0,0] neg_hi:[1,0,0]
    ds_read_b128 v[180:183], v10 offset:45056
    s_waitcnt lgkmcnt(7)
    v_lshlrev_b32 v240, 16, v196
    v_lshlrev_b32 v241, 16, v197
    v_and_b32 v242, 0xffff0000, v196
    v_and_b32 v243, 0xffff0000, v197
    v_pk_fma_f32 v[124:125], v[60:61], v[240:241], v[124:125]
    v_pk_fma_f32 v[140:141], v[60:61], v[242:243], v[140:141]
    v_pk_fma_f32 v[124:125], v[76:77], v[242:243], v[124:125]
    v_pk_fma_f32 v[140:141], v[76:77], v[240:241], v[140:141] neg_lo:[1,0,0] neg_hi:[1,0,0]
    v_lshlrev_b32 v244, 16, v198
    v_lshlrev_b32 v245, 16, v199
    v_and_b32 v246, 0xffff0000, v198
    v_and_b32 v247, 0xffff0000, v199
    v_pk_fma_f32 v[126:127], v[62:63], v[244:245], v[126:127]
    v_pk_fma_f32 v[142:143], v[62:63], v[246:247], v[142:143]
    v_pk_fma_f32 v[126:127], v[78:79], v[246:247], v[126:127]
    v_pk_fma_f32 v[142:143], v[78:79], v[244:245], v[142:143] neg_lo:[1,0,0] neg_hi:[1,0,0]
    ds_read_b128 v[196:199], v10 offset:46080
    s_waitcnt lgkmcnt(7)
    v_lshlrev_b32 v240, 16, v184
    v_lshlrev_b32 v241, 16, v185
    v_and_b32 v242, 0xffff0000, v184
    v_and_b32 v243, 0xffff0000, v185
    v_pk_fma_f32 v[144:145], v[80:81], v[240:241], v[144:145]
    v_pk_fma_f32 v[160:161], v[80:81], v[242:243], v[160:161]
    v_pk_fma_f32 v[144:145], v[96:97], v[242:243], v[144:145]
    v_pk_fma_f32 v[160:161], v[96:97], v[240:241], v[160:161] neg_lo:[1,0,0] neg_hi:[1,0,0]
    v_lshlrev_b32 v244, 16, v186
    v_lshlrev_b32 v245, 16, v187
    v_and_b32 v246, 0xffff0000, v186
    v_and_b32 v247, 0xffff0000, v187
    v_pk_fma_f32 v[146:147], v[82:83], v[244:245], v[146:147]
    v_pk_fma_f32 v[162:163], v[82:83], v[246:247], v[162:163]
    v_pk_fma_f32 v[146:147], v[98:99], v[246:247], v[146:147]
    v_pk_fma_f32 v[162:163], v[98:99], v[244:245], v[162:163] neg_lo:[1,0,0] neg_hi:[1,0,0]
    ds_read_b128 v[184:187], v10 offset:47104
    s_waitcnt lgkmcnt(7)
    v_lshlrev_b32 v240, 16, v200
    v_lshlrev_b32 v241, 16, v201
    v_and_b32 v242, 0xffff0000, v200
    v_and_b32 v243, 0xffff0000, v201
    v_pk_fma_f32 v[148:149], v[84:85], v[240:241], v[148:149]
    v_pk_fma_f32 v[164:165], v[84:85], v[242:243], v[164:165]
    v_pk_fma_f32 v[148:149], v[100:101], v[242:243], v[148:149]
    v_pk_fma_f32 v[164:165], v[100:101], v[240:241], v[164:165] neg_lo:[1,0,0] neg_hi:[1,0,0]
    v_lshlrev_b32 v244, 16, v202
    v_lshlrev_b32 v245, 16, v203
    v_and_b32 v246, 0xffff0000, v202
    v_and_b32 v247, 0xffff0000, v203
    v_pk_fma_f32 v[150:151], v[86:87], v[244:245], v[150:151]
    v_pk_fma_f32 v[166:167], v[86:87], v[246:247], v[166:167]
    v_pk_fma_f32 v[150:151], v[102:103], v[246:247], v[150:151]
    v_pk_fma_f32 v[166:167], v[102:103], v[244:245], v[166:167] neg_lo:[1,0,0] neg_hi:[1,0,0]
    ds_read_b128 v[200:203], v10 offset:48128
    s_waitcnt lgkmcnt(7)
    v_lshlrev_b32 v240, 16, v188
    v_lshlrev_b32 v241, 16, v189
    v_and_b32 v242, 0xffff0000, v188
    v_and_b32 v243, 0xffff0000, v189
    v_pk_fma_f32 v[152:153], v[88:89], v[240:241], v[152:153]
    v_pk_fma_f32 v[168:169], v[88:89], v[242:243], v[168:169]
    v_pk_fma_f32 v[152:153], v[104:105], v[242:243], v[152:153]
    v_pk_fma_f32 v[168:169], v[104:105], v[240:241], v[168:169] neg_lo:[1,0,0] neg_hi:[1,0,0]
    v_lshlrev_b32 v244, 16, v190
    v_lshlrev_b32 v245, 16, v191
    v_and_b32 v246, 0xffff0000, v190
    v_and_b32 v247, 0xffff0000, v191
    v_pk_fma_f32 v[154:155], v[90:91], v[244:245], v[154:155]
    v_pk_fma_f32 v[170:171], v[90:91], v[246:247], v[170:171]
    v_pk_fma_f32 v[154:155], v[106:107], v[246:247], v[154:155]
    v_pk_fma_f32 v[170:171], v[106:107], v[244:245], v[170:171] neg_lo:[1,0,0] neg_hi:[1,0,0]
    ds_read_b128 v[188:191], v10 offset:49152
    s_waitcnt lgkmcnt(7)
    v_lshlrev_b32 v240, 16, v204
    v_lshlrev_b32 v241, 16, v205
    v_and_b32 v242, 0xffff0000, v204
    v_and_b32 v243, 0xffff0000, v205
    v_pk_fma_f32 v[156:157], v[92:93], v[240:241], v[156:157]
    v_pk_fma_f32 v[172:173], v[92:93], v[242:243], v[172:173]
    v_pk_fma_f32 v[156:157], v[108:109], v[242:243], v[156:157]
    v_pk_fma_f32 v[172:173], v[108:109], v[240:241], v[172:173] neg_lo:[1,0,0] neg_hi:[1,0,0]
    v_lshlrev_b32 v244, 16, v206
    v_lshlrev_b32 v245, 16, v207
    v_and_b32 v246, 0xffff0000, v206
    v_and_b32 v247, 0xffff0000, v207
    v_pk_fma_f32 v[158:159], v[94:95], v[244:245], v[158:159]
    v_pk_fma_f32 v[174:175], v[94:95], v[246:247], v[174:175]
    v_pk_fma_f32 v[158:159], v[110:111], v[246:247], v[158:159]
    v_pk_fma_f32 v[174:175], v[110:111], v[244:245], v[174:175] neg_lo:[1,0,0] neg_hi:[1,0,0]
    ds_read_b128 v[204:207], v10 offset:50176
    v_cvt_pk_bf16_f32 v16, v112, v113
    v_cvt_pk_bf16_f32 v17, v114, v115
    v_cvt_pk_bf16_f32 v18, v116, v117
    v_cvt_pk_bf16_f32 v19, v118, v119
    v_cvt_pk_bf16_f32 v24, v128, v129
    v_cvt_pk_bf16_f32 v25, v130, v131
    v_cvt_pk_bf16_f32 v26, v132, v133
    v_cvt_pk_bf16_f32 v27, v134, v135
    v_cvt_pk_bf16_f32 v20, v120, v121
    v_cvt_pk_bf16_f32 v21, v122, v123
    v_cvt_pk_bf16_f32 v22, v124, v125
    v_cvt_pk_bf16_f32 v23, v126, v127
    v_cvt_pk_bf16_f32 v28, v136, v137
    v_cvt_pk_bf16_f32 v29, v138, v139
    v_cvt_pk_bf16_f32 v30, v140, v141
    v_cvt_pk_bf16_f32 v31, v142, v143
    v_cvt_pk_bf16_f32 v32, v144, v145
    v_cvt_pk_bf16_f32 v33, v146, v147
    v_cvt_pk_bf16_f32 v34, v148, v149
    v_cvt_pk_bf16_f32 v35, v150, v151
    v_cvt_pk_bf16_f32 v40, v160, v161
    v_cvt_pk_bf16_f32 v41, v162, v163
    v_cvt_pk_bf16_f32 v42, v164, v165
    v_cvt_pk_bf16_f32 v43, v166, v167
    v_cvt_pk_bf16_f32 v36, v152, v153
    v_cvt_pk_bf16_f32 v37, v154, v155
    v_cvt_pk_bf16_f32 v38, v156, v157
    v_cvt_pk_bf16_f32 v39, v158, v159
    v_cvt_pk_bf16_f32 v44, v168, v169
    v_cvt_pk_bf16_f32 v45, v170, v171
    v_cvt_pk_bf16_f32 v46, v172, v173
    v_cvt_pk_bf16_f32 v47, v174, v175
    v_mfma_f32_32x32x16_bf16 v[48:63], v[16:19], v[208:211], 0
    v_mfma_f32_32x32x16_bf16 v[64:79], v[16:19], v[212:215], 0
    v_mfma_f32_32x32x16_bf16 v[48:63], v[24:27], v[216:219], v[48:63]
    v_mfma_f32_32x32x16_bf16 v[64:79], v[24:27], v[208:211], v[64:79]
    ds_read_b128 v[208:211], v10 offset:20480
    ds_read_b128 v[212:215], v10 offset:22528
    ds_read_b128 v[216:219], v10 offset:24576
    v_mfma_f32_32x32x16_bf16 v[48:63], v[20:23], v[220:223], v[48:63]
    v_mfma_f32_32x32x16_bf16 v[64:79], v[20:23], v[224:227], v[64:79]
    v_mfma_f32_32x32x16_bf16 v[48:63], v[28:31], v[228:231], v[48:63]
    v_mfma_f32_32x32x16_bf16 v[64:79], v[28:31], v[220:223], v[64:79]
    ds_read_b128 v[220:223], v10 offset:21504
    ds_read_b128 v[224:227], v10 offset:23552
    ds_read_b128 v[228:231], v10 offset:25600
    s_waitcnt lgkmcnt(5)
    v_mfma_f32_32x32x16_bf16 v[80:95], v[32:35], v[208:211], 0
    s_waitcnt lgkmcnt(4)
    v_mfma_f32_32x32x16_bf16 v[96:111], v[32:35], v[212:215], 0
    s_waitcnt lgkmcnt(3)
    v_mfma_f32_32x32x16_bf16 v[80:95], v[40:43], v[216:219], v[80:95]
    v_mfma_f32_32x32x16_bf16 v[96:111], v[40:43], v[208:211], v[96:111]
    ds_read_b128 v[208:211], v10 offset:8192
    ds_read_b128 v[212:215], v10 offset:10240
    ds_read_b128 v[216:219], v10 offset:12288
    s_waitcnt lgkmcnt(5)
    v_mfma_f32_32x32x16_bf16 v[80:95], v[36:39], v[220:223], v[80:95]
    s_waitcnt lgkmcnt(4)
    v_mfma_f32_32x32x16_bf16 v[96:111], v[36:39], v[224:227], v[96:111]
    s_waitcnt lgkmcnt(3)
    v_mfma_f32_32x32x16_bf16 v[80:95], v[44:47], v[228:231], v[80:95]
    v_mfma_f32_32x32x16_bf16 v[96:111], v[44:47], v[220:223], v[96:111]
    ds_read_b128 v[220:223], v10 offset:14336
    ds_read_b128 v[224:227], v10 offset:16384
    ds_read_b128 v[228:231], v10 offset:18432
    s_waitcnt lgkmcnt(0)
    s_nop 7
L_fjoin:
    v_pk_mul_f32 v[240:241], v[48:49], v[176:177]
    v_pk_mul_f32 v[242:243], v[64:65], v[176:177]
    v_pk_fma_f32 v[240:241], v[64:65], v[178:179], v[240:241] neg_lo:[1,0,0] neg_hi:[1,0,0]
    v_pk_fma_f32 v[242:243], v[48:49], v[178:179], v[242:243]
    v_pk_fma_f32 v[48:49], v[80:81], v[176:177], v[240:241]
    v_pk_fma_f32 v[64:65], v[96:97], v[176:177], v[242:243]
    v_pk_fma_f32 v[48:49], v[96:97], v[178:179], v[48:49] neg_lo:[1,0,0] neg_hi:[1,0,0]
    v_pk_fma_f32 v[64:65], v[80:81], v[178:179], v[64:65]
    v_pk_fma_f32 v[80:81], v[240:241], v[254:255], v[48:49] neg_lo:[0,0,1] neg_hi:[0,0,1]
    v_pk_fma_f32 v[96:97], v[242:243], v[254:255], v[64:65] neg_lo:[0,0,1] neg_hi:[0,0,1]
    v_cvt_pk_bf16_f32 v16, v48, v49
    v_cvt_pk_bf16_f32 v24, v64, v65
    v_cvt_pk_bf16_f32 v32, v80, v81
    v_cvt_pk_bf16_f32 v40, v96, v97
    v_pk_mul_f32 v[244:245], v[50:51], v[192:193]
    v_pk_mul_f32 v[246:247], v[66:67], v[192:193]
    v_pk_fma_f32 v[244:245], v[66:67], v[194:195], v[244:245] neg_lo:[1,0,0] neg_hi:[1,0,0]
    v_pk_fma_f32 v[246:247], v[50:51], v[194:195], v[246:247]
    v_pk_fma_f32 v[50:51], v[82:83], v[192:193], v[244:245]
    v_pk_fma_f32 v[66:67], v[98:99], v[192:193], v[246:247]
    v_pk_fma_f32 v[50:51], v[98:99], v[194:195], v[50:51] neg_lo:[1,0,0] neg_hi:[1,0,0]
    v_pk_fma_f32 v[66:67], v[82:83], v[194:195], v[66:67]
    v_pk_fma_f32 v[82:83], v[244:245], v[254:255], v[50:51] neg_lo:[0,0,1] neg_hi:[0,0,1]
    v_pk_fma_f32 v[98:99], v[246:247], v[254:255], v[66:67] neg_lo:[0,0,1] neg_hi:[0,0,1]
    v_cvt_pk_bf16_f32 v17, v50, v51
    v_cvt_pk_bf16_f32 v25, v66, v67
    v_cvt_pk_bf16_f32 v33, v82, v83
    v_cvt_pk_bf16_f32 v41, v98, v99
    v_pk_mul_f32 v[240:241], v[52:53], v[180:181]
    v_pk_mul_f32 v[242:243], v[68:69], v[180:181]
    v_pk_fma_f32 v[240:241], v[68:69], v[182:183], v[240:241] neg_lo:[1,0,0] neg_hi:[1,0,0]
    v_pk_fma_f32 v[242:243], v[52:53], v[182:183], v[242:243]
    v_pk_fma_f32 v[52:53], v[84:85], v[180:181], v[240:241]
    v_pk_fma_f32 v[68:69], v[100:101], v[180:181], v[242:243]
    v_pk_fma_f32 v[52:53], v[100:101], v[182:183], v[52:53] neg_lo:[1,0,0] neg_hi:[1,0,0]
    v_pk_fma_f32 v[68:69], v[84:85], v[182:183], v[68:69]
    v_pk_fma_f32 v[84:85], v[240:241], v[254:255], v[52:53] neg_lo:[0,0,1] neg_hi:[0,0,1]
    v_pk_fma_f32 v[100:101], v[242:243], v[254:255], v[68:69] neg_lo:[0,0,1] neg_hi:[0,0,1]
    v_cvt_pk_bf16_f32 v18, v52, v53
    v_cvt_pk_bf16_f32 v26, v68, v69
    v_cvt_pk_bf16_f32 v34, v84, v85
    v_cvt_pk_bf16_f32 v42, v100, v101
    v_pk_mul_f32 v[244:245], v[54:55], v[196:197]
    v_pk_mul_f32 v[246:247], v[70:71], v[196:197]
    v_pk_fma_f32 v[244:245], v[70:71], v[198:199], v[244:245] neg_lo:[1,0,0] neg_hi:[1,0,0]
    v_pk_fma_f32 v[246:247], v[54:55], v[198:199], v[246:247]
    v_pk_fma_f32 v[54:55], v[86:87], v[196:197], v[244:245]
    v_pk_fma_f32 v[70:71], v[102:103], v[196:197], v[246:247]
    v_pk_fma_f32 v[54:55], v[102:103], v[198:199], v[54:55] neg_lo:[1,0,0] neg_hi:[1,0,0]
    v_pk_fma_f32 v[70:71], v[86:87], v[198:199], v[70:71]
    v_pk_fma_f32 v[86:87], v[244:245], v[254:255], v[54:55] neg_lo:[0,0,1] neg_hi:[0,0,1]
    v_pk_fma_f32 v[102:103], v[246:247], v[254:255], v[70:71] neg_lo:[0,0,1] neg_hi:[0,0,1]
    v_cvt_pk_bf16_f32 v19, v54, v55
    v_cvt_pk_bf16_f32 v27, v70, v71
    v_cvt_pk_bf16_f32 v35, v86, v87
    v_cvt_pk_bf16_f32 v43, v102, v103
    v_mfma_f32_32x32x16_bf16 v[112:127], v[208:211], v[16:19], 0
    v_pk_mul_f32 v[240:241], v[56:57], v[184:185]
    v_pk_mul_f32 v[242:243], v[72:73], v[184:185]
    v_pk_fma_f32 v[240:241], v[72:73], v[186:187], v[240:241] neg_lo:[1,0,0] neg_hi:[1,0,0]
    v_pk_fma_f32 v[242:243], v[56:57], v[186:187], v[242:243]
    v_pk_fma_f32 v[56:57], v[88:89], v[184:185], v[240:241]
    v_pk_fma_f32 v[72:73], v[104:105], v[184:185], v[242:243]
    v_pk_fma_f32 v[56:57], v[104:105], v[186:187], v[56:57] neg_lo:[1,0,0] neg_hi:[1,0,0]
    v_mfma_f32_32x32x16_bf16 v[128:143], v[212:215], v[16:19], 0
    v_pk_fma_f32 v[72:73], v[88:89], v[186:187], v[72:73]
    v_pk_fma_f32 v[88:89], v[240:241], v[254:255], v[56:57] neg_lo:[0,0,1] neg_hi:[0,0,1]
    v_pk_fma_f32 v[104:105], v[242:243], v[254:255], v[72:73] neg_lo:[0,0,1] neg_hi:[0,0,1]
    v_cvt_pk_bf16_f32 v20, v56, v57
    v_cvt_pk_bf16_f32 v28, v72, v73
    v_cvt_pk_bf16_f32 v36, v88, v89
    v_cvt_pk_bf16_f32 v44, v104, v105
    v_mfma_f32_32x32x16_bf16 v[112:127], v[216:219], v[24:27], v[112:127]
    v_pk_mul_f32 v[244:245], v[58:59], v[200:201]
    v_pk_mul_f32 v[246:247], v[74:75], v[200:201]
    v_pk_fma_f32 v[244:245], v[74:75], v[202:203], v[244:245] neg_lo:[1,0,0] neg_hi:[1,0,0]
    v_pk_fma_f32 v[246:247], v[58:59], v[202:203], v[246:247]
    v_pk_fma_f32 v[58:59], v[90:91], v[200:201], v[244:245]
    v_pk_fma_f32 v[74:75], v[106:107], v[200:201], v[246:247]
    v_pk_fma_f32 v[58:59], v[106:107], v[202:203], v[58:59] neg_lo:[1,0,0] neg_hi:[1,0,0]
    v_mfma_f32_32x32x16_bf16 v[128:143], v[208:211], v[24:27], v[128:143]
    ds_read_b128 v[208:211], v10 offset:9216
    ds_read_b128 v[212:215], v10 offset:11264
    ds_read_b128 v[216:219], v10 offset:13312
    v_pk_fma_f32 v[74:75], v[90:91], v[202:203], v[74:75]
    v_pk_fma_f32 v[90:91], v[244:245], v[254:255], v[58:59] neg_lo:[0,0,1] neg_hi:[0,0,1]
    v_pk_fma_f32 v[106:107], v[246:247], v[254:255], v[74:75] neg_lo:[0,0,1] neg_hi:[0,0,1]
    v_cvt_pk_bf16_f32 v21, v58, v59
    v_cvt_pk_bf16_f32 v29, v74, v75
    v_cvt_pk_bf16_f32 v37, v90, v91
    v_cvt_pk_bf16_f32 v45, v106, v107
    v_mfma_f32_32x32x16_bf16 v[144:159], v[220:223], v[32:35], 0
    v_pk_mul_f32 v[240:241], v[60:61], v[188:189]
    v_pk_mul_f32 v[242:243], v[76:77], v[188:189]
    v_pk_fma_f32 v[240:241], v[76:77], v[190:191], v[240:241] neg_lo:[1,0,0] neg_hi:[1,0,0]
    v_pk_fma_f32 v[242:243], v[60:61], v[190:191], v[242:243]
    v_pk_fma_f32 v[60:61], v[92:93], v[188:189], v[240:241]
    v_pk_fma_f32 v[76:77], v[108:109], v[188:189], v[242:243]
    v_pk_fma_f32 v[60:61], v[108:109], v[190:191], v[60:61] neg_lo:[1,0,0] neg_hi:[1,0,0]
    v_mfma_f32_32x32x16_bf16 v[160:175], v[224:227], v[32:35], 0
    v_pk_fma_f32 v[76:77], v[92:93], v[190:191], v[76:77]
    v_pk_fma_f32 v[92:93], v[240:241], v[254:255], v[60:61] neg_lo:[0,0,1] neg_hi:[0,0,1]
    v_pk_fma_f32 v[108:109], v[242:243], v[254:255], v[76:77] neg_lo:[0,0,1] neg_hi:[0,0,1]
    v_cvt_pk_bf16_f32 v22, v60, v61
    v_cvt_pk_bf16_f32 v30, v76, v77
    v_cvt_pk_bf16_f32 v38, v92, v93
    v_cvt_pk_bf16_f32 v46, v108, v109
    v_mfma_f32_32x32x16_bf16 v[144:159], v[228:231], v[40:43], v[144:159]
    v_pk_mul_f32 v[244:245], v[62:63], v[204:205]
    v_pk_mul_f32 v[246:247], v[78:79], v[204:205]
    v_pk_fma_f32 v[244:245], v[78:79], v[206:207], v[244:245] neg_lo:[1,0,0] neg_hi:[1,0,0]
    v_pk_fma_f32 v[246:247], v[62:63], v[206:207], v[246:247]
    v_pk_fma_f32 v[62:63], v[94:95], v[204:205], v[244:245]
    v_pk_fma_f32 v[78:79], v[110:111], v[204:205], v[246:247]
    v_pk_fma_f32 v[62:63], v[110:111], v[206:207], v[62:63] neg_lo:[1,0,0] neg_hi:[1,0,0]
    v_mfma_f32_32x32x16_bf16 v[160:175], v[220:223], v[40:43], v[160:175]
    ds_read_b128 v[220:223], v10 offset:15360
    ds_read_b128 v[224:227], v10 offset:17408
    ds_read_b128 v[228:231], v10 offset:19456
    v_pk_fma_f32 v[78:79], v[94:95], v[206:207], v[78:79]
    v_pk_fma_f32 v[94:95], v[244:245], v[254:255], v[62:63] neg_lo:[0,0,1] neg_hi:[0,0,1]
    v_pk_fma_f32 v[110:111], v[246:247], v[254:255], v[78:79] neg_lo:[0,0,1] neg_hi:[0,0,1]
    v_cvt_pk_bf16_f32 v23, v62, v63
    v_cvt_pk_bf16_f32 v31, v78, v79
    v_cvt_pk_bf16_f32 v39, v94, v95
    v_cvt_pk_bf16_f32 v47, v110, v111
    v_add_u32 v15, 128, v11
    s_waitcnt lgkmcnt(5)
    v_mfma_f32_32x32x16_bf16 v[112:127], v[208:211], v[20:23], v[112:127]
    s_waitcnt lgkmcnt(4)
    v_mfma_f32_32x32x16_bf16 v[128:143], v[212:215], v[20:23], v[128:143]
    s_waitcnt lgkmcnt(3)
    v_mfma_f32_32x32x16_bf16 v[112:127], v[216:219], v[28:31], v[112:127]
    v_mfma_f32_32x32x16_bf16 v[128:143], v[208:211], v[28:31], v[128:143]
    s_waitcnt lgkmcnt(2)
    v_mfma_f32_32x32x16_bf16 v[144:159], v[220:223], v[36:39], v[144:159]
    s_nop 9
    v_cvt_pk_bf16_f32 v240, v112, v128
    v_cvt_pk_bf16_f32 v241, v113, v129
    ds_write2st64_b32 v11, v240, v241 offset0:0 offset1:1
    s_waitcnt lgkmcnt(2)
    v_mfma_f32_32x32x16_bf16 v[160:175], v[224:227], v[36:39], v[160:175]
    v_cvt_pk_bf16_f32 v242, v114, v130
    v_cvt_pk_bf16_f32 v243, v115, v131
    ds_write2st64_b32 v11, v242, v243 offset0:2 offset1:3
    s_waitcnt lgkmcnt(2)
    v_mfma_f32_32x32x16_bf16 v[144:159], v[228:231], v[44:47], v[144:159]
    v_cvt_pk_bf16_f32 v244, v116, v132
    v_cvt_pk_bf16_f32 v245, v117, v133
    ds_write2st64_b32 v11, v244, v245 offset0:8 offset1:9
    v_mfma_f32_32x32x16_bf16 v[160:175], v[220:223], v[44:47], v[160:175]
    v_cvt_pk_bf16_f32 v246, v118, v134
    v_cvt_pk_bf16_f32 v247, v119, v135
    ds_write2st64_b32 v11, v246, v247 offset0:10 offset1:11
    v_cvt_pk_bf16_f32 v240, v120, v136
    v_cvt_pk_bf16_f32 v241, v121, v137
    ds_write2st64_b32 v11, v240, v241 offset0:16 offset1:17
    v_cvt_pk_bf16_f32 v242, v122, v138
    v_cvt_pk_bf16_f32 v243, v123, v139
    ds_write2st64_b32 v11, v242, v243 offset0:18 offset1:19
    v_cvt_pk_bf16_f32 v244, v124, v140
    v_cvt_pk_bf16_f32 v245, v125, v141
    ds_write2st64_b32 v11, v244, v245 offset0:24 offset1:25
    v_cvt_pk_bf16_f32 v246, v126, v142
    v_cvt_pk_bf16_f32 v247, v127, v143
    ds_write2st64_b32 v11, v246, v247 offset0:26 offset1:27
    v_cvt_pk_bf16_f32 v240, v144, v160
    v_cvt_pk_bf16_f32 v241, v145, v161
    ds_write2st64_b32 v15, v240, v241 offset0:0 offset1:1
    v_cvt_pk_bf16_f32 v242, v146, v162
    v_cvt_pk_bf16_f32 v243, v147, v163
    ds_write2st64_b32 v15, v242, v243 offset0:2 offset1:3
    v_cvt_pk_bf16_f32 v244, v148, v164
    v_cvt_pk_bf16_f32 v245, v149, v165
    ds_write2st64_b32 v15, v244, v245 offset0:8 offset1:9
    v_cvt_pk_bf16_f32 v246, v150, v166
    v_cvt_pk_bf16_f32 v247, v151, v167
    ds_write2st64_b32 v15, v246, v247 offset0:10 offset1:11
    v_cvt_pk_bf16_f32 v240, v152, v168
    v_cvt_pk_bf16_f32 v241, v153, v169
    ds_write2st64_b32 v15, v240, v241 offset0:16 offset1:17
    v_cvt_pk_bf16_f32 v242, v154, v170
    v_cvt_pk_bf16_f32 v243, v155, v171
    ds_write2st64_b32 v15, v242, v243 offset0:18 offset1:19
    v_cvt_pk_bf16_f32 v244, v156, v172
    v_cvt_pk_bf16_f32 v245, v157, v173
    ds_write2st64_b32 v15, v244, v245 offset0:24 offset1:25
    v_cvt_pk_bf16_f32 v246, v158, v174
    v_cvt_pk_bf16_f32 v247, v159, v175
    ds_write2st64_b32 v15, v246, v247 offset0:26 offset1:27
    s_waitcnt lgkmcnt(0)
    s_lshr_b32 s69, s48, 2
    s_lshl_b32 s70, s69, 2
    s_add_u32 s70, s70, 163792
    v_mov_b32 v12, s70
    v_mov_b32 v13, 1
    s_mov_b64 exec, 1
    ds_add_u32 v12, v13
    s_mov_b64 exec, -1
    v_and_b32 v14, 255, v0
    s_lshl_b32 s70, s69, 15
    v_lshlrev_b32 v15, 4, v14
    v_lshlrev_b32 v14, 2, v14
    v_add_u32 v14, s70, v14
    s_lshl_b32 s68, s62, 16
    s_add_u32 s68, s68, s70
    s_add_u32 s68, s68, 9437184
    s_setprio 3
    s_mov_b32 s79, 200000
    s_waitcnt lgkmcnt(0)
L_wc_44:
    ds_read_b32 v13, v12
    s_waitcnt lgkmcnt(0)
    v_readfirstlane_b32 s78, v13
    s_nop 0
    s_cmp_ge_u32 s78, 4
    s_cbranch_scc1 L_wcd_45
    s_sub_u32 s79, s79, 1
    s_cbranch_scc1 L_wcd_45
    s_branch L_wc_44
L_wcd_45:
    ds_read2st64_b32 v[64:65], v14 offset0:0 offset1:32
    ds_read2st64_b32 v[66:67], v14 offset0:64 offset1:96
    ds_read2st64_b32 v[68:69], v14 offset0:4 offset1:36
    ds_read2st64_b32 v[70:71], v14 offset0:68 offset1:100
    ds_read2st64_b32 v[72:73], v14 offset0:8 offset1:40
    ds_read2st64_b32 v[74:75], v14 offset0:72 offset1:104
    ds_read2st64_b32 v[76:77], v14 offset0:12 offset1:44
    ds_read2st64_b32 v[78:79], v14 offset0:76 offset1:108
    ds_read2st64_b32 v[80:81], v14 offset0:16 offset1:48
    ds_read2st64_b32 v[82:83], v14 offset0:80 offset1:112
    ds_read2st64_b32 v[84:85], v14 offset0:20 offset1:52
    ds_read2st64_b32 v[86:87], v14 offset0:84 offset1:116
    ds_read2st64_b32 v[88:89], v14 offset0:24 offset1:56
    ds_read2st64_b32 v[90:91], v14 offset0:88 offset1:120
    ds_read2st64_b32 v[92:93], v14 offset0:28 offset1:60
    ds_read2st64_b32 v[94:95], v14 offset0:92 offset1:124
    s_waitcnt lgkmcnt(14)
    buffer_store_dwordx4 v[64:67], v15, s[24:27], s68 offen sc1
    s_add_u32 s68, s68, 4096
    s_waitcnt lgkmcnt(12)
    buffer_store_dwordx4 v[68:71], v15, s[24:27], s68 offen sc1
    s_add_u32 s68, s68, 4096
    s_waitcnt lgkmcnt(10)
    buffer_store_dwordx4 v[72:75], v15, s[24:27], s68 offen sc1
    s_add_u32 s68, s68, 4096
    s_waitcnt lgkmcnt(8)
    buffer_store_dwordx4 v[76:79], v15, s[24:27], s68 offen sc1
    s_add_u32 s68, s68, 4096
    s_waitcnt lgkmcnt(6)
    buffer_store_dwordx4 v[80:83], v15, s[24:27], s68 offen sc1
    s_add_u32 s68, s68, 4096
    s_waitcnt lgkmcnt(4)
    buffer_store_dwordx4 v[84:87], v15, s[24:27], s68 offen sc1
    s_add_u32 s68, s68, 4096
    s_waitcnt lgkmcnt(2)
    buffer_store_dwordx4 v[88:91], v15, s[24:27], s68 offen sc1
    s_add_u32 s68, s68, 4096
    s_waitcnt lgkmcnt(0)
    buffer_store_dwordx4 v[92:95], v15, s[24:27], s68 offen sc1
    s_setprio 0
    v_mov_b32 v12, 163800
    v_mov_b32 v13, 1
    s_mov_b64 exec, 1
    ds_add_u32 v12, v13
    s_mov_b64 exec, -1
    s_lshl_b32 s72, s62, 6
    s_add_u32 s72, s72, 32768
    s_nop 0
    v_lshrrev_b32 v12, 3, v2
    s_mov_b32 s79, 4096
    v_mul_lo_u32 v14, v12, s79
    v_bfe_u32 v12, v2, 1, 2
    v_bfe_u32 v13, v2, 4, 1
    v_xor_b32 v12, v12, v13
    v_lshl_add_u32 v14, v12, 5, v14
    v_and_b32 v12, 1, v2
    v_lshl_add_u32 v14, v12, 4, v14
    v_xor_b32 v15, 64, v14
    s_and_b32 s76, s48, 3
    s_lshl_b32 s58, s76, 15
    s_mul_i32 s63, s76, 1835008
    s_lshl_b32 s76, s57, 7
    s_add_u32 s63, s63, s76
    s_and_b32 s77, s57, 3
    s_lshl_b32 s77, s77, 1
    s_and_b32 s76, s56, 7
    s_mul_i32 s76, s76, 0
    s_add_u32 s77, s77, s76
    s_mul_i32 s77, s77, 0
    s_lshr_b32 s77, s77, 2
    s_sub_u32 s76, s77, 14
    s_min_u32 s77, s77, s76
    s_cmp_ge_u32 s48, 4
    s_cbranch_scc1 L_fhelp
    s_lshl_b32 s58, s48, 15
    v_lshrrev_b32 v12, 3, v2
    s_mov_b32 s79, 4096
    v_mul_lo_u32 v4, v12, s79
    v_bfe_u32 v12, v2, 1, 2
    v_bfe_u32 v13, v2, 4, 1
    v_xor_b32 v12, v12, v13
    v_lshl_add_u32 v4, v12, 5, v4
    v_and_b32 v12, 1, v2
    v_lshl_add_u32 v4, v12, 4, v4
    v_xor_b32 v5, 64, v4
    v_lshrrev_b32 v13, 4, v2
    v_lshlrev_b32 v6, 10, v13
    v_and_b32 v12, 15, v2
    v_lshl_add_u32 v6, v12, 4, v6
    v_lshlrev_b32 v8, 10, v13
    v_bfe_u32 v12, v2, 2, 2
    v_lshl_add_u32 v8, v12, 7, v8
    v_bfe_u32 v12, v2, 3, 2
    v_lshl_add_u32 v8, v12, 5, v8
    v_and_b32 v12, 3, v2
    v_lshl_add_u32 v8, v12, 3, v8
    v_add_u32 v8, s58, v8
    v_xor_b32 v9, 32, v8
    v_xor_b32 v10, 64, v8
    v_xor_b32 v11, 96, v8
    v_add_u32 v7, s58, v3
    s_add_u32 s75, s77, 8
    s_sub_u32 s59, s75, 14
    s_min_u32 s75, s75, s59
    s_mul_i32 s75, s75, 131072
    s_add_u32 s75, s75, s63
    s_add_u32 s59, s75, 0
    buffer_load_dwordx4 v[160:163], v14, s[36:39], s59 offen
    s_add_u32 s59, s75, 32768
    buffer_load_dwordx4 v[164:167], v15, s[36:39], s59 offen
    s_add_u32 s59, s75, 65536
    buffer_load_dwordx4 v[168:171], v14, s[36:39], s59 offen
    s_add_u32 s59, s75, 98304
    buffer_load_dwordx4 v[172:175], v15, s[36:39], s59 offen
    s_add_u32 s75, s77, 9
    s_sub_u32 s59, s75, 14
    s_min_u32 s75, s75, s59
    s_mul_i32 s75, s75, 131072
    s_add_u32 s75, s75, s63
    s_add_u32 s59, s75, 0
    buffer_load_dwordx4 v[176:179], v14, s[36:39], s59 offen
    s_add_u32 s59, s75, 32768
    buffer_load_dwordx4 v[180:183], v15, s[36:39], s59 offen
    s_add_u32 s59, s75, 65536
    buffer_load_dwordx4 v[184:187], v14, s[36:39], s59 offen
    s_add_u32 s59, s75, 98304
    buffer_load_dwordx4 v[188:191], v15, s[36:39], s59 offen
    s_waitcnt vmcnt(8)
    v_mov_b32 v12, 163780
    v_mov_b32 v13, 1
    s_mov_b64 exec, 1
    ds_add_rtn_u32 v13, v12, v13
    s_mov_b64 exec, -1
    s_waitcnt lgkmcnt(0)
    v_readfirstlane_b32 s78, v13
    s_nop 0
    s_cmp_lg_u32 s78, 7
    s_cbranch_scc1 L_arr_46
    s_setprio 3
    v_mov_b32 v13, s51
    v_lshlrev_b32 v12, 17, v2
    v_add_u32 v12, 12582912, v12
    s_mov_b64 exec, 255
    buffer_store_dword v13, v12, s[24:27], s72 offen sc1
    s_mov_b64 exec, -1
    s_setprio 0
    s_nop 0
L_arr_46:
    s_add_u32 s75, s77, 10
    s_sub_u32 s59, s75, 14
    s_min_u32 s75, s75, s59
    s_mul_i32 s75, s75, 131072
    s_add_u32 s75, s75, s63
    s_add_u32 s59, s75, 0
    buffer_load_dwordx4 v[192:195], v14, s[36:39], s59 offen
    s_add_u32 s59, s75, 32768
    buffer_load_dwordx4 v[196:199], v15, s[36:39], s59 offen
    s_add_u32 s59, s75, 65536
    buffer_load_dwordx4 v[200:203], v14, s[36:39], s59 offen
    s_add_u32 s59, s75, 98304
    buffer_load_dwordx4 v[204:207], v15, s[36:39], s59 offen
    s_add_u32 s75, s77, 11
    s_sub_u32 s59, s75, 14
    s_min_u32 s75, s75, s59
    s_mul_i32 s75, s75, 131072
    s_add_u32 s75, s75, s63
    s_add_u32 s59, s75, 0
    buffer_load_dwordx4 v[208:211], v14, s[36:39], s59 offen
    s_add_u32 s59, s75, 32768
    buffer_load_dwordx4 v[212:215], v15, s[36:39], s59 offen
    s_add_u32 s59, s75, 65536
    buffer_load_dwordx4 v[216:219], v14, s[36:39], s59 offen
    s_add_u32 s59, s75, 98304
    buffer_load_dwordx4 v[220:223], v15, s[36:39], s59 offen
    s_add_u32 s75, s77, 12
    s_sub_u32 s59, s75, 14
    s_min_u32 s75, s75, s59
    s_mul_i32 s75, s75, 131072
    s_add_u32 s75, s75, s63
    s_add_u32 s59, s75, 0
    buffer_load_dwordx4 v[224:227], v14, s[36:39], s59 offen
    s_add_u32 s59, s75, 32768
    buffer_load_dwordx4 v[228:231], v15, s[36:39], s59 offen
    s_add_u32 s59, s75, 65536
    buffer_load_dwordx4 v[232:235], v14, s[36:39], s59 offen
    s_add_u32 s59, s75, 98304
    buffer_load_dwordx4 v[236:239], v15, s[36:39], s59 offen
    s_add_u32 s75, s77, 13
    s_sub_u32 s59, s75, 14
    s_min_u32 s75, s75, s59
    s_mul_i32 s75, s75, 131072
    s_add_u32 s75, s75, s63
    s_add_u32 s59, s75, 0
    buffer_load_dwordx4 v[240:243], v14, s[36:39], s59 offen
    s_add_u32 s59, s75, 32768
    buffer_load_dwordx4 v[244:247], v15, s[36:39], s59 offen
    s_add_u32 s59, s75, 65536
    buffer_load_dwordx4 v[248:251], v14, s[36:39], s59 offen
    s_add_u32 s59, s75, 98304
    buffer_load_dwordx4 v[252:255], v15, s[36:39], s59 offen
    v_mov_b32 v12, 163800
    s_mov_b32 s79, 200000
    s_nop 3
L_wc_47:
    ds_read_b32 v13, v12
    s_waitcnt lgkmcnt(0)
    v_readfirstlane_b32 s78, v13
    s_nop 0
    s_cmp_ge_u32 s78, 8
    s_cbranch_scc1 L_wcd_48
    s_sub_u32 s79, s79, 1
    s_cbranch_scc1 L_wcd_48
    s_sleep 2
    s_branch L_wc_47
L_wcd_48:
    s_add_u32 s75, s77, 0
    s_sub_u32 s59, s75, 14
    s_min_u32 s75, s75, s59
    s_mul_i32 s75, s75, 131072
    s_add_u32 s75, s75, s63
    s_add_u32 s59, s75, 0
    s_add_u32 m0, s58, 16384
    s_nop 0
    buffer_load_dwordx4 v14, s[36:39], s59 offen lds
    s_add_u32 s59, s75, 32768
    s_add_u32 m0, s58, 17408
    s_nop 0
    buffer_load_dwordx4 v15, s[36:39], s59 offen lds
    s_add_u32 s59, s75, 65536
    s_add_u32 m0, s58, 18432
    s_nop 0
    buffer_load_dwordx4 v14, s[36:39], s59 offen lds
    s_add_u32 s59, s75, 98304
    s_add_u32 m0, s58, 19456
    s_nop 0
    buffer_load_dwordx4 v15, s[36:39], s59 offen lds
    s_add_u32 s75, s77, 1
    s_sub_u32 s59, s75, 14
    s_min_u32 s75, s75, s59
    s_mul_i32 s75, s75, 131072
    s_add_u32 s75, s75, s63
    s_add_u32 s59, s75, 0
    s_add_u32 m0, s58, 20480
    s_nop 0
    buffer_load_dwordx4 v14, s[36:39], s59 offen lds
    s_add_u32 s59, s75, 32768
    s_add_u32 m0, s58, 21504
    s_nop 0
    buffer_load_dwordx4 v15, s[36:39], s59 offen lds
    s_add_u32 s59, s75, 65536
    s_add_u32 m0, s58, 22528
    s_nop 0
    buffer_load_dwordx4 v14, s[36:39], s59 offen lds
    s_add_u32 s59, s75, 98304
    s_add_u32 m0, s58, 23552
    s_nop 0
    buffer_load_dwordx4 v15, s[36:39], s59 offen lds
    s_add_u32 s75, s77, 2
    s_sub_u32 s59, s75, 14
    s_min_u32 s75, s75, s59
    s_mul_i32 s75, s75, 131072
    s_add_u32 s75, s75, s63
    s_add_u32 s59, s75, 0
    s_add_u32 m0, s58, 24576
    s_nop 0
    buffer_load_dwordx4 v14, s[36:39], s59 offen lds
    s_add_u32 s59, s75, 32768
    s_add_u32 m0, s58, 25600
    s_nop 0
    buffer_load_dwordx4 v15, s[36:39], s59 offen lds
    s_add_u32 s59, s75, 65536
    s_add_u32 m0, s58, 26624
    s_nop 0
    buffer_load_dwordx4 v14, s[36:39], s59 offen lds
    s_add_u32 s59, s75, 98304
    s_add_u32 m0, s58, 27648
    s_nop 0
    buffer_load_dwordx4 v15, s[36:39], s59 offen lds
    s_add_u32 s75, s77, 3
    s_sub_u32 s59, s75, 14
    s_min_u32 s75, s75, s59
    s_mul_i32 s75, s75, 131072
    s_add_u32 s75, s75, s63
    s_add_u32 s59, s75, 0
    s_add_u32 m0, s58, 28672
    s_nop 0
    buffer_load_dwordx4 v14, s[36:39], s59 offen lds
    s_add_u32 s59, s75, 32768
    s_add_u32 m0, s58, 29696
    s_nop 0
    buffer_load_dwordx4 v15, s[36:39], s59 offen lds
    s_add_u32 s59, s75, 65536
    s_add_u32 m0, s58, 30720
    s_nop 0
    buffer_load_dwordx4 v14, s[36:39], s59 offen lds
    s_add_u32 s59, s75, 98304
    s_add_u32 m0, s58, 31744
    s_nop 0
    buffer_load_dwordx4 v15, s[36:39], s59 offen lds
    s_branch L_pub3
L_fhelp:
    s_waitcnt vmcnt(0)
    v_mov_b32 v12, 163780
    v_mov_b32 v13, 1
    s_mov_b64 exec, 1
    ds_add_rtn_u32 v13, v12, v13
    s_mov_b64 exec, -1
    s_waitcnt lgkmcnt(0)
    v_readfirstlane_b32 s78, v13
    s_nop 0
    s_cmp_lg_u32 s78, 7
    s_cbranch_scc1 L_arr_49
    s_setprio 3
    v_mov_b32 v13, s51
    v_lshlrev_b32 v12, 17, v2
    v_add_u32 v12, 12582912, v12
    s_mov_b64 exec, 255
    buffer_store_dword v13, v12, s[24:27], s72 offen sc1
    s_mov_b64 exec, -1
    s_setprio 0
    s_nop 0
L_arr_49:
    s_cmp_lg_u32 s48, 7
    s_nop 0
    s_cbranch_scc1 L_nofg_50
    s_lshr_b32 s62, s57, 4
    s_lshl_b32 s62, s62, 12
    s_add_u32 s62, s62, 12640256
    v_min_u32 v12, 63, v2
    v_lshlrev_b32 v12, 6, v12
    v_add_u32 v12, s6, v12
    s_mov_b32 s79, 50000
    s_nop 3
L_gp_51:
    buffer_load_dword v4, v12, s[24:27], s62 offen sc1
    s_sub_u32 s79, s79, 1
    s_waitcnt vmcnt(0)
L_gpc_53:
    v_cmp_ne_u32 vcc, s51, v4
    s_nop 1
    s_cmp_eq_u64 vcc, 0
    s_cbranch_scc1 L_gpd_52
    s_cmp_eq_u32 s79, 0
    s_cbranch_scc1 L_gpd_52
    s_mov_b64 exec, vcc
    s_sleep 2
    s_branch L_gp_51
L_gpd_52:
    s_mov_b64 exec, -1
L_nofg_50:
    s_barrier
    s_bfe_u32 s70, s48, 0x10001
    s_and_b32 s71, s48, 1
    v_and_b32 v4, 15, v2
    v_lshrrev_b32 v5, 4, v2
    s_lshl_b32 s62, s56, 6
    v_add_u32 v7, s62, v4
    v_cvt_f32_u32 v8, v7
    v_mul_f32 v8, 0x3b000000, v8
    v_add_f32 v9, 0x3d000000, v8
    v_add_f32 v10, 0x3d000000, v9
    v_add_f32 v11, 0x3d000000, v10
    s_lshl_b32 s62, s70, 7
    v_lshlrev_b32 v12, 2, v5
    v_add_u32 v12, s62, v12
    v_cvt_f32_u32 v12, v12
    v_mul_f32 v240, v8, v12
    v_mul_f32 v244, 0x41500000, v8
    v_mul_f32 v241, v9, v12
    v_mul_f32 v245, 0x41500000, v9
    v_mul_f32 v242, v10, v12
    v_mul_f32 v246, 0x41500000, v10
    v_mul_f32 v243, v11, v12
    v_mul_f32 v247, 0x41500000, v11
    v_cos_f32 v248, v240
    v_sin_f32 v249, v240
    v_add_f32 v240, v240, v8
    v_cos_f32 v250, v241
    v_sin_f32 v251, v241
    v_add_f32 v241, v241, v9
    v_cos_f32 v252, v242
    v_sin_f32 v253, v242
    v_add_f32 v242, v242, v10
    v_cos_f32 v254, v243
    v_sin_f32 v255, v243
    v_add_f32 v243, v243, v11
    v_cvt_pk_bf16_f32 v112, v248, -v249
    v_cvt_pk_bf16_f32 v116, v250, -v251
    v_cvt_pk_bf16_f32 v120, v252, -v253
    v_cvt_pk_bf16_f32 v124, v254, -v255
    v_cos_f32 v248, v240
    v_sin_f32 v249, v240
    v_add_f32 v240, v240, v8
    v_cos_f32 v250, v241
    v_sin_f32 v251, v241
    v_add_f32 v241, v241, v9
    v_cos_f32 v252, v242
    v_sin_f32 v253, v242
    v_add_f32 v242, v242, v10
    v_cos_f32 v254, v243
    v_sin_f32 v255, v243
    v_add_f32 v243, v243, v11
    v_cvt_pk_bf16_f32 v113, v248, -v249
    v_cvt_pk_bf16_f32 v117, v250, -v251
    v_cvt_pk_bf16_f32 v121, v252, -v253
    v_cvt_pk_bf16_f32 v125, v254, -v255
    v_cos_f32 v248, v240
    v_sin_f32 v249, v240
    v_add_f32 v240, v240, v8
    v_cos_f32 v250, v241
    v_sin_f32 v251, v241
    v_add_f32 v241, v241, v9
    v_cos_f32 v252, v242
    v_sin_f32 v253, v242
    v_add_f32 v242, v242, v10
    v_cos_f32 v254, v243
    v_sin_f32 v255, v243
    v_add_f32 v243, v243, v11
    v_cvt_pk_bf16_f32 v114, v248, -v249
    v_cvt_pk_bf16_f32 v118, v250, -v251
    v_cvt_pk_bf16_f32 v122, v252, -v253
    v_cvt_pk_bf16_f32 v126, v254, -v255
    v_cos_f32 v248, v240
    v_sin_f32 v249, v240
    v_add_f32 v240, v240, v244
    v_cos_f32 v250, v241
    v_sin_f32 v251, v241
    v_add_f32 v241, v241, v245
    v_cos_f32 v252, v242
    v_sin_f32 v253, v242
    v_add_f32 v242, v242, v246
    v_cos_f32 v254, v243
    v_sin_f32 v255, v243
    v_add_f32 v243, v243, v247
    v_cvt_pk_bf16_f32 v115, v248, -v249
    v_cvt_pk_bf16_f32 v119, v250, -v251
    v_cvt_pk_bf16_f32 v123, v252, -v253
    v_cvt_pk_bf16_f32 v127, v254, -v255
    v_and_b32 v13, 1, v2
    v_lshlrev_b32 v13, 31, v13
    v_or_b32 v13, 0x3f003f00, v13
    s_cmp_eq_u32 s70, 0
    s_cselect_b32 s76, 0xffff, 0
    s_mov_b32 s77, 0
    v_cndmask_b32 v112, v112, v13, s[76:77]
    v_cndmask_b32 v116, v116, v13, s[76:77]
    v_cndmask_b32 v120, v120, v13, s[76:77]
    v_cndmask_b32 v124, v124, v13, s[76:77]
    v_cos_f32 v248, v240
    v_sin_f32 v249, v240
    v_add_f32 v240, v240, v8
    v_cos_f32 v250, v241
    v_sin_f32 v251, v241
    v_add_f32 v241, v241, v9
    v_cos_f32 v252, v242
    v_sin_f32 v253, v242
    v_add_f32 v242, v242, v10
    v_cos_f32 v254, v243
    v_sin_f32 v255, v243
    v_add_f32 v243, v243, v11
    v_cvt_pk_bf16_f32 v128, v248, -v249
    v_cvt_pk_bf16_f32 v132, v250, -v251
    v_cvt_pk_bf16_f32 v136, v252, -v253
    v_cvt_pk_bf16_f32 v140, v254, -v255
    v_cos_f32 v248, v240
    v_sin_f32 v249, v240
    v_add_f32 v240, v240, v8
    v_cos_f32 v250, v241
    v_sin_f32 v251, v241
    v_add_f32 v241, v241, v9
    v_cos_f32 v252, v242
    v_sin_f32 v253, v242
    v_add_f32 v242, v242, v10
    v_cos_f32 v254, v243
    v_sin_f32 v255, v243
    v_add_f32 v243, v243, v11
    v_cvt_pk_bf16_f32 v129, v248, -v249
    v_cvt_pk_bf16_f32 v133, v250, -v251
    v_cvt_pk_bf16_f32 v137, v252, -v253
    v_cvt_pk_bf16_f32 v141, v254, -v255
    v_cos_f32 v248, v240
    v_sin_f32 v249, v240
    v_add_f32 v240, v240, v8
    v_cos_f32 v250, v241
    v_sin_f32 v251, v241
    v_add_f32 v241, v241, v9
    v_cos_f32 v252, v242
    v_sin_f32 v253, v242
    v_add_f32 v242, v242, v10
    v_cos_f32 v254, v243
    v_sin_f32 v255, v243
    v_add_f32 v243, v243, v11
    v_cvt_pk_bf16_f32 v130, v248, -v249
    v_cvt_pk_bf16_f32 v134, v250, -v251
    v_cvt_pk_bf16_f32 v138, v252, -v253
    v_cvt_pk_bf16_f32 v142, v254, -v255
    v_cos_f32 v248, v240
    v_sin_f32 v249, v240
    v_add_f32 v240, v240, v244
    v_cos_f32 v250, v241
    v_sin_f32 v251, v241
    v_add_f32 v241, v241, v245
    v_cos_f32 v252, v242
    v_sin_f32 v253, v242
    v_add_f32 v242, v242, v246
    v_cos_f32 v254, v243
    v_sin_f32 v255, v243
    v_add_f32 v243, v243, v247
    v_cvt_pk_bf16_f32 v131, v248, -v249
    v_cvt_pk_bf16_f32 v135, v250, -v251
    v_cvt_pk_bf16_f32 v139, v252, -v253
    v_cvt_pk_bf16_f32 v143, v254, -v255
    v_cos_f32 v248, v240
    v_sin_f32 v249, v240
    v_add_f32 v240, v240, v8
    v_cos_f32 v250, v241
    v_sin_f32 v251, v241
    v_add_f32 v241, v241, v9
    v_cos_f32 v252, v242
    v_sin_f32 v253, v242
    v_add_f32 v242, v242, v10
    v_cos_f32 v254, v243
    v_sin_f32 v255, v243
    v_add_f32 v243, v243, v11
    v_cvt_pk_bf16_f32 v144, v248, -v249
    v_cvt_pk_bf16_f32 v148, v250, -v251
    v_cvt_pk_bf16_f32 v152, v252, -v253
    v_cvt_pk_bf16_f32 v156, v254, -v255
    v_cos_f32 v248, v240
    v_sin_f32 v249, v240
    v_add_f32 v240, v240, v8
    v_cos_f32 v250, v241
    v_sin_f32 v251, v241
    v_add_f32 v241, v241, v9
    v_cos_f32 v252, v242
    v_sin_f32 v253, v242
    v_add_f32 v242, v242, v10
    v_cos_f32 v254, v243
    v_sin_f32 v255, v243
    v_add_f32 v243, v243, v11
    v_cvt_pk_bf16_f32 v145, v248, -v249
    v_cvt_pk_bf16_f32 v149, v250, -v251
    v_cvt_pk_bf16_f32 v153, v252, -v253
    v_cvt_pk_bf16_f32 v157, v254, -v255
    v_cos_f32 v248, v240
    v_sin_f32 v249, v240
    v_add_f32 v240, v240, v8
    v_cos_f32 v250, v241
    v_sin_f32 v251, v241
    v_add_f32 v241, v241, v9
    v_cos_f32 v252, v242
    v_sin_f32 v253, v242
    v_add_f32 v242, v242, v10
    v_cos_f32 v254, v243
    v_sin_f32 v255, v243
    v_add_f32 v243, v243, v11
    v_cvt_pk_bf16_f32 v146, v248, -v249
    v_cvt_pk_bf16_f32 v150, v250, -v251
    v_cvt_pk_bf16_f32 v154, v252, -v253
    v_cvt_pk_bf16_f32 v158, v254, -v255
    v_cos_f32 v248, v240
    v_sin_f32 v249, v240
    v_add_f32 v240, v240, v244
    v_cos_f32 v250, v241
    v_sin_f32 v251, v241
    v_add_f32 v241, v241, v245
    v_cos_f32 v252, v242
    v_sin_f32 v253, v242
    v_add_f32 v242, v242, v246
    v_cos_f32 v254, v243
    v_sin_f32 v255, v243
    v_add_f32 v243, v243, v247
    v_cvt_pk_bf16_f32 v147, v248, -v249
    v_cvt_pk_bf16_f32 v151, v250, -v251
    v_cvt_pk_bf16_f32 v155, v252, -v253
    v_cvt_pk_bf16_f32 v159, v254, -v255
    v_cos_f32 v248, v240
    v_sin_f32 v249, v240
    v_add_f32 v240, v240, v8
    v_cos_f32 v250, v241
    v_sin_f32 v251, v241
    v_add_f32 v241, v241, v9
    v_cos_f32 v252, v242
    v_sin_f32 v253, v242
    v_add_f32 v242, v242, v10
    v_cos_f32 v254, v243
    v_sin_f32 v255, v243
    v_add_f32 v243, v243, v11
    v_cvt_pk_bf16_f32 v160, v248, -v249
    v_cvt_pk_bf16_f32 v164, v250, -v251
    v_cvt_pk_bf16_f32 v168, v252, -v253
    v_cvt_pk_bf16_f32 v172, v254, -v255
    v_cos_f32 v248, v240
    v_sin_f32 v249, v240
    v_add_f32 v240, v240, v8
    v_cos_f32 v250, v241
    v_sin_f32 v251, v241
    v_add_f32 v241, v241, v9
    v_cos_f32 v252, v242
    v_sin_f32 v253, v242
    v_add_f32 v242, v242, v10
    v_cos_f32 v254, v243
    v_sin_f32 v255, v243
    v_add_f32 v243, v243, v11
    v_cvt_pk_bf16_f32 v161, v248, -v249
    v_cvt_pk_bf16_f32 v165, v250, -v251
    v_cvt_pk_bf16_f32 v169, v252, -v253
    v_cvt_pk_bf16_f32 v173, v254, -v255
    v_cos_f32 v248, v240
    v_sin_f32 v249, v240
    v_add_f32 v240, v240, v8
    v_cos_f32 v250, v241
    v_sin_f32 v251, v241
    v_add_f32 v241, v241, v9
    v_cos_f32 v252, v242
    v_sin_f32 v253, v242
    v_add_f32 v242, v242, v10
    v_cos_f32 v254, v243
    v_sin_f32 v255, v243
    v_add_f32 v243, v243, v11
    v_cvt_pk_bf16_f32 v162, v248, -v249
    v_cvt_pk_bf16_f32 v166, v250, -v251
    v_cvt_pk_bf16_f32 v170, v252, -v253
    v_cvt_pk_bf16_f32 v174, v254, -v255
    v_cos_f32 v248, v240
    v_sin_f32 v249, v240
    v_add_f32 v240, v240, v244
    v_cos_f32 v250, v241
    v_sin_f32 v251, v241
    v_add_f32 v241, v241, v245
    v_cos_f32 v252, v242
    v_sin_f32 v253, v242
    v_add_f32 v242, v242, v246
    v_cos_f32 v254, v243
    v_sin_f32 v255, v243
    v_add_f32 v243, v243, v247
    v_cvt_pk_bf16_f32 v163, v248, -v249
    v_cvt_pk_bf16_f32 v167, v250, -v251
    v_cvt_pk_bf16_f32 v171, v252, -v253
    v_cvt_pk_bf16_f32 v175, v254, -v255
    v_cos_f32 v248, v240
    v_sin_f32 v249, v240
    v_add_f32 v240, v240, v8
    v_cos_f32 v250, v241
    v_sin_f32 v251, v241
    v_add_f32 v241, v241, v9
    v_cos_f32 v252, v242
    v_sin_f32 v253, v242
    v_add_f32 v242, v242, v10
    v_cos_f32 v254, v243
    v_sin_f32 v255, v243
    v_add_f32 v243, v243, v11
    v_cvt_pk_bf16_f32 v176, v248, -v249
    v_cvt_pk_bf16_f32 v180, v250, -v251
    v_cvt_pk_bf16_f32 v184, v252, -v253
    v_cvt_pk_bf16_f32 v188, v254, -v255
    v_cos_f32 v248, v240
    v_sin_f32 v249, v240
    v_add_f32 v240, v240, v8
    v_cos_f32 v250, v241
    v_sin_f32 v251, v241
    v_add_f32 v241, v241, v9
    v_cos_f32 v252, v242
    v_sin_f32 v253, v242
    v_add_f32 v242, v242, v10
    v_cos_f32 v254, v243
    v_sin_f32 v255, v243
    v_add_f32 v243, v243, v11
    v_cvt_pk_bf16_f32 v177, v248, -v249
    v_cvt_pk_bf16_f32 v181, v250, -v251
    v_cvt_pk_bf16_f32 v185, v252, -v253
    v_cvt_pk_bf16_f32 v189, v254, -v255
    v_cos_f32 v248, v240
    v_sin_f32 v249, v240
    v_add_f32 v240, v240, v8
    v_cos_f32 v250, v241
    v_sin_f32 v251, v241
    v_add_f32 v241, v241, v9
    v_cos_f32 v252, v242
    v_sin_f32 v253, v242
    v_add_f32 v242, v242, v10
    v_cos_f32 v254, v243
    v_sin_f32 v255, v243
    v_add_f32 v243, v243, v11
    v_cvt_pk_bf16_f32 v178, v248, -v249
    v_cvt_pk_bf16_f32 v182, v250, -v251
    v_cvt_pk_bf16_f32 v186, v252, -v253
    v_cvt_pk_bf16_f32 v190, v254, -v255
    v_cos_f32 v248, v240
    v_sin_f32 v249, v240
    v_add_f32 v240, v240, v244
    v_cos_f32 v250, v241
    v_sin_f32 v251, v241
    v_add_f32 v241, v241, v245
    v_cos_f32 v252, v242
    v_sin_f32 v253, v242
    v_add_f32 v242, v242, v246
    v_cos_f32 v254, v243
    v_sin_f32 v255, v243
    v_add_f32 v243, v243, v247
    v_cvt_pk_bf16_f32 v179, v248, -v249
    v_cvt_pk_bf16_f32 v183, v250, -v251
    v_cvt_pk_bf16_f32 v187, v252, -v253
    v_cvt_pk_bf16_f32 v191, v254, -v255
    v_cos_f32 v248, v240
    v_sin_f32 v249, v240
    v_add_f32 v240, v240, v8
    v_cos_f32 v250, v241
    v_sin_f32 v251, v241
    v_add_f32 v241, v241, v9
    v_cos_f32 v252, v242
    v_sin_f32 v253, v242
    v_add_f32 v242, v242, v10
    v_cos_f32 v254, v243
    v_sin_f32 v255, v243
    v_add_f32 v243, v243, v11
    v_cvt_pk_bf16_f32 v192, v248, -v249
    v_cvt_pk_bf16_f32 v196, v250, -v251
    v_cvt_pk_bf16_f32 v200, v252, -v253
    v_cvt_pk_bf16_f32 v204, v254, -v255
    v_cos_f32 v248, v240
    v_sin_f32 v249, v240
    v_add_f32 v240, v240, v8
    v_cos_f32 v250, v241
    v_sin_f32 v251, v241
    v_add_f32 v241, v241, v9
    v_cos_f32 v252, v242
    v_sin_f32 v253, v242
    v_add_f32 v242, v242, v10
    v_cos_f32 v254, v243
    v_sin_f32 v255, v243
    v_add_f32 v243, v243, v11
    v_cvt_pk_bf16_f32 v193, v248, -v249
    v_cvt_pk_bf16_f32 v197, v250, -v251
    v_cvt_pk_bf16_f32 v201, v252, -v253
    v_cvt_pk_bf16_f32 v205, v254, -v255
    v_cos_f32 v248, v240
    v_sin_f32 v249, v240
    v_add_f32 v240, v240, v8
    v_cos_f32 v250, v241
    v_sin_f32 v251, v241
    v_add_f32 v241, v241, v9
    v_cos_f32 v252, v242
    v_sin_f32 v253, v242
    v_add_f32 v242, v242, v10
    v_cos_f32 v254, v243
    v_sin_f32 v255, v243
    v_add_f32 v243, v243, v11
    v_cvt_pk_bf16_f32 v194, v248, -v249
    v_cvt_pk_bf16_f32 v198, v250, -v251
    v_cvt_pk_bf16_f32 v202, v252, -v253
    v_cvt_pk_bf16_f32 v206, v254, -v255
    v_cos_f32 v248, v240
    v_sin_f32 v249, v240
    v_add_f32 v240, v240, v244
    v_cos_f32 v250, v241
    v_sin_f32 v251, v241
    v_add_f32 v241, v241, v245
    v_cos_f32 v252, v242
    v_sin_f32 v253, v242
    v_add_f32 v242, v242, v246
    v_cos_f32 v254, v243
    v_sin_f32 v255, v243
    v_add_f32 v243, v243, v247
    v_cvt_pk_bf16_f32 v195, v248, -v249
    v_cvt_pk_bf16_f32 v199, v250, -v251
    v_cvt_pk_bf16_f32 v203, v252, -v253
    v_cvt_pk_bf16_f32 v207, v254, -v255
    v_cos_f32 v248, v240
    v_sin_f32 v249, v240
    v_add_f32 v240, v240, v8
    v_cos_f32 v250, v241
    v_sin_f32 v251, v241
    v_add_f32 v241, v241, v9
    v_cos_f32 v252, v242
    v_sin_f32 v253, v242
    v_add_f32 v242, v242, v10
    v_cos_f32 v254, v243
    v_sin_f32 v255, v243
    v_add_f32 v243, v243, v11
    v_cvt_pk_bf16_f32 v208, v248, -v249
    v_cvt_pk_bf16_f32 v212, v250, -v251
    v_cvt_pk_bf16_f32 v216, v252, -v253
    v_cvt_pk_bf16_f32 v220, v254, -v255
    v_cos_f32 v248, v240
    v_sin_f32 v249, v240
    v_add_f32 v240, v240, v8
    v_cos_f32 v250, v241
    v_sin_f32 v251, v241
    v_add_f32 v241, v241, v9
    v_cos_f32 v252, v242
    v_sin_f32 v253, v242
    v_add_f32 v242, v242, v10
    v_cos_f32 v254, v243
    v_sin_f32 v255, v243
    v_add_f32 v243, v243, v11
    v_cvt_pk_bf16_f32 v209, v248, -v249
    v_cvt_pk_bf16_f32 v213, v250, -v251
    v_cvt_pk_bf16_f32 v217, v252, -v253
    v_cvt_pk_bf16_f32 v221, v254, -v255
    v_cos_f32 v248, v240
    v_sin_f32 v249, v240
    v_add_f32 v240, v240, v8
    v_cos_f32 v250, v241
    v_sin_f32 v251, v241
    v_add_f32 v241, v241, v9
    v_cos_f32 v252, v242
    v_sin_f32 v253, v242
    v_add_f32 v242, v242, v10
    v_cos_f32 v254, v243
    v_sin_f32 v255, v243
    v_add_f32 v243, v243, v11
    v_cvt_pk_bf16_f32 v210, v248, -v249
    v_cvt_pk_bf16_f32 v214, v250, -v251
    v_cvt_pk_bf16_f32 v218, v252, -v253
    v_cvt_pk_bf16_f32 v222, v254, -v255
    v_cos_f32 v248, v240
    v_sin_f32 v249, v240
    v_add_f32 v240, v240, v244
    v_cos_f32 v250, v241
    v_sin_f32 v251, v241
    v_add_f32 v241, v241, v245
    v_cos_f32 v252, v242
    v_sin_f32 v253, v242
    v_add_f32 v242, v242, v246
    v_cos_f32 v254, v243
    v_sin_f32 v255, v243
    v_add_f32 v243, v243, v247
    v_cvt_pk_bf16_f32 v211, v248, -v249
    v_cvt_pk_bf16_f32 v215, v250, -v251
    v_cvt_pk_bf16_f32 v219, v252, -v253
    v_cvt_pk_bf16_f32 v223, v254, -v255
    v_cos_f32 v248, v240
    v_sin_f32 v249, v240
    v_add_f32 v240, v240, v8
    v_cos_f32 v250, v241
    v_sin_f32 v251, v241
    v_add_f32 v241, v241, v9
    v_cos_f32 v252, v242
    v_sin_f32 v253, v242
    v_add_f32 v242, v242, v10
    v_cos_f32 v254, v243
    v_sin_f32 v255, v243
    v_add_f32 v243, v243, v11
    v_cvt_pk_bf16_f32 v224, v248, -v249
    v_cvt_pk_bf16_f32 v228, v250, -v251
    v_cvt_pk_bf16_f32 v232, v252, -v253
    v_cvt_pk_bf16_f32 v236, v254, -v255
    v_cos_f32 v248, v240
    v_sin_f32 v249, v240
    v_add_f32 v240, v240, v8
    v_cos_f32 v250, v241
    v_sin_f32 v251, v241
    v_add_f32 v241, v241, v9
    v_cos_f32 v252, v242
    v_sin_f32 v253, v242
    v_add_f32 v242, v242, v10
    v_cos_f32 v254, v243
    v_sin_f32 v255, v243
    v_add_f32 v243, v243, v11
    v_cvt_pk_bf16_f32 v225, v248, -v249
    v_cvt_pk_bf16_f32 v229, v250, -v251
    v_cvt_pk_bf16_f32 v233, v252, -v253
    v_cvt_pk_bf16_f32 v237, v254, -v255
    v_cos_f32 v248, v240
    v_sin_f32 v249, v240
    v_add_f32 v240, v240, v8
    v_cos_f32 v250, v241
    v_sin_f32 v251, v241
    v_add_f32 v241, v241, v9
    v_cos_f32 v252, v242
    v_sin_f32 v253, v242
    v_add_f32 v242, v242, v10
    v_cos_f32 v254, v243
    v_sin_f32 v255, v243
    v_add_f32 v243, v243, v11
    v_cvt_pk_bf16_f32 v226, v248, -v249
    v_cvt_pk_bf16_f32 v230, v250, -v251
    v_cvt_pk_bf16_f32 v234, v252, -v253
    v_cvt_pk_bf16_f32 v238, v254, -v255
    v_cos_f32 v248, v240
    v_sin_f32 v249, v240
    v_cos_f32 v250, v241
    v_sin_f32 v251, v241
    v_cos_f32 v252, v242
    v_sin_f32 v253, v242
    v_cos_f32 v254, v243
    v_sin_f32 v255, v243
    v_cvt_pk_bf16_f32 v227, v248, -v249
    v_cvt_pk_bf16_f32 v231, v250, -v251
    v_cvt_pk_bf16_f32 v235, v252, -v253
    v_cvt_pk_bf16_f32 v239, v254, -v255
    s_nop 4
    s_branch L_g2help3
L_pub2:
    s_cmp_ge_u32 s48, 4
    s_cbranch_scc1 L_g2help
    s_add_u32 s75, s77, 0
    s_sub_u32 s59, s75, 14
    s_min_u32 s75, s75, s59
    s_mul_i32 s75, s75, 131072
    s_add_u32 s75, s75, s63
    s_add_u32 s59, s75, 0
    s_add_u32 m0, s58, 16384
    s_nop 0
    buffer_load_dwordx4 v14, s[36:39], s59 offen lds
    s_add_u32 s59, s75, 32768
    s_add_u32 m0, s58, 17408
    s_nop 0
    buffer_load_dwordx4 v15, s[36:39], s59 offen lds
    s_add_u32 s59, s75, 65536
    s_add_u32 m0, s58, 18432
    s_nop 0
    buffer_load_dwordx4 v14, s[36:39], s59 offen lds
    s_add_u32 s59, s75, 98304
    s_add_u32 m0, s58, 19456
    s_nop 0
    buffer_load_dwordx4 v15, s[36:39], s59 offen lds
    s_add_u32 s75, s77, 1
    s_sub_u32 s59, s75, 14
    s_min_u32 s75, s75, s59
    s_mul_i32 s75, s75, 131072
    s_add_u32 s75, s75, s63
    s_add_u32 s59, s75, 0
    s_add_u32 m0, s58, 20480
    s_nop 0
    buffer_load_dwordx4 v14, s[36:39], s59 offen lds
    s_add_u32 s59, s75, 32768
    s_add_u32 m0, s58, 21504
    s_nop 0
    buffer_load_dwordx4 v15, s[36:39], s59 offen lds
    s_add_u32 s59, s75, 65536
    s_add_u32 m0, s58, 22528
    s_nop 0
    buffer_load_dwordx4 v14, s[36:39], s59 offen lds
    s_add_u32 s59, s75, 98304
    s_add_u32 m0, s58, 23552
    s_nop 0
    buffer_load_dwordx4 v15, s[36:39], s59 offen lds
    s_waitcnt vmcnt(8)
    v_mov_b32 v12, 163780
    v_mov_b32 v13, 1
    s_mov_b64 exec, 1
    ds_add_rtn_u32 v13, v12, v13
    s_mov_b64 exec, -1
    s_waitcnt lgkmcnt(0)
    v_readfirstlane_b32 s78, v13
    s_nop 0
    s_cmp_lg_u32 s78, 7
    s_cbranch_scc1 L_arr_54
    s_setprio 3
    v_mov_b32 v13, s51
    v_lshlrev_b32 v12, 17, v2
    v_add_u32 v12, 12582912, v12
    s_mov_b64 exec, 255
    buffer_store_dword v13, v12, s[24:27], s72 offen sc1
    s_mov_b64 exec, -1
    s_setprio 0
    s_nop 0
L_arr_54:
    s_add_u32 s75, s77, 2
    s_sub_u32 s59, s75, 14
    s_min_u32 s75, s75, s59
    s_mul_i32 s75, s75, 131072
    s_add_u32 s75, s75, s63
    s_add_u32 s59, s75, 0
    s_add_u32 m0, s58, 24576
    s_nop 0
    buffer_load_dwordx4 v14, s[36:39], s59 offen lds
    s_add_u32 s59, s75, 32768
    s_add_u32 m0, s58, 25600
    s_nop 0
    buffer_load_dwordx4 v15, s[36:39], s59 offen lds
    s_add_u32 s59, s75, 65536
    s_add_u32 m0, s58, 26624
    s_nop 0
    buffer_load_dwordx4 v14, s[36:39], s59 offen lds
    s_add_u32 s59, s75, 98304
    s_add_u32 m0, s58, 27648
    s_nop 0
    buffer_load_dwordx4 v15, s[36:39], s59 offen lds
    s_add_u32 s75, s77, 3
    s_sub_u32 s59, s75, 14
    s_min_u32 s75, s75, s59
    s_mul_i32 s75, s75, 131072
    s_add_u32 s75, s75, s63
    s_add_u32 s59, s75, 0
    s_add_u32 m0, s58, 28672
    s_nop 0
    buffer_load_dwordx4 v14, s[36:39], s59 offen lds
    s_add_u32 s59, s75, 32768
    s_add_u32 m0, s58, 29696
    s_nop 0
    buffer_load_dwordx4 v15, s[36:39], s59 offen lds
    s_add_u32 s59, s75, 65536
    s_add_u32 m0, s58, 30720
    s_nop 0
    buffer_load_dwordx4 v14, s[36:39], s59 offen lds
    s_add_u32 s59, s75, 98304
    s_add_u32 m0, s58, 31744
    s_nop 0
    buffer_load_dwordx4 v15, s[36:39], s59 offen lds
    s_add_u32 s75, s77, 8
    s_sub_u32 s59, s75, 14
    s_min_u32 s75, s75, s59
    s_mul_i32 s75, s75, 131072
    s_add_u32 s75, s75, s63
    s_add_u32 s59, s75, 0
    buffer_load_dwordx4 v[160:163], v14, s[36:39], s59 offen
    s_add_u32 s59, s75, 32768
    buffer_load_dwordx4 v[164:167], v15, s[36:39], s59 offen
    s_add_u32 s59, s75, 65536
    buffer_load_dwordx4 v[168:171], v14, s[36:39], s59 offen
    s_add_u32 s59, s75, 98304
    buffer_load_dwordx4 v[172:175], v15, s[36:39], s59 offen
    s_add_u32 s75, s77, 9
    s_sub_u32 s59, s75, 14
    s_min_u32 s75, s75, s59
    s_mul_i32 s75, s75, 131072
    s_add_u32 s75, s75, s63
    s_add_u32 s59, s75, 0
    buffer_load_dwordx4 v[176:179], v14, s[36:39], s59 offen
    s_add_u32 s59, s75, 32768
    buffer_load_dwordx4 v[180:183], v15, s[36:39], s59 offen
    s_add_u32 s59, s75, 65536
    buffer_load_dwordx4 v[184:187], v14, s[36:39], s59 offen
    s_add_u32 s59, s75, 98304
    buffer_load_dwordx4 v[188:191], v15, s[36:39], s59 offen
    s_add_u32 s75, s77, 10
    s_sub_u32 s59, s75, 14
    s_min_u32 s75, s75, s59
    s_mul_i32 s75, s75, 131072
    s_add_u32 s75, s75, s63
    s_add_u32 s59, s75, 0
    buffer_load_dwordx4 v[192:195], v14, s[36:39], s59 offen
    s_add_u32 s59, s75, 32768
    buffer_load_dwordx4 v[196:199], v15, s[36:39], s59 offen
    s_add_u32 s59, s75, 65536
    buffer_load_dwordx4 v[200:203], v14, s[36:39], s59 offen
    s_add_u32 s59, s75, 98304
    buffer_load_dwordx4 v[204:207], v15, s[36:39], s59 offen
    s_add_u32 s75, s77, 11
    s_sub_u32 s59, s75, 14
    s_min_u32 s75, s75, s59
    s_mul_i32 s75, s75, 131072
    s_add_u32 s75, s75, s63
    s_add_u32 s59, s75, 0
    buffer_load_dwordx4 v[208:211], v14, s[36:39], s59 offen
    s_add_u32 s59, s75, 32768
    buffer_load_dwordx4 v[212:215], v15, s[36:39], s59 offen
    s_add_u32 s59, s75, 65536
    buffer_load_dwordx4 v[216:219], v14, s[36:39], s59 offen
    s_add_u32 s59, s75, 98304
    buffer_load_dwordx4 v[220:223], v15, s[36:39], s59 offen
    s_add_u32 s75, s77, 12
    s_sub_u32 s59, s75, 14
    s_min_u32 s75, s75, s59
    s_mul_i32 s75, s75, 131072
    s_add_u32 s75, s75, s63
    s_add_u32 s59, s75, 0
    buffer_load_dwordx4 v[224:227], v14, s[36:39], s59 offen
    s_add_u32 s59, s75, 32768
    buffer_load_dwordx4 v[228:231], v15, s[36:39], s59 offen
    s_add_u32 s59, s75, 65536
    buffer_load_dwordx4 v[232:235], v14, s[36:39], s59 offen
    s_add_u32 s59, s75, 98304
    buffer_load_dwordx4 v[236:239], v15, s[36:39], s59 offen
    s_add_u32 s75, s77, 13
    s_sub_u32 s59, s75, 14
    s_min_u32 s75, s75, s59
    s_mul_i32 s75, s75, 131072
    s_add_u32 s75, s75, s63
    s_add_u32 s59, s75, 0
    buffer_load_dwordx4 v[240:243], v14, s[36:39], s59 offen
    s_add_u32 s59, s75, 32768
    buffer_load_dwordx4 v[244:247], v15, s[36:39], s59 offen
    s_add_u32 s59, s75, 65536
    buffer_load_dwordx4 v[248:251], v14, s[36:39], s59 offen
    s_add_u32 s59, s75, 98304
    buffer_load_dwordx4 v[252:255], v15, s[36:39], s59 offen
L_pub3:
    s_mul_i32 s60, s56, 229376
    s_mul_i32 s61, s48, 57344
    s_add_u32 s60, s60, s61
    s_add_u32 s60, s60, 7340032
    s_barrier
    s_lshl_b32 s72, s56, 11
    s_mul_i32 s73, s48, 448
    s_add_u32 s72, s72, s73
    s_add_u32 s72, s72, 12599296
    v_min_u32 v12, 6, v2
    v_lshlrev_b32 v12, 6, v12
    v_add_u32 v12, s6, v12
    buffer_load_dword v16, v12, s[24:27], s72 offen sc1
    s_add_u32 s75, s77, 4
    s_sub_u32 s59, s75, 14
    s_min_u32 s75, s75, s59
    s_mul_i32 s75, s75, 131072
    s_add_u32 s75, s75, s63
    s_add_u32 s59, s75, 0
    s_add_u32 m0, s58, 0
    s_nop 0
    buffer_load_dwordx4 v14, s[36:39], s59 offen lds
    s_add_u32 s59, s75, 32768
    s_add_u32 m0, s58, 1024
    s_nop 0
    buffer_load_dwordx4 v15, s[36:39], s59 offen lds
    s_add_u32 s59, s75, 65536
    s_add_u32 m0, s58, 2048
    s_nop 0
    buffer_load_dwordx4 v14, s[36:39], s59 offen lds
    s_add_u32 s59, s75, 98304
    s_add_u32 m0, s58, 3072
    s_nop 0
    buffer_load_dwordx4 v15, s[36:39], s59 offen lds
    s_add_u32 s75, s77, 5
    s_sub_u32 s59, s75, 14
    s_min_u32 s75, s75, s59
    s_mul_i32 s75, s75, 131072
    s_add_u32 s75, s75, s63
    s_add_u32 s59, s75, 0
    s_add_u32 m0, s58, 4096
    s_nop 0
    buffer_load_dwordx4 v14, s[36:39], s59 offen lds
    s_add_u32 s59, s75, 32768
    s_add_u32 m0, s58, 5120
    s_nop 0
    buffer_load_dwordx4 v15, s[36:39], s59 offen lds
    s_add_u32 s59, s75, 65536
    s_add_u32 m0, s58, 6144
    s_nop 0
    buffer_load_dwordx4 v14, s[36:39], s59 offen lds
    s_add_u32 s59, s75, 98304
    s_add_u32 m0, s58, 7168
    s_nop 0
    buffer_load_dwordx4 v15, s[36:39], s59 offen lds
    s_add_u32 s75, s77, 6
    s_sub_u32 s59, s75, 14
    s_min_u32 s75, s75, s59
    s_mul_i32 s75, s75, 131072
    s_add_u32 s75, s75, s63
    s_add_u32 s59, s75, 0
    s_add_u32 m0, s58, 8192
    s_nop 0
    buffer_load_dwordx4 v14, s[36:39], s59 offen lds
    s_add_u32 s59, s75, 32768
    s_add_u32 m0, s58, 9216
    s_nop 0
    buffer_load_dwordx4 v15, s[36:39], s59 offen lds
    s_add_u32 s59, s75, 65536
    s_add_u32 m0, s58, 10240
    s_nop 0
    buffer_load_dwordx4 v14, s[36:39], s59 offen lds
    s_add_u32 s59, s75, 98304
    s_add_u32 m0, s58, 11264
    s_nop 0
    buffer_load_dwordx4 v15, s[36:39], s59 offen lds
    s_add_u32 s75, s77, 7
    s_sub_u32 s59, s75, 14
    s_min_u32 s75, s75, s59
    s_mul_i32 s75, s75, 131072
    s_add_u32 s75, s75, s63
    s_add_u32 s59, s75, 0
    s_add_u32 m0, s58, 12288
    s_nop 0
    buffer_load_dwordx4 v14, s[36:39], s59 offen lds
    s_add_u32 s59, s75, 32768
    s_add_u32 m0, s58, 13312
    s_nop 0
    buffer_load_dwordx4 v15, s[36:39], s59 offen lds
    s_add_u32 s59, s75, 65536
    s_add_u32 m0, s58, 14336
    s_nop 0
    buffer_load_dwordx4 v14, s[36:39], s59 offen lds
    s_add_u32 s59, s75, 98304
    s_add_u32 m0, s58, 15360
    s_nop 0
    buffer_load_dwordx4 v15, s[36:39], s59 offen lds
    s_waitcnt vmcnt(16)
    s_mov_b32 s79, 50000
    s_nop 0
    s_branch L_gpc_57
    s_mov_b64 exec, 0x7f
L_gp_55:
    buffer_load_dword v16, v12, s[24:27], s72 offen sc1
    s_sub_u32 s79, s79, 1
    s_waitcnt vmcnt(0)
L_gpc_57:
    v_cmp_ne_u32 vcc, s51, v16
    s_nop 1
    s_cmp_eq_u64 vcc, 0
    s_cbranch_scc1 L_gpd_56
    s_cmp_eq_u32 s79, 0
    s_cbranch_scc1 L_gpd_56
    s_mov_b64 exec, vcc
    s_sleep 2
    s_branch L_gp_55
L_gpd_56:
    s_mov_b64 exec, -1
    s_mov_b64 s[66:67], s[70:71]
    v_lshrrev_b32 v16, 3, v0
    s_lshr_b32 s69, s57, 4
    s_lshl_b32 s69, s69, 12
    s_and_b32 s70, s57, 15
    s_lshl_b32 s70, s70, 2
    s_add_u32 s69, s69, s70
    s_add_u32 s69, s69, 11534336
    v_lshlrev_b32 v17, 6, v16
    buffer_load_dword v12, v17, s[24:27], s69 offen sc1
    v_mov_b32 v13, 0
    v_lshlrev_b32 v16, 1, v16
    s_lshl_b32 s70, s57, 7
    buffer_load_short_d16_hi v13, v16, s[44:47], s70 offen
    v_lshrrev_b32 v4, 5, v2
    v_lshlrev_b32 v4, 6, v4
    v_xor_b32 v4, v4, v7
    v_xor_b32 v5, 128, v4
    s_add_u32 s61, s77, 0
    s_sub_u32 s73, s61, 14
    s_min_u32 s61, s61, s73
    s_lshl_b32 s61, s61, 12
    s_add_u32 s61, s61, s60
    buffer_load_dwordx4 v[112:115], v6, s[24:27], s61 offen offset:0 sc1
    buffer_load_dwordx4 v[116:119], v6, s[24:27], s61 offen offset:256 sc1
    buffer_load_dwordx4 v[120:123], v6, s[24:27], s61 offen offset:512 sc1
    buffer_load_dwordx4 v[124:127], v6, s[24:27], s61 offen offset:768 sc1
    s_add_u32 s61, s77, 1
    s_sub_u32 s73, s61, 14
    s_min_u32 s61, s61, s73
    s_lshl_b32 s61, s61, 12
    s_add_u32 s61, s61, s60
    buffer_load_dwordx4 v[128:131], v6, s[24:27], s61 offen offset:0 sc1
    buffer_load_dwordx4 v[132:135], v6, s[24:27], s61 offen offset:256 sc1
    buffer_load_dwordx4 v[136:139], v6, s[24:27], s61 offen offset:512 sc1
    buffer_load_dwordx4 v[140:143], v6, s[24:27], s61 offen offset:768 sc1
    s_add_u32 s61, s77, 2
    s_sub_u32 s73, s61, 14
    s_min_u32 s61, s61, s73
    s_lshl_b32 s61, s61, 12
    s_add_u32 s61, s61, s60
    buffer_load_dwordx4 v[144:147], v6, s[24:27], s61 offen offset:0 sc1
    buffer_load_dwordx4 v[148:151], v6, s[24:27], s61 offen offset:256 sc1
    buffer_load_dwordx4 v[152:155], v6, s[24:27], s61 offen offset:512 sc1
    buffer_load_dwordx4 v[156:159], v6, s[24:27], s61 offen offset:768 sc1
    ds_read_b64_tr_b16 v[80:81], v8 offset:16384
    ds_read_b64_tr_b16 v[82:83], v8 offset:16896
    ds_read_b64_tr_b16 v[84:85], v9 offset:16384
    ds_read_b64_tr_b16 v[86:87], v9 offset:16896
    ds_read_b64_tr_b16 v[88:89], v10 offset:16384
    ds_read_b64_tr_b16 v[90:91], v10 offset:16896
    ds_read_b64_tr_b16 v[92:93], v11 offset:16384
    ds_read_b64_tr_b16 v[94:95], v11 offset:16896
    s_waitcnt lgkmcnt(0)
    s_waitcnt vmcnt(11)
    v_mfma_f32_16x16x32_bf16 v[16:19], v[112:115], v[80:83], 0
    ds_write_b128 v7, v[160:163] offset:16384
    s_waitcnt vmcnt(10)
    v_mfma_f32_16x16x32_bf16 v[32:35], v[116:119], v[80:83], 0
    ds_write_b128 v7, v[164:167] offset:17408
    s_waitcnt vmcnt(9)
    v_mfma_f32_16x16x32_bf16 v[48:51], v[120:123], v[80:83], 0
    ds_write_b128 v7, v[168:171] offset:18432
    s_waitcnt vmcnt(8)
    v_mfma_f32_16x16x32_bf16 v[64:67], v[124:127], v[80:83], 0
    ds_write_b128 v7, v[172:175] offset:19456
    v_mfma_f32_16x16x32_bf16 v[20:23], v[112:115], v[84:87], 0
    v_mfma_f32_16x16x32_bf16 v[36:39], v[116:119], v[84:87], 0
    v_mfma_f32_16x16x32_bf16 v[52:55], v[120:123], v[84:87], 0
    ds_read_b64_tr_b16 v[96:97], v8 offset:20480
    v_mfma_f32_16x16x32_bf16 v[68:71], v[124:127], v[84:87], 0
    ds_read_b64_tr_b16 v[98:99], v8 offset:20992
    v_mfma_f32_16x16x32_bf16 v[24:27], v[112:115], v[88:91], 0
    ds_read_b64_tr_b16 v[100:101], v9 offset:20480
    v_mfma_f32_16x16x32_bf16 v[40:43], v[116:119], v[88:91], 0
    ds_read_b64_tr_b16 v[102:103], v9 offset:20992
    v_mfma_f32_16x16x32_bf16 v[56:59], v[120:123], v[88:91], 0
    ds_read_b64_tr_b16 v[104:105], v10 offset:20480
    v_mfma_f32_16x16x32_bf16 v[72:75], v[124:127], v[88:91], 0
    ds_read_b64_tr_b16 v[106:107], v10 offset:20992
    v_mfma_f32_16x16x32_bf16 v[28:31], v[112:115], v[92:95], 0
    ds_read_b64_tr_b16 v[108:109], v11 offset:20480
    s_add_u32 s61, s77, 3
    s_sub_u32 s73, s61, 14
    s_min_u32 s61, s61, s73
    s_lshl_b32 s61, s61, 12
    s_add_u32 s61, s61, s60
    buffer_load_dwordx4 v[112:115], v6, s[24:27], s61 offen offset:0 sc1
    v_mfma_f32_16x16x32_bf16 v[44:47], v[116:119], v[92:95], 0
    ds_read_b64_tr_b16 v[110:111], v11 offset:20992
    buffer_load_dwordx4 v[116:119], v6, s[24:27], s61 offen offset:256 sc1
    v_mfma_f32_16x16x32_bf16 v[60:63], v[120:123], v[92:95], 0
    buffer_load_dwordx4 v[120:123], v6, s[24:27], s61 offen offset:512 sc1
    v_mfma_f32_16x16x32_bf16 v[76:79], v[124:127], v[92:95], 0
    buffer_load_dwordx4 v[124:127], v6, s[24:27], s61 offen offset:768 sc1
    s_waitcnt lgkmcnt(0)
    s_waitcnt vmcnt(11)
    v_mfma_f32_16x16x32_bf16 v[16:19], v[128:131], v[96:99], v[16:19]
    ds_write_b128 v7, v[176:179] offset:20480
    s_waitcnt vmcnt(10)
    v_mfma_f32_16x16x32_bf16 v[32:35], v[132:135], v[96:99], v[32:35]
    ds_write_b128 v7, v[180:183] offset:21504
    s_waitcnt vmcnt(9)
    v_mfma_f32_16x16x32_bf16 v[48:51], v[136:139], v[96:99], v[48:51]
    ds_write_b128 v7, v[184:187] offset:22528
    s_waitcnt vmcnt(8)
    v_mfma_f32_16x16x32_bf16 v[64:67], v[140:143], v[96:99], v[64:67]
    ds_write_b128 v7, v[188:191] offset:23552
    v_mfma_f32_16x16x32_bf16 v[20:23], v[128:131], v[100:103], v[20:23]
    v_mfma_f32_16x16x32_bf16 v[36:39], v[132:135], v[100:103], v[36:39]
    v_mfma_f32_16x16x32_bf16 v[52:55], v[136:139], v[100:103], v[52:55]
    ds_read_b64_tr_b16 v[80:81], v8 offset:24576
    v_mfma_f32_16x16x32_bf16 v[68:71], v[140:143], v[100:103], v[68:71]
    ds_read_b64_tr_b16 v[82:83], v8 offset:25088
    v_mfma_f32_16x16x32_bf16 v[24:27], v[128:131], v[104:107], v[24:27]
    ds_read_b64_tr_b16 v[84:85], v9 offset:24576
    v_mfma_f32_16x16x32_bf16 v[40:43], v[132:135], v[104:107], v[40:43]
    ds_read_b64_tr_b16 v[86:87], v9 offset:25088
    v_mfma_f32_16x16x32_bf16 v[56:59], v[136:139], v[104:107], v[56:59]
    ds_read_b64_tr_b16 v[88:89], v10 offset:24576
    v_mfma_f32_16x16x32_bf16 v[72:75], v[140:143], v[104:107], v[72:75]
    ds_read_b64_tr_b16 v[90:91], v10 offset:25088
    v_mfma_f32_16x16x32_bf16 v[28:31], v[128:131], v[108:111], v[28:31]
    ds_read_b64_tr_b16 v[92:93], v11 offset:24576
    s_add_u32 s61, s77, 4
    s_sub_u32 s73, s61, 14
    s_min_u32 s61, s61, s73
    s_lshl_b32 s61, s61, 12
    s_add_u32 s61, s61, s60
    buffer_load_dwordx4 v[128:131], v6, s[24:27], s61 offen offset:0 sc1
    v_mfma_f32_16x16x32_bf16 v[44:47], v[132:135], v[108:111], v[44:47]
    ds_read_b64_tr_b16 v[94:95], v11 offset:25088
    buffer_load_dwordx4 v[132:135], v6, s[24:27], s61 offen offset:256 sc1
    v_mfma_f32_16x16x32_bf16 v[60:63], v[136:139], v[108:111], v[60:63]
    buffer_load_dwordx4 v[136:139], v6, s[24:27], s61 offen offset:512 sc1
    v_mfma_f32_16x16x32_bf16 v[76:79], v[140:143], v[108:111], v[76:79]
    buffer_load_dwordx4 v[140:143], v6, s[24:27], s61 offen offset:768 sc1
    s_waitcnt lgkmcnt(0)
    s_waitcnt vmcnt(11)
    v_mfma_f32_16x16x32_bf16 v[16:19], v[144:147], v[80:83], v[16:19]
    ds_write_b128 v7, v[192:195] offset:24576
    s_waitcnt vmcnt(10)
    v_mfma_f32_16x16x32_bf16 v[32:35], v[148:151], v[80:83], v[32:35]
    ds_write_b128 v7, v[196:199] offset:25600
    s_waitcnt vmcnt(9)
    v_mfma_f32_16x16x32_bf16 v[48:51], v[152:155], v[80:83], v[48:51]
    ds_write_b128 v7, v[200:203] offset:26624
    s_waitcnt vmcnt(8)
    v_mfma_f32_16x16x32_bf16 v[64:67], v[156:159], v[80:83], v[64:67]
    ds_write_b128 v7, v[204:207] offset:27648
    v_mfma_f32_16x16x32_bf16 v[20:23], v[144:147], v[84:87], v[20:23]
    v_mfma_f32_16x16x32_bf16 v[36:39], v[148:151], v[84:87], v[36:39]
    v_mfma_f32_16x16x32_bf16 v[52:55], v[152:155], v[84:87], v[52:55]
    ds_read_b64_tr_b16 v[96:97], v8 offset:28672
    v_mfma_f32_16x16x32_bf16 v[68:71], v[156:159], v[84:87], v[68:71]
    ds_read_b64_tr_b16 v[98:99], v8 offset:29184
    v_mfma_f32_16x16x32_bf16 v[24:27], v[144:147], v[88:91], v[24:27]
    ds_read_b64_tr_b16 v[100:101], v9 offset:28672
    v_mfma_f32_16x16x32_bf16 v[40:43], v[148:151], v[88:91], v[40:43]
    ds_read_b64_tr_b16 v[102:103], v9 offset:29184
    v_mfma_f32_16x16x32_bf16 v[56:59], v[152:155], v[88:91], v[56:59]
    ds_read_b64_tr_b16 v[104:105], v10 offset:28672
    v_mfma_f32_16x16x32_bf16 v[72:75], v[156:159], v[88:91], v[72:75]
    ds_read_b64_tr_b16 v[106:107], v10 offset:29184
    v_mfma_f32_16x16x32_bf16 v[28:31], v[144:147], v[92:95], v[28:31]
    ds_read_b64_tr_b16 v[108:109], v11 offset:28672
    s_add_u32 s61, s77, 5
    s_sub_u32 s73, s61, 14
    s_min_u32 s61, s61, s73
    s_lshl_b32 s61, s61, 12
    s_add_u32 s61, s61, s60
    buffer_load_dwordx4 v[144:147], v6, s[24:27], s61 offen offset:0 sc1
    v_mfma_f32_16x16x32_bf16 v[44:47], v[148:151], v[92:95], v[44:47]
    ds_read_b64_tr_b16 v[110:111], v11 offset:29184
    buffer_load_dwordx4 v[148:151], v6, s[24:27], s61 offen offset:256 sc1
    v_mfma_f32_16x16x32_bf16 v[60:63], v[152:155], v[92:95], v[60:63]
    buffer_load_dwordx4 v[152:155], v6, s[24:27], s61 offen offset:512 sc1
    v_mfma_f32_16x16x32_bf16 v[76:79], v[156:159], v[92:95], v[76:79]
    buffer_load_dwordx4 v[156:159], v6, s[24:27], s61 offen offset:768 sc1
    s_waitcnt lgkmcnt(0)
    s_waitcnt vmcnt(11)
    v_mfma_f32_16x16x32_bf16 v[16:19], v[112:115], v[96:99], v[16:19]
    ds_write_b128 v7, v[208:211] offset:28672
    s_waitcnt vmcnt(10)
    v_mfma_f32_16x16x32_bf16 v[32:35], v[116:119], v[96:99], v[32:35]
    ds_write_b128 v7, v[212:215] offset:29696
    s_waitcnt vmcnt(9)
    v_mfma_f32_16x16x32_bf16 v[48:51], v[120:123], v[96:99], v[48:51]
    ds_write_b128 v7, v[216:219] offset:30720
    s_waitcnt vmcnt(8)
    v_mfma_f32_16x16x32_bf16 v[64:67], v[124:127], v[96:99], v[64:67]
    ds_write_b128 v7, v[220:223] offset:31744
    v_mfma_f32_16x16x32_bf16 v[20:23], v[112:115], v[100:103], v[20:23]
    v_mfma_f32_16x16x32_bf16 v[36:39], v[116:119], v[100:103], v[36:39]
    v_mfma_f32_16x16x32_bf16 v[52:55], v[120:123], v[100:103], v[52:55]
    ds_read_b64_tr_b16 v[80:81], v8 offset:0
    v_mfma_f32_16x16x32_bf16 v[68:71], v[124:127], v[100:103], v[68:71]
    ds_read_b64_tr_b16 v[82:83], v8 offset:512
    v_mfma_f32_16x16x32_bf16 v[24:27], v[112:115], v[104:107], v[24:27]
    ds_read_b64_tr_b16 v[84:85], v9 offset:0
    v_mfma_f32_16x16x32_bf16 v[40:43], v[116:119], v[104:107], v[40:43]
    ds_read_b64_tr_b16 v[86:87], v9 offset:512
    v_mfma_f32_16x16x32_bf16 v[56:59], v[120:123], v[104:107], v[56:59]
    ds_read_b64_tr_b16 v[88:89], v10 offset:0
    v_mfma_f32_16x16x32_bf16 v[72:75], v[124:127], v[104:107], v[72:75]
    ds_read_b64_tr_b16 v[90:91], v10 offset:512
    v_mfma_f32_16x16x32_bf16 v[28:31], v[112:115], v[108:111], v[28:31]
    ds_read_b64_tr_b16 v[92:93], v11 offset:0
    s_add_u32 s61, s77, 6
    s_sub_u32 s73, s61, 14
    s_min_u32 s61, s61, s73
    s_lshl_b32 s61, s61, 12
    s_add_u32 s61, s61, s60
    buffer_load_dwordx4 v[112:115], v6, s[24:27], s61 offen offset:0 sc1
    v_mfma_f32_16x16x32_bf16 v[44:47], v[116:119], v[108:111], v[44:47]
    ds_read_b64_tr_b16 v[94:95], v11 offset:512
    buffer_load_dwordx4 v[116:119], v6, s[24:27], s61 offen offset:256 sc1
    v_mfma_f32_16x16x32_bf16 v[60:63], v[120:123], v[108:111], v[60:63]
    buffer_load_dwordx4 v[120:123], v6, s[24:27], s61 offen offset:512 sc1
    v_mfma_f32_16x16x32_bf16 v[76:79], v[124:127], v[108:111], v[76:79]
    buffer_load_dwordx4 v[124:127], v6, s[24:27], s61 offen offset:768 sc1
    s_waitcnt lgkmcnt(0)
    s_waitcnt vmcnt(11)
    v_mfma_f32_16x16x32_bf16 v[16:19], v[128:131], v[80:83], v[16:19]
    ds_write_b128 v7, v[224:227] offset:0
    s_waitcnt vmcnt(10)
    v_mfma_f32_16x16x32_bf16 v[32:35], v[132:135], v[80:83], v[32:35]
    ds_write_b128 v7, v[228:231] offset:1024
    s_waitcnt vmcnt(9)
    v_mfma_f32_16x16x32_bf16 v[48:51], v[136:139], v[80:83], v[48:51]
    ds_write_b128 v7, v[232:235] offset:2048
    s_waitcnt vmcnt(8)
    v_mfma_f32_16x16x32_bf16 v[64:67], v[140:143], v[80:83], v[64:67]
    ds_write_b128 v7, v[236:239] offset:3072
    v_mfma_f32_16x16x32_bf16 v[20:23], v[128:131], v[84:87], v[20:23]
    v_mfma_f32_16x16x32_bf16 v[36:39], v[132:135], v[84:87], v[36:39]
    v_mfma_f32_16x16x32_bf16 v[52:55], v[136:139], v[84:87], v[52:55]
    ds_read_b64_tr_b16 v[96:97], v8 offset:4096
    v_mfma_f32_16x16x32_bf16 v[68:71], v[140:143], v[84:87], v[68:71]
    ds_read_b64_tr_b16 v[98:99], v8 offset:4608
    v_mfma_f32_16x16x32_bf16 v[24:27], v[128:131], v[88:91], v[24:27]
    ds_read_b64_tr_b16 v[100:101], v9 offset:4096
    v_mfma_f32_16x16x32_bf16 v[40:43], v[132:135], v[88:91], v[40:43]
    ds_read_b64_tr_b16 v[102:103], v9 offset:4608
    v_mfma_f32_16x16x32_bf16 v[56:59], v[136:139], v[88:91], v[56:59]
    ds_read_b64_tr_b16 v[104:105], v10 offset:4096
    v_mfma_f32_16x16x32_bf16 v[72:75], v[140:143], v[88:91], v[72:75]
    ds_read_b64_tr_b16 v[106:107], v10 offset:4608
    v_mfma_f32_16x16x32_bf16 v[28:31], v[128:131], v[92:95], v[28:31]
    ds_read_b64_tr_b16 v[108:109], v11 offset:4096
    s_add_u32 s61, s77, 7
    s_sub_u32 s73, s61, 14
    s_min_u32 s61, s61, s73
    s_lshl_b32 s61, s61, 12
    s_add_u32 s61, s61, s60
    buffer_load_dwordx4 v[128:131], v6, s[24:27], s61 offen offset:0 sc1
    v_mfma_f32_16x16x32_bf16 v[44:47], v[132:135], v[92:95], v[44:47]
    ds_read_b64_tr_b16 v[110:111], v11 offset:4608
    buffer_load_dwordx4 v[132:135], v6, s[24:27], s61 offen offset:256 sc1
    v_mfma_f32_16x16x32_bf16 v[60:63], v[136:139], v[92:95], v[60:63]
    buffer_load_dwordx4 v[136:139], v6, s[24:27], s61 offen offset:512 sc1
    v_mfma_f32_16x16x32_bf16 v[76:79], v[140:143], v[92:95], v[76:79]
    buffer_load_dwordx4 v[140:143], v6, s[24:27], s61 offen offset:768 sc1
    s_waitcnt lgkmcnt(0)
    s_waitcnt vmcnt(11)
    v_mfma_f32_16x16x32_bf16 v[16:19], v[144:147], v[96:99], v[16:19]
    ds_write_b128 v7, v[240:243] offset:4096
    s_waitcnt vmcnt(10)
    v_mfma_f32_16x16x32_bf16 v[32:35], v[148:151], v[96:99], v[32:35]
    ds_write_b128 v7, v[244:247] offset:5120
    s_waitcnt vmcnt(9)
    v_mfma_f32_16x16x32_bf16 v[48:51], v[152:155], v[96:99], v[48:51]
    ds_write_b128 v7, v[248:251] offset:6144
    s_waitcnt vmcnt(8)
    v_mfma_f32_16x16x32_bf16 v[64:67], v[156:159], v[96:99], v[64:67]
    ds_write_b128 v7, v[252:255] offset:7168
    v_mfma_f32_16x16x32_bf16 v[20:23], v[144:147], v[100:103], v[20:23]
    v_mfma_f32_16x16x32_bf16 v[36:39], v[148:151], v[100:103], v[36:39]
    v_mfma_f32_16x16x32_bf16 v[52:55], v[152:155], v[100:103], v[52:55]
    ds_read_b64_tr_b16 v[80:81], v8 offset:8192
    v_mfma_f32_16x16x32_bf16 v[68:71], v[156:159], v[100:103], v[68:71]
    ds_read_b64_tr_b16 v[82:83], v8 offset:8704
    v_mfma_f32_16x16x32_bf16 v[24:27], v[144:147], v[104:107], v[24:27]
    ds_read_b64_tr_b16 v[84:85], v9 offset:8192
    v_mfma_f32_16x16x32_bf16 v[40:43], v[148:151], v[104:107], v[40:43]
    ds_read_b64_tr_b16 v[86:87], v9 offset:8704
    v_mfma_f32_16x16x32_bf16 v[56:59], v[152:155], v[104:107], v[56:59]
    ds_read_b64_tr_b16 v[88:89], v10 offset:8192
    v_mfma_f32_16x16x32_bf16 v[72:75], v[156:159], v[104:107], v[72:75]
    ds_read_b64_tr_b16 v[90:91], v10 offset:8704
    v_mfma_f32_16x16x32_bf16 v[28:31], v[144:147], v[108:111], v[28:31]
    ds_read_b64_tr_b16 v[92:93], v11 offset:8192
    s_add_u32 s61, s77, 8
    s_sub_u32 s73, s61, 14
    s_min_u32 s61, s61, s73
    s_lshl_b32 s61, s61, 12
    s_add_u32 s61, s61, s60
    buffer_load_dwordx4 v[144:147], v6, s[24:27], s61 offen offset:0 sc1
    v_mfma_f32_16x16x32_bf16 v[44:47], v[148:151], v[108:111], v[44:47]
    ds_read_b64_tr_b16 v[94:95], v11 offset:8704
    buffer_load_dwordx4 v[148:151], v6, s[24:27], s61 offen offset:256 sc1
    v_mfma_f32_16x16x32_bf16 v[60:63], v[152:155], v[108:111], v[60:63]
    buffer_load_dwordx4 v[152:155], v6, s[24:27], s61 offen offset:512 sc1
    v_mfma_f32_16x16x32_bf16 v[76:79], v[156:159], v[108:111], v[76:79]
    buffer_load_dwordx4 v[156:159], v6, s[24:27], s61 offen offset:768 sc1
    s_waitcnt vmcnt(11) lgkmcnt(6)
    v_mfma_f32_16x16x32_bf16 v[16:19], v[112:115], v[80:83], v[16:19]
    s_waitcnt vmcnt(10)
    v_mfma_f32_16x16x32_bf16 v[32:35], v[116:119], v[80:83], v[32:35]
    s_waitcnt vmcnt(9)
    v_mfma_f32_16x16x32_bf16 v[48:51], v[120:123], v[80:83], v[48:51]
    s_waitcnt vmcnt(8)
    v_mfma_f32_16x16x32_bf16 v[64:67], v[124:127], v[80:83], v[64:67]
    s_waitcnt lgkmcnt(4)
    v_mfma_f32_16x16x32_bf16 v[20:23], v[112:115], v[84:87], v[20:23]
    v_mfma_f32_16x16x32_bf16 v[36:39], v[116:119], v[84:87], v[36:39]
    v_mfma_f32_16x16x32_bf16 v[52:55], v[120:123], v[84:87], v[52:55]
    ds_read_b64_tr_b16 v[96:97], v8 offset:12288
    v_mfma_f32_16x16x32_bf16 v[68:71], v[124:127], v[84:87], v[68:71]
    ds_read_b64_tr_b16 v[98:99], v8 offset:12800
    s_waitcnt lgkmcnt(4)
    v_mfma_f32_16x16x32_bf16 v[24:27], v[112:115], v[88:91], v[24:27]
    ds_read_b64_tr_b16 v[100:101], v9 offset:12288
    v_mfma_f32_16x16x32_bf16 v[40:43], v[116:119], v[88:91], v[40:43]
    ds_read_b64_tr_b16 v[102:103], v9 offset:12800
    v_mfma_f32_16x16x32_bf16 v[56:59], v[120:123], v[88:91], v[56:59]
    ds_read_b64_tr_b16 v[104:105], v10 offset:12288
    v_mfma_f32_16x16x32_bf16 v[72:75], v[124:127], v[88:91], v[72:75]
    ds_read_b64_tr_b16 v[106:107], v10 offset:12800
    s_waitcnt lgkmcnt(6)
    v_mfma_f32_16x16x32_bf16 v[28:31], v[112:115], v[92:95], v[28:31]
    ds_read_b64_tr_b16 v[108:109], v11 offset:12288
    s_add_u32 s61, s77, 9
    s_sub_u32 s73, s61, 14
    s_min_u32 s61, s61, s73
    s_lshl_b32 s61, s61, 12
    s_add_u32 s61, s61, s60
    buffer_load_dwordx4 v[112:115], v6, s[24:27], s61 offen offset:0 sc1
    v_mfma_f32_16x16x32_bf16 v[44:47], v[116:119], v[92:95], v[44:47]
    ds_read_b64_tr_b16 v[110:111], v11 offset:12800
    buffer_load_dwordx4 v[116:119], v6, s[24:27], s61 offen offset:256 sc1
    v_mfma_f32_16x16x32_bf16 v[60:63], v[120:123], v[92:95], v[60:63]
    buffer_load_dwordx4 v[120:123], v6, s[24:27], s61 offen offset:512 sc1
    v_mfma_f32_16x16x32_bf16 v[76:79], v[124:127], v[92:95], v[76:79]
    buffer_load_dwordx4 v[124:127], v6, s[24:27], s61 offen offset:768 sc1
    s_waitcnt vmcnt(11) lgkmcnt(6)
    v_mfma_f32_16x16x32_bf16 v[16:19], v[128:131], v[96:99], v[16:19]
    s_waitcnt vmcnt(10)
    v_mfma_f32_16x16x32_bf16 v[32:35], v[132:135], v[96:99], v[32:35]
    s_waitcnt vmcnt(9)
    v_mfma_f32_16x16x32_bf16 v[48:51], v[136:139], v[96:99], v[48:51]
    s_waitcnt vmcnt(8)
    v_mfma_f32_16x16x32_bf16 v[64:67], v[140:143], v[96:99], v[64:67]
    s_waitcnt lgkmcnt(4)
    v_mfma_f32_16x16x32_bf16 v[20:23], v[128:131], v[100:103], v[20:23]
    v_mfma_f32_16x16x32_bf16 v[36:39], v[132:135], v[100:103], v[36:39]
    v_mfma_f32_16x16x32_bf16 v[52:55], v[136:139], v[100:103], v[52:55]
    ds_read_b64_tr_b16 v[80:81], v8 offset:16384
    v_mfma_f32_16x16x32_bf16 v[68:71], v[140:143], v[100:103], v[68:71]
    ds_read_b64_tr_b16 v[82:83], v8 offset:16896
    s_waitcnt lgkmcnt(4)
    v_mfma_f32_16x16x32_bf16 v[24:27], v[128:131], v[104:107], v[24:27]
    ds_read_b64_tr_b16 v[84:85], v9 offset:16384
    v_mfma_f32_16x16x32_bf16 v[40:43], v[132:135], v[104:107], v[40:43]
    ds_read_b64_tr_b16 v[86:87], v9 offset:16896
    v_mfma_f32_16x16x32_bf16 v[56:59], v[136:139], v[104:107], v[56:59]
    ds_read_b64_tr_b16 v[88:89], v10 offset:16384
    v_mfma_f32_16x16x32_bf16 v[72:75], v[140:143], v[104:107], v[72:75]
    ds_read_b64_tr_b16 v[90:91], v10 offset:16896
    s_waitcnt lgkmcnt(6)
    v_mfma_f32_16x16x32_bf16 v[28:31], v[128:131], v[108:111], v[28:31]
    ds_read_b64_tr_b16 v[92:93], v11 offset:16384
    s_add_u32 s61, s77, 10
    s_sub_u32 s73, s61, 14
    s_min_u32 s61, s61, s73
    s_lshl_b32 s61, s61, 12
    s_add_u32 s61, s61, s60
    buffer_load_dwordx4 v[128:131], v6, s[24:27], s61 offen offset:0 sc1
    v_mfma_f32_16x16x32_bf16 v[44:47], v[132:135], v[108:111], v[44:47]
    ds_read_b64_tr_b16 v[94:95], v11 offset:16896
    buffer_load_dwordx4 v[132:135], v6, s[24:27], s61 offen offset:256 sc1
    v_mfma_f32_16x16x32_bf16 v[60:63], v[136:139], v[108:111], v[60:63]
    buffer_load_dwordx4 v[136:139], v6, s[24:27], s61 offen offset:512 sc1
    v_mfma_f32_16x16x32_bf16 v[76:79], v[140:143], v[108:111], v[76:79]
    buffer_load_dwordx4 v[140:143], v6, s[24:27], s61 offen offset:768 sc1
    s_waitcnt vmcnt(11) lgkmcnt(6)
    v_mfma_f32_16x16x32_bf16 v[16:19], v[144:147], v[80:83], v[16:19]
    s_waitcnt vmcnt(10)
    v_mfma_f32_16x16x32_bf16 v[32:35], v[148:151], v[80:83], v[32:35]
    s_waitcnt vmcnt(9)
    v_mfma_f32_16x16x32_bf16 v[48:51], v[152:155], v[80:83], v[48:51]
    s_waitcnt vmcnt(8)
    v_mfma_f32_16x16x32_bf16 v[64:67], v[156:159], v[80:83], v[64:67]
    s_waitcnt lgkmcnt(4)
    v_mfma_f32_16x16x32_bf16 v[20:23], v[144:147], v[84:87], v[20:23]
    v_mfma_f32_16x16x32_bf16 v[36:39], v[148:151], v[84:87], v[36:39]
    v_mfma_f32_16x16x32_bf16 v[52:55], v[152:155], v[84:87], v[52:55]
    ds_read_b64_tr_b16 v[96:97], v8 offset:20480
    v_mfma_f32_16x16x32_bf16 v[68:71], v[156:159], v[84:87], v[68:71]
    ds_read_b64_tr_b16 v[98:99], v8 offset:20992
    s_waitcnt lgkmcnt(4)
    v_mfma_f32_16x16x32_bf16 v[24:27], v[144:147], v[88:91], v[24:27]
    ds_read_b64_tr_b16 v[100:101], v9 offset:20480
    v_mfma_f32_16x16x32_bf16 v[40:43], v[148:151], v[88:91], v[40:43]
    ds_read_b64_tr_b16 v[102:103], v9 offset:20992
    v_mfma_f32_16x16x32_bf16 v[56:59], v[152:155], v[88:91], v[56:59]
    ds_read_b64_tr_b16 v[104:105], v10 offset:20480
    v_mfma_f32_16x16x32_bf16 v[72:75], v[156:159], v[88:91], v[72:75]
    ds_read_b64_tr_b16 v[106:107], v10 offset:20992
    s_waitcnt lgkmcnt(6)
    v_mfma_f32_16x16x32_bf16 v[28:31], v[144:147], v[92:95], v[28:31]
    ds_read_b64_tr_b16 v[108:109], v11 offset:20480
    s_add_u32 s61, s77, 11
    s_sub_u32 s73, s61, 14
    s_min_u32 s61, s61, s73
    s_lshl_b32 s61, s61, 12
    s_add_u32 s61, s61, s60
    buffer_load_dwordx4 v[144:147], v6, s[24:27], s61 offen offset:0 sc1
    v_mfma_f32_16x16x32_bf16 v[44:47], v[148:151], v[92:95], v[44:47]
    ds_read_b64_tr_b16 v[110:111], v11 offset:20992
    buffer_load_dwordx4 v[148:151], v6, s[24:27], s61 offen offset:256 sc1
    v_mfma_f32_16x16x32_bf16 v[60:63], v[152:155], v[92:95], v[60:63]
    buffer_load_dwordx4 v[152:155], v6, s[24:27], s61 offen offset:512 sc1
    v_mfma_f32_16x16x32_bf16 v[76:79], v[156:159], v[92:95], v[76:79]
    buffer_load_dwordx4 v[156:159], v6, s[24:27], s61 offen offset:768 sc1
    s_waitcnt vmcnt(11) lgkmcnt(6)
    v_mfma_f32_16x16x32_bf16 v[16:19], v[112:115], v[96:99], v[16:19]
    s_waitcnt vmcnt(10)
    v_mfma_f32_16x16x32_bf16 v[32:35], v[116:119], v[96:99], v[32:35]
    s_waitcnt vmcnt(9)
    v_mfma_f32_16x16x32_bf16 v[48:51], v[120:123], v[96:99], v[48:51]
    s_waitcnt vmcnt(8)
    v_mfma_f32_16x16x32_bf16 v[64:67], v[124:127], v[96:99], v[64:67]
    s_waitcnt lgkmcnt(4)
    v_mfma_f32_16x16x32_bf16 v[20:23], v[112:115], v[100:103], v[20:23]
    v_mfma_f32_16x16x32_bf16 v[36:39], v[116:119], v[100:103], v[36:39]
    v_mfma_f32_16x16x32_bf16 v[52:55], v[120:123], v[100:103], v[52:55]
    ds_read_b64_tr_b16 v[80:81], v8 offset:24576
    v_mfma_f32_16x16x32_bf16 v[68:71], v[124:127], v[100:103], v[68:71]
    ds_read_b64_tr_b16 v[82:83], v8 offset:25088
    s_waitcnt lgkmcnt(4)
    v_mfma_f32_16x16x32_bf16 v[24:27], v[112:115], v[104:107], v[24:27]
    ds_read_b64_tr_b16 v[84:85], v9 offset:24576
    v_mfma_f32_16x16x32_bf16 v[40:43], v[116:119], v[104:107], v[40:43]
    ds_read_b64_tr_b16 v[86:87], v9 offset:25088
    v_mfma_f32_16x16x32_bf16 v[56:59], v[120:123], v[104:107], v[56:59]
    ds_read_b64_tr_b16 v[88:89], v10 offset:24576
    v_mfma_f32_16x16x32_bf16 v[72:75], v[124:127], v[104:107], v[72:75]
    ds_read_b64_tr_b16 v[90:91], v10 offset:25088
    s_waitcnt lgkmcnt(6)
    v_mfma_f32_16x16x32_bf16 v[28:31], v[112:115], v[108:111], v[28:31]
    ds_read_b64_tr_b16 v[92:93], v11 offset:24576
    s_add_u32 s61, s77, 12
    s_sub_u32 s73, s61, 14
    s_min_u32 s61, s61, s73
    s_lshl_b32 s61, s61, 12
    s_add_u32 s61, s61, s60
    buffer_load_dwordx4 v[112:115], v6, s[24:27], s61 offen offset:0 sc1
    v_mfma_f32_16x16x32_bf16 v[44:47], v[116:119], v[108:111], v[44:47]
    ds_read_b64_tr_b16 v[94:95], v11 offset:25088
    buffer_load_dwordx4 v[116:119], v6, s[24:27], s61 offen offset:256 sc1
    v_mfma_f32_16x16x32_bf16 v[60:63], v[120:123], v[108:111], v[60:63]
    buffer_load_dwordx4 v[120:123], v6, s[24:27], s61 offen offset:512 sc1
    v_mfma_f32_16x16x32_bf16 v[76:79], v[124:127], v[108:111], v[76:79]
    buffer_load_dwordx4 v[124:127], v6, s[24:27], s61 offen offset:768 sc1
    s_waitcnt vmcnt(11) lgkmcnt(6)
    v_mfma_f32_16x16x32_bf16 v[16:19], v[128:131], v[80:83], v[16:19]
    s_waitcnt vmcnt(10)
    v_mfma_f32_16x16x32_bf16 v[32:35], v[132:135], v[80:83], v[32:35]
    s_waitcnt vmcnt(9)
    v_mfma_f32_16x16x32_bf16 v[48:51], v[136:139], v[80:83], v[48:51]
    s_waitcnt vmcnt(8)
    v_mfma_f32_16x16x32_bf16 v[64:67], v[140:143], v[80:83], v[64:67]
    s_waitcnt lgkmcnt(4)
    v_mfma_f32_16x16x32_bf16 v[20:23], v[128:131], v[84:87], v[20:23]
    v_mfma_f32_16x16x32_bf16 v[36:39], v[132:135], v[84:87], v[36:39]
    v_mfma_f32_16x16x32_bf16 v[52:55], v[136:139], v[84:87], v[52:55]
    ds_read_b64_tr_b16 v[96:97], v8 offset:28672
    v_mfma_f32_16x16x32_bf16 v[68:71], v[140:143], v[84:87], v[68:71]
    ds_read_b64_tr_b16 v[98:99], v8 offset:29184
    s_waitcnt lgkmcnt(4)
    v_mfma_f32_16x16x32_bf16 v[24:27], v[128:131], v[88:91], v[24:27]
    ds_read_b64_tr_b16 v[100:101], v9 offset:28672
    v_mfma_f32_16x16x32_bf16 v[40:43], v[132:135], v[88:91], v[40:43]
    ds_read_b64_tr_b16 v[102:103], v9 offset:29184
    v_mfma_f32_16x16x32_bf16 v[56:59], v[136:139], v[88:91], v[56:59]
    ds_read_b64_tr_b16 v[104:105], v10 offset:28672
    v_mfma_f32_16x16x32_bf16 v[72:75], v[140:143], v[88:91], v[72:75]
    ds_read_b64_tr_b16 v[106:107], v10 offset:29184
    s_waitcnt lgkmcnt(6)
    v_mfma_f32_16x16x32_bf16 v[28:31], v[128:131], v[92:95], v[28:31]
    ds_read_b64_tr_b16 v[108:109], v11 offset:28672
    s_add_u32 s61, s77, 13
    s_sub_u32 s73, s61, 14
    s_min_u32 s61, s61, s73
    s_lshl_b32 s61, s61, 12
    s_add_u32 s61, s61, s60
    buffer_load_dwordx4 v[128:131], v6, s[24:27], s61 offen offset:0 sc1
    v_mfma_f32_16x16x32_bf16 v[44:47], v[132:135], v[92:95], v[44:47]
    ds_read_b64_tr_b16 v[110:111], v11 offset:29184
    buffer_load_dwordx4 v[132:135], v6, s[24:27], s61 offen offset:256 sc1
    v_mfma_f32_16x16x32_bf16 v[60:63], v[136:139], v[92:95], v[60:63]
    buffer_load_dwordx4 v[136:139], v6, s[24:27], s61 offen offset:512 sc1
    v_mfma_f32_16x16x32_bf16 v[76:79], v[140:143], v[92:95], v[76:79]
    buffer_load_dwordx4 v[140:143], v6, s[24:27], s61 offen offset:768 sc1
    s_waitcnt vmcnt(11) lgkmcnt(6)
    v_mfma_f32_16x16x32_bf16 v[16:19], v[144:147], v[96:99], v[16:19]
    s_waitcnt vmcnt(10)
    v_mfma_f32_16x16x32_bf16 v[32:35], v[148:151], v[96:99], v[32:35]
    s_waitcnt vmcnt(9)
    v_mfma_f32_16x16x32_bf16 v[48:51], v[152:155], v[96:99], v[48:51]
    s_waitcnt vmcnt(8)
    v_mfma_f32_16x16x32_bf16 v[64:67], v[156:159], v[96:99], v[64:67]
    s_waitcnt lgkmcnt(4)
    v_mfma_f32_16x16x32_bf16 v[20:23], v[144:147], v[100:103], v[20:23]
    v_mfma_f32_16x16x32_bf16 v[36:39], v[148:151], v[100:103], v[36:39]
    v_mfma_f32_16x16x32_bf16 v[52:55], v[152:155], v[100:103], v[52:55]
    ds_read_b64_tr_b16 v[80:81], v8 offset:0
    v_mfma_f32_16x16x32_bf16 v[68:71], v[156:159], v[100:103], v[68:71]
    ds_read_b64_tr_b16 v[82:83], v8 offset:512
    s_waitcnt lgkmcnt(4)
    v_mfma_f32_16x16x32_bf16 v[24:27], v[144:147], v[104:107], v[24:27]
    ds_read_b64_tr_b16 v[84:85], v9 offset:0
    v_mfma_f32_16x16x32_bf16 v[40:43], v[148:151], v[104:107], v[40:43]
    ds_read_b64_tr_b16 v[86:87], v9 offset:512
    v_mfma_f32_16x16x32_bf16 v[56:59], v[152:155], v[104:107], v[56:59]
    ds_read_b64_tr_b16 v[88:89], v10 offset:0
    v_mfma_f32_16x16x32_bf16 v[72:75], v[156:159], v[104:107], v[72:75]
    ds_read_b64_tr_b16 v[90:91], v10 offset:512
    s_waitcnt lgkmcnt(6)
    v_mfma_f32_16x16x32_bf16 v[28:31], v[144:147], v[108:111], v[28:31]
    ds_read_b64_tr_b16 v[92:93], v11 offset:0
    v_mfma_f32_16x16x32_bf16 v[44:47], v[148:151], v[108:111], v[44:47]
    ds_read_b64_tr_b16 v[94:95], v11 offset:512
    v_mfma_f32_16x16x32_bf16 v[60:63], v[152:155], v[108:111], v[60:63]
    v_mfma_f32_16x16x32_bf16 v[76:79], v[156:159], v[108:111], v[76:79]
    s_waitcnt vmcnt(7) lgkmcnt(6)
    v_mfma_f32_16x16x32_bf16 v[16:19], v[112:115], v[80:83], v[16:19]
    s_waitcnt vmcnt(6)
    v_mfma_f32_16x16x32_bf16 v[32:35], v[116:119], v[80:83], v[32:35]
    s_waitcnt vmcnt(5)
    v_mfma_f32_16x16x32_bf16 v[48:51], v[120:123], v[80:83], v[48:51]
    s_waitcnt vmcnt(4)
    v_mfma_f32_16x16x32_bf16 v[64:67], v[124:127], v[80:83], v[64:67]
    s_waitcnt lgkmcnt(4)
    v_mfma_f32_16x16x32_bf16 v[20:23], v[112:115], v[84:87], v[20:23]
    v_mfma_f32_16x16x32_bf16 v[36:39], v[116:119], v[84:87], v[36:39]
    v_mfma_f32_16x16x32_bf16 v[52:55], v[120:123], v[84:87], v[52:55]
    ds_read_b64_tr_b16 v[96:97], v8 offset:4096
    v_mfma_f32_16x16x32_bf16 v[68:71], v[124:127], v[84:87], v[68:71]
    ds_read_b64_tr_b16 v[98:99], v8 offset:4608
    s_waitcnt lgkmcnt(4)
    v_mfma_f32_16x16x32_bf16 v[24:27], v[112:115], v[88:91], v[24:27]
    ds_read_b64_tr_b16 v[100:101], v9 offset:4096
    v_mfma_f32_16x16x32_bf16 v[40:43], v[116:119], v[88:91], v[40:43]
    ds_read_b64_tr_b16 v[102:103], v9 offset:4608
    v_mfma_f32_16x16x32_bf16 v[56:59], v[120:123], v[88:91], v[56:59]
    ds_read_b64_tr_b16 v[104:105], v10 offset:4096
    v_mfma_f32_16x16x32_bf16 v[72:75], v[124:127], v[88:91], v[72:75]
    ds_read_b64_tr_b16 v[106:107], v10 offset:4608
    s_waitcnt lgkmcnt(6)
    v_mfma_f32_16x16x32_bf16 v[28:31], v[112:115], v[92:95], v[28:31]
    ds_read_b64_tr_b16 v[108:109], v11 offset:4096
    v_mfma_f32_16x16x32_bf16 v[44:47], v[116:119], v[92:95], v[44:47]
    ds_read_b64_tr_b16 v[110:111], v11 offset:4608
    v_mfma_f32_16x16x32_bf16 v[60:63], v[120:123], v[92:95], v[60:63]
    v_mfma_f32_16x16x32_bf16 v[76:79], v[124:127], v[92:95], v[76:79]
    s_waitcnt vmcnt(3) lgkmcnt(6)
    v_mfma_f32_16x16x32_bf16 v[16:19], v[128:131], v[96:99], v[16:19]
    s_waitcnt vmcnt(2)
    v_mfma_f32_16x16x32_bf16 v[32:35], v[132:135], v[96:99], v[32:35]
    s_waitcnt vmcnt(1)
    v_mfma_f32_16x16x32_bf16 v[48:51], v[136:139], v[96:99], v[48:51]
    s_waitcnt vmcnt(0)
    v_mfma_f32_16x16x32_bf16 v[64:67], v[140:143], v[96:99], v[64:67]
    s_waitcnt lgkmcnt(4)
    v_mfma_f32_16x16x32_bf16 v[20:23], v[128:131], v[100:103], v[20:23]
    v_mfma_f32_16x16x32_bf16 v[36:39], v[132:135], v[100:103], v[36:39]
    v_mfma_f32_16x16x32_bf16 v[52:55], v[136:139], v[100:103], v[52:55]
    v_mfma_f32_16x16x32_bf16 v[68:71], v[140:143], v[100:103], v[68:71]
    s_waitcnt lgkmcnt(2)
    v_mfma_f32_16x16x32_bf16 v[24:27], v[128:131], v[104:107], v[24:27]
    ds_write_b128 v4, v[16:19] offset:8192
    v_mfma_f32_16x16x32_bf16 v[40:43], v[132:135], v[104:107], v[40:43]
    ds_write_b128 v5, v[32:35] offset:12288
    v_mfma_f32_16x16x32_bf16 v[56:59], v[136:139], v[104:107], v[56:59]
    ds_write_b128 v4, v[48:51] offset:16384
    v_mfma_f32_16x16x32_bf16 v[72:75], v[140:143], v[104:107], v[72:75]
    ds_write_b128 v5, v[64:67] offset:20480
    s_waitcnt lgkmcnt(4)
    v_mfma_f32_16x16x32_bf16 v[28:31], v[128:131], v[108:111], v[28:31]
    ds_write_b128 v4, v[20:23] offset:9216
    v_mfma_f32_16x16x32_bf16 v[44:47], v[132:135], v[108:111], v[44:47]
    ds_write_b128 v5, v[36:39] offset:13312
    v_mfma_f32_16x16x32_bf16 v[60:63], v[136:139], v[108:111], v[60:63]
    ds_write_b128 v4, v[52:55] offset:17408
    v_mfma_f32_16x16x32_bf16 v[76:79], v[140:143], v[108:111], v[76:79]
    ds_write_b128 v5, v[68:71] offset:21504
    ds_write_b128 v4, v[24:27] offset:10240
    ds_write_b128 v5, v[40:43] offset:14336
    ds_write_b128 v4, v[56:59] offset:18432
    ds_write_b128 v5, v[72:75] offset:22528
    ds_write_b128 v4, v[28:31] offset:11264
    ds_write_b128 v5, v[44:47] offset:15360
    ds_write_b128 v4, v[60:63] offset:19456
    ds_write_b128 v5, v[76:79] offset:23552
    v_mov_b32 v10, v12
    v_mov_b32 v11, v13
    s_waitcnt lgkmcnt(0)
    s_nop 3
    s_branch L_g2red
L_g2help:
    s_setprio 3
    s_waitcnt vmcnt(0)
    v_mov_b32 v12, 163780
    v_mov_b32 v13, 1
    s_mov_b64 exec, 1
    ds_add_rtn_u32 v13, v12, v13
    s_mov_b64 exec, -1
    s_waitcnt lgkmcnt(0)
    v_readfirstlane_b32 s78, v13
    s_nop 0
    s_cmp_lg_u32 s78, 7
    s_cbranch_scc1 L_arr_58
    v_mov_b32 v13, s51
    v_lshlrev_b32 v12, 17, v2
    v_add_u32 v12, 12582912, v12
    s_mov_b64 exec, 255
    buffer_store_dword v13, v12, s[24:27], s72 offen sc1
    s_mov_b64 exec, -1
    s_nop 1
L_arr_58:
    s_nop 1
L_g2help2:
    s_cmp_lg_u32 s48, 7
    s_nop 0
    s_cbranch_scc1 L_nofg_59
    s_lshr_b32 s62, s57, 4
    s_lshl_b32 s62, s62, 12
    s_add_u32 s62, s62, 12640256
    v_min_u32 v12, 63, v2
    v_lshlrev_b32 v12, 6, v12
    v_add_u32 v12, s6, v12
    s_mov_b32 s79, 50000
    s_nop 3
L_gp_60:
    buffer_load_dword v4, v12, s[24:27], s62 offen sc1
    s_sub_u32 s79, s79, 1
    s_waitcnt vmcnt(0)
L_gpc_62:
    v_cmp_ne_u32 vcc, s51, v4
    s_nop 1
    s_cmp_eq_u64 vcc, 0
    s_cbranch_scc1 L_gpd_61
    s_cmp_eq_u32 s79, 0
    s_cbranch_scc1 L_gpd_61
    s_mov_b64 exec, vcc
    s_sleep 2
    s_branch L_gp_60
L_gpd_61:
    s_mov_b64 exec, -1
L_nofg_59:
    s_setprio 0
    s_barrier
L_g2help3:
    s_bfe_u32 s64, s48, 0x10001
    s_and_b32 s65, s48, 1
    v_and_b32 v4, 15, v2
    v_lshrrev_b32 v5, 4, v2
    v_lshlrev_b32 v6, 15, v5
    v_lshl_add_u32 v6, v4, 4, v6
    s_lshl_b32 s62, s64, 10
    s_add_u32 s62, s62, 32768
    s_lshl_b32 s66, s64, 20
    s_lshl_b32 s67, s57, 10
    s_add_u32 s66, s66, s67
    s_lshl_b32 s67, s65, 9
    s_add_u32 s66, s66, s67
    s_add_u32 s66, s66, 9437184
    s_add_u32 s62, s62, 12582912
    v_min_u32 v12, 15, v2
    v_lshlrev_b32 v12, 6, v12
    v_add_u32 v12, s6, v12
    s_mov_b32 s79, 50000
    s_nop 3
L_gp_63:
    buffer_load_dword v14, v12, s[24:27], s62 offen sc1
    s_sub_u32 s79, s79, 1
    s_waitcnt vmcnt(0)
L_gpc_65:
    v_cmp_ne_u32 vcc, s51, v14
    s_nop 1
    s_cmp_eq_u64 vcc, 0
    s_cbranch_scc1 L_gpd_64
    s_cmp_eq_u32 s79, 0
    s_cbranch_scc1 L_gpd_64
    s_mov_b64 exec, vcc
    s_sleep 40
    s_branch L_gp_63
L_gpd_64:
    s_mov_b64 exec, -1
    v_lshrrev_b32 v12, 3, v0
    s_lshr_b32 s69, s57, 4
    s_lshl_b32 s69, s69, 12
    s_and_b32 s70, s57, 15
    s_lshl_b32 s70, s70, 2
    s_add_u32 s69, s69, s70
    s_add_u32 s69, s69, 11534336
    v_lshlrev_b32 v13, 6, v12
    buffer_load_dword v10, v13, s[24:27], s69 offen sc1
    v_mov_b32 v11, 0
    v_lshlrev_b32 v12, 1, v12
    s_lshl_b32 s70, s57, 7
    buffer_load_short_d16_hi v11, v12, s[44:47], s70 offen
    buffer_load_dwordx4 v[48:51], v6, s[24:27], s66 offen offset:0 sc1
    buffer_load_dwordx4 v[52:55], v6, s[24:27], s66 offen offset:256 sc1
    s_add_u32 s66, s66, 131072
    buffer_load_dwordx4 v[56:59], v6, s[24:27], s66 offen offset:0 sc1
    buffer_load_dwordx4 v[60:63], v6, s[24:27], s66 offen offset:256 sc1
    s_add_u32 s66, s66, 131072
    buffer_load_dwordx4 v[64:67], v6, s[24:27], s66 offen offset:0 sc1
    buffer_load_dwordx4 v[68:71], v6, s[24:27], s66 offen offset:256 sc1
    s_add_u32 s66, s66, 131072
    buffer_load_dwordx4 v[72:75], v6, s[24:27], s66 offen offset:0 sc1
    buffer_load_dwordx4 v[76:79], v6, s[24:27], s66 offen offset:256 sc1
    s_add_u32 s66, s66, 131072
    buffer_load_dwordx4 v[80:83], v6, s[24:27], s66 offen offset:0 sc1
    buffer_load_dwordx4 v[84:87], v6, s[24:27], s66 offen offset:256 sc1
    s_add_u32 s66, s66, 131072
    buffer_load_dwordx4 v[88:91], v6, s[24:27], s66 offen offset:0 sc1
    buffer_load_dwordx4 v[92:95], v6, s[24:27], s66 offen offset:256 sc1
    s_add_u32 s66, s66, 131072
    buffer_load_dwordx4 v[96:99], v6, s[24:27], s66 offen offset:0 sc1
    buffer_load_dwordx4 v[100:103], v6, s[24:27], s66 offen offset:256 sc1
    s_add_u32 s66, s66, 131072
    buffer_load_dwordx4 v[104:107], v6, s[24:27], s66 offen offset:0 sc1
    buffer_load_dwordx4 v[108:111], v6, s[24:27], s66 offen offset:256 sc1
    s_waitcnt vmcnt(15)
    v_mfma_f32_16x16x32_bf16 v[16:19], v[112:115], v[48:51], 0
    s_waitcnt vmcnt(14)
    v_mfma_f32_16x16x32_bf16 v[20:23], v[112:115], v[52:55], 0
    v_mfma_f32_16x16x32_bf16 v[24:27], v[116:119], v[48:51], 0
    v_mfma_f32_16x16x32_bf16 v[28:31], v[116:119], v[52:55], 0
    v_mfma_f32_16x16x32_bf16 v[32:35], v[120:123], v[48:51], 0
    v_mfma_f32_16x16x32_bf16 v[36:39], v[120:123], v[52:55], 0
    v_mfma_f32_16x16x32_bf16 v[40:43], v[124:127], v[48:51], 0
    v_mfma_f32_16x16x32_bf16 v[44:47], v[124:127], v[52:55], 0
    s_waitcnt vmcnt(13)
    v_mfma_f32_16x16x32_bf16 v[16:19], v[128:131], v[56:59], v[16:19]
    s_waitcnt vmcnt(12)
    v_mfma_f32_16x16x32_bf16 v[20:23], v[128:131], v[60:63], v[20:23]
    v_mfma_f32_16x16x32_bf16 v[24:27], v[132:135], v[56:59], v[24:27]
    v_mfma_f32_16x16x32_bf16 v[28:31], v[132:135], v[60:63], v[28:31]
    v_mfma_f32_16x16x32_bf16 v[32:35], v[136:139], v[56:59], v[32:35]
    v_mfma_f32_16x16x32_bf16 v[36:39], v[136:139], v[60:63], v[36:39]
    v_mfma_f32_16x16x32_bf16 v[40:43], v[140:143], v[56:59], v[40:43]
    v_mfma_f32_16x16x32_bf16 v[44:47], v[140:143], v[60:63], v[44:47]
    s_waitcnt vmcnt(11)
    v_mfma_f32_16x16x32_bf16 v[16:19], v[144:147], v[64:67], v[16:19]
    s_waitcnt vmcnt(10)
    v_mfma_f32_16x16x32_bf16 v[20:23], v[144:147], v[68:71], v[20:23]
    v_mfma_f32_16x16x32_bf16 v[24:27], v[148:151], v[64:67], v[24:27]
    v_mfma_f32_16x16x32_bf16 v[28:31], v[148:151], v[68:71], v[28:31]
    v_mfma_f32_16x16x32_bf16 v[32:35], v[152:155], v[64:67], v[32:35]
    v_mfma_f32_16x16x32_bf16 v[36:39], v[152:155], v[68:71], v[36:39]
    v_mfma_f32_16x16x32_bf16 v[40:43], v[156:159], v[64:67], v[40:43]
    v_mfma_f32_16x16x32_bf16 v[44:47], v[156:159], v[68:71], v[44:47]
    s_waitcnt vmcnt(9)
    v_mfma_f32_16x16x32_bf16 v[16:19], v[160:163], v[72:75], v[16:19]
    s_waitcnt vmcnt(8)
    v_mfma_f32_16x16x32_bf16 v[20:23], v[160:163], v[76:79], v[20:23]
    v_mfma_f32_16x16x32_bf16 v[24:27], v[164:167], v[72:75], v[24:27]
    v_mfma_f32_16x16x32_bf16 v[28:31], v[164:167], v[76:79], v[28:31]
    v_mfma_f32_16x16x32_bf16 v[32:35], v[168:171], v[72:75], v[32:35]
    v_mfma_f32_16x16x32_bf16 v[36:39], v[168:171], v[76:79], v[36:39]
    v_mfma_f32_16x16x32_bf16 v[40:43], v[172:175], v[72:75], v[40:43]
    v_mfma_f32_16x16x32_bf16 v[44:47], v[172:175], v[76:79], v[44:47]
    s_waitcnt vmcnt(7)
    v_mfma_f32_16x16x32_bf16 v[16:19], v[176:179], v[80:83], v[16:19]
    s_waitcnt vmcnt(6)
    v_mfma_f32_16x16x32_bf16 v[20:23], v[176:179], v[84:87], v[20:23]
    v_mfma_f32_16x16x32_bf16 v[24:27], v[180:183], v[80:83], v[24:27]
    v_mfma_f32_16x16x32_bf16 v[28:31], v[180:183], v[84:87], v[28:31]
    v_mfma_f32_16x16x32_bf16 v[32:35], v[184:187], v[80:83], v[32:35]
    v_mfma_f32_16x16x32_bf16 v[36:39], v[184:187], v[84:87], v[36:39]
    v_mfma_f32_16x16x32_bf16 v[40:43], v[188:191], v[80:83], v[40:43]
    v_mfma_f32_16x16x32_bf16 v[44:47], v[188:191], v[84:87], v[44:47]
    s_waitcnt vmcnt(5)
    v_mfma_f32_16x16x32_bf16 v[16:19], v[192:195], v[88:91], v[16:19]
    s_waitcnt vmcnt(4)
    v_mfma_f32_16x16x32_bf16 v[20:23], v[192:195], v[92:95], v[20:23]
    v_mfma_f32_16x16x32_bf16 v[24:27], v[196:199], v[88:91], v[24:27]
    v_mfma_f32_16x16x32_bf16 v[28:31], v[196:199], v[92:95], v[28:31]
    v_mfma_f32_16x16x32_bf16 v[32:35], v[200:203], v[88:91], v[32:35]
    v_mfma_f32_16x16x32_bf16 v[36:39], v[200:203], v[92:95], v[36:39]
    v_mfma_f32_16x16x32_bf16 v[40:43], v[204:207], v[88:91], v[40:43]
    v_mfma_f32_16x16x32_bf16 v[44:47], v[204:207], v[92:95], v[44:47]
    s_waitcnt vmcnt(3)
    v_mfma_f32_16x16x32_bf16 v[16:19], v[208:211], v[96:99], v[16:19]
    s_waitcnt vmcnt(2)
    v_mfma_f32_16x16x32_bf16 v[20:23], v[208:211], v[100:103], v[20:23]
    v_mfma_f32_16x16x32_bf16 v[24:27], v[212:215], v[96:99], v[24:27]
    v_mfma_f32_16x16x32_bf16 v[28:31], v[212:215], v[100:103], v[28:31]
    v_mfma_f32_16x16x32_bf16 v[32:35], v[216:219], v[96:99], v[32:35]
    v_mfma_f32_16x16x32_bf16 v[36:39], v[216:219], v[100:103], v[36:39]
    v_mfma_f32_16x16x32_bf16 v[40:43], v[220:223], v[96:99], v[40:43]
    v_mfma_f32_16x16x32_bf16 v[44:47], v[220:223], v[100:103], v[44:47]
    s_waitcnt vmcnt(1)
    v_mfma_f32_16x16x32_bf16 v[16:19], v[224:227], v[104:107], v[16:19]
    s_waitcnt vmcnt(0)
    v_mfma_f32_16x16x32_bf16 v[20:23], v[224:227], v[108:111], v[20:23]
    v_mfma_f32_16x16x32_bf16 v[24:27], v[228:231], v[104:107], v[24:27]
    v_mfma_f32_16x16x32_bf16 v[28:31], v[228:231], v[108:111], v[28:31]
    v_mfma_f32_16x16x32_bf16 v[32:35], v[232:235], v[104:107], v[32:35]
    v_mfma_f32_16x16x32_bf16 v[36:39], v[232:235], v[108:111], v[36:39]
    v_mfma_f32_16x16x32_bf16 v[40:43], v[236:239], v[104:107], v[40:43]
    v_mfma_f32_16x16x32_bf16 v[44:47], v[236:239], v[108:111], v[44:47]
    s_lshl_b32 s66, s64, 14
    s_lshl_b32 s67, s65, 11
    s_add_u32 s66, s66, s67
    s_add_u32 s66, s66, 131072
    v_lshrrev_b32 v12, 5, v2
    v_lshlrev_b32 v12, 6, v12
    v_xor_b32 v12, v12, v3
    v_add_u32 v12, s66, v12
    v_xor_b32 v13, 128, v12
    ds_write_b128 v12, v[16:19] offset:0
    ds_write_b128 v12, v[20:23] offset:1024
    ds_write_b128 v13, v[24:27] offset:4096
    ds_write_b128 v13, v[28:31] offset:5120
    ds_write_b128 v12, v[32:35] offset:8192
    ds_write_b128 v12, v[36:39] offset:9216
    ds_write_b128 v13, v[40:43] offset:12288
    ds_write_b128 v13, v[44:47] offset:13312
    s_waitcnt lgkmcnt(0)
    s_setprio 0
L_g2red:
    v_lshrrev_b32 v4, 3, v0
    s_lshl_b32 s68, s57, 6
    v_add_u32 v5, s68, v4
    v_and_b32 v6, 7, v0
    v_lshrrev_b32 v7, 1, v6
    v_lshlrev_b32 v7, 12, v7
    v_lshrrev_b32 v8, 4, v4
    v_lshl_add_u32 v7, v8, 10, v7
    v_and_b32 v8, 1, v6
    v_lshl_add_u32 v7, v8, 9, v7
    v_and_b32 v8, 3, v6
    v_lshlrev_b32 v8, 2, v8
    v_and_b32 v9, 15, v4
    v_xor_b32 v8, v8, v9
    v_lshl_add_u32 v7, v8, 4, v7
    v_add_u32 v12, 131072, v7
    v_add_u32 v8, 65536, v7
    v_lshlrev_b32 v9, 10, v5
    v_lshl_add_u32 v9, v6, 4, v9
    s_lshl_b32 s70, s56, 7
    s_barrier
    ds_read_b128 v[16:19], v7 offset:8192
    ds_read_b128 v[20:23], v7 offset:8448
    ds_read_b128 v[24:27], v7 offset:40960
    ds_read_b128 v[28:31], v7 offset:41216
    ds_read_b128 v[32:35], v8 offset:8192
    ds_read_b128 v[36:39], v8 offset:8448
    ds_read_b128 v[40:43], v8 offset:40960
    ds_read_b128 v[44:47], v8 offset:41216
    ds_read_b128 v[48:51], v12 offset:0
    ds_read_b128 v[52:55], v12 offset:256
    ds_read_b128 v[56:59], v12 offset:16384
    ds_read_b128 v[60:63], v12 offset:16640
    v_sub_f32 v68, 1.0, v10
    v_cvt_pk_bf16_f32 v68, v68, v68
    v_lshlrev_b32 v68, 16, v68
    v_mov_b32 v69, v68
    v_mov_b32 v70, v10
    v_mov_b32 v71, v10
    v_mov_b32 v72, v11
    v_mov_b32 v73, v11
    v_mov_b32 v74, 0x36000000
    v_mov_b32 v75, 0x36000000
    s_waitcnt lgkmcnt(9)
    v_pk_add_f32 v[16:17], v[16:17], v[24:25]
    v_pk_add_f32 v[18:19], v[18:19], v[26:27]
    s_waitcnt lgkmcnt(8)
    v_pk_add_f32 v[20:21], v[20:21], v[28:29]
    v_pk_add_f32 v[22:23], v[22:23], v[30:31]
    s_waitcnt lgkmcnt(5)
    v_pk_add_f32 v[32:33], v[32:33], v[40:41]
    v_pk_add_f32 v[34:35], v[34:35], v[42:43]
    s_waitcnt lgkmcnt(4)
    v_pk_add_f32 v[36:37], v[36:37], v[44:45]
    v_pk_add_f32 v[38:39], v[38:39], v[46:47]
    v_pk_add_f32 v[16:17], v[16:17], v[32:33]
    v_pk_add_f32 v[18:19], v[18:19], v[34:35]
    v_pk_add_f32 v[20:21], v[20:21], v[36:37]
    v_pk_add_f32 v[22:23], v[22:23], v[38:39]
    s_waitcnt lgkmcnt(1)
    v_pk_add_f32 v[48:49], v[48:49], v[56:57]
    v_pk_add_f32 v[50:51], v[50:51], v[58:59]
    s_waitcnt lgkmcnt(0)
    v_pk_add_f32 v[52:53], v[52:53], v[60:61]
    v_pk_add_f32 v[54:55], v[54:55], v[62:63]
    v_cvt_pk_bf16_f32 v24, v16, v17
    v_cvt_pk_bf16_f32 v25, v18, v19
    v_cvt_pk_bf16_f32 v26, v20, v21
    v_cvt_pk_bf16_f32 v27, v22, v23
    v_lshlrev_b32 v16, 16, v24
    v_and_b32 v17, 0xffff0000, v24
    v_lshlrev_b32 v18, 16, v25
    v_and_b32 v19, 0xffff0000, v25
    v_lshlrev_b32 v20, 16, v26
    v_and_b32 v21, 0xffff0000, v26
    v_lshlrev_b32 v22, 16, v27
    v_and_b32 v23, 0xffff0000, v27
    v_pk_mul_f32 v[48:49], v[48:49], v[74:75]
    v_pk_mul_f32 v[50:51], v[50:51], v[74:75]
    v_pk_mul_f32 v[52:53], v[52:53], v[74:75]
    v_pk_mul_f32 v[54:55], v[54:55], v[74:75]
    v_pk_add_f32 v[16:17], v[16:17], v[72:73]
    v_pk_add_f32 v[18:19], v[18:19], v[72:73]
    v_pk_add_f32 v[20:21], v[20:21], v[72:73]
    v_pk_add_f32 v[22:23], v[22:23], v[72:73]
    v_cvt_pk_bf16_f32 v56, v48, v49
    v_cvt_pk_bf16_f32 v57, v50, v51
    v_cvt_pk_bf16_f32 v58, v52, v53
    v_cvt_pk_bf16_f32 v59, v54, v55
    v_lshlrev_b32 v48, 16, v56
    v_and_b32 v49, 0xffff0000, v56
    v_lshlrev_b32 v50, 16, v57
    v_and_b32 v51, 0xffff0000, v57
    v_lshlrev_b32 v52, 16, v58
    v_and_b32 v53, 0xffff0000, v58
    v_lshlrev_b32 v54, 16, v59
    v_and_b32 v55, 0xffff0000, v59
    v_cvt_pk_bf16_f32 v24, v16, v17
    v_cvt_pk_bf16_f32 v25, v18, v19
    v_cvt_pk_bf16_f32 v26, v20, v21
    v_cvt_pk_bf16_f32 v27, v22, v23
    v_lshlrev_b32 v16, 16, v24
    v_and_b32 v17, 0xffff0000, v24
    v_lshlrev_b32 v18, 16, v25
    v_and_b32 v19, 0xffff0000, v25
    v_lshlrev_b32 v20, 16, v26
    v_and_b32 v21, 0xffff0000, v26
    v_lshlrev_b32 v22, 16, v27
    v_and_b32 v23, 0xffff0000, v27
    v_pk_mul_f32 v[48:49], v[48:49], v[70:71]
    v_pk_mul_f32 v[50:51], v[50:51], v[70:71]
    v_pk_mul_f32 v[52:53], v[52:53], v[70:71]
    v_pk_mul_f32 v[54:55], v[54:55], v[70:71]
    v_pk_mul_f32 v[16:17], v[16:17], v[68:69]
    v_pk_mul_f32 v[18:19], v[18:19], v[68:69]
    v_pk_mul_f32 v[20:21], v[20:21], v[68:69]
    v_pk_mul_f32 v[22:23], v[22:23], v[68:69]
    v_cvt_pk_bf16_f32 v56, v48, v49
    v_cvt_pk_bf16_f32 v57, v50, v51
    v_cvt_pk_bf16_f32 v58, v52, v53
    v_cvt_pk_bf16_f32 v59, v54, v55
    v_lshlrev_b32 v48, 16, v56
    v_and_b32 v49, 0xffff0000, v56
    v_lshlrev_b32 v50, 16, v57
    v_and_b32 v51, 0xffff0000, v57
    v_lshlrev_b32 v52, 16, v58
    v_and_b32 v53, 0xffff0000, v58
    v_lshlrev_b32 v54, 16, v59
    v_and_b32 v55, 0xffff0000, v59
    v_cvt_pk_bf16_f32 v24, v16, v17
    v_cvt_pk_bf16_f32 v25, v18, v19
    v_cvt_pk_bf16_f32 v26, v20, v21
    v_cvt_pk_bf16_f32 v27, v22, v23
    v_lshlrev_b32 v16, 16, v24
    v_and_b32 v17, 0xffff0000, v24
    v_lshlrev_b32 v18, 16, v25
    v_and_b32 v19, 0xffff0000, v25
    v_lshlrev_b32 v20, 16, v26
    v_and_b32 v21, 0xffff0000, v26
    v_lshlrev_b32 v22, 16, v27
    v_and_b32 v23, 0xffff0000, v27
    v_pk_add_f32 v[48:49], v[48:49], v[16:17]
    v_pk_add_f32 v[50:51], v[50:51], v[18:19]
    v_pk_add_f32 v[52:53], v[52:53], v[20:21]
    v_pk_add_f32 v[54:55], v[54:55], v[22:23]
    v_cvt_pk_bf16_f32 v16, v48, v49
    v_cvt_pk_bf16_f32 v17, v50, v51
    v_cvt_pk_bf16_f32 v18, v52, v53
    v_cvt_pk_bf16_f32 v19, v54, v55
    buffer_store_dwordx4 v[16:19], v9, s[40:43], s70 offen
    s_or_b32 s71, s2, s48
    s_cmp_lg_u32 s71, 0
    s_cbranch_scc1 L_noep
    s_mov_b32 s72, 40960
    s_add_u32 s72, s72, 12582912
    v_mov_b32 v13, s51
    v_mov_b32 v14, 0
    s_mov_b64 exec, 1
    buffer_store_dword v13, v14, s[24:27], s72 offen sc1
    s_mov_b64 exec, -1
    s_nop 1
L_noep:
L_end:
    s_endpgm
.p2align 8
TABLES:
.long 0x3f803f80,0x3f803f80,0x3f803f80,0x3f803f80,0x3f7b3f80,0x3f553f6d,0x3f0e3f35,0x3e483ec4
.long 0x3f6d3f80,0x3ec43f35,0xbec4248d,0xbf6dbf35,0x3f553f80,0xbe483ec4,0xbf7bbf35,0xbf0ebf6d
.long 0x3f353f80,0xbf35248d,0xbf35bf80,0x3f35a554,0x3f0e3f80,0xbf7bbec4,0x3e48bf35,0x3f553f6d
.long 0x3ec43f80,0xbf6dbf35,0x3f6da554,0xbec43f35,0x3e483f80,0xbf0ebf6d,0x3f553f35,0xbf7bbec4
.long 0x248d3f80,0xa554bf80,0x248d3f80,0xa554bf80,0xbe483f80,0x3f0ebf6d,0xbf553f35,0x3f7bbec4
.long 0xbec43f80,0x3f6dbf35,0xbf6d248d,0x3ec43f35,0xbf0e3f80,0x3f7bbec4,0xbe48bf35,0xbf553f6d
.long 0xbf353f80,0x3f35a554,0x3f35bf80,0xbf35248d,0xbf553f80,0x3e483ec4,0x3f7bbf35,0x3f0ebf6d
.long 0xbf6d3f80,0xbec43f35,0x3ec4a554,0x3f6dbf35,0xbf7b3f80,0xbf553f6d,0xbf0e3f35,0xbe483ec4
.long 0x3f803f80,0x3f803f80,0x3f803f80,0x3f803f80,0xbe48248d,0xbf0ebec4,0xbf55bf35,0xbf7bbf6d
.long 0xbf6dbf80,0xbec4bf35,0x3ec4a554,0x3f6d3f35,0x3f0ea554,0x3f7b3f6d,0x3e483f35,0xbf55bec4
.long 0x3f353f80,0xbf35248d,0xbf35bf80,0x3f35a554,0xbf55248d,0xbe48bf6d,0x3f7b3f35,0xbf0e3ec4
.long 0xbec4bf80,0x3f6d3f35,0xbf6d248d,0x3ec4bf35,0x3f7ba554,0xbf553ec4,0x3f0ebf35,0xbe483f6d
.long 0x248d3f80,0xa554bf80,0x248d3f80,0xa554bf80,0xbf7b248d,0x3f553ec4,0xbf0ebf35,0x3e483f6d
.long 0x3ec4bf80,0xbf6d3f35,0x3f6da554,0xbec4bf35,0x3f55a554,0x3e48bf6d,0xbf7b3f35,0x3f0e3ec4
.long 0xbf353f80,0x3f35a554,0x3f35bf80,0xbf35248d,0xbf0e248d,0xbf7b3f6d,0xbe483f35,0x3f55bec4
.long 0x3f6dbf80,0x3ec4bf35,0xbec4248d,0xbf6d3f35,0x3e48a554,0x3f0ebec4,0x3f55bf35,0x3f7bbf6d
.long 0x3f803f80,0x3f803f80,0x3f803f80,0x3f803f80,0xbf7bbf80,0xbf55bf6d,0xbf0ebf35,0xbe48bec4
.long 0x3f6d3f80,0x3ec43f35,0xbec4248d,0xbf6dbf35,0xbf55bf80,0x3e48bec4,0x3f7b3f35,0x3f0e3f6d
.long 0x3f353f80,0xbf35248d,0xbf35bf80,0x3f35a554,0xbf0ebf80,0x3f7b3ec4,0xbe483f35,0xbf55bf6d
.long 0x3ec43f80,0xbf6dbf35,0x3f6da554,0xbec43f35,0xbe48bf80,0x3f0e3f6d,0xbf55bf35,0x3f7b3ec4
.long 0x248d3f80,0xa554bf80,0x248d3f80,0xa554bf80,0x3e48bf80,0xbf0e3f6d,0x3f55bf35,0xbf7b3ec4
.long 0xbec43f80,0x3f6dbf35,0xbf6d248d,0x3ec43f35,0x3f0ebf80,0xbf7b3ec4,0x3e483f35,0x3f55bf6d
.long 0xbf353f80,0x3f35a554,0x3f35bf80,0xbf35248d,0x3f55bf80,0xbe48bec4,0xbf7b3f35,0xbf0e3f6d
.long 0xbf6d3f80,0xbec43f35,0x3ec4a554,0x3f6dbf35,0x3f7bbf80,0x3f55bf6d,0x3f0ebf35,0x3e48bec4
.long 0x3f803f80,0x3f803f80,0x3f803f80,0x3f803f80,0x3e48a554,0x3f0e3ec4,0x3f553f35,0x3f7b3f6d
.long 0xbf6dbf80,0xbec4bf35,0x3ec4a554,0x3f6d3f35,0xbf0e248d,0xbf7bbf6d,0xbe48bf35,0x3f553ec4
.long 0x3f353f80,0xbf35248d,0xbf35bf80,0x3f35a554,0x3f55a554,0x3e483f6d,0xbf7bbf35,0x3f0ebec4
.long 0xbec4bf80,0x3f6d3f35,0xbf6d248d,0x3ec4bf35,0xbf7b248d,0x3f55bec4,0xbf0e3f35,0x3e48bf6d
.long 0x248d3f80,0xa554bf80,0x248d3f80,0xa554bf80,0x3f7ba554,0xbf55bec4,0x3f0e3f35,0xbe48bf6d
.long 0x3ec4bf80,0xbf6d3f35,0x3f6da554,0xbec4bf35,0xbf55248d,0xbe483f6d,0x3f7bbf35,0xbf0ebec4
.long 0xbf353f80,0x3f35a554,0x3f35bf80,0xbf35248d,0x3f0ea554,0x3f7bbf6d,0x3e48bf35,0xbf553ec4
.long 0x3f6dbf80,0x3ec4bf35,0xbec4248d,0xbf6d3f35,0xbe48248d,0xbf0e3ec4,0xbf553f35,0xbf7b3f6d
.long 0xbf803f80,0xbf803f80,0xbf803f80,0xbf803f80,0xbf7b3f80,0xbf553f6d,0xbf0e3f35,0xbe483ec4
.long 0xbf6d3f80,0xbec43f35,0x3ec4248d,0x3f6dbf35,0xbf553f80,0x3e483ec4,0x3f7bbf35,0x3f0ebf6d
.long 0xbf353f80,0x3f35248d,0x3f35bf80,0xbf35a554,0xbf0e3f80,0x3f7bbec4,0xbe48bf35,0xbf553f6d
.long 0xbec43f80,0x3f6dbf35,0xbf6da554,0x3ec43f35,0xbe483f80,0x3f0ebf6d,0xbf553f35,0x3f7bbec4
.long 0xa5543f80,0x248dbf80,0xa5543f80,0x248dbf80,0x3e483f80,0xbf0ebf6d,0x3f553f35,0xbf7bbec4
.long 0x3ec43f80,0xbf6dbf35,0x3f6d248d,0xbec43f35,0x3f0e3f80,0xbf7bbec4,0x3e48bf35,0x3f553f6d
.long 0x3f353f80,0xbf35a554,0xbf35bf80,0x3f35248d,0x3f553f80,0xbe483ec4,0xbf7bbf35,0xbf0ebf6d
.long 0x3f6d3f80,0x3ec43f35,0xbec4a554,0xbf6dbf35,0x3f7b3f80,0x3f553f6d,0x3f0e3f35,0x3e483ec4
.long 0xbf803f80,0xbf803f80,0xbf803f80,0xbf803f80,0x3e48248d,0x3f0ebec4,0x3f55bf35,0x3f7bbf6d
.long 0x3f6dbf80,0x3ec4bf35,0xbec4a554,0xbf6d3f35,0xbf0ea554,0xbf7b3f6d,0xbe483f35,0x3f55bec4
.long 0xbf353f80,0x3f35248d,0x3f35bf80,0xbf35a554,0x3f55248d,0x3e48bf6d,0xbf7b3f35,0x3f0e3ec4
.long 0x3ec4bf80,0xbf6d3f35,0x3f6d248d,0xbec4bf35,0xbf7ba554,0x3f553ec4,0xbf0ebf35,0x3e483f6d
.long 0xa5543f80,0x248dbf80,0xa5543f80,0x248dbf80,0x3f7b248d,0xbf553ec4,0x3f0ebf35,0xbe483f6d
.long 0xbec4bf80,0x3f6d3f35,0xbf6da554,0x3ec4bf35,0xbf55a554,0xbe48bf6d,0x3f7b3f35,0xbf0e3ec4
.long 0x3f353f80,0xbf35a554,0xbf35bf80,0x3f35248d,0x3f0e248d,0x3f7b3f6d,0x3e483f35,0xbf55bec4
.long 0xbf6dbf80,0xbec4bf35,0x3ec4248d,0x3f6d3f35,0xbe48a554,0xbf0ebec4,0xbf55bf35,0xbf7bbf6d
.long 0xbf803f80,0xbf803f80,0xbf803f80,0xbf803f80,0x3f7bbf80,0x3f55bf6d,0x3f0ebf35,0x3e48bec4
.long 0xbf6d3f80,0xbec43f35,0x3ec4248d,0x3f6dbf35,0x3f55bf80,0xbe48bec4,0xbf7b3f35,0xbf0e3f6d
.long 0xbf353f80,0x3f35248d,0x3f35bf80,0xbf35a554,0x3f0ebf80,0xbf7b3ec4,0x3e483f35,0x3f55bf6d
.long 0xbec43f80,0x3f6dbf35,0xbf6da554,0x3ec43f35,0x3e48bf80,0xbf0e3f6d,0x3f55bf35,0xbf7b3ec4
.long 0xa5543f80,0x248dbf80,0xa5543f80,0x248dbf80,0xbe48bf80,0x3f0e3f6d,0xbf55bf35,0x3f7b3ec4
.long 0x3ec43f80,0xbf6dbf35,0x3f6d248d,0xbec43f35,0xbf0ebf80,0x3f7b3ec4,0xbe483f35,0xbf55bf6d
.long 0x3f353f80,0xbf35a554,0xbf35bf80,0x3f35248d,0xbf55bf80,0x3e48bec4,0x3f7b3f35,0x3f0e3f6d
.long 0x3f6d3f80,0x3ec43f35,0xbec4a554,0xbf6dbf35,0xbf7bbf80,0xbf55bf6d,0xbf0ebf35,0xbe48bec4
.long 0xbf803f80,0xbf803f80,0xbf803f80,0xbf803f80,0xbe48a554,0xbf0e3ec4,0xbf553f35,0xbf7b3f6d
.long 0x3f6dbf80,0x3ec4bf35,0xbec4a554,0xbf6d3f35,0x3f0e248d,0x3f7bbf6d,0x3e48bf35,0xbf553ec4
.long 0xbf353f80,0x3f35248d,0x3f35bf80,0xbf35a554,0xbf55a554,0xbe483f6d,0x3f7bbf35,0xbf0ebec4
.long 0x3ec4bf80,0xbf6d3f35,0x3f6d248d,0xbec4bf35,0x3f7b248d,0xbf55bec4,0x3f0e3f35,0xbe48bf6d
.long 0xa5543f80,0x248dbf80,0xa5543f80,0x248dbf80,0xbf7ba554,0x3f55bec4,0xbf0e3f35,0x3e48bf6d
.long 0xbec4bf80,0x3f6d3f35,0xbf6da554,0x3ec4bf35,0x3f55248d,0x3e483f6d,0xbf7bbf35,0x3f0ebec4
.long 0x3f353f80,0xbf35a554,0xbf35bf80,0x3f35248d,0xbf0ea554,0xbf7bbf6d,0xbe48bf35,0x3f553ec4
.long 0xbf6dbf80,0xbec4bf35,0x3ec4248d,0x3f6d3f35,0x3e48248d,0x3f0e3ec4,0x3f553f35,0x3f7b3f6d
.long 0x0,0x0,0x0,0x0,0x3e480000,0x3f0e3ec4,0x3f553f35,0x3f7b3f6d
.long 0x3ec40000,0x3f6d3f35,0x3f6d3f80,0x3ec43f35,0x3f0e0000,0x3f7b3f6d,0x3e483f35,0xbf55bec4
.long 0x3f350000,0x3f353f80,0xbf35250d,0xbf35bf80,0x3f550000,0x3e483f6d,0xbf7bbf35,0x3f0ebec4
.long 0x3f6d0000,0xbec43f35,0xbec4bf80,0x3f6d3f35,0x3f7b0000,0xbf553ec4,0x3f0ebf35,0xbe483f6d
.long 0x3f800000,0xbf80250d,0x3f800000,0xbf80250d,0x3f7b0000,0xbf55bec4,0x3f0e3f35,0xbe48bf6d
.long 0x3f6d0000,0xbec4bf35,0xbec43f80,0x3f6dbf35,0x3f550000,0x3e48bf6d,0xbf7b3f35,0x3f0e3ec4
.long 0x3f350000,0x3f35bf80,0xbf35250d,0xbf353f80,0x3f0e0000,0x3f7bbf6d,0x3e48bf35,0xbf553ec4
.long 0x3ec40000,0x3f6dbf35,0x3f6dbf80,0x3ec4bf35,0x3e480000,0x3f0ebec4,0x3f55bf35,0x3f7bbf6d
.long 0x0,0x0,0x0,0x0,0x3f7b3f80,0x3f553f6d,0x3f0e3f35,0x3e483ec4
.long 0xbec4250d,0xbf6dbf35,0xbf6dbf80,0xbec4bf35,0xbf55bf80,0x3e48bec4,0x3f7b3f35,0x3f0e3f6d
.long 0x3f350000,0x3f353f80,0xbf35250d,0xbf35bf80,0x3f0e3f80,0xbf7bbec4,0x3e48bf35,0x3f553f6d
.long 0xbf6d250d,0x3ec4bf35,0x3ec43f80,0xbf6dbf35,0xbe48bf80,0x3f0e3f6d,0xbf55bf35,0x3f7b3ec4
.long 0x3f800000,0xbf80250d,0x3f800000,0xbf80250d,0xbe483f80,0x3f0ebf6d,0xbf553f35,0x3f7bbec4
.long 0xbf6d250d,0x3ec43f35,0x3ec4bf80,0xbf6d3f35,0x3f0ebf80,0xbf7b3ec4,0x3e483f35,0x3f55bf6d
.long 0x3f350000,0x3f35bf80,0xbf35250d,0xbf353f80,0xbf553f80,0x3e483ec4,0x3f7bbf35,0x3f0ebf6d
.long 0xbec4250d,0xbf6d3f35,0xbf6d3f80,0xbec43f35,0x3f7bbf80,0x3f55bf6d,0x3f0ebf35,0x3e48bec4
.long 0x0,0x0,0x0,0x0,0xbe48250d,0xbf0ebec4,0xbf55bf35,0xbf7bbf6d
.long 0x3ec40000,0x3f6d3f35,0x3f6d3f80,0x3ec43f35,0xbf0e250d,0xbf7bbf6d,0xbe48bf35,0x3f553ec4
.long 0x3f350000,0x3f353f80,0xbf35250d,0xbf35bf80,0xbf55250d,0xbe48bf6d,0x3f7b3f35,0xbf0e3ec4
.long 0x3f6d0000,0xbec43f35,0xbec4bf80,0x3f6d3f35,0xbf7b250d,0x3f55bec4,0xbf0e3f35,0x3e48bf6d
.long 0x3f800000,0xbf80250d,0x3f800000,0xbf80250d,0xbf7b250d,0x3f553ec4,0xbf0ebf35,0x3e483f6d
.long 0x3f6d0000,0xbec4bf35,0xbec43f80,0x3f6dbf35,0xbf55250d,0xbe483f6d,0x3f7bbf35,0xbf0ebec4
.long 0x3f350000,0x3f35bf80,0xbf35250d,0xbf353f80,0xbf0e250d,0xbf7b3f6d,0xbe483f35,0x3f55bec4
.long 0x3ec40000,0x3f6dbf35,0x3f6dbf80,0x3ec4bf35,0xbe48250d,0xbf0e3ec4,0xbf553f35,0xbf7b3f6d
.long 0x0,0x0,0x0,0x0,0xbf7bbf80,0xbf55bf6d,0xbf0ebf35,0xbe48bec4
.long 0xbec4250d,0xbf6dbf35,0xbf6dbf80,0xbec4bf35,0x3f553f80,0xbe483ec4,0xbf7bbf35,0xbf0ebf6d
.long 0x3f350000,0x3f353f80,0xbf35250d,0xbf35bf80,0xbf0ebf80,0x3f7b3ec4,0xbe483f35,0xbf55bf6d
.long 0xbf6d250d,0x3ec4bf35,0x3ec43f80,0xbf6dbf35,0x3e483f80,0xbf0ebf6d,0x3f553f35,0xbf7bbec4
.long 0x3f800000,0xbf80250d,0x3f800000,0xbf80250d,0x3e48bf80,0xbf0e3f6d,0x3f55bf35,0xbf7b3ec4
.long 0xbf6d250d,0x3ec43f35,0x3ec4bf80,0xbf6d3f35,0xbf0e3f80,0x3f7bbec4,0xbe48bf35,0xbf553f6d
.long 0x3f350000,0x3f35bf80,0xbf35250d,0xbf353f80,0x3f55bf80,0xbe48bec4,0xbf7b3f35,0xbf0e3f6d
.long 0xbec4250d,0xbf6d3f35,0xbf6d3f80,0xbec43f35,0xbf7b3f80,0xbf553f6d,0xbf0e3f35,0xbe483ec4
.long 0x250d0000,0x250d0000,0x250d0000,0x250d0000,0xbe480000,0xbf0e3ec4,0xbf553f35,0xbf7b3f6d
.long 0xbec40000,0xbf6d3f35,0xbf6d3f80,0xbec43f35,0xbf0e0000,0xbf7b3f6d,0xbe483f35,0x3f55bec4
.long 0xbf350000,0xbf353f80,0x3f35250d,0x3f35bf80,0xbf550000,0xbe483f6d,0x3f7bbf35,0xbf0ebec4
.long 0xbf6d0000,0x3ec43f35,0x3ec4bf80,0xbf6d3f35,0xbf7b0000,0x3f553ec4,0xbf0ebf35,0x3e483f6d
.long 0xbf800000,0x3f80250d,0xbf800000,0x3f80250d,0xbf7b0000,0x3f55bec4,0xbf0e3f35,0x3e48bf6d
.long 0xbf6d0000,0x3ec4bf35,0x3ec43f80,0xbf6dbf35,0xbf550000,0xbe48bf6d,0x3f7b3f35,0xbf0e3ec4
.long 0xbf350000,0xbf35bf80,0x3f35250d,0x3f353f80,0xbf0e0000,0xbf7bbf6d,0xbe48bf35,0x3f553ec4
.long 0xbec40000,0xbf6dbf35,0xbf6dbf80,0xbec4bf35,0xbe480000,0xbf0ebec4,0xbf55bf35,0xbf7bbf6d
.long 0x250d0000,0x250d0000,0x250d0000,0x250d0000,0xbf7b3f80,0xbf553f6d,0xbf0e3f35,0xbe483ec4
.long 0x3ec4250d,0x3f6dbf35,0x3f6dbf80,0x3ec4bf35,0x3f55bf80,0xbe48bec4,0xbf7b3f35,0xbf0e3f6d
.long 0xbf350000,0xbf353f80,0x3f35250d,0x3f35bf80,0xbf0e3f80,0x3f7bbec4,0xbe48bf35,0xbf553f6d
.long 0x3f6d250d,0xbec4bf35,0xbec43f80,0x3f6dbf35,0x3e48bf80,0xbf0e3f6d,0x3f55bf35,0xbf7b3ec4
.long 0xbf800000,0x3f80250d,0xbf800000,0x3f80250d,0x3e483f80,0xbf0ebf6d,0x3f553f35,0xbf7bbec4
.long 0x3f6d250d,0xbec43f35,0xbec4bf80,0x3f6d3f35,0xbf0ebf80,0x3f7b3ec4,0xbe483f35,0xbf55bf6d
.long 0xbf350000,0xbf35bf80,0x3f35250d,0x3f353f80,0x3f553f80,0xbe483ec4,0xbf7bbf35,0xbf0ebf6d
.long 0x3ec4250d,0x3f6d3f35,0x3f6d3f80,0x3ec43f35,0xbf7bbf80,0xbf55bf6d,0xbf0ebf35,0xbe48bec4
.long 0x250d0000,0x250d0000,0x250d0000,0x250d0000,0x3e48250d,0x3f0ebec4,0x3f55bf35,0x3f7bbf6d
.long 0xbec40000,0xbf6d3f35,0xbf6d3f80,0xbec43f35,0x3f0e250d,0x3f7bbf6d,0x3e48bf35,0xbf553ec4
.long 0xbf350000,0xbf353f80,0x3f35250d,0x3f35bf80,0x3f55250d,0x3e48bf6d,0xbf7b3f35,0x3f0e3ec4
.long 0xbf6d0000,0x3ec43f35,0x3ec4bf80,0xbf6d3f35,0x3f7b250d,0xbf55bec4,0x3f0e3f35,0xbe48bf6d
.long 0xbf800000,0x3f80250d,0xbf800000,0x3f80250d,0x3f7b250d,0xbf553ec4,0x3f0ebf35,0xbe483f6d
.long 0xbf6d0000,0x3ec4bf35,0x3ec43f80,0xbf6dbf35,0x3f55250d,0x3e483f6d,0xbf7bbf35,0x3f0ebec4
.long 0xbf350000,0xbf35bf80,0x3f35250d,0x3f353f80,0x3f0e250d,0x3f7b3f6d,0x3e483f35,0xbf55bec4
.long 0xbec40000,0xbf6dbf35,0xbf6dbf80,0xbec4bf35,0x3e48250d,0x3f0e3ec4,0x3f553f35,0x3f7b3f6d
.long 0x250d0000,0x250d0000,0x250d0000,0x250d0000,0x3f7bbf80,0x3f55bf6d,0x3f0ebf35,0x3e48bec4
.long 0x3ec4250d,0x3f6dbf35,0x3f6dbf80,0x3ec4bf35,0xbf553f80,0x3e483ec4,0x3f7bbf35,0x3f0ebf6d
.long 0xbf350000,0xbf353f80,0x3f35250d,0x3f35bf80,0x3f0ebf80,0xbf7b3ec4,0x3e483f35,0x3f55bf6d
.long 0x3f6d250d,0xbec4bf35,0xbec43f80,0x3f6dbf35,0xbe483f80,0x3f0ebf6d,0xbf553f35,0x3f7bbec4
.long 0xbf800000,0x3f80250d,0xbf800000,0x3f80250d,0xbe48bf80,0x3f0e3f6d,0xbf55bf35,0x3f7b3ec4
.long 0x3f6d250d,0xbec43f35,0xbec4bf80,0x3f6d3f35,0x3f0e3f80,0xbf7bbec4,0x3e48bf35,0x3f553f6d
.long 0xbf350000,0xbf35bf80,0x3f35250d,0x3f353f80,0xbf55bf80,0x3e48bec4,0x3f7b3f35,0x3f0e3f6d
.long 0x3ec4250d,0x3f6d3f35,0x3f6d3f80,0x3ec43f35,0x3f7b3f80,0x3f553f6d,0x3f0e3f35,0x3e483ec4
.long 0x80008000,0x80008000,0x80008000,0x80008000,0xbe488000,0xbf0ebec4,0xbf55bf35,0xbf7bbf6d
.long 0xbec48000,0xbf6dbf35,0xbf6dbf80,0xbec4bf35,0xbf0e8000,0xbf7bbf6d,0xbe48bf35,0x3f553ec4
.long 0xbf358000,0xbf35bf80,0x3f35a50d,0x3f353f80,0xbf558000,0xbe48bf6d,0x3f7b3f35,0xbf0e3ec4
.long 0xbf6d8000,0x3ec4bf35,0x3ec43f80,0xbf6dbf35,0xbf7b8000,0x3f55bec4,0xbf0e3f35,0x3e48bf6d
.long 0xbf808000,0x3f80a50d,0xbf808000,0x3f80a50d,0xbf7b8000,0x3f553ec4,0xbf0ebf35,0x3e483f6d
.long 0xbf6d8000,0x3ec43f35,0x3ec4bf80,0xbf6d3f35,0xbf558000,0xbe483f6d,0x3f7bbf35,0xbf0ebec4
.long 0xbf358000,0xbf353f80,0x3f35a50d,0x3f35bf80,0xbf0e8000,0xbf7b3f6d,0xbe483f35,0x3f55bec4
.long 0xbec48000,0xbf6d3f35,0xbf6d3f80,0xbec43f35,0xbe488000,0xbf0e3ec4,0xbf553f35,0xbf7b3f6d
.long 0x80008000,0x80008000,0x80008000,0x80008000,0xbf7bbf80,0xbf55bf6d,0xbf0ebf35,0xbe48bec4
.long 0x3ec4a50d,0x3f6d3f35,0x3f6d3f80,0x3ec43f35,0x3f553f80,0xbe483ec4,0xbf7bbf35,0xbf0ebf6d
.long 0xbf358000,0xbf35bf80,0x3f35a50d,0x3f353f80,0xbf0ebf80,0x3f7b3ec4,0xbe483f35,0xbf55bf6d
.long 0x3f6da50d,0xbec43f35,0xbec4bf80,0x3f6d3f35,0x3e483f80,0xbf0ebf6d,0x3f553f35,0xbf7bbec4
.long 0xbf808000,0x3f80a50d,0xbf808000,0x3f80a50d,0x3e48bf80,0xbf0e3f6d,0x3f55bf35,0xbf7b3ec4
.long 0x3f6da50d,0xbec4bf35,0xbec43f80,0x3f6dbf35,0xbf0e3f80,0x3f7bbec4,0xbe48bf35,0xbf553f6d
.long 0xbf358000,0xbf353f80,0x3f35a50d,0x3f35bf80,0x3f55bf80,0xbe48bec4,0xbf7b3f35,0xbf0e3f6d
.long 0x3ec4a50d,0x3f6dbf35,0x3f6dbf80,0x3ec4bf35,0xbf7b3f80,0xbf553f6d,0xbf0e3f35,0xbe483ec4
.long 0x80008000,0x80008000,0x80008000,0x80008000,0x3e48a50d,0x3f0e3ec4,0x3f553f35,0x3f7b3f6d
.long 0xbec48000,0xbf6dbf35,0xbf6dbf80,0xbec4bf35,0x3f0ea50d,0x3f7b3f6d,0x3e483f35,0xbf55bec4
.long 0xbf358000,0xbf35bf80,0x3f35a50d,0x3f353f80,0x3f55a50d,0x3e483f6d,0xbf7bbf35,0x3f0ebec4
.long 0xbf6d8000,0x3ec4bf35,0x3ec43f80,0xbf6dbf35,0x3f7ba50d,0xbf553ec4,0x3f0ebf35,0xbe483f6d
.long 0xbf808000,0x3f80a50d,0xbf808000,0x3f80a50d,0x3f7ba50d,0xbf55bec4,0x3f0e3f35,0xbe48bf6d
.long 0xbf6d8000,0x3ec43f35,0x3ec4bf80,0xbf6d3f35,0x3f55a50d,0x3e48bf6d,0xbf7b3f35,0x3f0e3ec4
.long 0xbf358000,0xbf353f80,0x3f35a50d,0x3f35bf80,0x3f0ea50d,0x3f7bbf6d,0x3e48bf35,0xbf553ec4
.long 0xbec48000,0xbf6d3f35,0xbf6d3f80,0xbec43f35,0x3e48a50d,0x3f0ebec4,0x3f55bf35,0x3f7bbf6d
.long 0x80008000,0x80008000,0x80008000,0x80008000,0x3f7b3f80,0x3f553f6d,0x3f0e3f35,0x3e483ec4
.long 0x3ec4a50d,0x3f6d3f35,0x3f6d3f80,0x3ec43f35,0xbf55bf80,0x3e48bec4,0x3f7b3f35,0x3f0e3f6d
.long 0xbf358000,0xbf35bf80,0x3f35a50d,0x3f353f80,0x3f0e3f80,0xbf7bbec4,0x3e48bf35,0x3f553f6d
.long 0x3f6da50d,0xbec43f35,0xbec4bf80,0x3f6d3f35,0xbe48bf80,0x3f0e3f6d,0xbf55bf35,0x3f7b3ec4
.long 0xbf808000,0x3f80a50d,0xbf808000,0x3f80a50d,0xbe483f80,0x3f0ebf6d,0xbf553f35,0x3f7bbec4
.long 0x3f6da50d,0xbec4bf35,0xbec43f80,0x3f6dbf35,0x3f0ebf80,0xbf7b3ec4,0x3e483f35,0x3f55bf6d
.long 0xbf358000,0xbf353f80,0x3f35a50d,0x3f35bf80,0xbf553f80,0x3e483ec4,0x3f7bbf35,0x3f0ebf6d
.long 0x3ec4a50d,0x3f6dbf35,0x3f6dbf80,0x3ec4bf35,0x3f7bbf80,0x3f55bf6d,0x3f0ebf35,0x3e48bec4
.long 0xa50d8000,0xa50d8000,0xa50d8000,0xa50d8000,0x3e488000,0x3f0ebec4,0x3f55bf35,0x3f7bbf6d
.long 0x3ec48000,0x3f6dbf35,0x3f6dbf80,0x3ec4bf35,0x3f0e8000,0x3f7bbf6d,0x3e48bf35,0xbf553ec4
.long 0x3f358000,0x3f35bf80,0xbf35a50d,0xbf353f80,0x3f558000,0x3e48bf6d,0xbf7b3f35,0x3f0e3ec4
.long 0x3f6d8000,0xbec4bf35,0xbec43f80,0x3f6dbf35,0x3f7b8000,0xbf55bec4,0x3f0e3f35,0xbe48bf6d
.long 0x3f808000,0xbf80a50d,0x3f808000,0xbf80a50d,0x3f7b8000,0xbf553ec4,0x3f0ebf35,0xbe483f6d
.long 0x3f6d8000,0xbec43f35,0xbec4bf80,0x3f6d3f35,0x3f558000,0x3e483f6d,0xbf7bbf35,0x3f0ebec4
.long 0x3f358000,0x3f353f80,0xbf35a50d,0xbf35bf80,0x3f0e8000,0x3f7b3f6d,0x3e483f35,0xbf55bec4
.long 0x3ec48000,0x3f6d3f35,0x3f6d3f80,0x3ec43f35,0x3e488000,0x3f0e3ec4,0x3f553f35,0x3f7b3f6d
.long 0xa50d8000,0xa50d8000,0xa50d8000,0xa50d8000,0x3f7bbf80,0x3f55bf6d,0x3f0ebf35,0x3e48bec4
.long 0xbec4a50d,0xbf6d3f35,0xbf6d3f80,0xbec43f35,0xbf553f80,0x3e483ec4,0x3f7bbf35,0x3f0ebf6d
.long 0x3f358000,0x3f35bf80,0xbf35a50d,0xbf353f80,0x3f0ebf80,0xbf7b3ec4,0x3e483f35,0x3f55bf6d
.long 0xbf6da50d,0x3ec43f35,0x3ec4bf80,0xbf6d3f35,0xbe483f80,0x3f0ebf6d,0xbf553f35,0x3f7bbec4
.long 0x3f808000,0xbf80a50d,0x3f808000,0xbf80a50d,0xbe48bf80,0x3f0e3f6d,0xbf55bf35,0x3f7b3ec4
.long 0xbf6da50d,0x3ec4bf35,0x3ec43f80,0xbf6dbf35,0x3f0e3f80,0xbf7bbec4,0x3e48bf35,0x3f553f6d
.long 0x3f358000,0x3f353f80,0xbf35a50d,0xbf35bf80,0xbf55bf80,0x3e48bec4,0x3f7b3f35,0x3f0e3f6d
.long 0xbec4a50d,0xbf6dbf35,0xbf6dbf80,0xbec4bf35,0x3f7b3f80,0x3f553f6d,0x3f0e3f35,0x3e483ec4
.long 0xa50d8000,0xa50d8000,0xa50d8000,0xa50d8000,0xbe48a50d,0xbf0e3ec4,0xbf553f35,0xbf7b3f6d
.long 0x3ec48000,0x3f6dbf35,0x3f6dbf80,0x3ec4bf35,0xbf0ea50d,0xbf7b3f6d,0xbe483f35,0x3f55bec4
.long 0x3f358000,0x3f35bf80,0xbf35a50d,0xbf353f80,0xbf55a50d,0xbe483f6d,0x3f7bbf35,0xbf0ebec4
.long 0x3f6d8000,0xbec4bf35,0xbec43f80,0x3f6dbf35,0xbf7ba50d,0x3f553ec4,0xbf0ebf35,0x3e483f6d
.long 0x3f808000,0xbf80a50d,0x3f808000,0xbf80a50d,0xbf7ba50d,0x3f55bec4,0xbf0e3f35,0x3e48bf6d
.long 0x3f6d8000,0xbec43f35,0xbec4bf80,0x3f6d3f35,0xbf55a50d,0xbe48bf6d,0x3f7b3f35,0xbf0e3ec4
.long 0x3f358000,0x3f353f80,0xbf35a50d,0xbf35bf80,0xbf0ea50d,0xbf7bbf6d,0xbe48bf35,0x3f553ec4
.long 0x3ec48000,0x3f6d3f35,0x3f6d3f80,0x3ec43f35,0xbe48a50d,0xbf0ebec4,0xbf55bf35,0xbf7bbf6d
.long 0xa50d8000,0xa50d8000,0xa50d8000,0xa50d8000,0xbf7b3f80,0xbf553f6d,0xbf0e3f35,0xbe483ec4
.long 0xbec4a50d,0xbf6d3f35,0xbf6d3f80,0xbec43f35,0x3f55bf80,0xbe48bec4,0xbf7b3f35,0xbf0e3f6d
.long 0x3f358000,0x3f35bf80,0xbf35a50d,0xbf353f80,0xbf0e3f80,0x3f7bbec4,0xbe48bf35,0xbf553f6d
.long 0xbf6da50d,0x3ec43f35,0x3ec4bf80,0xbf6d3f35,0x3e48bf80,0xbf0e3f6d,0x3f55bf35,0xbf7b3ec4
.long 0x3f808000,0xbf80a50d,0x3f808000,0xbf80a50d,0x3e483f80,0xbf0ebf6d,0x3f553f35,0xbf7bbec4
.long 0xbf6da50d,0x3ec4bf35,0x3ec43f80,0xbf6dbf35,0xbf0ebf80,0x3f7b3ec4,0xbe483f35,0xbf55bf6d
.long 0x3f358000,0x3f353f80,0xbf35a50d,0xbf35bf80,0x3f553f80,0xbe483ec4,0xbf7bbf35,0xbf0ebf6d
.long 0xbec4a50d,0xbf6dbf35,0xbf6dbf80,0xbec4bf35,0xbf7bbf80,0xbf55bf6d,0xbf0ebf35,0xbe48bec4
.long 0x3f803f80,0x3f803f80,0x0,0x0,0x3f6d3f80,0x3ec43f35,0x3ec40000,0x3f6d3f35
.long 0x3f353f80,0xbf35248d,0x3f350000,0x3f353f80,0x3ec43f80,0xbf6dbf35,0x3f6d0000,0xbec43f35
.long 0x248d3f80,0xa554bf80,0x3f800000,0xbf80250d,0xbec43f80,0x3f6dbf35,0x3f6d0000,0xbec4bf35
.long 0xbf353f80,0x3f35a554,0x3f350000,0x3f35bf80,0xbf6d3f80,0xbec43f35,0x3ec40000,0x3f6dbf35
.long 0xbf803f80,0xbf803f80,0x250d0000,0x250d0000,0xbf6d3f80,0xbec43f35,0xbec40000,0xbf6d3f35
.long 0xbf353f80,0x3f35248d,0xbf350000,0xbf353f80,0xbec43f80,0x3f6dbf35,0xbf6d0000,0x3ec43f35
.long 0xa5543f80,0x248dbf80,0xbf800000,0x3f80250d,0x3ec43f80,0xbf6dbf35,0xbf6d0000,0x3ec4bf35
.long 0x3f353f80,0xbf35a554,0xbf350000,0xbf35bf80,0x3f6d3f80,0x3ec43f35,0xbec40000,0xbf6dbf35
.long 0x3f803f80,0x3f803f80,0x0,0x0,0xbec4248d,0xbf6dbf35,0x3f6d3f80,0x3ec43f35
.long 0xbf35bf80,0x3f35a554,0xbf35250d,0xbf35bf80,0x3f6da554,0xbec43f35,0xbec4bf80,0x3f6d3f35
.long 0x248d3f80,0xa554bf80,0x3f800000,0xbf80250d,0xbf6d248d,0x3ec43f35,0xbec43f80,0x3f6dbf35
.long 0x3f35bf80,0xbf35248d,0xbf35250d,0xbf353f80,0x3ec4a554,0x3f6dbf35,0x3f6dbf80,0x3ec4bf35
.long 0xbf803f80,0xbf803f80,0x250d0000,0x250d0000,0x3ec4248d,0x3f6dbf35,0xbf6d3f80,0xbec43f35
.long 0x3f35bf80,0xbf35a554,0x3f35250d,0x3f35bf80,0xbf6da554,0x3ec43f35,0x3ec4bf80,0xbf6d3f35
.long 0xa5543f80,0x248dbf80,0xbf800000,0x3f80250d,0x3f6d248d,0xbec43f35,0x3ec43f80,0xbf6dbf35
.long 0xbf35bf80,0x3f35248d,0x3f35250d,0x3f353f80,0xbec4a554,0xbf6dbf35,0xbf6dbf80,0xbec4bf35
.long 0x3f803f80,0x3f803f80,0x0,0x0,0xbf6dbf80,0xbec4bf35,0xbec4250d,0xbf6dbf35
.long 0x3f353f80,0xbf35248d,0x3f350000,0x3f353f80,0xbec4bf80,0x3f6d3f35,0xbf6d250d,0x3ec4bf35
.long 0x248d3f80,0xa554bf80,0x3f800000,0xbf80250d,0x3ec4bf80,0xbf6d3f35,0xbf6d250d,0x3ec43f35
.long 0xbf353f80,0x3f35a554,0x3f350000,0x3f35bf80,0x3f6dbf80,0x3ec4bf35,0xbec4250d,0xbf6d3f35
.long 0xbf803f80,0xbf803f80,0x250d0000,0x250d0000,0x3f6dbf80,0x3ec4bf35,0x3ec4250d,0x3f6dbf35
.long 0xbf353f80,0x3f35248d,0xbf350000,0xbf353f80,0x3ec4bf80,0xbf6d3f35,0x3f6d250d,0xbec4bf35
.long 0xa5543f80,0x248dbf80,0xbf800000,0x3f80250d,0xbec4bf80,0x3f6d3f35,0x3f6d250d,0xbec43f35
.long 0x3f353f80,0xbf35a554,0xbf350000,0xbf35bf80,0xbf6dbf80,0xbec4bf35,0x3ec4250d,0x3f6d3f35
.long 0x3f803f80,0x3f803f80,0x0,0x0,0x3ec4a554,0x3f6d3f35,0xbf6dbf80,0xbec4bf35
.long 0xbf35bf80,0x3f35a554,0xbf35250d,0xbf35bf80,0xbf6d248d,0x3ec4bf35,0x3ec43f80,0xbf6dbf35
.long 0x248d3f80,0xa554bf80,0x3f800000,0xbf80250d,0x3f6da554,0xbec4bf35,0x3ec4bf80,0xbf6d3f35
.long 0x3f35bf80,0xbf35248d,0xbf35250d,0xbf353f80,0xbec4248d,0xbf6d3f35,0xbf6d3f80,0xbec43f35
.long 0xbf803f80,0xbf803f80,0x250d0000,0x250d0000,0xbec4a554,0xbf6d3f35,0x3f6dbf80,0x3ec4bf35
.long 0x3f35bf80,0xbf35a554,0x3f35250d,0x3f35bf80,0x3f6d248d,0xbec4bf35,0xbec43f80,0x3f6dbf35
.long 0xa5543f80,0x248dbf80,0xbf800000,0x3f80250d,0xbf6da554,0x3ec4bf35,0xbec4bf80,0x3f6d3f35
.long 0xbf35bf80,0x3f35248d,0x3f35250d,0x3f353f80,0x3ec4248d,0x3f6d3f35,0x3f6d3f80,0x3ec43f35
.long 0x80008000,0x80008000,0x3f803f80,0x3f803f80,0xbec48000,0xbf6dbf35,0x3f6d3f80,0x3ec43f35
.long 0xbf358000,0xbf35bf80,0x3f353f80,0xbf35248d,0xbf6d8000,0x3ec4bf35,0x3ec43f80,0xbf6dbf35
.long 0xbf808000,0x3f80a50d,0x248d3f80,0xa554bf80,0xbf6d8000,0x3ec43f35,0xbec43f80,0x3f6dbf35
.long 0xbf358000,0xbf353f80,0xbf353f80,0x3f35a554,0xbec48000,0xbf6d3f35,0xbf6d3f80,0xbec43f35
.long 0xa50d8000,0xa50d8000,0xbf803f80,0xbf803f80,0x3ec48000,0x3f6dbf35,0xbf6d3f80,0xbec43f35
.long 0x3f358000,0x3f35bf80,0xbf353f80,0x3f35248d,0x3f6d8000,0xbec4bf35,0xbec43f80,0x3f6dbf35
.long 0x3f808000,0xbf80a50d,0xa5543f80,0x248dbf80,0x3f6d8000,0xbec43f35,0x3ec43f80,0xbf6dbf35
.long 0x3f358000,0x3f353f80,0x3f353f80,0xbf35a554,0x3ec48000,0x3f6d3f35,0x3f6d3f80,0x3ec43f35
.long 0x80008000,0x80008000,0x3f803f80,0x3f803f80,0xbf6dbf80,0xbec4bf35,0xbec4248d,0xbf6dbf35
.long 0x3f35a50d,0x3f353f80,0xbf35bf80,0x3f35a554,0x3ec43f80,0xbf6dbf35,0x3f6da554,0xbec43f35
.long 0xbf808000,0x3f80a50d,0x248d3f80,0xa554bf80,0x3ec4bf80,0xbf6d3f35,0xbf6d248d,0x3ec43f35
.long 0x3f35a50d,0x3f35bf80,0x3f35bf80,0xbf35248d,0xbf6d3f80,0xbec43f35,0x3ec4a554,0x3f6dbf35
.long 0xa50d8000,0xa50d8000,0xbf803f80,0xbf803f80,0x3f6dbf80,0x3ec4bf35,0x3ec4248d,0x3f6dbf35
.long 0xbf35a50d,0xbf353f80,0x3f35bf80,0xbf35a554,0xbec43f80,0x3f6dbf35,0xbf6da554,0x3ec43f35
.long 0x3f808000,0xbf80a50d,0xa5543f80,0x248dbf80,0xbec4bf80,0x3f6d3f35,0x3f6d248d,0xbec43f35
.long 0xbf35a50d,0xbf35bf80,0xbf35bf80,0x3f35248d,0x3f6d3f80,0x3ec43f35,0xbec4a554,0xbf6dbf35
.long 0x80008000,0x80008000,0x3f803f80,0x3f803f80,0x3ec4a50d,0x3f6d3f35,0xbf6dbf80,0xbec4bf35
.long 0xbf358000,0xbf35bf80,0x3f353f80,0xbf35248d,0x3f6da50d,0xbec43f35,0xbec4bf80,0x3f6d3f35
.long 0xbf808000,0x3f80a50d,0x248d3f80,0xa554bf80,0x3f6da50d,0xbec4bf35,0x3ec4bf80,0xbf6d3f35
.long 0xbf358000,0xbf353f80,0xbf353f80,0x3f35a554,0x3ec4a50d,0x3f6dbf35,0x3f6dbf80,0x3ec4bf35
.long 0xa50d8000,0xa50d8000,0xbf803f80,0xbf803f80,0xbec4a50d,0xbf6d3f35,0x3f6dbf80,0x3ec4bf35
.long 0x3f358000,0x3f35bf80,0xbf353f80,0x3f35248d,0xbf6da50d,0x3ec43f35,0x3ec4bf80,0xbf6d3f35
.long 0x3f808000,0xbf80a50d,0xa5543f80,0x248dbf80,0xbf6da50d,0x3ec4bf35,0xbec4bf80,0x3f6d3f35
.long 0x3f358000,0x3f353f80,0x3f353f80,0xbf35a554,0xbec4a50d,0xbf6dbf35,0xbf6dbf80,0xbec4bf35
.long 0x80008000,0x80008000,0x3f803f80,0x3f803f80,0x3f6d3f80,0x3ec43f35,0x3ec4a554,0x3f6d3f35
.long 0x3f35a50d,0x3f353f80,0xbf35bf80,0x3f35a554,0xbec4bf80,0x3f6d3f35,0xbf6d248d,0x3ec4bf35
.long 0xbf808000,0x3f80a50d,0x248d3f80,0xa554bf80,0xbec43f80,0x3f6dbf35,0x3f6da554,0xbec4bf35
.long 0x3f35a50d,0x3f35bf80,0x3f35bf80,0xbf35248d,0x3f6dbf80,0x3ec4bf35,0xbec4248d,0xbf6d3f35
.long 0xa50d8000,0xa50d8000,0xbf803f80,0xbf803f80,0xbf6d3f80,0xbec43f35,0xbec4a554,0xbf6d3f35
.long 0xbf35a50d,0xbf353f80,0x3f35bf80,0xbf35a554,0x3ec4bf80,0xbf6d3f35,0x3f6d248d,0xbec4bf35
.long 0x3f808000,0xbf80a50d,0xa5543f80,0x248dbf80,0x3ec43f80,0xbf6dbf35,0xbf6da554,0x3ec4bf35
.long 0xbf35a50d,0xbf35bf80,0xbf35bf80,0x3f35248d,0xbf6dbf80,0xbec4bf35,0x3ec4248d,0x3f6d3f35
.long 0x3c00,0x3c00,0x3c00,0x3c00,0x3c00,0x22483c00,0x26483bff,0x28b63bff
.long 0x3c00,0x26483bff,0x2a483bfe,0x2cb53bfa,0x3c00,0x28b63bff,0x2cb53bfa,0x2f0e3bf4
.long 0x3c00,0x2a483bfe,0x2e463bf6,0x30b23bea,0x3c00,0x2bd93bfc,0x2fd63bf1,0x31db3bdd
.long 0x3c00,0x2cb53bfa,0x30b23bea,0x33033bce,0x3c00,0x2d7e3bf8,0x31793be2,0x34143bbc
.long 0x3c00,0x2e463bf6,0x323e3bd9,0x34a53ba8,0x3c00,0x2f0e3bf4,0x33033bce,0x35343b91
.long 0x3c00,0x2fd63bf1,0x33c63bc3,0x35c23b77,0x3c00,0x304e3bed,0x34443bb6,0x364e3b5a
.long 0x3c00,0x30b23bea,0x34a53ba8,0x36d73b3b,0x3c00,0x31153be6,0x35053b99,0x375e3b1a
.long 0x3c00,0x31793be2,0x35643b88,0x37e33af6,0x3c00,0x31db3bdd,0x35c23b77,0x38323ad0
.long 0x3c00,0x3c00,0x3c00,0x3c00,0x2a483bfe,0x2bd93bfc,0x2cb53bfa,0x2d7e3bf8
.long 0x2e463bf6,0x2fd63bf1,0x30b23bea,0x31793be2,0x30b23bea,0x31db3bdd,0x33033bce,0x34143bbc
.long 0x323e3bd9,0x33c63bc3,0x34a53ba8,0x35643b88,0x33c63bc3,0x34d53ba0,0x35c23b77,0x36aa3b46
.long 0x34a53ba8,0x35c23b77,0x36d73b3b,0x37e33af6,0x35643b88,0x36aa3b46,0x37e33af6,0x38873a99
.long 0x361f3b64,0x378b3b0e,0x38723aa7,0x39133a2f,0x36d73b3b,0x38323ad0,0x38ec3a4f,0x399639ba
.long 0x378b3b0e,0x389b3a8a,0x395f39ed,0x3a0f393a,0x381d3add,0x39003a3f,0x39cb3984,0x3a7c38b0
.long 0x38723aa7,0x395f39ed,0x3a2f3913,0x3add381d,0x38c43a6d,0x39ba3996,0x3a8a389b,0x3b303705
.long 0x39133a2f,0x3a0f393a,0x3add381d,0x3b7735c2,0x395f39ed,0x3a5e38d8,0x3b253732,0x3baf3475
.long 0x3c00,0x3c00,0x3c00,0x3c00,0x2e463bf6,0x2f0e3bf4,0x2fd63bf1,0x304e3bed
.long 0x323e3bd9,0x33033bce,0x33c63bc3,0x34443bb6,0x34a53ba8,0x35343b91,0x35c23b77,0x364e3b5a
.long 0x361f3b64,0x36d73b3b,0x378b3b0e,0x381d3add,0x378b3b0e,0x38323ad0,0x389b3a8a,0x39003a3f
.long 0x38723aa7,0x38ec3a4f,0x395f39ed,0x39cb3984,0x39133a2f,0x399639ba,0x3a0f393a,0x3a7c38b0
.long 0x39a839a8,0x3a2f3913,0x3aa73872,0x3b0e378b,0x3a2f3913,0x3ab5385d,0x3b253732,0x3b803593
.long 0x3aa73872,0x3b253732,0x3b883564,0x3bce3303,0x3b0e378b,0x3b803593,0x3bce3303,0x3bf82d7e
.long 0x3b64361f,0x3bc333c6,0x3bf62e46,0x3bfeaa48,0x3ba834a5,0x3bed304e,0x3bffa648,0x3bddb1db
.long 0x3bd9323e,0x3bff2648,0x3beab0b2,0x3b99b505,0x3bf62e46,0x3bf8ad7e,0x3bb6b444,0x3b30b705
.long 0x3c00,0x3c00,0x3c00,0x3c00,0x30b23bea,0x31153be6,0x31793be2,0x31db3bdd
.long 0x34a53ba8,0x35053b99,0x35643b88,0x35c23b77,0x36d73b3b,0x375e3b1a,0x37e33af6,0x38323ad0
.long 0x38723aa7,0x38c43a6d,0x39133a2f,0x395f39ed,0x395f39ed,0x39ba3996,0x3a0f393a,0x3a5e38d8
.long 0x3a2f3913,0x3a8a389b,0x3add381d,0x3b253732,0x3add381d,0x3b303705,0x3b7735c2,0x3baf3475
.long 0x3b64361f,0x3ba834a5,0x3bd9323e,0x3bf62e46,0x3bc333c6,0x3bed304e,0x3bff2648,0x3bf8ad7e
.long 0x3bf62e46,0x3bffa648,0x3beab0b2,0x3bb6b444,0x3bfeaa48,0x3bddb1db,0x3b99b505,0x3b30b705
.long 0x3bd9b23e,0x3b88b564,0x3b0eb78b,0x3a6db8c4,0x3b88b564,0x3b02b7b7,0x3a4fb8ec,0x3972b9dc
.long 0x3b0eb78b,0x3a4fb8ec,0x395fb9ed,0x3848bac2,0x3a6db8c4,0x3972b9dc,0x3848bac2,0x35f1bb6e
.long 0x3c00,0x323e3bd9,0x361f3b64,0x38723aa7,0x3c00,0x32a13bd4,0x367c3b50,0x38b03a7c
.long 0x3c00,0x33033bce,0x36d73b3b,0x38ec3a4f,0x3c00,0x33653bc9,0x37323b25,0x39273a1f
.long 0x3c00,0x33c63bc3,0x378b3b0e,0x395f39ed,0x3c00,0x34143bbc,0x37e33af6,0x399639ba
.long 0x3c00,0x34443bb6,0x381d3add,0x39cb3984,0x3c00,0x34753baf,0x38483ac2,0x39fe394d
.long 0x3c00,0x34a53ba8,0x38723aa7,0x3a2f3913,0x3c00,0x34d53ba0,0x389b3a8a,0x3a5e38d8
.long 0x3c00,0x35053b99,0x38c43a6d,0x3a8a389b,0x3c00,0x35343b91,0x38ec3a4f,0x3ab5385d
.long 0x3c00,0x35643b88,0x39133a2f,0x3add381d,0x3c00,0x35933b80,0x393a3a0f,0x3b0237b7
.long 0x3c00,0x35c23b77,0x395f39ed,0x3b253732,0x3c00,0x35f13b6e,0x398439cb,0x3b4636aa
.long 0x39a839a8,0x3aa73872,0x3b64361f,0x3bd9323e,0x39ed395f,0x3ae93807,0x3b993505,0x3bf42f0e
.long 0x3a2f3913,0x3b253732,0x3bc333c6,0x3bff2648,0x3a6d38c4,0x3b5a364e,0x3be23179,0x3bfcabd9
.long 0x3aa73872,0x3b883564,0x3bf62e46,0x3beab0b2,0x3add381d,0x3baf3475,0x3bff2648,0x3bc9b365
.long 0x3b0e378b,0x3bce3303,0x3bfeaa48,0x3b99b505,0x3b3b36d7,0x3be63115,0x3bf1afd6,0x3b5ab64e
.long 0x3b64361f,0x3bf62e46,0x3bd9b23e,0x3b0eb78b,0x3b883564,0x3bff28b6,0x3bb6b444,0x3ab5b85d
.long 0x3ba834a5,0x3bffa648,0x3b88b564,0x3a4fb8ec,0x3bc333c6,0x3bf8ad7e,0x3b50b67c,0x39dcb972
.long 0x3bd9323e,0x3beab0b2,0x3b0eb78b,0x395fb9ed,0x3bea30b2,0x3bd4b2a1,0x3ac2b848,0x38d8ba5e
.long 0x3bf62e46,0x3bb6b444,0x3a6db8c4,0x3848bac2,0x3bfe2a48,0x3b91b534,0x3a0fb93a,0x375ebb1a
.long 0x3c000000,0x3bd9b23e,0x3b64b61f,0x3aa7b872,0x3bf6ae46,0x3ba0b4d5,0x3af6b7e3,0x39feb94d
.long 0x3bd9b23e,0x3b50b67c,0x3a6db8c4,0x393aba0f,0x3ba8b4a5,0x3ae9b807,0x39cbb984,0x385dbab5
.long 0x3b64b61f,0x3a6db8c4,0x3913ba2f,0x36d7bb3b,0x3b0eb78b,0x39dcb972,0x3848bac2,0x34d5bba0
.long 0x3aa7b872,0x393aba0f,0x36d7bb3b,0x3179bbe2,0x3a2fb913,0x3887ba99,0x3505bb99,0x28b6bbff
.long 0x39a8b9a8,0x378bbb0e,0x323ebbd9,0xae46bbf6,0x3913ba2f,0x35f1bb6e,0x2cb5bbfa,0xb365bbc9
.long 0x3872baa7,0x3444bbb6,0xaa48bbfe,0xb5c2bb77,0x378bbb0e,0x3115bbe6,0xb179bbe2,0xb7b7bb02
.long 0x361fbb64,0x2a48bbfe,0xb4a5bba8,0xb8c4ba6d,0x34a5bba8,0xabd9bbfc,0xb67cbb50,0xb996b9ba
.long 0x323ebbd9,0xb179bbe2,0xb81dbadd,0xba4fb8ec,0x2e46bbf6,0xb475bbaf,0xb8ecba4f,0xbae9b807
.long 0x39a8b9a8,0x3872baa7,0x361fbb64,0x323ebbd9,0x38c4ba6d,0x36aabb46,0x3303bbce,0x2248bc00
.long 0x378bbb0e,0x3444bbb6,0x2a48bbfe,0xb179bbe2,0x3564bb88,0x2f0ebbf4,0xafd6bbf1,0xb593bb80
.long 0x323ebbd9,0xaa48bbfe,0xb4a5bba8,0xb81dbadd,0x2a48bbfe,0xb2a1bbd4,0xb732bb25,0xb94db9fe
.long 0xae46bbf6,0xb5c2bb77,0xb8c4ba6d,0xba4fb8ec,0xb3c6bbc3,0xb807bae9,0xb9cbb984,0xbb1ab75e
.long 0xb61fbb64,0xb913ba2f,0xbaa7b872,0xbba8b4a5,0xb81dbadd,0xb9feb94d,0xbb50b67c,0xbbf4af0e
.long 0xb913ba2f,0xbac2b848,0xbbc3b3c6,0xbbfa2cb5,0xb9edb95f,0xbb5ab64e,0xbbfaacb5,0xbbbc3414
.long 0xbaa7b872,0xbbc3b3c6,0xbbf62e46,0xbb3b36d7,0xbb3bb6d7,0xbbf8ad7e,0xbbb63444,0xba7c38b0
.long 0xbba8b4a5,0xbbfa2cb5,0xbb3b36d7,0xb98439cb,0xbbeab0b2,0xbbc93365,0xba8a389b,0xb85d3ab5
.long 0x3f003f00,0x3f003f00,0x3f003f00,0x3f003f00,0x3efb3ece,0x3f1b3e3d,0x3f22bd7f,0x3f0fbe99
.long 0x3eed3e9e,0x3f0bbdde,0x3e9ebeed,0xbddebf0b,0x3ed53e64,0x3ebbbe99,0xbe0cbee7,0xbef0bd3d
.long 0x3eb53e16,0x3e16beb5,0xbeb5be16,0xbe163eb5,0x3e8e3dad,0xbce9be94,0xbe833e0c,0x3e663e3d
.long 0x3e443d1c,0xbddebe26,0xbd1c3e44,0x3e26bdde,0x3dc83c1d,0xbdb1bd3d,0x3d7f3d9b,0xbce9bdc0
.long 0x240d0000,0xa40d0000,0x240d0000,0xa40d0000,0xbdc83c1d,0x3db1bd3d,0xbd7f3d9b,0x3ce9bdc0
.long 0xbe443d1c,0x3ddebe26,0x3d1c3e44,0xbe26bdde,0xbe8e3dad,0x3ce9be94,0x3e833e0c,0xbe663e3d
.long 0xbeb53e16,0xbe16beb5,0x3eb5be16,0x3e163eb5,0xbed53e64,0xbebbbe99,0x3e0cbee7,0x3ef0bd3d
.long 0xbeed3e9e,0xbf0bbdde,0xbe9ebeed,0x3ddebf0b,0xbefb3ece,0xbf1b3e3d,0xbf22bd7f,0xbf0fbe99
.long 0xbf003f00,0xbf003f00,0xbf003f00,0xbf003f00,0xbefb3f19,0xbe663f3d,0x3d9b3f45,0x3ebb3f2f
.long 0xbeed3f31,0x3e263f51,0x3f313eed,0x3f51be26,0xbed53f47,0x3f0f3f2f,0x3f58be83,0x3db1bf61
.long 0xbeb53f5b,0x3f5b3eb5,0x3eb5bf5b,0xbf5bbeb5,0xbe8e3f6a,0x3f74bdc0,0xbee7bf58,0xbf1b3f3d
.long 0xbe443f76,0x3f51bf0b,0xbf76be44,0x3f0b3f51,0xbdc83f7e,0x3ef0bf61,0xbf453f22,0x3f74be94
.long 0xa4d43f80,0x24d4bf80,0xa4d43f80,0x24d4bf80,0x3dc83f7e,0xbef0bf61,0x3f453f22,0xbf74be94
.long 0x3e443f76,0xbf51bf0b,0x3f76be44,0xbf0b3f51,0x3e8e3f6a,0xbf74bdc0,0x3ee7bf58,0x3f1b3f3d
.long 0x3eb53f5b,0xbf5b3eb5,0xbeb5bf5b,0x3f5bbeb5,0x3ed53f47,0xbf0f3f2f,0xbf58be83,0xbdb1bf61
.long 0x3eed3f31,0xbe263f51,0xbf313eed,0xbf51be26,0x3efb3f19,0x3e663f3d,0xbd9b3f45,0xbebb3f2f
.long 0x3f003f00,0x3f003f00,0x3f003f00,0x3f003f00,0x3efb3f19,0x3e663f3d,0xbd9b3f45,0xbebb3f2f
.long 0x3eed3f31,0xbe263f51,0xbf313eed,0xbf51be26,0x3ed53f47,0xbf0f3f2f,0xbf58be83,0xbdb1bf61
.long 0x3eb53f5b,0xbf5b3eb5,0xbeb5bf5b,0x3f5bbeb5,0x3e8e3f6a,0xbf74bdc0,0x3ee7bf58,0x3f1b3f3d
.long 0x3e443f76,0xbf51bf0b,0x3f76be44,0xbf0b3f51,0x3dc83f7e,0xbef0bf61,0x3f453f22,0xbf74be94
.long 0x240d3f80,0xa530bf80,0x240d3f80,0xa530bf80,0xbdc83f7e,0x3ef0bf61,0xbf453f22,0x3f74be94
.long 0xbe443f76,0x3f51bf0b,0xbf76be44,0x3f0b3f51,0xbe8e3f6a,0x3f74bdc0,0xbee7bf58,0xbf1b3f3d
.long 0xbeb53f5b,0x3f5b3eb5,0x3eb5bf5b,0xbf5bbeb5,0xbed53f47,0x3f0f3f2f,0x3f58be83,0x3db1bf61
.long 0xbeed3f31,0x3e263f51,0x3f313eed,0x3f51be26,0xbefb3f19,0xbe663f3d,0x3d9b3f45,0x3ebb3f2f
.long 0xbf003f00,0xbf003f00,0xbf003f00,0xbf003f00,0xbefb3ece,0xbf1b3e3d,0xbf22bd7f,0xbf0fbe99
.long 0xbeed3e9e,0xbf0bbdde,0xbe9ebeed,0x3ddebf0b,0xbed53e64,0xbebbbe99,0x3e0cbee7,0x3ef0bd3d
.long 0xbeb53e16,0xbe16beb5,0x3eb5be16,0x3e163eb5,0xbe8e3dad,0x3ce9be94,0x3e833e0c,0xbe663e3d
.long 0xbe443d1c,0x3ddebe26,0x3d1c3e44,0xbe26bdde,0xbdc83c1d,0x3db1bd3d,0xbd7f3d9b,0x3ce9bdc0
.long 0xa4d40000,0xa40d0000,0xa4d40000,0xa40d0000,0x3dc83c1d,0xbdb1bd3d,0x3d7f3d9b,0xbce9bdc0
.long 0x3e443d1c,0xbddebe26,0xbd1c3e44,0x3e26bdde,0x3e8e3dad,0xbce9be94,0xbe833e0c,0x3e663e3d
.long 0x3eb53e16,0x3e16beb5,0xbeb5be16,0xbe163eb5,0x3ed53e64,0x3ebbbe99,0xbe0cbee7,0xbef0bd3d
.long 0x3eed3e9e,0x3f0bbdde,0x3e9ebeed,0xbddebf0b,0x3efb3ece,0x3f1b3e3d,0x3f22bd7f,0x3f0fbe99
.long 0x3f003f00,0x3f003f00,0x3f003f00,0x3f003f00,0x3ecebefb,0x3e3dbf1b,0xbd7fbf22,0xbe99bf0f
.long 0xbeedbe9e,0xbf0b3dde,0xbe9e3eed,0x3dde3f0b,0xbe643ed5,0x3e993ebb,0x3ee7be0c,0x3d3dbef0
.long 0x3eb53e16,0x3e16beb5,0xbeb5be16,0xbe163eb5,0x3dadbe8e,0xbe943ce9,0x3e0c3e83,0x3e3dbe66
.long 0xbe44bd1c,0x3dde3e26,0x3d1cbe44,0xbe263dde,0xbc1d3dc8,0x3d3dbdb1,0xbd9b3d7f,0x3dc0bce9
.long 0x240d0000,0xa40d0000,0x240d0000,0xa40d0000,0x3c1d3dc8,0xbd3dbdb1,0x3d9b3d7f,0xbdc0bce9
.long 0x3e44bd1c,0xbdde3e26,0xbd1cbe44,0x3e263dde,0xbdadbe8e,0x3e943ce9,0xbe0c3e83,0xbe3dbe66
.long 0xbeb53e16,0xbe16beb5,0x3eb5be16,0x3e163eb5,0x3e643ed5,0xbe993ebb,0xbee7be0c,0xbd3dbef0
.long 0x3eedbe9e,0x3f0b3dde,0x3e9e3eed,0xbdde3f0b,0xbecebefb,0xbe3dbf1b,0x3d7fbf22,0x3e99bf0f
.long 0xbf003f00,0xbf003f00,0xbf003f00,0xbf003f00,0x3f193efb,0x3f3d3e66,0x3f45bd9b,0x3f2fbebb
.long 0x3eedbf31,0xbe26bf51,0xbf31beed,0xbf513e26,0xbf47bed5,0xbf2f3f0f,0x3e833f58,0x3f613db1
.long 0xbeb53f5b,0x3f5b3eb5,0x3eb5bf5b,0xbf5bbeb5,0x3f6a3e8e,0xbdc0bf74,0xbf583ee7,0x3f3d3f1b
.long 0x3e44bf76,0xbf513f0b,0x3f763e44,0xbf0bbf51,0xbf7ebdc8,0x3f613ef0,0xbf22bf45,0x3e943f74
.long 0xa4d43f80,0x24d4bf80,0xa4d43f80,0x24d4bf80,0x3f7ebdc8,0xbf613ef0,0x3f22bf45,0xbe943f74
.long 0xbe44bf76,0x3f513f0b,0xbf763e44,0x3f0bbf51,0xbf6a3e8e,0x3dc0bf74,0x3f583ee7,0xbf3d3f1b
.long 0x3eb53f5b,0xbf5b3eb5,0xbeb5bf5b,0x3f5bbeb5,0x3f47bed5,0x3f2f3f0f,0xbe833f58,0xbf613db1
.long 0xbeedbf31,0x3e26bf51,0x3f31beed,0x3f513e26,0xbf193efb,0xbf3d3e66,0xbf45bd9b,0xbf2fbebb
.long 0x3f003f00,0x3f003f00,0x3f003f00,0x3f003f00,0xbf193efb,0xbf3d3e66,0xbf45bd9b,0xbf2fbebb
.long 0xbeedbf31,0x3e26bf51,0x3f31beed,0x3f513e26,0x3f47bed5,0x3f2f3f0f,0xbe833f58,0xbf613db1
.long 0x3eb53f5b,0xbf5b3eb5,0xbeb5bf5b,0x3f5bbeb5,0xbf6a3e8e,0x3dc0bf74,0x3f583ee7,0xbf3d3f1b
.long 0xbe44bf76,0x3f513f0b,0xbf763e44,0x3f0bbf51,0x3f7ebdc8,0xbf613ef0,0x3f22bf45,0xbe943f74
.long 0x240d3f80,0xa530bf80,0x240d3f80,0xa530bf80,0xbf7ebdc8,0x3f613ef0,0xbf22bf45,0x3e943f74
.long 0x3e44bf76,0xbf513f0b,0x3f763e44,0xbf0bbf51,0x3f6a3e8e,0xbdc0bf74,0xbf583ee7,0x3f3d3f1b
.long 0xbeb53f5b,0x3f5b3eb5,0x3eb5bf5b,0xbf5bbeb5,0xbf47bed5,0xbf2f3f0f,0x3e833f58,0x3f613db1
.long 0x3eedbf31,0xbe26bf51,0xbf31beed,0xbf513e26,0x3f193efb,0x3f3d3e66,0x3f45bd9b,0x3f2fbebb
.long 0xbf003f00,0xbf003f00,0xbf003f00,0xbf003f00,0xbecebefb,0xbe3dbf1b,0x3d7fbf22,0x3e99bf0f
.long 0x3eedbe9e,0x3f0b3dde,0x3e9e3eed,0xbdde3f0b,0x3e643ed5,0xbe993ebb,0xbee7be0c,0xbd3dbef0
.long 0xbeb53e16,0xbe16beb5,0x3eb5be16,0x3e163eb5,0xbdadbe8e,0x3e943ce9,0xbe0c3e83,0xbe3dbe66
.long 0x3e44bd1c,0xbdde3e26,0xbd1cbe44,0x3e263dde,0x3c1d3dc8,0xbd3dbdb1,0x3d9b3d7f,0xbdc0bce9
.long 0xa4d40000,0xa40d0000,0xa4d40000,0xa40d0000,0xbc1d3dc8,0x3d3dbdb1,0xbd9b3d7f,0x3dc0bce9
.long 0xbe44bd1c,0x3dde3e26,0x3d1cbe44,0xbe263dde,0x3dadbe8e,0xbe943ce9,0x3e0c3e83,0x3e3dbe66
.long 0x3eb53e16,0x3e16beb5,0xbeb5be16,0xbe163eb5,0xbe643ed5,0x3e993ebb,0x3ee7be0c,0x3d3dbef0
.long 0xbeedbe9e,0xbf0b3dde,0xbe9e3eed,0x3dde3f0b,0x3ecebefb,0x3e3dbf1b,0xbd7fbf22,0xbe99bf0f
.long 0x3f003f00,0x3f003f00,0x3f003f00,0x3f003f00,0xbefbbece,0xbf1bbe3d,0xbf223d7f,0xbf0f3e99
.long 0x3eed3e9e,0x3f0bbdde,0x3e9ebeed,0xbddebf0b,0xbed5be64,0xbebb3e99,0x3e0c3ee7,0x3ef03d3d
.long 0x3eb53e16,0x3e16beb5,0xbeb5be16,0xbe163eb5,0xbe8ebdad,0x3ce93e94,0x3e83be0c,0xbe66be3d
.long 0x3e443d1c,0xbddebe26,0xbd1c3e44,0x3e26bdde,0xbdc8bc1d,0x3db13d3d,0xbd7fbd9b,0x3ce93dc0
.long 0x240d0000,0xa40d0000,0x240d0000,0xa40d0000,0x3dc8bc1d,0xbdb13d3d,0x3d7fbd9b,0xbce93dc0
.long 0xbe443d1c,0x3ddebe26,0x3d1c3e44,0xbe26bdde,0x3e8ebdad,0xbce93e94,0xbe83be0c,0x3e66be3d
.long 0xbeb53e16,0xbe16beb5,0x3eb5be16,0x3e163eb5,0x3ed5be64,0x3ebb3e99,0xbe0c3ee7,0xbef03d3d
.long 0xbeed3e9e,0xbf0bbdde,0xbe9ebeed,0x3ddebf0b,0x3efbbece,0x3f1bbe3d,0x3f223d7f,0x3f0f3e99
.long 0xbf003f00,0xbf003f00,0xbf003f00,0xbf003f00,0x3efbbf19,0x3e66bf3d,0xbd9bbf45,0xbebbbf2f
.long 0xbeed3f31,0x3e263f51,0x3f313eed,0x3f51be26,0x3ed5bf47,0xbf0fbf2f,0xbf583e83,0xbdb13f61
.long 0xbeb53f5b,0x3f5b3eb5,0x3eb5bf5b,0xbf5bbeb5,0x3e8ebf6a,0xbf743dc0,0x3ee73f58,0x3f1bbf3d
.long 0xbe443f76,0x3f51bf0b,0xbf76be44,0x3f0b3f51,0x3dc8bf7e,0xbef03f61,0x3f45bf22,0xbf743e94
.long 0xa4d43f80,0x24d4bf80,0xa4d43f80,0x24d4bf80,0xbdc8bf7e,0x3ef03f61,0xbf45bf22,0x3f743e94
.long 0x3e443f76,0xbf51bf0b,0x3f76be44,0xbf0b3f51,0xbe8ebf6a,0x3f743dc0,0xbee73f58,0xbf1bbf3d
.long 0x3eb53f5b,0xbf5b3eb5,0xbeb5bf5b,0x3f5bbeb5,0xbed5bf47,0x3f0fbf2f,0x3f583e83,0x3db13f61
.long 0x3eed3f31,0xbe263f51,0xbf313eed,0xbf51be26,0xbefbbf19,0xbe66bf3d,0x3d9bbf45,0x3ebbbf2f
.long 0x3f003f00,0x3f003f00,0x3f003f00,0x3f003f00,0xbefbbf19,0xbe66bf3d,0x3d9bbf45,0x3ebbbf2f
.long 0x3eed3f31,0xbe263f51,0xbf313eed,0xbf51be26,0xbed5bf47,0x3f0fbf2f,0x3f583e83,0x3db13f61
.long 0x3eb53f5b,0xbf5b3eb5,0xbeb5bf5b,0x3f5bbeb5,0xbe8ebf6a,0x3f743dc0,0xbee73f58,0xbf1bbf3d
.long 0x3e443f76,0xbf51bf0b,0x3f76be44,0xbf0b3f51,0xbdc8bf7e,0x3ef03f61,0xbf45bf22,0x3f743e94
.long 0x240d3f80,0xa530bf80,0x240d3f80,0xa530bf80,0x3dc8bf7e,0xbef03f61,0x3f45bf22,0xbf743e94
.long 0xbe443f76,0x3f51bf0b,0xbf76be44,0x3f0b3f51,0x3e8ebf6a,0xbf743dc0,0x3ee73f58,0x3f1bbf3d
.long 0xbeb53f5b,0x3f5b3eb5,0x3eb5bf5b,0xbf5bbeb5,0x3ed5bf47,0xbf0fbf2f,0xbf583e83,0xbdb13f61
.long 0xbeed3f31,0x3e263f51,0x3f313eed,0x3f51be26,0x3efbbf19,0x3e66bf3d,0xbd9bbf45,0xbebbbf2f
.long 0xbf003f00,0xbf003f00,0xbf003f00,0xbf003f00,0x3efbbece,0x3f1bbe3d,0x3f223d7f,0x3f0f3e99
.long 0xbeed3e9e,0xbf0bbdde,0xbe9ebeed,0x3ddebf0b,0x3ed5be64,0x3ebb3e99,0xbe0c3ee7,0xbef03d3d
.long 0xbeb53e16,0xbe16beb5,0x3eb5be16,0x3e163eb5,0x3e8ebdad,0xbce93e94,0xbe83be0c,0x3e66be3d
.long 0xbe443d1c,0x3ddebe26,0x3d1c3e44,0xbe26bdde,0x3dc8bc1d,0xbdb13d3d,0x3d7fbd9b,0xbce93dc0
.long 0xa4d40000,0xa40d0000,0xa4d40000,0xa40d0000,0xbdc8bc1d,0x3db13d3d,0xbd7fbd9b,0x3ce93dc0
.long 0x3e443d1c,0xbddebe26,0xbd1c3e44,0x3e26bdde,0xbe8ebdad,0x3ce93e94,0x3e83be0c,0xbe66be3d
.long 0x3eb53e16,0x3e16beb5,0xbeb5be16,0xbe163eb5,0xbed5be64,0xbebb3e99,0x3e0c3ee7,0x3ef03d3d
.long 0x3eed3e9e,0x3f0bbdde,0x3e9ebeed,0xbddebf0b,0xbefbbece,0xbf1bbe3d,0xbf223d7f,0xbf0f3e99
.long 0x3f003f00,0x3f003f00,0x3f003f00,0x3f003f00,0xbece3efb,0xbe3d3f1b,0x3d7f3f22,0x3e993f0f
.long 0xbeedbe9e,0xbf0b3dde,0xbe9e3eed,0x3dde3f0b,0x3e64bed5,0xbe99bebb,0xbee73e0c,0xbd3d3ef0
.long 0x3eb53e16,0x3e16beb5,0xbeb5be16,0xbe163eb5,0xbdad3e8e,0x3e94bce9,0xbe0cbe83,0xbe3d3e66
.long 0xbe44bd1c,0x3dde3e26,0x3d1cbe44,0xbe263dde,0x3c1dbdc8,0xbd3d3db1,0x3d9bbd7f,0xbdc03ce9
.long 0x240d0000,0xa40d0000,0x240d0000,0xa40d0000,0xbc1dbdc8,0x3d3d3db1,0xbd9bbd7f,0x3dc03ce9
.long 0x3e44bd1c,0xbdde3e26,0xbd1cbe44,0x3e263dde,0x3dad3e8e,0xbe94bce9,0x3e0cbe83,0x3e3d3e66
.long 0xbeb53e16,0xbe16beb5,0x3eb5be16,0x3e163eb5,0xbe64bed5,0x3e99bebb,0x3ee73e0c,0x3d3d3ef0
.long 0x3eedbe9e,0x3f0b3dde,0x3e9e3eed,0xbdde3f0b,0x3ece3efb,0x3e3d3f1b,0xbd7f3f22,0xbe993f0f
.long 0xbf003f00,0xbf003f00,0xbf003f00,0xbf003f00,0xbf19befb,0xbf3dbe66,0xbf453d9b,0xbf2f3ebb
.long 0x3eedbf31,0xbe26bf51,0xbf31beed,0xbf513e26,0x3f473ed5,0x3f2fbf0f,0xbe83bf58,0xbf61bdb1
.long 0xbeb53f5b,0x3f5b3eb5,0x3eb5bf5b,0xbf5bbeb5,0xbf6abe8e,0x3dc03f74,0x3f58bee7,0xbf3dbf1b
.long 0x3e44bf76,0xbf513f0b,0x3f763e44,0xbf0bbf51,0x3f7e3dc8,0xbf61bef0,0x3f223f45,0xbe94bf74
.long 0xa4d43f80,0x24d4bf80,0xa4d43f80,0x24d4bf80,0xbf7e3dc8,0x3f61bef0,0xbf223f45,0x3e94bf74
.long 0xbe44bf76,0x3f513f0b,0xbf763e44,0x3f0bbf51,0x3f6abe8e,0xbdc03f74,0xbf58bee7,0x3f3dbf1b
.long 0x3eb53f5b,0xbf5b3eb5,0xbeb5bf5b,0x3f5bbeb5,0xbf473ed5,0xbf2fbf0f,0x3e83bf58,0x3f61bdb1
.long 0xbeedbf31,0x3e26bf51,0x3f31beed,0x3f513e26,0x3f19befb,0x3f3dbe66,0x3f453d9b,0x3f2f3ebb
.long 0x3f003f00,0x3f003f00,0x3f003f00,0x3f003f00,0x3f19befb,0x3f3dbe66,0x3f453d9b,0x3f2f3ebb
.long 0xbeedbf31,0x3e26bf51,0x3f31beed,0x3f513e26,0xbf473ed5,0xbf2fbf0f,0x3e83bf58,0x3f61bdb1
.long 0x3eb53f5b,0xbf5b3eb5,0xbeb5bf5b,0x3f5bbeb5,0x3f6abe8e,0xbdc03f74,0xbf58bee7,0x3f3dbf1b
.long 0xbe44bf76,0x3f513f0b,0xbf763e44,0x3f0bbf51,0xbf7e3dc8,0x3f61bef0,0xbf223f45,0x3e94bf74
.long 0x240d3f80,0xa530bf80,0x240d3f80,0xa530bf80,0x3f7e3dc8,0xbf61bef0,0x3f223f45,0xbe94bf74
.long 0x3e44bf76,0xbf513f0b,0x3f763e44,0xbf0bbf51,0xbf6abe8e,0x3dc03f74,0x3f58bee7,0xbf3dbf1b
.long 0xbeb53f5b,0x3f5b3eb5,0x3eb5bf5b,0xbf5bbeb5,0x3f473ed5,0x3f2fbf0f,0xbe83bf58,0xbf61bdb1
.long 0x3eedbf31,0xbe26bf51,0xbf31beed,0xbf513e26,0xbf19befb,0xbf3dbe66,0xbf453d9b,0xbf2f3ebb
.long 0xbf003f00,0xbf003f00,0xbf003f00,0xbf003f00,0x3ece3efb,0x3e3d3f1b,0xbd7f3f22,0xbe993f0f
.long 0x3eedbe9e,0x3f0b3dde,0x3e9e3eed,0xbdde3f0b,0xbe64bed5,0x3e99bebb,0x3ee73e0c,0x3d3d3ef0
.long 0xbeb53e16,0xbe16beb5,0x3eb5be16,0x3e163eb5,0x3dad3e8e,0xbe94bce9,0x3e0cbe83,0x3e3d3e66
.long 0x3e44bd1c,0xbdde3e26,0xbd1cbe44,0x3e263dde,0xbc1dbdc8,0x3d3d3db1,0xbd9bbd7f,0x3dc03ce9
.long 0xa4d40000,0xa40d0000,0xa4d40000,0xa40d0000,0x3c1dbdc8,0xbd3d3db1,0x3d9bbd7f,0xbdc03ce9
.long 0xbe44bd1c,0x3dde3e26,0x3d1cbe44,0xbe263dde,0xbdad3e8e,0x3e94bce9,0xbe0cbe83,0xbe3d3e66
.long 0x3eb53e16,0x3e16beb5,0xbeb5be16,0xbe163eb5,0x3e64bed5,0xbe99bebb,0xbee73e0c,0xbd3d3ef0
.long 0xbeedbe9e,0xbf0b3dde,0xbe9e3eed,0x3dde3f0b,0xbece3efb,0xbe3d3f1b,0x3d7f3f22,0x3e993f0f
.long 0x3f00bf00,0x3f00bf00,0x3f00bf00,0x3f00bf00,0x3ecebefb,0x3e3dbf1b,0xbd7fbf22,0xbe99bf0f
.long 0x3e9ebeed,0xbddebf0b,0xbeedbe9e,0xbf0b3dde,0x3e64bed5,0xbe99bebb,0xbee73e0c,0xbd3d3ef0
.long 0x3e16beb5,0xbeb5be16,0xbe163eb5,0x3eb53e16,0x3dadbe8e,0xbe943ce9,0x3e0c3e83,0x3e3dbe66
.long 0x3d1cbe44,0xbe263dde,0x3e443d1c,0xbddebe26,0x3c1dbdc8,0xbd3d3db1,0x3d9bbd7f,0xbdc03ce9
.long 0xa40d,0x240d,0xa40d,0x240d,0x3c1d3dc8,0xbd3dbdb1,0x3d9b3d7f,0xbdc0bce9
.long 0x3d1c3e44,0xbe26bdde,0x3e44bd1c,0xbdde3e26,0x3dad3e8e,0xbe94bce9,0x3e0cbe83,0x3e3d3e66
.long 0x3e163eb5,0xbeb53e16,0xbe16beb5,0x3eb5be16,0x3e643ed5,0xbe993ebb,0xbee7be0c,0xbd3dbef0
.long 0x3e9e3eed,0xbdde3f0b,0xbeed3e9e,0xbf0bbdde,0x3ece3efb,0x3e3d3f1b,0xbd7f3f22,0xbe993f0f
.long 0x3f003f00,0x3f003f00,0x3f003f00,0x3f003f00,0x3f193efb,0x3f3d3e66,0x3f45bd9b,0x3f2fbebb
.long 0x3f313eed,0x3f51be26,0x3eedbf31,0xbe26bf51,0x3f473ed5,0x3f2fbf0f,0xbe83bf58,0xbf61bdb1
.long 0x3f5b3eb5,0x3eb5bf5b,0xbf5bbeb5,0xbeb53f5b,0x3f6a3e8e,0xbdc0bf74,0xbf583ee7,0x3f3d3f1b
.long 0x3f763e44,0xbf0bbf51,0xbe443f76,0x3f51bf0b,0x3f7e3dc8,0xbf61bef0,0x3f223f45,0xbe94bf74
.long 0x3f8024d4,0xbf80a4d4,0x3f8024d4,0xbf80a4d4,0x3f7ebdc8,0xbf613ef0,0x3f22bf45,0xbe943f74
.long 0x3f76be44,0xbf0b3f51,0xbe44bf76,0x3f513f0b,0x3f6abe8e,0xbdc03f74,0xbf58bee7,0x3f3dbf1b
.long 0x3f5bbeb5,0x3eb53f5b,0xbf5b3eb5,0xbeb5bf5b,0x3f47bed5,0x3f2f3f0f,0xbe833f58,0xbf613db1
.long 0x3f31beed,0x3f513e26,0x3eed3f31,0xbe263f51,0x3f19befb,0x3f3dbe66,0x3f453d9b,0x3f2f3ebb
.long 0xbf003f00,0xbf003f00,0xbf003f00,0xbf003f00,0xbf193efb,0xbf3d3e66,0xbf45bd9b,0xbf2fbebb
.long 0xbf313eed,0xbf51be26,0xbeedbf31,0x3e26bf51,0xbf473ed5,0xbf2fbf0f,0x3e83bf58,0x3f61bdb1
.long 0xbf5b3eb5,0xbeb5bf5b,0x3f5bbeb5,0x3eb53f5b,0xbf6a3e8e,0x3dc0bf74,0x3f583ee7,0xbf3d3f1b
.long 0xbf763e44,0x3f0bbf51,0x3e443f76,0xbf51bf0b,0xbf7e3dc8,0x3f61bef0,0xbf223f45,0x3e94bf74
.long 0xbf80240d,0x3f80a530,0xbf80240d,0x3f80a530,0xbf7ebdc8,0x3f613ef0,0xbf22bf45,0x3e943f74
.long 0xbf76be44,0x3f0b3f51,0x3e44bf76,0xbf513f0b,0xbf6abe8e,0x3dc03f74,0x3f58bee7,0xbf3dbf1b
.long 0xbf5bbeb5,0xbeb53f5b,0x3f5b3eb5,0x3eb5bf5b,0xbf47bed5,0xbf2f3f0f,0x3e833f58,0x3f613db1
.long 0xbf31beed,0xbf513e26,0xbeed3f31,0x3e263f51,0xbf19befb,0xbf3dbe66,0xbf453d9b,0xbf2f3ebb
.long 0xbf00bf00,0xbf00bf00,0xbf00bf00,0xbf00bf00,0xbecebefb,0xbe3dbf1b,0x3d7fbf22,0x3e99bf0f
.long 0xbe9ebeed,0x3ddebf0b,0x3eedbe9e,0x3f0b3dde,0xbe64bed5,0x3e99bebb,0x3ee73e0c,0x3d3d3ef0
.long 0xbe16beb5,0x3eb5be16,0x3e163eb5,0xbeb53e16,0xbdadbe8e,0x3e943ce9,0xbe0c3e83,0xbe3dbe66
.long 0xbd1cbe44,0x3e263dde,0xbe443d1c,0x3ddebe26,0xbc1dbdc8,0x3d3d3db1,0xbd9bbd7f,0x3dc03ce9
.long 0xa4d4,0xa40d,0xa4d4,0xa40d,0xbc1d3dc8,0x3d3dbdb1,0xbd9b3d7f,0x3dc0bce9
.long 0xbd1c3e44,0x3e26bdde,0xbe44bd1c,0x3dde3e26,0xbdad3e8e,0x3e94bce9,0xbe0cbe83,0xbe3d3e66
.long 0xbe163eb5,0x3eb53e16,0x3e16beb5,0xbeb5be16,0xbe643ed5,0x3e993ebb,0x3ee7be0c,0x3d3dbef0
.long 0xbe9e3eed,0x3dde3f0b,0x3eed3e9e,0x3f0bbdde,0xbece3efb,0xbe3d3f1b,0x3d7f3f22,0x3e993f0f
.long 0x3f00bf00,0x3f00bf00,0x3f00bf00,0x3f00bf00,0xbefbbece,0xbf1bbe3d,0xbf223d7f,0xbf0f3e99
.long 0xbe9e3eed,0x3dde3f0b,0x3eed3e9e,0x3f0bbdde,0x3ed53e64,0x3ebbbe99,0xbe0cbee7,0xbef0bd3d
.long 0x3e16beb5,0xbeb5be16,0xbe163eb5,0x3eb53e16,0xbe8ebdad,0x3ce93e94,0x3e83be0c,0xbe66be3d
.long 0xbd1c3e44,0x3e26bdde,0xbe44bd1c,0x3dde3e26,0x3dc83c1d,0xbdb1bd3d,0x3d7f3d9b,0xbce9bdc0
.long 0xa40d,0x240d,0xa40d,0x240d,0x3dc8bc1d,0xbdb13d3d,0x3d7fbd9b,0xbce93dc0
.long 0xbd1cbe44,0x3e263dde,0xbe443d1c,0x3ddebe26,0xbe8e3dad,0x3ce9be94,0x3e833e0c,0xbe663e3d
.long 0x3e163eb5,0xbeb53e16,0xbe16beb5,0x3eb5be16,0x3ed5be64,0x3ebb3e99,0xbe0c3ee7,0xbef03d3d
.long 0xbe9ebeed,0x3ddebf0b,0x3eedbe9e,0x3f0b3dde,0xbefb3ece,0xbf1b3e3d,0xbf22bd7f,0xbf0fbe99
.long 0x3f003f00,0x3f003f00,0x3f003f00,0x3f003f00,0x3efbbf19,0x3e66bf3d,0xbd9bbf45,0xbebbbf2f
.long 0xbf31beed,0xbf513e26,0xbeed3f31,0x3e263f51,0xbed53f47,0x3f0f3f2f,0x3f58be83,0x3db1bf61
.long 0x3f5b3eb5,0x3eb5bf5b,0xbf5bbeb5,0xbeb53f5b,0x3e8ebf6a,0xbf743dc0,0x3ee73f58,0x3f1bbf3d
.long 0xbf76be44,0x3f0b3f51,0x3e44bf76,0xbf513f0b,0xbdc83f7e,0x3ef0bf61,0xbf453f22,0x3f74be94
.long 0x3f8024d4,0xbf80a4d4,0x3f8024d4,0xbf80a4d4,0xbdc8bf7e,0x3ef03f61,0xbf45bf22,0x3f743e94
.long 0xbf763e44,0x3f0bbf51,0x3e443f76,0xbf51bf0b,0x3e8e3f6a,0xbf74bdc0,0x3ee7bf58,0x3f1b3f3d
.long 0x3f5bbeb5,0x3eb53f5b,0xbf5b3eb5,0xbeb5bf5b,0xbed5bf47,0x3f0fbf2f,0x3f583e83,0x3db13f61
.long 0xbf313eed,0xbf51be26,0xbeedbf31,0x3e26bf51,0x3efb3f19,0x3e663f3d,0xbd9b3f45,0xbebb3f2f
.long 0xbf003f00,0xbf003f00,0xbf003f00,0xbf003f00,0xbefbbf19,0xbe66bf3d,0x3d9bbf45,0x3ebbbf2f
.long 0x3f31beed,0x3f513e26,0x3eed3f31,0xbe263f51,0x3ed53f47,0xbf0f3f2f,0xbf58be83,0xbdb1bf61
.long 0xbf5b3eb5,0xbeb5bf5b,0x3f5bbeb5,0x3eb53f5b,0xbe8ebf6a,0x3f743dc0,0xbee73f58,0xbf1bbf3d
.long 0x3f76be44,0xbf0b3f51,0xbe44bf76,0x3f513f0b,0x3dc83f7e,0xbef0bf61,0x3f453f22,0xbf74be94
.long 0xbf80240d,0x3f80a530,0xbf80240d,0x3f80a530,0x3dc8bf7e,0xbef03f61,0x3f45bf22,0xbf743e94
.long 0x3f763e44,0xbf0bbf51,0xbe443f76,0x3f51bf0b,0xbe8e3f6a,0x3f74bdc0,0xbee7bf58,0xbf1b3f3d
.long 0xbf5bbeb5,0xbeb53f5b,0x3f5b3eb5,0x3eb5bf5b,0x3ed5bf47,0xbf0fbf2f,0xbf583e83,0xbdb13f61
.long 0x3f313eed,0x3f51be26,0x3eedbf31,0xbe26bf51,0xbefb3f19,0xbe663f3d,0x3d9b3f45,0x3ebb3f2f
.long 0xbf00bf00,0xbf00bf00,0xbf00bf00,0xbf00bf00,0x3efbbece,0x3f1bbe3d,0x3f223d7f,0x3f0f3e99
.long 0x3e9e3eed,0xbdde3f0b,0xbeed3e9e,0xbf0bbdde,0xbed53e64,0xbebbbe99,0x3e0cbee7,0x3ef0bd3d
.long 0xbe16beb5,0x3eb5be16,0x3e163eb5,0xbeb53e16,0x3e8ebdad,0xbce93e94,0xbe83be0c,0x3e66be3d
.long 0x3d1c3e44,0xbe26bdde,0x3e44bd1c,0xbdde3e26,0xbdc83c1d,0x3db1bd3d,0xbd7f3d9b,0x3ce9bdc0
.long 0xa4d4,0xa40d,0xa4d4,0xa40d,0xbdc8bc1d,0x3db13d3d,0xbd7fbd9b,0x3ce93dc0
.long 0x3d1cbe44,0xbe263dde,0x3e443d1c,0xbddebe26,0x3e8e3dad,0xbce9be94,0xbe833e0c,0x3e663e3d
.long 0xbe163eb5,0x3eb53e16,0x3e16beb5,0xbeb5be16,0xbed5be64,0xbebb3e99,0x3e0c3ee7,0x3ef03d3d
.long 0x3e9ebeed,0xbddebf0b,0xbeedbe9e,0xbf0b3dde,0x3efb3ece,0x3f1b3e3d,0x3f22bd7f,0x3f0fbe99
.long 0x3f00bf00,0x3f00bf00,0x3f00bf00,0x3f00bf00,0xbece3efb,0xbe3d3f1b,0x3d7f3f22,0x3e993f0f
.long 0x3e9ebeed,0xbddebf0b,0xbeedbe9e,0xbf0b3dde,0xbe643ed5,0x3e993ebb,0x3ee7be0c,0x3d3dbef0
.long 0x3e16beb5,0xbeb5be16,0xbe163eb5,0x3eb53e16,0xbdad3e8e,0x3e94bce9,0xbe0cbe83,0xbe3d3e66
.long 0x3d1cbe44,0xbe263dde,0x3e443d1c,0xbddebe26,0xbc1d3dc8,0x3d3dbdb1,0xbd9b3d7f,0x3dc0bce9
.long 0xa40d,0x240d,0xa40d,0x240d,0xbc1dbdc8,0x3d3d3db1,0xbd9bbd7f,0x3dc03ce9
.long 0x3d1c3e44,0xbe26bdde,0x3e44bd1c,0xbdde3e26,0xbdadbe8e,0x3e943ce9,0xbe0c3e83,0xbe3dbe66
.long 0x3e163eb5,0xbeb53e16,0xbe16beb5,0x3eb5be16,0xbe64bed5,0x3e99bebb,0x3ee73e0c,0x3d3d3ef0
.long 0x3e9e3eed,0xbdde3f0b,0xbeed3e9e,0xbf0bbdde,0xbecebefb,0xbe3dbf1b,0x3d7fbf22,0x3e99bf0f
.long 0x3f003f00,0x3f003f00,0x3f003f00,0x3f003f00,0xbf19befb,0xbf3dbe66,0xbf453d9b,0xbf2f3ebb
.long 0x3f313eed,0x3f51be26,0x3eedbf31,0xbe26bf51,0xbf47bed5,0xbf2f3f0f,0x3e833f58,0x3f613db1
.long 0x3f5b3eb5,0x3eb5bf5b,0xbf5bbeb5,0xbeb53f5b,0xbf6abe8e,0x3dc03f74,0x3f58bee7,0xbf3dbf1b
.long 0x3f763e44,0xbf0bbf51,0xbe443f76,0x3f51bf0b,0xbf7ebdc8,0x3f613ef0,0xbf22bf45,0x3e943f74
.long 0x3f8024d4,0xbf80a4d4,0x3f8024d4,0xbf80a4d4,0xbf7e3dc8,0x3f61bef0,0xbf223f45,0x3e94bf74
.long 0x3f76be44,0xbf0b3f51,0xbe44bf76,0x3f513f0b,0xbf6a3e8e,0x3dc0bf74,0x3f583ee7,0xbf3d3f1b
.long 0x3f5bbeb5,0x3eb53f5b,0xbf5b3eb5,0xbeb5bf5b,0xbf473ed5,0xbf2fbf0f,0x3e83bf58,0x3f61bdb1
.long 0x3f31beed,0x3f513e26,0x3eed3f31,0xbe263f51,0xbf193efb,0xbf3d3e66,0xbf45bd9b,0xbf2fbebb
.long 0xbf003f00,0xbf003f00,0xbf003f00,0xbf003f00,0x3f19befb,0x3f3dbe66,0x3f453d9b,0x3f2f3ebb
.long 0xbf313eed,0xbf51be26,0xbeedbf31,0x3e26bf51,0x3f47bed5,0x3f2f3f0f,0xbe833f58,0xbf613db1
.long 0xbf5b3eb5,0xbeb5bf5b,0x3f5bbeb5,0x3eb53f5b,0x3f6abe8e,0xbdc03f74,0xbf58bee7,0x3f3dbf1b
.long 0xbf763e44,0x3f0bbf51,0x3e443f76,0xbf51bf0b,0x3f7ebdc8,0xbf613ef0,0x3f22bf45,0xbe943f74
.long 0xbf80240d,0x3f80a530,0xbf80240d,0x3f80a530,0x3f7e3dc8,0xbf61bef0,0x3f223f45,0xbe94bf74
.long 0xbf76be44,0x3f0b3f51,0x3e44bf76,0xbf513f0b,0x3f6a3e8e,0xbdc0bf74,0xbf583ee7,0x3f3d3f1b
.long 0xbf5bbeb5,0xbeb53f5b,0x3f5b3eb5,0x3eb5bf5b,0x3f473ed5,0x3f2fbf0f,0xbe83bf58,0xbf61bdb1
.long 0xbf31beed,0xbf513e26,0xbeed3f31,0x3e263f51,0x3f193efb,0x3f3d3e66,0x3f45bd9b,0x3f2fbebb
.long 0xbf00bf00,0xbf00bf00,0xbf00bf00,0xbf00bf00,0x3ece3efb,0x3e3d3f1b,0xbd7f3f22,0xbe993f0f
.long 0xbe9ebeed,0x3ddebf0b,0x3eedbe9e,0x3f0b3dde,0x3e643ed5,0xbe993ebb,0xbee7be0c,0xbd3dbef0
.long 0xbe16beb5,0x3eb5be16,0x3e163eb5,0xbeb53e16,0x3dad3e8e,0xbe94bce9,0x3e0cbe83,0x3e3d3e66
.long 0xbd1cbe44,0x3e263dde,0xbe443d1c,0x3ddebe26,0x3c1d3dc8,0xbd3dbdb1,0x3d9b3d7f,0xbdc0bce9
.long 0xa4d4,0xa40d,0xa4d4,0xa40d,0x3c1dbdc8,0xbd3d3db1,0x3d9bbd7f,0xbdc03ce9
.long 0xbd1c3e44,0x3e26bdde,0xbe44bd1c,0x3dde3e26,0x3dadbe8e,0xbe943ce9,0x3e0c3e83,0x3e3dbe66
.long 0xbe163eb5,0x3eb53e16,0x3e16beb5,0xbeb5be16,0x3e64bed5,0xbe99bebb,0xbee73e0c,0xbd3d3ef0
.long 0xbe9e3eed,0x3dde3f0b,0x3eed3e9e,0x3f0bbdde,0x3ecebefb,0x3e3dbf1b,0xbd7fbf22,0xbe99bf0f
.long 0x3f00bf00,0x3f00bf00,0x3f00bf00,0x3f00bf00,0x3efb3ece,0x3f1b3e3d,0x3f22bd7f,0x3f0fbe99
.long 0xbe9e3eed,0x3dde3f0b,0x3eed3e9e,0x3f0bbdde,0xbed5be64,0xbebb3e99,0x3e0c3ee7,0x3ef03d3d
.long 0x3e16beb5,0xbeb5be16,0xbe163eb5,0x3eb53e16,0x3e8e3dad,0xbce9be94,0xbe833e0c,0x3e663e3d
.long 0xbd1c3e44,0x3e26bdde,0xbe44bd1c,0x3dde3e26,0xbdc8bc1d,0x3db13d3d,0xbd7fbd9b,0x3ce93dc0
.long 0xa40d,0x240d,0xa40d,0x240d,0xbdc83c1d,0x3db1bd3d,0xbd7f3d9b,0x3ce9bdc0
.long 0xbd1cbe44,0x3e263dde,0xbe443d1c,0x3ddebe26,0x3e8ebdad,0xbce93e94,0xbe83be0c,0x3e66be3d
.long 0x3e163eb5,0xbeb53e16,0xbe16beb5,0x3eb5be16,0xbed53e64,0xbebbbe99,0x3e0cbee7,0x3ef0bd3d
.long 0xbe9ebeed,0x3ddebf0b,0x3eedbe9e,0x3f0b3dde,0x3efbbece,0x3f1bbe3d,0x3f223d7f,0x3f0f3e99
.long 0x3f003f00,0x3f003f00,0x3f003f00,0x3f003f00,0xbefb3f19,0xbe663f3d,0x3d9b3f45,0x3ebb3f2f
.long 0xbf31beed,0xbf513e26,0xbeed3f31,0x3e263f51,0x3ed5bf47,0xbf0fbf2f,0xbf583e83,0xbdb13f61
.long 0x3f5b3eb5,0x3eb5bf5b,0xbf5bbeb5,0xbeb53f5b,0xbe8e3f6a,0x3f74bdc0,0xbee7bf58,0xbf1b3f3d
.long 0xbf76be44,0x3f0b3f51,0x3e44bf76,0xbf513f0b,0x3dc8bf7e,0xbef03f61,0x3f45bf22,0xbf743e94
.long 0x3f8024d4,0xbf80a4d4,0x3f8024d4,0xbf80a4d4,0x3dc83f7e,0xbef0bf61,0x3f453f22,0xbf74be94
.long 0xbf763e44,0x3f0bbf51,0x3e443f76,0xbf51bf0b,0xbe8ebf6a,0x3f743dc0,0xbee73f58,0xbf1bbf3d
.long 0x3f5bbeb5,0x3eb53f5b,0xbf5b3eb5,0xbeb5bf5b,0x3ed53f47,0xbf0f3f2f,0xbf58be83,0xbdb1bf61
.long 0xbf313eed,0xbf51be26,0xbeedbf31,0x3e26bf51,0xbefbbf19,0xbe66bf3d,0x3d9bbf45,0x3ebbbf2f
.long 0xbf003f00,0xbf003f00,0xbf003f00,0xbf003f00,0x3efb3f19,0x3e663f3d,0xbd9b3f45,0xbebb3f2f
.long 0x3f31beed,0x3f513e26,0x3eed3f31,0xbe263f51,0xbed5bf47,0x3f0fbf2f,0x3f583e83,0x3db13f61
.long 0xbf5b3eb5,0xbeb5bf5b,0x3f5bbeb5,0x3eb53f5b,0x3e8e3f6a,0xbf74bdc0,0x3ee7bf58,0x3f1b3f3d
.long 0x3f76be44,0xbf0b3f51,0xbe44bf76,0x3f513f0b,0xbdc8bf7e,0x3ef03f61,0xbf45bf22,0x3f743e94
.long 0xbf80240d,0x3f80a530,0xbf80240d,0x3f80a530,0xbdc83f7e,0x3ef0bf61,0xbf453f22,0x3f74be94
.long 0x3f763e44,0xbf0bbf51,0xbe443f76,0x3f51bf0b,0x3e8ebf6a,0xbf743dc0,0x3ee73f58,0x3f1bbf3d
.long 0xbf5bbeb5,0xbeb53f5b,0x3f5b3eb5,0x3eb5bf5b,0xbed53f47,0x3f0f3f2f,0x3f58be83,0x3db1bf61
.long 0x3f313eed,0x3f51be26,0x3eedbf31,0xbe26bf51,0x3efbbf19,0x3e66bf3d,0xbd9bbf45,0xbebbbf2f
.long 0xbf00bf00,0xbf00bf00,0xbf00bf00,0xbf00bf00,0xbefb3ece,0xbf1b3e3d,0xbf22bd7f,0xbf0fbe99
.long 0x3e9e3eed,0xbdde3f0b,0xbeed3e9e,0xbf0bbdde,0x3ed5be64,0x3ebb3e99,0xbe0c3ee7,0xbef03d3d
.long 0xbe16beb5,0x3eb5be16,0x3e163eb5,0xbeb53e16,0xbe8e3dad,0x3ce9be94,0x3e833e0c,0xbe663e3d
.long 0x3d1c3e44,0xbe26bdde,0x3e44bd1c,0xbdde3e26,0x3dc8bc1d,0xbdb13d3d,0x3d7fbd9b,0xbce93dc0
.long 0xa4d4,0xa40d,0xa4d4,0xa40d,0x3dc83c1d,0xbdb1bd3d,0x3d7f3d9b,0xbce9bdc0
.long 0x3d1cbe44,0xbe263dde,0x3e443d1c,0xbddebe26,0xbe8ebdad,0x3ce93e94,0x3e83be0c,0xbe66be3d
.long 0xbe163eb5,0x3eb53e16,0x3e16beb5,0xbeb5be16,0x3ed53e64,0x3ebbbe99,0xbe0cbee7,0xbef0bd3d
.long 0x3e9ebeed,0xbddebf0b,0xbeedbe9e,0xbf0b3dde,0xbefbbece,0xbf1bbe3d,0xbf223d7f,0xbf0f3e99
.long 0x3f803f80,0x3f803f80,0x3f803f80,0x3f803f80,0x3f7b3f80,0x3f553f6d,0xbe48248d,0xbf0ebec4
.long 0x3f6d3f80,0x3ec43f35,0xbf6dbf80,0xbec4bf35,0x3f553f80,0xbe483ec4,0x3f0ea554,0x3f7b3f6d
.long 0x3f353f80,0xbf35248d,0x3f353f80,0xbf35248d,0x3f0e3f80,0xbf7bbec4,0xbf55248d,0xbe48bf6d
.long 0x3ec43f80,0xbf6dbf35,0xbec4bf80,0x3f6d3f35,0x3e483f80,0xbf0ebf6d,0x3f7ba554,0xbf553ec4
.long 0x248d3f80,0xa554bf80,0x248d3f80,0xa554bf80,0xbe483f80,0x3f0ebf6d,0xbf7b248d,0x3f553ec4
.long 0xbec43f80,0x3f6dbf35,0x3ec4bf80,0xbf6d3f35,0xbf0e3f80,0x3f7bbec4,0x3f55a554,0x3e48bf6d
.long 0xbf353f80,0x3f35a554,0xbf353f80,0x3f35a554,0xbf553f80,0x3e483ec4,0xbf0e248d,0xbf7b3f6d
.long 0xbf6d3f80,0xbec43f35,0x3f6dbf80,0x3ec4bf35,0xbf7b3f80,0xbf553f6d,0x3e48a554,0x3f0ebec4
.long 0xbf803f80,0xbf803f80,0xbf803f80,0xbf803f80,0xbf7b3f80,0xbf553f6d,0x3e48248d,0x3f0ebec4
.long 0xbf6d3f80,0xbec43f35,0x3f6dbf80,0x3ec4bf35,0xbf553f80,0x3e483ec4,0xbf0ea554,0xbf7b3f6d
.long 0xbf353f80,0x3f35248d,0xbf353f80,0x3f35248d,0xbf0e3f80,0x3f7bbec4,0x3f55248d,0x3e48bf6d
.long 0xbec43f80,0x3f6dbf35,0x3ec4bf80,0xbf6d3f35,0xbe483f80,0x3f0ebf6d,0xbf7ba554,0x3f553ec4
.long 0xa5543f80,0x248dbf80,0xa5543f80,0x248dbf80,0x3e483f80,0xbf0ebf6d,0x3f7b248d,0xbf553ec4
.long 0x3ec43f80,0xbf6dbf35,0xbec4bf80,0x3f6d3f35,0x3f0e3f80,0xbf7bbec4,0xbf55a554,0xbe48bf6d
.long 0x3f353f80,0xbf35a554,0x3f353f80,0xbf35a554,0x3f553f80,0xbe483ec4,0x3f0e248d,0x3f7b3f6d
.long 0x3f6d3f80,0x3ec43f35,0xbf6dbf80,0xbec4bf35,0x3f7b3f80,0x3f553f6d,0xbe48a554,0xbf0ebec4
.long 0x3f803f80,0x3f803f80,0x3f803f80,0x3f803f80,0x3f0e3f35,0x3e483ec4,0xbf55bf35,0xbf7bbf6d
.long 0xbec4248d,0xbf6dbf35,0x3ec4a554,0x3f6d3f35,0xbf7bbf35,0xbf0ebf6d,0x3e483f35,0xbf55bec4
.long 0xbf35bf80,0x3f35a554,0xbf35bf80,0x3f35a554,0x3e48bf35,0x3f553f6d,0x3f7b3f35,0xbf0e3ec4
.long 0x3f6da554,0xbec43f35,0xbf6d248d,0x3ec4bf35,0x3f553f35,0xbf7bbec4,0x3f0ebf35,0xbe483f6d
.long 0x248d3f80,0xa554bf80,0x248d3f80,0xa554bf80,0xbf553f35,0x3f7bbec4,0xbf0ebf35,0x3e483f6d
.long 0xbf6d248d,0x3ec43f35,0x3f6da554,0xbec4bf35,0xbe48bf35,0xbf553f6d,0xbf7b3f35,0x3f0e3ec4
.long 0x3f35bf80,0xbf35248d,0x3f35bf80,0xbf35248d,0x3f7bbf35,0x3f0ebf6d,0xbe483f35,0x3f55bec4
.long 0x3ec4a554,0x3f6dbf35,0xbec4248d,0xbf6d3f35,0xbf0e3f35,0xbe483ec4,0x3f55bf35,0x3f7bbf6d
.long 0xbf803f80,0xbf803f80,0xbf803f80,0xbf803f80,0xbf0e3f35,0xbe483ec4,0x3f55bf35,0x3f7bbf6d
.long 0x3ec4248d,0x3f6dbf35,0xbec4a554,0xbf6d3f35,0x3f7bbf35,0x3f0ebf6d,0xbe483f35,0x3f55bec4
.long 0x3f35bf80,0xbf35a554,0x3f35bf80,0xbf35a554,0xbe48bf35,0xbf553f6d,0xbf7b3f35,0x3f0e3ec4
.long 0xbf6da554,0x3ec43f35,0x3f6d248d,0xbec4bf35,0xbf553f35,0x3f7bbec4,0xbf0ebf35,0x3e483f6d
.long 0xa5543f80,0x248dbf80,0xa5543f80,0x248dbf80,0x3f553f35,0xbf7bbec4,0x3f0ebf35,0xbe483f6d
.long 0x3f6d248d,0xbec43f35,0xbf6da554,0x3ec4bf35,0x3e48bf35,0x3f553f6d,0x3f7b3f35,0xbf0e3ec4
.long 0xbf35bf80,0x3f35248d,0xbf35bf80,0x3f35248d,0xbf7bbf35,0xbf0ebf6d,0x3e483f35,0xbf55bec4
.long 0xbec4a554,0xbf6dbf35,0x3ec4248d,0x3f6d3f35,0x3f0e3f35,0x3e483ec4,0xbf55bf35,0xbf7bbf6d
.long 0x3f803f80,0x3f803f80,0x3f803f80,0x3f803f80,0xbf7bbf80,0xbf55bf6d,0x3e48a554,0x3f0e3ec4
.long 0x3f6d3f80,0x3ec43f35,0xbf6dbf80,0xbec4bf35,0xbf55bf80,0x3e48bec4,0xbf0e248d,0xbf7bbf6d
.long 0x3f353f80,0xbf35248d,0x3f353f80,0xbf35248d,0xbf0ebf80,0x3f7b3ec4,0x3f55a554,0x3e483f6d
.long 0x3ec43f80,0xbf6dbf35,0xbec4bf80,0x3f6d3f35,0xbe48bf80,0x3f0e3f6d,0xbf7b248d,0x3f55bec4
.long 0x248d3f80,0xa554bf80,0x248d3f80,0xa554bf80,0x3e48bf80,0xbf0e3f6d,0x3f7ba554,0xbf55bec4
.long 0xbec43f80,0x3f6dbf35,0x3ec4bf80,0xbf6d3f35,0x3f0ebf80,0xbf7b3ec4,0xbf55248d,0xbe483f6d
.long 0xbf353f80,0x3f35a554,0xbf353f80,0x3f35a554,0x3f55bf80,0xbe48bec4,0x3f0ea554,0x3f7bbf6d
.long 0xbf6d3f80,0xbec43f35,0x3f6dbf80,0x3ec4bf35,0x3f7bbf80,0x3f55bf6d,0xbe48248d,0xbf0e3ec4
.long 0xbf803f80,0xbf803f80,0xbf803f80,0xbf803f80,0x3f7bbf80,0x3f55bf6d,0xbe48a554,0xbf0e3ec4
.long 0xbf6d3f80,0xbec43f35,0x3f6dbf80,0x3ec4bf35,0x3f55bf80,0xbe48bec4,0x3f0e248d,0x3f7bbf6d
.long 0xbf353f80,0x3f35248d,0xbf353f80,0x3f35248d,0x3f0ebf80,0xbf7b3ec4,0xbf55a554,0xbe483f6d
.long 0xbec43f80,0x3f6dbf35,0x3ec4bf80,0xbf6d3f35,0x3e48bf80,0xbf0e3f6d,0x3f7b248d,0xbf55bec4
.long 0xa5543f80,0x248dbf80,0xa5543f80,0x248dbf80,0xbe48bf80,0x3f0e3f6d,0xbf7ba554,0x3f55bec4
.long 0x3ec43f80,0xbf6dbf35,0xbec4bf80,0x3f6d3f35,0xbf0ebf80,0x3f7b3ec4,0x3f55248d,0x3e483f6d
.long 0x3f353f80,0xbf35a554,0x3f353f80,0xbf35a554,0xbf55bf80,0x3e48bec4,0xbf0ea554,0xbf7bbf6d
.long 0x3f6d3f80,0x3ec43f35,0xbf6dbf80,0xbec4bf35,0xbf7bbf80,0xbf55bf6d,0x3e48248d,0x3f0e3ec4
.long 0x3f803f80,0x3f803f80,0x3f803f80,0x3f803f80,0xbf0ebf35,0xbe48bec4,0x3f553f35,0x3f7b3f6d
.long 0xbec4248d,0xbf6dbf35,0x3ec4a554,0x3f6d3f35,0x3f7b3f35,0x3f0e3f6d,0xbe48bf35,0x3f553ec4
.long 0xbf35bf80,0x3f35a554,0xbf35bf80,0x3f35a554,0xbe483f35,0xbf55bf6d,0xbf7bbf35,0x3f0ebec4
.long 0x3f6da554,0xbec43f35,0xbf6d248d,0x3ec4bf35,0xbf55bf35,0x3f7b3ec4,0xbf0e3f35,0x3e48bf6d
.long 0x248d3f80,0xa554bf80,0x248d3f80,0xa554bf80,0x3f55bf35,0xbf7b3ec4,0x3f0e3f35,0xbe48bf6d
.long 0xbf6d248d,0x3ec43f35,0x3f6da554,0xbec4bf35,0x3e483f35,0x3f55bf6d,0x3f7bbf35,0xbf0ebec4
.long 0x3f35bf80,0xbf35248d,0x3f35bf80,0xbf35248d,0xbf7b3f35,0xbf0e3f6d,0x3e48bf35,0xbf553ec4
.long 0x3ec4a554,0x3f6dbf35,0xbec4248d,0xbf6d3f35,0x3f0ebf35,0x3e48bec4,0xbf553f35,0xbf7b3f6d
.long 0xbf803f80,0xbf803f80,0xbf803f80,0xbf803f80,0x3f0ebf35,0x3e48bec4,0xbf553f35,0xbf7b3f6d
.long 0x3ec4248d,0x3f6dbf35,0xbec4a554,0xbf6d3f35,0xbf7b3f35,0xbf0e3f6d,0x3e48bf35,0xbf553ec4
.long 0x3f35bf80,0xbf35a554,0x3f35bf80,0xbf35a554,0x3e483f35,0x3f55bf6d,0x3f7bbf35,0xbf0ebec4
.long 0xbf6da554,0x3ec43f35,0x3f6d248d,0xbec4bf35,0x3f55bf35,0xbf7b3ec4,0x3f0e3f35,0xbe48bf6d
.long 0xa5543f80,0x248dbf80,0xa5543f80,0x248dbf80,0xbf55bf35,0x3f7b3ec4,0xbf0e3f35,0x3e48bf6d
.long 0x3f6d248d,0xbec43f35,0xbf6da554,0x3ec4bf35,0xbe483f35,0xbf55bf6d,0xbf7bbf35,0x3f0ebec4
.long 0xbf35bf80,0x3f35248d,0xbf35bf80,0x3f35248d,0x3f7b3f35,0x3f0e3f6d,0xbe48bf35,0x3f553ec4
.long 0xbec4a554,0xbf6dbf35,0x3ec4248d,0x3f6d3f35,0xbf0ebf35,0xbe48bec4,0x3f553f35,0x3f7b3f6d
.long 0x0,0x0,0x0,0x0,0x3e480000,0x3f0e3ec4,0x3f7b3f80,0x3f553f6d
.long 0x3ec40000,0x3f6d3f35,0xbec4250d,0xbf6dbf35,0x3f0e0000,0x3f7b3f6d,0xbf55bf80,0x3e48bec4
.long 0x3f350000,0x3f353f80,0x3f350000,0x3f353f80,0x3f550000,0x3e483f6d,0x3f0e3f80,0xbf7bbec4
.long 0x3f6d0000,0xbec43f35,0xbf6d250d,0x3ec4bf35,0x3f7b0000,0xbf553ec4,0xbe48bf80,0x3f0e3f6d
.long 0x3f800000,0xbf80250d,0x3f800000,0xbf80250d,0x3f7b0000,0xbf55bec4,0xbe483f80,0x3f0ebf6d
.long 0x3f6d0000,0xbec4bf35,0xbf6d250d,0x3ec43f35,0x3f550000,0x3e48bf6d,0x3f0ebf80,0xbf7b3ec4
.long 0x3f350000,0x3f35bf80,0x3f350000,0x3f35bf80,0x3f0e0000,0x3f7bbf6d,0xbf553f80,0x3e483ec4
.long 0x3ec40000,0x3f6dbf35,0xbec4250d,0xbf6d3f35,0x3e480000,0x3f0ebec4,0x3f7bbf80,0x3f55bf6d
.long 0x250d0000,0x250d0000,0x250d0000,0x250d0000,0xbe480000,0xbf0e3ec4,0xbf7b3f80,0xbf553f6d
.long 0xbec40000,0xbf6d3f35,0x3ec4250d,0x3f6dbf35,0xbf0e0000,0xbf7b3f6d,0x3f55bf80,0xbe48bec4
.long 0xbf350000,0xbf353f80,0xbf350000,0xbf353f80,0xbf550000,0xbe483f6d,0xbf0e3f80,0x3f7bbec4
.long 0xbf6d0000,0x3ec43f35,0x3f6d250d,0xbec4bf35,0xbf7b0000,0x3f553ec4,0x3e48bf80,0xbf0e3f6d
.long 0xbf800000,0x3f80250d,0xbf800000,0x3f80250d,0xbf7b0000,0x3f55bec4,0x3e483f80,0xbf0ebf6d
.long 0xbf6d0000,0x3ec4bf35,0x3f6d250d,0xbec43f35,0xbf550000,0xbe48bf6d,0xbf0ebf80,0x3f7b3ec4
.long 0xbf350000,0xbf35bf80,0xbf350000,0xbf35bf80,0xbf0e0000,0xbf7bbf6d,0x3f553f80,0xbe483ec4
.long 0xbec40000,0xbf6dbf35,0x3ec4250d,0x3f6d3f35,0xbe480000,0xbf0ebec4,0xbf7bbf80,0xbf55bf6d
.long 0x0,0x0,0x0,0x0,0x3f553f35,0x3f7b3f6d,0x3f0e3f35,0x3e483ec4
.long 0x3f6d3f80,0x3ec43f35,0xbf6dbf80,0xbec4bf35,0x3e483f35,0xbf55bec4,0x3f7b3f35,0x3f0e3f6d
.long 0xbf35250d,0xbf35bf80,0xbf35250d,0xbf35bf80,0xbf7bbf35,0x3f0ebec4,0x3e48bf35,0x3f553f6d
.long 0xbec4bf80,0x3f6d3f35,0x3ec43f80,0xbf6dbf35,0x3f0ebf35,0xbe483f6d,0xbf55bf35,0x3f7b3ec4
.long 0x3f800000,0xbf80250d,0x3f800000,0xbf80250d,0x3f0e3f35,0xbe48bf6d,0xbf553f35,0x3f7bbec4
.long 0xbec43f80,0x3f6dbf35,0x3ec4bf80,0xbf6d3f35,0xbf7b3f35,0x3f0e3ec4,0x3e483f35,0x3f55bf6d
.long 0xbf35250d,0xbf353f80,0xbf35250d,0xbf353f80,0x3e48bf35,0xbf553ec4,0x3f7bbf35,0x3f0ebf6d
.long 0x3f6dbf80,0x3ec4bf35,0xbf6d3f80,0xbec43f35,0x3f55bf35,0x3f7bbf6d,0x3f0ebf35,0x3e48bec4
.long 0x250d0000,0x250d0000,0x250d0000,0x250d0000,0xbf553f35,0xbf7b3f6d,0xbf0e3f35,0xbe483ec4
.long 0xbf6d3f80,0xbec43f35,0x3f6dbf80,0x3ec4bf35,0xbe483f35,0x3f55bec4,0xbf7b3f35,0xbf0e3f6d
.long 0x3f35250d,0x3f35bf80,0x3f35250d,0x3f35bf80,0x3f7bbf35,0xbf0ebec4,0xbe48bf35,0xbf553f6d
.long 0x3ec4bf80,0xbf6d3f35,0xbec43f80,0x3f6dbf35,0xbf0ebf35,0x3e483f6d,0x3f55bf35,0xbf7b3ec4
.long 0xbf800000,0x3f80250d,0xbf800000,0x3f80250d,0xbf0e3f35,0x3e48bf6d,0x3f553f35,0xbf7bbec4
.long 0x3ec43f80,0xbf6dbf35,0xbec4bf80,0x3f6d3f35,0x3f7b3f35,0xbf0e3ec4,0xbe483f35,0xbf55bf6d
.long 0x3f35250d,0x3f353f80,0x3f35250d,0x3f353f80,0xbe48bf35,0x3f553ec4,0xbf7bbf35,0xbf0ebf6d
.long 0xbf6dbf80,0xbec4bf35,0x3f6d3f80,0x3ec43f35,0xbf55bf35,0xbf7bbf6d,0xbf0ebf35,0xbe48bec4
.long 0x0,0x0,0x0,0x0,0xbe48250d,0xbf0ebec4,0xbf7bbf80,0xbf55bf6d
.long 0x3ec40000,0x3f6d3f35,0xbec4250d,0xbf6dbf35,0xbf0e250d,0xbf7bbf6d,0x3f553f80,0xbe483ec4
.long 0x3f350000,0x3f353f80,0x3f350000,0x3f353f80,0xbf55250d,0xbe48bf6d,0xbf0ebf80,0x3f7b3ec4
.long 0x3f6d0000,0xbec43f35,0xbf6d250d,0x3ec4bf35,0xbf7b250d,0x3f55bec4,0x3e483f80,0xbf0ebf6d
.long 0x3f800000,0xbf80250d,0x3f800000,0xbf80250d,0xbf7b250d,0x3f553ec4,0x3e48bf80,0xbf0e3f6d
.long 0x3f6d0000,0xbec4bf35,0xbf6d250d,0x3ec43f35,0xbf55250d,0xbe483f6d,0xbf0e3f80,0x3f7bbec4
.long 0x3f350000,0x3f35bf80,0x3f350000,0x3f35bf80,0xbf0e250d,0xbf7b3f6d,0x3f55bf80,0xbe48bec4
.long 0x3ec40000,0x3f6dbf35,0xbec4250d,0xbf6d3f35,0xbe48250d,0xbf0e3ec4,0xbf7b3f80,0xbf553f6d
.long 0x250d0000,0x250d0000,0x250d0000,0x250d0000,0x3e48250d,0x3f0ebec4,0x3f7bbf80,0x3f55bf6d
.long 0xbec40000,0xbf6d3f35,0x3ec4250d,0x3f6dbf35,0x3f0e250d,0x3f7bbf6d,0xbf553f80,0x3e483ec4
.long 0xbf350000,0xbf353f80,0xbf350000,0xbf353f80,0x3f55250d,0x3e48bf6d,0x3f0ebf80,0xbf7b3ec4
.long 0xbf6d0000,0x3ec43f35,0x3f6d250d,0xbec4bf35,0x3f7b250d,0xbf55bec4,0xbe483f80,0x3f0ebf6d
.long 0xbf800000,0x3f80250d,0xbf800000,0x3f80250d,0x3f7b250d,0xbf553ec4,0xbe48bf80,0x3f0e3f6d
.long 0xbf6d0000,0x3ec4bf35,0x3f6d250d,0xbec43f35,0x3f55250d,0x3e483f6d,0x3f0e3f80,0xbf7bbec4
.long 0xbf350000,0xbf35bf80,0xbf350000,0xbf35bf80,0x3f0e250d,0x3f7b3f6d,0xbf55bf80,0x3e48bec4
.long 0xbec40000,0xbf6dbf35,0x3ec4250d,0x3f6d3f35,0x3e48250d,0x3f0e3ec4,0x3f7b3f80,0x3f553f6d
.long 0x0,0x0,0x0,0x0,0xbf55bf35,0xbf7bbf6d,0xbf0ebf35,0xbe48bec4
.long 0x3f6d3f80,0x3ec43f35,0xbf6dbf80,0xbec4bf35,0xbe48bf35,0x3f553ec4,0xbf7bbf35,0xbf0ebf6d
.long 0xbf35250d,0xbf35bf80,0xbf35250d,0xbf35bf80,0x3f7b3f35,0xbf0e3ec4,0xbe483f35,0xbf55bf6d
.long 0xbec4bf80,0x3f6d3f35,0x3ec43f80,0xbf6dbf35,0xbf0e3f35,0x3e48bf6d,0x3f553f35,0xbf7bbec4
.long 0x3f800000,0xbf80250d,0x3f800000,0xbf80250d,0xbf0ebf35,0x3e483f6d,0x3f55bf35,0xbf7b3ec4
.long 0xbec43f80,0x3f6dbf35,0x3ec4bf80,0xbf6d3f35,0x3f7bbf35,0xbf0ebec4,0xbe48bf35,0xbf553f6d
.long 0xbf35250d,0xbf353f80,0xbf35250d,0xbf353f80,0xbe483f35,0x3f55bec4,0xbf7b3f35,0xbf0e3f6d
.long 0x3f6dbf80,0x3ec4bf35,0xbf6d3f80,0xbec43f35,0xbf553f35,0xbf7b3f6d,0xbf0e3f35,0xbe483ec4
.long 0x250d0000,0x250d0000,0x250d0000,0x250d0000,0x3f55bf35,0x3f7bbf6d,0x3f0ebf35,0x3e48bec4
.long 0xbf6d3f80,0xbec43f35,0x3f6dbf80,0x3ec4bf35,0x3e48bf35,0xbf553ec4,0x3f7bbf35,0x3f0ebf6d
.long 0x3f35250d,0x3f35bf80,0x3f35250d,0x3f35bf80,0xbf7b3f35,0x3f0e3ec4,0x3e483f35,0x3f55bf6d
.long 0x3ec4bf80,0xbf6d3f35,0xbec43f80,0x3f6dbf35,0x3f0e3f35,0xbe48bf6d,0xbf553f35,0x3f7bbec4
.long 0xbf800000,0x3f80250d,0xbf800000,0x3f80250d,0x3f0ebf35,0xbe483f6d,0xbf55bf35,0x3f7b3ec4
.long 0x3ec43f80,0xbf6dbf35,0xbec4bf80,0x3f6d3f35,0xbf7bbf35,0x3f0ebec4,0x3e48bf35,0x3f553f6d
.long 0x3f35250d,0x3f353f80,0x3f35250d,0x3f353f80,0x3e483f35,0xbf55bec4,0x3f7b3f35,0x3f0e3f6d
.long 0xbf6dbf80,0xbec4bf35,0x3f6d3f80,0x3ec43f35,0x3f553f35,0x3f7b3f6d,0x3f0e3f35,0x3e483ec4
.long 0x80008000,0x80008000,0x80008000,0x80008000,0xbe488000,0xbf0ebec4,0xbf7bbf80,0xbf55bf6d
.long 0xbec48000,0xbf6dbf35,0x3ec4a50d,0x3f6d3f35,0xbf0e8000,0xbf7bbf6d,0x3f553f80,0xbe483ec4
.long 0xbf358000,0xbf35bf80,0xbf358000,0xbf35bf80,0xbf558000,0xbe48bf6d,0xbf0ebf80,0x3f7b3ec4
.long 0xbf6d8000,0x3ec4bf35,0x3f6da50d,0xbec43f35,0xbf7b8000,0x3f55bec4,0x3e483f80,0xbf0ebf6d
.long 0xbf808000,0x3f80a50d,0xbf808000,0x3f80a50d,0xbf7b8000,0x3f553ec4,0x3e48bf80,0xbf0e3f6d
.long 0xbf6d8000,0x3ec43f35,0x3f6da50d,0xbec4bf35,0xbf558000,0xbe483f6d,0xbf0e3f80,0x3f7bbec4
.long 0xbf358000,0xbf353f80,0xbf358000,0xbf353f80,0xbf0e8000,0xbf7b3f6d,0x3f55bf80,0xbe48bec4
.long 0xbec48000,0xbf6d3f35,0x3ec4a50d,0x3f6dbf35,0xbe488000,0xbf0e3ec4,0xbf7b3f80,0xbf553f6d
.long 0xa50d8000,0xa50d8000,0xa50d8000,0xa50d8000,0x3e488000,0x3f0ebec4,0x3f7bbf80,0x3f55bf6d
.long 0x3ec48000,0x3f6dbf35,0xbec4a50d,0xbf6d3f35,0x3f0e8000,0x3f7bbf6d,0xbf553f80,0x3e483ec4
.long 0x3f358000,0x3f35bf80,0x3f358000,0x3f35bf80,0x3f558000,0x3e48bf6d,0x3f0ebf80,0xbf7b3ec4
.long 0x3f6d8000,0xbec4bf35,0xbf6da50d,0x3ec43f35,0x3f7b8000,0xbf55bec4,0xbe483f80,0x3f0ebf6d
.long 0x3f808000,0xbf80a50d,0x3f808000,0xbf80a50d,0x3f7b8000,0xbf553ec4,0xbe48bf80,0x3f0e3f6d
.long 0x3f6d8000,0xbec43f35,0xbf6da50d,0x3ec4bf35,0x3f558000,0x3e483f6d,0x3f0e3f80,0xbf7bbec4
.long 0x3f358000,0x3f353f80,0x3f358000,0x3f353f80,0x3f0e8000,0x3f7b3f6d,0xbf55bf80,0x3e48bec4
.long 0x3ec48000,0x3f6d3f35,0xbec4a50d,0xbf6dbf35,0x3e488000,0x3f0e3ec4,0x3f7b3f80,0x3f553f6d
.long 0x80008000,0x80008000,0x80008000,0x80008000,0xbf55bf35,0xbf7bbf6d,0xbf0ebf35,0xbe48bec4
.long 0xbf6dbf80,0xbec4bf35,0x3f6d3f80,0x3ec43f35,0xbe48bf35,0x3f553ec4,0xbf7bbf35,0xbf0ebf6d
.long 0x3f35a50d,0x3f353f80,0x3f35a50d,0x3f353f80,0x3f7b3f35,0xbf0e3ec4,0xbe483f35,0xbf55bf6d
.long 0x3ec43f80,0xbf6dbf35,0xbec4bf80,0x3f6d3f35,0xbf0e3f35,0x3e48bf6d,0x3f553f35,0xbf7bbec4
.long 0xbf808000,0x3f80a50d,0xbf808000,0x3f80a50d,0xbf0ebf35,0x3e483f6d,0x3f55bf35,0xbf7b3ec4
.long 0x3ec4bf80,0xbf6d3f35,0xbec43f80,0x3f6dbf35,0x3f7bbf35,0xbf0ebec4,0xbe48bf35,0xbf553f6d
.long 0x3f35a50d,0x3f35bf80,0x3f35a50d,0x3f35bf80,0xbe483f35,0x3f55bec4,0xbf7b3f35,0xbf0e3f6d
.long 0xbf6d3f80,0xbec43f35,0x3f6dbf80,0x3ec4bf35,0xbf553f35,0xbf7b3f6d,0xbf0e3f35,0xbe483ec4
.long 0xa50d8000,0xa50d8000,0xa50d8000,0xa50d8000,0x3f55bf35,0x3f7bbf6d,0x3f0ebf35,0x3e48bec4
.long 0x3f6dbf80,0x3ec4bf35,0xbf6d3f80,0xbec43f35,0x3e48bf35,0xbf553ec4,0x3f7bbf35,0x3f0ebf6d
.long 0xbf35a50d,0xbf353f80,0xbf35a50d,0xbf353f80,0xbf7b3f35,0x3f0e3ec4,0x3e483f35,0x3f55bf6d
.long 0xbec43f80,0x3f6dbf35,0x3ec4bf80,0xbf6d3f35,0x3f0e3f35,0xbe48bf6d,0xbf553f35,0x3f7bbec4
.long 0x3f808000,0xbf80a50d,0x3f808000,0xbf80a50d,0x3f0ebf35,0xbe483f6d,0xbf55bf35,0x3f7b3ec4
.long 0xbec4bf80,0x3f6d3f35,0x3ec43f80,0xbf6dbf35,0xbf7bbf35,0x3f0ebec4,0x3e48bf35,0x3f553f6d
.long 0xbf35a50d,0xbf35bf80,0xbf35a50d,0xbf35bf80,0x3e483f35,0xbf55bec4,0x3f7b3f35,0x3f0e3f6d
.long 0x3f6d3f80,0x3ec43f35,0xbf6dbf80,0xbec4bf35,0x3f553f35,0x3f7b3f6d,0x3f0e3f35,0x3e483ec4
.long 0x80008000,0x80008000,0x80008000,0x80008000,0x3e48a50d,0x3f0e3ec4,0x3f7b3f80,0x3f553f6d
.long 0xbec48000,0xbf6dbf35,0x3ec4a50d,0x3f6d3f35,0x3f0ea50d,0x3f7b3f6d,0xbf55bf80,0x3e48bec4
.long 0xbf358000,0xbf35bf80,0xbf358000,0xbf35bf80,0x3f55a50d,0x3e483f6d,0x3f0e3f80,0xbf7bbec4
.long 0xbf6d8000,0x3ec4bf35,0x3f6da50d,0xbec43f35,0x3f7ba50d,0xbf553ec4,0xbe48bf80,0x3f0e3f6d
.long 0xbf808000,0x3f80a50d,0xbf808000,0x3f80a50d,0x3f7ba50d,0xbf55bec4,0xbe483f80,0x3f0ebf6d
.long 0xbf6d8000,0x3ec43f35,0x3f6da50d,0xbec4bf35,0x3f55a50d,0x3e48bf6d,0x3f0ebf80,0xbf7b3ec4
.long 0xbf358000,0xbf353f80,0xbf358000,0xbf353f80,0x3f0ea50d,0x3f7bbf6d,0xbf553f80,0x3e483ec4
.long 0xbec48000,0xbf6d3f35,0x3ec4a50d,0x3f6dbf35,0x3e48a50d,0x3f0ebec4,0x3f7bbf80,0x3f55bf6d
.long 0xa50d8000,0xa50d8000,0xa50d8000,0xa50d8000,0xbe48a50d,0xbf0e3ec4,0xbf7b3f80,0xbf553f6d
.long 0x3ec48000,0x3f6dbf35,0xbec4a50d,0xbf6d3f35,0xbf0ea50d,0xbf7b3f6d,0x3f55bf80,0xbe48bec4
.long 0x3f358000,0x3f35bf80,0x3f358000,0x3f35bf80,0xbf55a50d,0xbe483f6d,0xbf0e3f80,0x3f7bbec4
.long 0x3f6d8000,0xbec4bf35,0xbf6da50d,0x3ec43f35,0xbf7ba50d,0x3f553ec4,0x3e48bf80,0xbf0e3f6d
.long 0x3f808000,0xbf80a50d,0x3f808000,0xbf80a50d,0xbf7ba50d,0x3f55bec4,0x3e483f80,0xbf0ebf6d
.long 0x3f6d8000,0xbec43f35,0xbf6da50d,0x3ec4bf35,0xbf55a50d,0xbe48bf6d,0xbf0ebf80,0x3f7b3ec4
.long 0x3f358000,0x3f353f80,0x3f358000,0x3f353f80,0xbf0ea50d,0xbf7bbf6d,0x3f553f80,0xbe483ec4
.long 0x3ec48000,0x3f6d3f35,0xbec4a50d,0xbf6dbf35,0xbe48a50d,0xbf0ebec4,0xbf7bbf80,0xbf55bf6d
.long 0x80008000,0x80008000,0x80008000,0x80008000,0x3f553f35,0x3f7b3f6d,0x3f0e3f35,0x3e483ec4
.long 0xbf6dbf80,0xbec4bf35,0x3f6d3f80,0x3ec43f35,0x3e483f35,0xbf55bec4,0x3f7b3f35,0x3f0e3f6d
.long 0x3f35a50d,0x3f353f80,0x3f35a50d,0x3f353f80,0xbf7bbf35,0x3f0ebec4,0x3e48bf35,0x3f553f6d
.long 0x3ec43f80,0xbf6dbf35,0xbec4bf80,0x3f6d3f35,0x3f0ebf35,0xbe483f6d,0xbf55bf35,0x3f7b3ec4
.long 0xbf808000,0x3f80a50d,0xbf808000,0x3f80a50d,0x3f0e3f35,0xbe48bf6d,0xbf553f35,0x3f7bbec4
.long 0x3ec4bf80,0xbf6d3f35,0xbec43f80,0x3f6dbf35,0xbf7b3f35,0x3f0e3ec4,0x3e483f35,0x3f55bf6d
.long 0x3f35a50d,0x3f35bf80,0x3f35a50d,0x3f35bf80,0x3e48bf35,0xbf553ec4,0x3f7bbf35,0x3f0ebf6d
.long 0xbf6d3f80,0xbec43f35,0x3f6dbf80,0x3ec4bf35,0x3f55bf35,0x3f7bbf6d,0x3f0ebf35,0x3e48bec4
.long 0xa50d8000,0xa50d8000,0xa50d8000,0xa50d8000,0xbf553f35,0xbf7b3f6d,0xbf0e3f35,0xbe483ec4
.long 0x3f6dbf80,0x3ec4bf35,0xbf6d3f80,0xbec43f35,0xbe483f35,0x3f55bec4,0xbf7b3f35,0xbf0e3f6d
.long 0xbf35a50d,0xbf353f80,0xbf35a50d,0xbf353f80,0x3f7bbf35,0xbf0ebec4,0xbe48bf35,0xbf553f6d
.long 0xbec43f80,0x3f6dbf35,0x3ec4bf80,0xbf6d3f35,0xbf0ebf35,0x3e483f6d,0x3f55bf35,0xbf7b3ec4
.long 0x3f808000,0xbf80a50d,0x3f808000,0xbf80a50d,0xbf0e3f35,0x3e48bf6d,0x3f553f35,0xbf7bbec4
.long 0xbec4bf80,0x3f6d3f35,0x3ec43f80,0xbf6dbf35,0x3f7b3f35,0xbf0e3ec4,0xbe483f35,0xbf55bf6d
.long 0xbf35a50d,0xbf35bf80,0xbf35a50d,0xbf35bf80,0xbe48bf35,0x3f553ec4,0xbf7bbf35,0xbf0ebf6d
.long 0x3f6d3f80,0x3ec43f35,0xbf6dbf80,0xbec4bf35,0xbf55bf35,0xbf7bbf6d,0xbf0ebf35,0xbe48bec4
.long 0x3f7f3f80,0x3f753f7b,0x3f223f35,0x3ef13f0e,0x3f753f80,0x3f223f55,0xbf62bf35,0xbf7fbf7b
.long 0x3f623f80,0x3dc93f0e,0xbe95bf35,0x3f223e48,0x3f463f80,0xbef13e48,0x3f7f3f35,0x3e953f55
.long 0x3f223f80,0xbf62be48,0xbdc93f35,0xbf75bf55,0x3ef13f80,0xbf7fbf0e,0xbf75bf35,0x3f46be48
.long 0x3e953f80,0xbf46bf55,0x3ef1bf35,0x3dc93f7b,0x3dc93f80,0xbe95bf7b,0x3f463f35,0xbf62bf0e
.long 0xbdc93f80,0x3e95bf7b,0xbf463f35,0x3f62bf0e,0xbe953f80,0x3f46bf55,0xbef1bf35,0xbdc93f7b
.long 0xbef13f80,0x3f7fbf0e,0x3f75bf35,0xbf46be48,0xbf223f80,0x3f62be48,0x3dc93f35,0x3f75bf55
.long 0xbf463f80,0x3ef13e48,0xbf7f3f35,0xbe953f55,0xbf623f80,0xbdc93f0e,0x3e95bf35,0xbf223e48
.long 0xbf753f80,0xbf223f55,0x3f62bf35,0x3f7fbf7b,0xbf7f3f80,0xbf753f7b,0xbf223f35,0xbef13f0e
.long 0xbf7f3f80,0xbf753f7b,0xbf223f35,0xbef13f0e,0xbf753f80,0xbf223f55,0x3f62bf35,0x3f7fbf7b
.long 0xbf623f80,0xbdc93f0e,0x3e95bf35,0xbf223e48,0xbf463f80,0x3ef13e48,0xbf7f3f35,0xbe953f55
.long 0xbf223f80,0x3f62be48,0x3dc93f35,0x3f75bf55,0xbef13f80,0x3f7fbf0e,0x3f75bf35,0xbf46be48
.long 0xbe953f80,0x3f46bf55,0xbef1bf35,0xbdc93f7b,0xbdc93f80,0x3e95bf7b,0xbf463f35,0x3f62bf0e
.long 0x3dc93f80,0xbe95bf7b,0x3f463f35,0xbf62bf0e,0x3e953f80,0xbf46bf55,0x3ef1bf35,0x3dc93f7b
.long 0x3ef13f80,0xbf7fbf0e,0xbf75bf35,0x3f46be48,0x3f223f80,0xbf62be48,0xbdc93f35,0xbf75bf55
.long 0x3f463f80,0xbef13e48,0x3f7f3f35,0x3e953f55,0x3f623f80,0x3dc93f0e,0xbe95bf35,0x3f223e48
.long 0x3f753f80,0x3f223f55,0xbf62bf35,0xbf7fbf7b,0x3f7f3f80,0x3f753f7b,0x3f223f35,0x3ef13f0e
.long 0x3f623f6d,0x3f463f55,0x3e953ec4,0x3dc93e48,0x3dc93ec4,0xbef1be48,0xbf46bf6d,0xbe95bf0e
.long 0xbf46bec4,0xbf75bf7b,0x3f7f3f6d,0x3ef13f55,0xbf75bf6d,0x3dc9bf0e,0xbf62bec4,0xbf22bf7b
.long 0xbe95bf6d,0x3f7f3f0e,0x3ef1bec4,0x3f463f7b,0x3f22bec4,0x3e953f7b,0x3dc93f6d,0xbf62bf55
.long 0x3f7f3ec4,0xbf623e48,0xbf22bf6d,0x3f753f0e,0x3ef13f6d,0xbf22bf55,0x3f753ec4,0xbf7fbe48
.long 0xbef13f6d,0x3f22bf55,0xbf753ec4,0x3f7fbe48,0xbf7f3ec4,0x3f623e48,0x3f22bf6d,0xbf753f0e
.long 0xbf22bec4,0xbe953f7b,0xbdc93f6d,0x3f62bf55,0x3e95bf6d,0xbf7f3f0e,0xbef1bec4,0xbf463f7b
.long 0x3f75bf6d,0xbdc9bf0e,0x3f62bec4,0x3f22bf7b,0x3f46bec4,0x3f75bf7b,0xbf7f3f6d,0xbef13f55
.long 0xbdc93ec4,0x3ef1be48,0x3f46bf6d,0x3e95bf0e,0xbf623f6d,0xbf463f55,0xbe953ec4,0xbdc93e48
.long 0xbf623f6d,0xbf463f55,0xbe953ec4,0xbdc93e48,0xbdc93ec4,0x3ef1be48,0x3f46bf6d,0x3e95bf0e
.long 0x3f46bec4,0x3f75bf7b,0xbf7f3f6d,0xbef13f55,0x3f75bf6d,0xbdc9bf0e,0x3f62bec4,0x3f22bf7b
.long 0x3e95bf6d,0xbf7f3f0e,0xbef1bec4,0xbf463f7b,0xbf22bec4,0xbe953f7b,0xbdc93f6d,0x3f62bf55
.long 0xbf7f3ec4,0x3f623e48,0x3f22bf6d,0xbf753f0e,0xbef13f6d,0x3f22bf55,0xbf753ec4,0x3f7fbe48
.long 0x3ef13f6d,0xbf22bf55,0x3f753ec4,0xbf7fbe48,0x3f7f3ec4,0xbf623e48,0xbf22bf6d,0x3f753f0e
.long 0x3f22bec4,0x3e953f7b,0x3dc93f6d,0xbf62bf55,0xbe95bf6d,0x3f7f3f0e,0x3ef1bec4,0x3f463f7b
.long 0xbf75bf6d,0x3dc9bf0e,0xbf62bec4,0xbf22bf7b,0xbf46bec4,0xbf75bf7b,0x3f7f3f6d,0x3ef13f55
.long 0x3dc93ec4,0xbef1be48,0xbf46bf6d,0xbe95bf0e,0x3f623f6d,0x3f463f55,0x3e953ec4,0x3dc93e48
.long 0xbdc9248d,0xbe95be48,0xbf46bf35,0xbf62bf55,0x3e95a554,0x3f463f0e,0x3ef13f35,0xbdc93e48
.long 0xbef1248d,0xbf7fbf55,0x3f753f35,0x3f463f7b,0x3f22a554,0x3f623f7b,0xbdc9bf35,0x3f753f0e
.long 0xbf46248d,0xbef1bf7b,0xbf7fbf35,0x3e95bf0e,0x3f62a554,0xbdc93f55,0xbe953f35,0xbf22bf7b
.long 0xbf75248d,0x3f22bf0e,0x3f623f35,0xbf7fbe48,0x3f7fa554,0xbf753e48,0x3f22bf35,0xbef13f55
.long 0xbf7f248d,0x3f753e48,0xbf22bf35,0x3ef13f55,0x3f75a554,0xbf22bf0e,0xbf623f35,0x3f7fbe48
.long 0xbf62248d,0x3dc93f55,0x3e953f35,0x3f22bf7b,0x3f46a554,0x3ef1bf7b,0x3f7fbf35,0xbe95bf0e
.long 0xbf22248d,0xbf623f7b,0x3dc9bf35,0xbf753f0e,0x3ef1a554,0x3f7fbf55,0xbf753f35,0xbf463f7b
.long 0xbe95248d,0xbf463f0e,0xbef13f35,0x3dc93e48,0x3dc9a554,0x3e95be48,0x3f46bf35,0x3f62bf55
.long 0x3dc9248d,0x3e95be48,0x3f46bf35,0x3f62bf55,0xbe95a554,0xbf463f0e,0xbef13f35,0x3dc93e48
.long 0x3ef1248d,0x3f7fbf55,0xbf753f35,0xbf463f7b,0xbf22a554,0xbf623f7b,0x3dc9bf35,0xbf753f0e
.long 0x3f46248d,0x3ef1bf7b,0x3f7fbf35,0xbe95bf0e,0xbf62a554,0x3dc93f55,0x3e953f35,0x3f22bf7b
.long 0x3f75248d,0xbf22bf0e,0xbf623f35,0x3f7fbe48,0xbf7fa554,0x3f753e48,0xbf22bf35,0x3ef13f55
.long 0x3f7f248d,0xbf753e48,0x3f22bf35,0xbef13f55,0xbf75a554,0x3f22bf0e,0x3f623f35,0xbf7fbe48
.long 0x3f62248d,0xbdc93f55,0xbe953f35,0xbf22bf7b,0xbf46a554,0xbef1bf7b,0xbf7fbf35,0x3e95bf0e
.long 0x3f22248d,0x3f623f7b,0xbdc9bf35,0x3f753f0e,0xbef1a554,0xbf7fbf55,0x3f753f35,0x3f463f7b
.long 0x3e95248d,0x3f463f0e,0x3ef13f35,0xbdc93e48,0xbdc9a554,0xbe95be48,0xbf46bf35,0xbf62bf55
.long 0xbef1bec4,0xbf22bf0e,0xbf75bf6d,0xbf7fbf7b,0x3f7f3f6d,0x3f623f7b,0xbf22bec4,0xbf75bf55
.long 0xbf22bf6d,0x3e95be48,0xbdc93ec4,0xbf62bf0e,0xbe953ec4,0xbf7fbf55,0x3ef13f6d,0xbf46be48
.long 0x3f753ec4,0x3dc93f55,0x3f623f6d,0xbf223e48,0xbf46bf6d,0x3f753e48,0x3f7f3ec4,0xbef13f0e
.long 0xbdc93f6d,0xbef1bf7b,0x3f46bec4,0xbe953f55,0x3f62bec4,0xbf463f0e,0x3e95bf6d,0xbdc93f7b
.long 0xbf62bec4,0x3f463f0e,0xbe95bf6d,0x3dc93f7b,0x3dc93f6d,0x3ef1bf7b,0xbf46bec4,0x3e953f55
.long 0x3f46bf6d,0xbf753e48,0xbf7f3ec4,0x3ef13f0e,0xbf753ec4,0xbdc93f55,0xbf623f6d,0x3f223e48
.long 0x3e953ec4,0x3f7fbf55,0xbef13f6d,0x3f46be48,0x3f22bf6d,0xbe95be48,0x3dc93ec4,0x3f62bf0e
.long 0xbf7f3f6d,0xbf623f7b,0x3f22bec4,0x3f75bf55,0x3ef1bec4,0x3f22bf0e,0x3f75bf6d,0x3f7fbf7b
.long 0x3ef1bec4,0x3f22bf0e,0x3f75bf6d,0x3f7fbf7b,0xbf7f3f6d,0xbf623f7b,0x3f22bec4,0x3f75bf55
.long 0x3f22bf6d,0xbe95be48,0x3dc93ec4,0x3f62bf0e,0x3e953ec4,0x3f7fbf55,0xbef13f6d,0x3f46be48
.long 0xbf753ec4,0xbdc93f55,0xbf623f6d,0x3f223e48,0x3f46bf6d,0xbf753e48,0xbf7f3ec4,0x3ef13f0e
.long 0x3dc93f6d,0x3ef1bf7b,0xbf46bec4,0x3e953f55,0xbf62bec4,0x3f463f0e,0xbe95bf6d,0x3dc93f7b
.long 0x3f62bec4,0xbf463f0e,0x3e95bf6d,0xbdc93f7b,0xbdc93f6d,0xbef1bf7b,0x3f46bec4,0xbe953f55
.long 0xbf46bf6d,0x3f753e48,0x3f7f3ec4,0xbef13f0e,0x3f753ec4,0x3dc93f55,0x3f623f6d,0xbf223e48
.long 0xbe953ec4,0xbf7fbf55,0x3ef13f6d,0xbf46be48,0xbf22bf6d,0x3e95be48,0xbdc93ec4,0xbf62bf0e
.long 0x3f7f3f6d,0x3f623f7b,0xbf22bec4,0xbf75bf55,0xbef1bec4,0xbf22bf0e,0xbf75bf6d,0xbf7fbf7b
.long 0x3dc90000,0x3e953e48,0x3f463f35,0x3f623f55,0x3e950000,0x3f463f0e,0x3ef13f35,0xbdc93e48
.long 0x3ef10000,0x3f7f3f55,0xbf75bf35,0xbf46bf7b,0x3f220000,0x3f623f7b,0xbdc9bf35,0x3f753f0e
.long 0x3f460000,0x3ef13f7b,0x3f7f3f35,0xbe953f0e,0x3f620000,0xbdc93f55,0xbe953f35,0xbf22bf7b
.long 0x3f750000,0xbf223f0e,0xbf62bf35,0x3f7f3e48,0x3f7f0000,0xbf753e48,0x3f22bf35,0xbef13f55
.long 0x3f7f0000,0xbf75be48,0x3f223f35,0xbef1bf55,0x3f750000,0xbf22bf0e,0xbf623f35,0x3f7fbe48
.long 0x3f620000,0xbdc9bf55,0xbe95bf35,0xbf223f7b,0x3f460000,0x3ef1bf7b,0x3f7fbf35,0xbe95bf0e
.long 0x3f220000,0x3f62bf7b,0xbdc93f35,0x3f75bf0e,0x3ef10000,0x3f7fbf55,0xbf753f35,0xbf463f7b
.long 0x3e950000,0x3f46bf0e,0x3ef1bf35,0xbdc9be48,0x3dc90000,0x3e95be48,0x3f46bf35,0x3f62bf55
.long 0xbdc90000,0xbe953e48,0xbf463f35,0xbf623f55,0xbe950000,0xbf463f0e,0xbef13f35,0x3dc93e48
.long 0xbef10000,0xbf7f3f55,0x3f75bf35,0x3f46bf7b,0xbf220000,0xbf623f7b,0x3dc9bf35,0xbf753f0e
.long 0xbf460000,0xbef13f7b,0xbf7f3f35,0x3e953f0e,0xbf620000,0x3dc93f55,0x3e953f35,0x3f22bf7b
.long 0xbf750000,0x3f223f0e,0x3f62bf35,0xbf7f3e48,0xbf7f0000,0x3f753e48,0xbf22bf35,0x3ef13f55
.long 0xbf7f0000,0x3f75be48,0xbf223f35,0x3ef1bf55,0xbf750000,0x3f22bf0e,0x3f623f35,0xbf7fbe48
.long 0xbf620000,0x3dc9bf55,0x3e95bf35,0x3f223f7b,0xbf460000,0xbef1bf7b,0xbf7fbf35,0x3e95bf0e
.long 0xbf220000,0xbf62bf7b,0x3dc93f35,0xbf75bf0e,0xbef10000,0xbf7fbf55,0x3f753f35,0x3f463f7b
.long 0xbe950000,0xbf46bf0e,0xbef1bf35,0x3dc9be48,0xbdc90000,0xbe95be48,0xbf46bf35,0xbf62bf55
.long 0x3ef13ec4,0x3f223f0e,0x3f753f6d,0x3f7f3f7b,0x3f7f3f6d,0x3f623f7b,0xbf22bec4,0xbf75bf55
.long 0x3f223f6d,0xbe953e48,0x3dc9bec4,0x3f623f0e,0xbe953ec4,0xbf7fbf55,0x3ef13f6d,0xbf46be48
.long 0xbf75bec4,0xbdc9bf55,0xbf62bf6d,0x3f22be48,0xbf46bf6d,0x3f753e48,0x3f7f3ec4,0xbef13f0e
.long 0x3dc9bf6d,0x3ef13f7b,0xbf463ec4,0x3e95bf55,0x3f62bec4,0xbf463f0e,0x3e95bf6d,0xbdc93f7b
.long 0x3f623ec4,0xbf46bf0e,0x3e953f6d,0xbdc9bf7b,0x3dc93f6d,0x3ef1bf7b,0xbf46bec4,0x3e953f55
.long 0xbf463f6d,0x3f75be48,0x3f7fbec4,0xbef1bf0e,0xbf753ec4,0xbdc93f55,0xbf623f6d,0x3f223e48
.long 0xbe95bec4,0xbf7f3f55,0x3ef1bf6d,0xbf463e48,0x3f22bf6d,0xbe95be48,0x3dc93ec4,0x3f62bf0e
.long 0x3f7fbf6d,0x3f62bf7b,0xbf223ec4,0xbf753f55,0x3ef1bec4,0x3f22bf0e,0x3f75bf6d,0x3f7fbf7b
.long 0xbef13ec4,0xbf223f0e,0xbf753f6d,0xbf7f3f7b,0xbf7f3f6d,0xbf623f7b,0x3f22bec4,0x3f75bf55
.long 0xbf223f6d,0x3e953e48,0xbdc9bec4,0xbf623f0e,0x3e953ec4,0x3f7fbf55,0xbef13f6d,0x3f46be48
.long 0x3f75bec4,0x3dc9bf55,0x3f62bf6d,0xbf22be48,0x3f46bf6d,0xbf753e48,0xbf7f3ec4,0x3ef13f0e
.long 0xbdc9bf6d,0xbef13f7b,0x3f463ec4,0xbe95bf55,0xbf62bec4,0x3f463f0e,0xbe95bf6d,0x3dc93f7b
.long 0xbf623ec4,0x3f46bf0e,0xbe953f6d,0x3dc9bf7b,0xbdc93f6d,0xbef1bf7b,0x3f46bec4,0xbe953f55
.long 0x3f463f6d,0xbf75be48,0xbf7fbec4,0x3ef1bf0e,0x3f753ec4,0x3dc93f55,0x3f623f6d,0xbf223e48
.long 0x3e95bec4,0x3f7f3f55,0xbef1bf6d,0x3f463e48,0xbf22bf6d,0x3e95be48,0xbdc93ec4,0xbf62bf0e
.long 0xbf7fbf6d,0xbf62bf7b,0x3f223ec4,0x3f753f55,0xbef1bec4,0xbf22bf0e,0xbf75bf6d,0xbf7fbf7b
.long 0x3f7f3f80,0x3f753f7b,0x3f223f35,0x3ef13f0e,0xbf75bf80,0xbf22bf55,0x3f623f35,0x3f7f3f7b
.long 0x3f623f80,0x3dc93f0e,0xbe95bf35,0x3f223e48,0xbf46bf80,0x3ef1be48,0xbf7fbf35,0xbe95bf55
.long 0x3f223f80,0xbf62be48,0xbdc93f35,0xbf75bf55,0xbef1bf80,0x3f7f3f0e,0x3f753f35,0xbf463e48
.long 0x3e953f80,0xbf46bf55,0x3ef1bf35,0x3dc93f7b,0xbdc9bf80,0x3e953f7b,0xbf46bf35,0x3f623f0e
.long 0xbdc93f80,0x3e95bf7b,0xbf463f35,0x3f62bf0e,0x3e95bf80,0xbf463f55,0x3ef13f35,0x3dc9bf7b
.long 0xbef13f80,0x3f7fbf0e,0x3f75bf35,0xbf46be48,0x3f22bf80,0xbf623e48,0xbdc9bf35,0xbf753f55
.long 0xbf463f80,0x3ef13e48,0xbf7f3f35,0xbe953f55,0x3f62bf80,0x3dc9bf0e,0xbe953f35,0x3f22be48
.long 0xbf753f80,0xbf223f55,0x3f62bf35,0x3f7fbf7b,0x3f7fbf80,0x3f75bf7b,0x3f22bf35,0x3ef1bf0e
.long 0xbf7f3f80,0xbf753f7b,0xbf223f35,0xbef13f0e,0x3f75bf80,0x3f22bf55,0xbf623f35,0xbf7f3f7b
.long 0xbf623f80,0xbdc93f0e,0x3e95bf35,0xbf223e48,0x3f46bf80,0xbef1be48,0x3f7fbf35,0x3e95bf55
.long 0xbf223f80,0x3f62be48,0x3dc93f35,0x3f75bf55,0x3ef1bf80,0xbf7f3f0e,0xbf753f35,0x3f463e48
.long 0xbe953f80,0x3f46bf55,0xbef1bf35,0xbdc93f7b,0x3dc9bf80,0xbe953f7b,0x3f46bf35,0xbf623f0e
.long 0x3dc93f80,0xbe95bf7b,0x3f463f35,0xbf62bf0e,0xbe95bf80,0x3f463f55,0xbef13f35,0xbdc9bf7b
.long 0x3ef13f80,0xbf7fbf0e,0xbf75bf35,0x3f46be48,0xbf22bf80,0x3f623e48,0x3dc9bf35,0x3f753f55
.long 0x3f463f80,0xbef13e48,0x3f7f3f35,0x3e953f55,0xbf62bf80,0xbdc9bf0e,0x3e953f35,0xbf22be48
.long 0x3f753f80,0x3f223f55,0xbf62bf35,0xbf7fbf7b,0xbf7fbf80,0xbf75bf7b,0xbf22bf35,0xbef1bf0e
.long 0x3f623f6d,0x3f463f55,0x3e953ec4,0x3dc93e48,0xbdc9bec4,0x3ef13e48,0x3f463f6d,0x3e953f0e
.long 0xbf46bec4,0xbf75bf7b,0x3f7f3f6d,0x3ef13f55,0x3f753f6d,0xbdc93f0e,0x3f623ec4,0x3f223f7b
.long 0xbe95bf6d,0x3f7f3f0e,0x3ef1bec4,0x3f463f7b,0xbf223ec4,0xbe95bf7b,0xbdc9bf6d,0x3f623f55
.long 0x3f7f3ec4,0xbf623e48,0xbf22bf6d,0x3f753f0e,0xbef1bf6d,0x3f223f55,0xbf75bec4,0x3f7f3e48
.long 0xbef13f6d,0x3f22bf55,0xbf753ec4,0x3f7fbe48,0x3f7fbec4,0xbf62be48,0xbf223f6d,0x3f75bf0e
.long 0xbf22bec4,0xbe953f7b,0xbdc93f6d,0x3f62bf55,0xbe953f6d,0x3f7fbf0e,0x3ef13ec4,0x3f46bf7b
.long 0x3f75bf6d,0xbdc9bf0e,0x3f62bec4,0x3f22bf7b,0xbf463ec4,0xbf753f7b,0x3f7fbf6d,0x3ef1bf55
.long 0xbdc93ec4,0x3ef1be48,0x3f46bf6d,0x3e95bf0e,0x3f62bf6d,0x3f46bf55,0x3e95bec4,0x3dc9be48
.long 0xbf623f6d,0xbf463f55,0xbe953ec4,0xbdc93e48,0x3dc9bec4,0xbef13e48,0xbf463f6d,0xbe953f0e
.long 0x3f46bec4,0x3f75bf7b,0xbf7f3f6d,0xbef13f55,0xbf753f6d,0x3dc93f0e,0xbf623ec4,0xbf223f7b
.long 0x3e95bf6d,0xbf7f3f0e,0xbef1bec4,0xbf463f7b,0x3f223ec4,0x3e95bf7b,0x3dc9bf6d,0xbf623f55
.long 0xbf7f3ec4,0x3f623e48,0x3f22bf6d,0xbf753f0e,0x3ef1bf6d,0xbf223f55,0x3f75bec4,0xbf7f3e48
.long 0x3ef13f6d,0xbf22bf55,0x3f753ec4,0xbf7fbe48,0xbf7fbec4,0x3f62be48,0x3f223f6d,0xbf75bf0e
.long 0x3f22bec4,0x3e953f7b,0x3dc93f6d,0xbf62bf55,0x3e953f6d,0xbf7fbf0e,0xbef13ec4,0xbf46bf7b
.long 0xbf75bf6d,0x3dc9bf0e,0xbf62bec4,0xbf22bf7b,0x3f463ec4,0x3f753f7b,0xbf7fbf6d,0xbef1bf55
.long 0x3dc93ec4,0xbef1be48,0xbf46bf6d,0xbe95bf0e,0xbf62bf6d,0xbf46bf55,0xbe95bec4,0xbdc9be48
.long 0xbdc98000,0xbe95be48,0xbf46bf35,0xbf62bf55,0xbe958000,0xbf46bf0e,0xbef1bf35,0x3dc9be48
.long 0xbef18000,0xbf7fbf55,0x3f753f35,0x3f463f7b,0xbf228000,0xbf62bf7b,0x3dc93f35,0xbf75bf0e
.long 0xbf468000,0xbef1bf7b,0xbf7fbf35,0x3e95bf0e,0xbf628000,0x3dc9bf55,0x3e95bf35,0x3f223f7b
.long 0xbf758000,0x3f22bf0e,0x3f623f35,0xbf7fbe48,0xbf7f8000,0x3f75be48,0xbf223f35,0x3ef1bf55
.long 0xbf7f8000,0x3f753e48,0xbf22bf35,0x3ef13f55,0xbf758000,0x3f223f0e,0x3f62bf35,0xbf7f3e48
.long 0xbf628000,0x3dc93f55,0x3e953f35,0x3f22bf7b,0xbf468000,0xbef13f7b,0xbf7f3f35,0x3e953f0e
.long 0xbf228000,0xbf623f7b,0x3dc9bf35,0xbf753f0e,0xbef18000,0xbf7f3f55,0x3f75bf35,0x3f46bf7b
.long 0xbe958000,0xbf463f0e,0xbef13f35,0x3dc93e48,0xbdc98000,0xbe953e48,0xbf463f35,0xbf623f55
.long 0x3dc98000,0x3e95be48,0x3f46bf35,0x3f62bf55,0x3e958000,0x3f46bf0e,0x3ef1bf35,0xbdc9be48
.long 0x3ef18000,0x3f7fbf55,0xbf753f35,0xbf463f7b,0x3f228000,0x3f62bf7b,0xbdc93f35,0x3f75bf0e
.long 0x3f468000,0x3ef1bf7b,0x3f7fbf35,0xbe95bf0e,0x3f628000,0xbdc9bf55,0xbe95bf35,0xbf223f7b
.long 0x3f758000,0xbf22bf0e,0xbf623f35,0x3f7fbe48,0x3f7f8000,0xbf75be48,0x3f223f35,0xbef1bf55
.long 0x3f7f8000,0xbf753e48,0x3f22bf35,0xbef13f55,0x3f758000,0xbf223f0e,0xbf62bf35,0x3f7f3e48
.long 0x3f628000,0xbdc93f55,0xbe953f35,0xbf22bf7b,0x3f468000,0x3ef13f7b,0x3f7f3f35,0xbe953f0e
.long 0x3f228000,0x3f623f7b,0xbdc9bf35,0x3f753f0e,0x3ef18000,0x3f7f3f55,0xbf75bf35,0xbf46bf7b
.long 0x3e958000,0x3f463f0e,0x3ef13f35,0xbdc93e48,0x3dc98000,0x3e953e48,0x3f463f35,0x3f623f55
.long 0xbef1bec4,0xbf22bf0e,0xbf75bf6d,0xbf7fbf7b,0xbf7fbf6d,0xbf62bf7b,0x3f223ec4,0x3f753f55
.long 0xbf22bf6d,0x3e95be48,0xbdc93ec4,0xbf62bf0e,0x3e95bec4,0x3f7f3f55,0xbef1bf6d,0x3f463e48
.long 0x3f753ec4,0x3dc93f55,0x3f623f6d,0xbf223e48,0x3f463f6d,0xbf75be48,0xbf7fbec4,0x3ef1bf0e
.long 0xbdc93f6d,0xbef1bf7b,0x3f46bec4,0xbe953f55,0xbf623ec4,0x3f46bf0e,0xbe953f6d,0x3dc9bf7b
.long 0xbf62bec4,0x3f463f0e,0xbe95bf6d,0x3dc93f7b,0xbdc9bf6d,0xbef13f7b,0x3f463ec4,0xbe95bf55
.long 0x3f46bf6d,0xbf753e48,0xbf7f3ec4,0x3ef13f0e,0x3f75bec4,0x3dc9bf55,0x3f62bf6d,0xbf22be48
.long 0x3e953ec4,0x3f7fbf55,0xbef13f6d,0x3f46be48,0xbf223f6d,0x3e953e48,0xbdc9bec4,0xbf623f0e
.long 0xbf7f3f6d,0xbf623f7b,0x3f22bec4,0x3f75bf55,0xbef13ec4,0xbf223f0e,0xbf753f6d,0xbf7f3f7b
.long 0x3ef1bec4,0x3f22bf0e,0x3f75bf6d,0x3f7fbf7b,0x3f7fbf6d,0x3f62bf7b,0xbf223ec4,0xbf753f55
.long 0x3f22bf6d,0xbe95be48,0x3dc93ec4,0x3f62bf0e,0xbe95bec4,0xbf7f3f55,0x3ef1bf6d,0xbf463e48
.long 0xbf753ec4,0xbdc93f55,0xbf623f6d,0x3f223e48,0xbf463f6d,0x3f75be48,0x3f7fbec4,0xbef1bf0e
.long 0x3dc93f6d,0x3ef1bf7b,0xbf46bec4,0x3e953f55,0x3f623ec4,0xbf46bf0e,0x3e953f6d,0xbdc9bf7b
.long 0x3f62bec4,0xbf463f0e,0x3e95bf6d,0xbdc93f7b,0x3dc9bf6d,0x3ef13f7b,0xbf463ec4,0x3e95bf55
.long 0xbf46bf6d,0x3f753e48,0x3f7f3ec4,0xbef13f0e,0xbf75bec4,0xbdc9bf55,0xbf62bf6d,0x3f22be48
.long 0xbe953ec4,0xbf7fbf55,0x3ef13f6d,0xbf46be48,0x3f223f6d,0xbe953e48,0x3dc9bec4,0x3f623f0e
.long 0x3f7f3f6d,0x3f623f7b,0xbf22bec4,0xbf75bf55,0x3ef13ec4,0x3f223f0e,0x3f753f6d,0x3f7f3f7b
.long 0xbf7fbf80,0xbf75bf7b,0xbf22bf35,0xbef1bf0e,0x3f753f80,0x3f223f55,0xbf62bf35,0xbf7fbf7b
.long 0xbf62bf80,0xbdc9bf0e,0x3e953f35,0xbf22be48,0x3f463f80,0xbef13e48,0x3f7f3f35,0x3e953f55
.long 0xbf22bf80,0x3f623e48,0x3dc9bf35,0x3f753f55,0x3ef13f80,0xbf7fbf0e,0xbf75bf35,0x3f46be48
.long 0xbe95bf80,0x3f463f55,0xbef13f35,0xbdc9bf7b,0x3dc93f80,0xbe95bf7b,0x3f463f35,0xbf62bf0e
.long 0x3dc9bf80,0xbe953f7b,0x3f46bf35,0xbf623f0e,0xbe953f80,0x3f46bf55,0xbef1bf35,0xbdc93f7b
.long 0x3ef1bf80,0xbf7f3f0e,0xbf753f35,0x3f463e48,0xbf223f80,0x3f62be48,0x3dc93f35,0x3f75bf55
.long 0x3f46bf80,0xbef1be48,0x3f7fbf35,0x3e95bf55,0xbf623f80,0xbdc93f0e,0x3e95bf35,0xbf223e48
.long 0x3f75bf80,0x3f22bf55,0xbf623f35,0xbf7f3f7b,0xbf7f3f80,0xbf753f7b,0xbf223f35,0xbef13f0e
.long 0x3f7fbf80,0x3f75bf7b,0x3f22bf35,0x3ef1bf0e,0xbf753f80,0xbf223f55,0x3f62bf35,0x3f7fbf7b
.long 0x3f62bf80,0x3dc9bf0e,0xbe953f35,0x3f22be48,0xbf463f80,0x3ef13e48,0xbf7f3f35,0xbe953f55
.long 0x3f22bf80,0xbf623e48,0xbdc9bf35,0xbf753f55,0xbef13f80,0x3f7fbf0e,0x3f75bf35,0xbf46be48
.long 0x3e95bf80,0xbf463f55,0x3ef13f35,0x3dc9bf7b,0xbdc93f80,0x3e95bf7b,0xbf463f35,0x3f62bf0e
.long 0xbdc9bf80,0x3e953f7b,0xbf46bf35,0x3f623f0e,0x3e953f80,0xbf46bf55,0x3ef1bf35,0x3dc93f7b
.long 0xbef1bf80,0x3f7f3f0e,0x3f753f35,0xbf463e48,0x3f223f80,0xbf62be48,0xbdc93f35,0xbf75bf55
.long 0xbf46bf80,0x3ef1be48,0xbf7fbf35,0xbe95bf55,0x3f623f80,0x3dc93f0e,0xbe95bf35,0x3f223e48
.long 0xbf75bf80,0xbf22bf55,0x3f623f35,0x3f7f3f7b,0x3f7f3f80,0x3f753f7b,0x3f223f35,0x3ef13f0e
.long 0xbf62bf6d,0xbf46bf55,0xbe95bec4,0xbdc9be48,0x3dc93ec4,0xbef1be48,0xbf46bf6d,0xbe95bf0e
.long 0x3f463ec4,0x3f753f7b,0xbf7fbf6d,0xbef1bf55,0xbf75bf6d,0x3dc9bf0e,0xbf62bec4,0xbf22bf7b
.long 0x3e953f6d,0xbf7fbf0e,0xbef13ec4,0xbf46bf7b,0x3f22bec4,0x3e953f7b,0x3dc93f6d,0xbf62bf55
.long 0xbf7fbec4,0x3f62be48,0x3f223f6d,0xbf75bf0e,0x3ef13f6d,0xbf22bf55,0x3f753ec4,0xbf7fbe48
.long 0x3ef1bf6d,0xbf223f55,0x3f75bec4,0xbf7f3e48,0xbf7f3ec4,0x3f623e48,0x3f22bf6d,0xbf753f0e
.long 0x3f223ec4,0x3e95bf7b,0x3dc9bf6d,0xbf623f55,0x3e95bf6d,0xbf7f3f0e,0xbef1bec4,0xbf463f7b
.long 0xbf753f6d,0x3dc93f0e,0xbf623ec4,0xbf223f7b,0x3f46bec4,0x3f75bf7b,0xbf7f3f6d,0xbef13f55
.long 0x3dc9bec4,0xbef13e48,0xbf463f6d,0xbe953f0e,0xbf623f6d,0xbf463f55,0xbe953ec4,0xbdc93e48
.long 0x3f62bf6d,0x3f46bf55,0x3e95bec4,0x3dc9be48,0xbdc93ec4,0x3ef1be48,0x3f46bf6d,0x3e95bf0e
.long 0xbf463ec4,0xbf753f7b,0x3f7fbf6d,0x3ef1bf55,0x3f75bf6d,0xbdc9bf0e,0x3f62bec4,0x3f22bf7b
.long 0xbe953f6d,0x3f7fbf0e,0x3ef13ec4,0x3f46bf7b,0xbf22bec4,0xbe953f7b,0xbdc93f6d,0x3f62bf55
.long 0x3f7fbec4,0xbf62be48,0xbf223f6d,0x3f75bf0e,0xbef13f6d,0x3f22bf55,0xbf753ec4,0x3f7fbe48
.long 0xbef1bf6d,0x3f223f55,0xbf75bec4,0x3f7f3e48,0x3f7f3ec4,0xbf623e48,0xbf22bf6d,0x3f753f0e
.long 0xbf223ec4,0xbe95bf7b,0xbdc9bf6d,0x3f623f55,0xbe95bf6d,0x3f7f3f0e,0x3ef1bec4,0x3f463f7b
.long 0x3f753f6d,0xbdc93f0e,0x3f623ec4,0x3f223f7b,0xbf46bec4,0xbf75bf7b,0x3f7f3f6d,0x3ef13f55
.long 0xbdc9bec4,0x3ef13e48,0x3f463f6d,0x3e953f0e,0x3f623f6d,0x3f463f55,0x3e953ec4,0x3dc93e48
.long 0x3f803f80,0x3f803f80,0x3f803f80,0x3f803f80,0x3f753f7f,0x3f463f62,0xbe95bdc9,0xbf22bef1
.long 0x3f553f7b,0x3e483f0e,0xbf55bf7b,0xbe48bf0e,0x3f223f75,0xbef13dc9,0x3f463e95,0x3f623f7f
.long 0x3ec43f6d,0xbf6dbec4,0x3ec43f6d,0xbf6dbec4,0x3dc93f62,0xbf75bf46,0xbf7fbef1,0x3e95bf22
.long 0xbe483f55,0xbf0ebf7b,0x3e48bf55,0x3f0e3f7b,0xbef13f46,0x3dc9bf75,0x3f623f22,0xbf7fbe95
.long 0xbf353f35,0x3f35bf35,0xbf353f35,0x3f35bf35,0xbf623f22,0x3f7fbe95,0xbef1bf46,0x3dc93f75
.long 0xbf7b3f0e,0x3f553e48,0x3f7bbf0e,0xbf55be48,0xbf7f3ef1,0x3e953f22,0xbdc93f62,0x3f75bf46
.long 0xbf6d3ec4,0xbec43f6d,0xbf6d3ec4,0xbec43f6d,0xbf463e95,0xbf623f7f,0x3f22bf75,0xbef1bdc9
.long 0xbf0e3e48,0xbf7b3f55,0x3f0ebe48,0x3f7bbf55,0xbe953dc9,0xbf223ef1,0xbf753f7f,0xbf463f62
.long 0xa554248d,0xa554248d,0xa554248d,0xa554248d,0x3e95bdc9,0x3f22bef1,0x3f75bf7f,0x3f46bf62
.long 0x3f0ebe48,0x3f7bbf55,0xbf0e3e48,0xbf7b3f55,0x3f46be95,0x3f62bf7f,0xbf223f75,0x3ef13dc9
.long 0x3f6dbec4,0x3ec4bf6d,0x3f6dbec4,0x3ec4bf6d,0x3f7fbef1,0xbe95bf22,0x3dc9bf62,0xbf753f46
.long 0x3f7bbf0e,0xbf55be48,0xbf7b3f0e,0x3f553e48,0x3f62bf22,0xbf7f3e95,0x3ef13f46,0xbdc9bf75
.long 0x3f35bf35,0xbf353f35,0x3f35bf35,0xbf353f35,0x3ef1bf46,0xbdc93f75,0xbf62bf22,0x3f7f3e95
.long 0x3e48bf55,0x3f0e3f7b,0xbe483f55,0xbf0ebf7b,0xbdc9bf62,0x3f753f46,0x3f7f3ef1,0xbe953f22
.long 0xbec4bf6d,0x3f6d3ec4,0xbec4bf6d,0x3f6d3ec4,0xbf22bf75,0x3ef1bdc9,0xbf46be95,0xbf62bf7f
.long 0xbf55bf7b,0xbe48bf0e,0x3f553f7b,0x3e483f0e,0xbf75bf7f,0xbf46bf62,0x3e953dc9,0x3f223ef1
.long 0x3f803f80,0x3f803f80,0x3f803f80,0x3f803f80,0x3ef13f22,0x3dc93e95,0xbf62bf46,0xbf7fbf75
.long 0xbf0ebe48,0xbf7bbf55,0x3f0e3e48,0x3f7b3f55,0xbf7fbf62,0xbe95bf46,0xbdc93ef1,0xbf75bf22
.long 0xbec4bf6d,0x3f6d3ec4,0xbec4bf6d,0x3f6d3ec4,0x3f22be95,0x3ef13f7f,0x3f463f75,0xbf62bdc9
.long 0x3f7b3f0e,0xbf553e48,0xbf7bbf0e,0x3f55be48,0x3e953f7f,0xbf22bf62,0x3f75bdc9,0xbf463ef1
.long 0xbf353f35,0x3f35bf35,0xbf353f35,0x3f35bf35,0xbf75bdc9,0x3f463ef1,0x3e95bf7f,0xbf223f62
.long 0xbe48bf55,0xbf0e3f7b,0x3e483f55,0x3f0ebf7b,0x3f46bf75,0xbf623dc9,0xbf22be95,0xbef13f7f
.long 0x3f6dbec4,0x3ec4bf6d,0x3f6dbec4,0x3ec4bf6d,0x3dc93ef1,0x3f75bf22,0xbf7f3f62,0xbe953f46
.long 0xbf553f7b,0xbe483f0e,0x3f55bf7b,0x3e48bf0e,0xbf623f46,0xbf7f3f75,0xbef13f22,0xbdc93e95
.long 0xa554248d,0xa554248d,0xa554248d,0xa554248d,0x3f62bf46,0x3f7fbf75,0x3ef1bf22,0x3dc9be95
.long 0x3f55bf7b,0x3e48bf0e,0xbf553f7b,0xbe483f0e,0xbdc9bef1,0xbf753f22,0x3f7fbf62,0x3e95bf46
.long 0xbf6d3ec4,0xbec43f6d,0xbf6d3ec4,0xbec43f6d,0xbf463f75,0x3f62bdc9,0x3f223e95,0x3ef1bf7f
.long 0x3e483f55,0x3f0ebf7b,0xbe48bf55,0xbf0e3f7b,0x3f753dc9,0xbf46bef1,0xbe953f7f,0x3f22bf62
.long 0x3f35bf35,0xbf353f35,0x3f35bf35,0xbf353f35,0xbe95bf7f,0x3f223f62,0xbf753dc9,0x3f46bef1
.long 0xbf7bbf0e,0x3f55be48,0x3f7b3f0e,0xbf553e48,0xbf223e95,0xbef1bf7f,0xbf46bf75,0x3f623dc9
.long 0x3ec43f6d,0xbf6dbec4,0x3ec43f6d,0xbf6dbec4,0x3f7f3f62,0x3e953f46,0x3dc9bef1,0x3f753f22
.long 0x3f0e3e48,0x3f7b3f55,0xbf0ebe48,0xbf7bbf55,0xbef1bf22,0xbdc9be95,0x3f623f46,0x3f7f3f75
.long 0x3f803f80,0x3f803f80,0x3f803f80,0x3f803f80,0xbf75bf7f,0xbf46bf62,0x3e953dc9,0x3f223ef1
.long 0x3f553f7b,0x3e483f0e,0xbf55bf7b,0xbe48bf0e,0xbf22bf75,0x3ef1bdc9,0xbf46be95,0xbf62bf7f
.long 0x3ec43f6d,0xbf6dbec4,0x3ec43f6d,0xbf6dbec4,0xbdc9bf62,0x3f753f46,0x3f7f3ef1,0xbe953f22
.long 0xbe483f55,0xbf0ebf7b,0x3e48bf55,0x3f0e3f7b,0x3ef1bf46,0xbdc93f75,0xbf62bf22,0x3f7f3e95
.long 0xbf353f35,0x3f35bf35,0xbf353f35,0x3f35bf35,0x3f62bf22,0xbf7f3e95,0x3ef13f46,0xbdc9bf75
.long 0xbf7b3f0e,0x3f553e48,0x3f7bbf0e,0xbf55be48,0x3f7fbef1,0xbe95bf22,0x3dc9bf62,0xbf753f46
.long 0xbf6d3ec4,0xbec43f6d,0xbf6d3ec4,0xbec43f6d,0x3f46be95,0x3f62bf7f,0xbf223f75,0x3ef13dc9
.long 0xbf0e3e48,0xbf7b3f55,0x3f0ebe48,0x3f7bbf55,0x3e95bdc9,0x3f22bef1,0x3f75bf7f,0x3f46bf62
.long 0xa554248d,0xa554248d,0xa554248d,0xa554248d,0xbe953dc9,0xbf223ef1,0xbf753f7f,0xbf463f62
.long 0x3f0ebe48,0x3f7bbf55,0xbf0e3e48,0xbf7b3f55,0xbf463e95,0xbf623f7f,0x3f22bf75,0xbef1bdc9
.long 0x3f6dbec4,0x3ec4bf6d,0x3f6dbec4,0x3ec4bf6d,0xbf7f3ef1,0x3e953f22,0xbdc93f62,0x3f75bf46
.long 0x3f7bbf0e,0xbf55be48,0xbf7b3f0e,0x3f553e48,0xbf623f22,0x3f7fbe95,0xbef1bf46,0x3dc93f75
.long 0x3f35bf35,0xbf353f35,0x3f35bf35,0xbf353f35,0xbef13f46,0x3dc9bf75,0x3f623f22,0xbf7fbe95
.long 0x3e48bf55,0x3f0e3f7b,0xbe483f55,0xbf0ebf7b,0x3dc93f62,0xbf75bf46,0xbf7fbef1,0x3e95bf22
.long 0xbec4bf6d,0x3f6d3ec4,0xbec4bf6d,0x3f6d3ec4,0x3f223f75,0xbef13dc9,0x3f463e95,0x3f623f7f
.long 0xbf55bf7b,0xbe48bf0e,0x3f553f7b,0x3e483f0e,0x3f753f7f,0x3f463f62,0xbe95bdc9,0xbf22bef1
.long 0x3f803f80,0x3f803f80,0x3f803f80,0x3f803f80,0xbef1bf22,0xbdc9be95,0x3f623f46,0x3f7f3f75
.long 0xbf0ebe48,0xbf7bbf55,0x3f0e3e48,0x3f7b3f55,0x3f7f3f62,0x3e953f46,0x3dc9bef1,0x3f753f22
.long 0xbec4bf6d,0x3f6d3ec4,0xbec4bf6d,0x3f6d3ec4,0xbf223e95,0xbef1bf7f,0xbf46bf75,0x3f623dc9
.long 0x3f7b3f0e,0xbf553e48,0xbf7bbf0e,0x3f55be48,0xbe95bf7f,0x3f223f62,0xbf753dc9,0x3f46bef1
.long 0xbf353f35,0x3f35bf35,0xbf353f35,0x3f35bf35,0x3f753dc9,0xbf46bef1,0xbe953f7f,0x3f22bf62
.long 0xbe48bf55,0xbf0e3f7b,0x3e483f55,0x3f0ebf7b,0xbf463f75,0x3f62bdc9,0x3f223e95,0x3ef1bf7f
.long 0x3f6dbec4,0x3ec4bf6d,0x3f6dbec4,0x3ec4bf6d,0xbdc9bef1,0xbf753f22,0x3f7fbf62,0x3e95bf46
.long 0xbf553f7b,0xbe483f0e,0x3f55bf7b,0x3e48bf0e,0x3f62bf46,0x3f7fbf75,0x3ef1bf22,0x3dc9be95
.long 0xa554248d,0xa554248d,0xa554248d,0xa554248d,0xbf623f46,0xbf7f3f75,0xbef13f22,0xbdc93e95
.long 0x3f55bf7b,0x3e48bf0e,0xbf553f7b,0xbe483f0e,0x3dc93ef1,0x3f75bf22,0xbf7f3f62,0xbe953f46
.long 0xbf6d3ec4,0xbec43f6d,0xbf6d3ec4,0xbec43f6d,0x3f46bf75,0xbf623dc9,0xbf22be95,0xbef13f7f
.long 0x3e483f55,0x3f0ebf7b,0xbe48bf55,0xbf0e3f7b,0xbf75bdc9,0x3f463ef1,0x3e95bf7f,0xbf223f62
.long 0x3f35bf35,0xbf353f35,0x3f35bf35,0xbf353f35,0x3e953f7f,0xbf22bf62,0x3f75bdc9,0xbf463ef1
.long 0xbf7bbf0e,0x3f55be48,0x3f7b3f0e,0xbf553e48,0x3f22be95,0x3ef13f7f,0x3f463f75,0xbf62bdc9
.long 0x3ec43f6d,0xbf6dbec4,0x3ec43f6d,0xbf6dbec4,0xbf7fbf62,0xbe95bf46,0xbdc93ef1,0xbf75bf22
.long 0x3f0e3e48,0x3f7b3f55,0xbf0ebe48,0xbf7bbf55,0x3ef13f22,0x3dc93e95,0xbf62bf46,0xbf7fbf75
.long 0x0,0x0,0x0,0x0,0x3e953dc9,0x3f223ef1,0x3f753f7f,0x3f463f62
.long 0x3f0e3e48,0x3f7b3f55,0xbf0ebe48,0xbf7bbf55,0x3f463e95,0x3f623f7f,0xbf22bf75,0x3ef1bdc9
.long 0x3f6d3ec4,0x3ec43f6d,0x3f6d3ec4,0x3ec43f6d,0x3f7f3ef1,0xbe953f22,0x3dc93f62,0xbf75bf46
.long 0x3f7b3f0e,0xbf553e48,0xbf7bbf0e,0x3f55be48,0x3f623f22,0xbf7fbe95,0x3ef1bf46,0xbdc93f75
.long 0x3f353f35,0xbf35bf35,0x3f353f35,0xbf35bf35,0x3ef13f46,0xbdc9bf75,0xbf623f22,0x3f7fbe95
.long 0x3e483f55,0x3f0ebf7b,0xbe48bf55,0xbf0e3f7b,0xbdc93f62,0x3f75bf46,0x3f7fbef1,0xbe95bf22
.long 0xbec43f6d,0x3f6dbec4,0xbec43f6d,0x3f6dbec4,0xbf223f75,0x3ef13dc9,0xbf463e95,0xbf623f7f
.long 0xbf553f7b,0xbe483f0e,0x3f55bf7b,0x3e48bf0e,0xbf753f7f,0xbf463f62,0x3e95bdc9,0x3f22bef1
.long 0xbf803f80,0xbf803f80,0xbf803f80,0xbf803f80,0xbf753f7f,0xbf463f62,0x3e95bdc9,0x3f22bef1
.long 0xbf553f7b,0xbe483f0e,0x3f55bf7b,0x3e48bf0e,0xbf223f75,0x3ef13dc9,0xbf463e95,0xbf623f7f
.long 0xbec43f6d,0x3f6dbec4,0xbec43f6d,0x3f6dbec4,0xbdc93f62,0x3f75bf46,0x3f7fbef1,0xbe95bf22
.long 0x3e483f55,0x3f0ebf7b,0xbe48bf55,0xbf0e3f7b,0x3ef13f46,0xbdc9bf75,0xbf623f22,0x3f7fbe95
.long 0x3f353f35,0xbf35bf35,0x3f353f35,0xbf35bf35,0x3f623f22,0xbf7fbe95,0x3ef1bf46,0xbdc93f75
.long 0x3f7b3f0e,0xbf553e48,0xbf7bbf0e,0x3f55be48,0x3f7f3ef1,0xbe953f22,0x3dc93f62,0xbf75bf46
.long 0x3f6d3ec4,0x3ec43f6d,0x3f6d3ec4,0x3ec43f6d,0x3f463e95,0x3f623f7f,0xbf22bf75,0x3ef1bdc9
.long 0x3f0e3e48,0x3f7b3f55,0xbf0ebe48,0xbf7bbf55,0x3e953dc9,0x3f223ef1,0x3f753f7f,0x3f463f62
.long 0x0,0x0,0x0,0x0,0x3f623f46,0x3f7f3f75,0x3ef13f22,0x3dc93e95
.long 0x3f553f7b,0x3e483f0e,0xbf55bf7b,0xbe48bf0e,0xbdc93ef1,0xbf75bf22,0x3f7f3f62,0x3e953f46
.long 0xbf6dbec4,0xbec4bf6d,0xbf6dbec4,0xbec4bf6d,0xbf46bf75,0x3f623dc9,0x3f22be95,0x3ef13f7f
.long 0x3e48bf55,0x3f0e3f7b,0xbe483f55,0xbf0ebf7b,0x3f75bdc9,0xbf463ef1,0xbe95bf7f,0x3f223f62
.long 0x3f353f35,0xbf35bf35,0x3f353f35,0xbf35bf35,0xbe953f7f,0x3f22bf62,0xbf75bdc9,0x3f463ef1
.long 0xbf7b3f0e,0x3f553e48,0x3f7bbf0e,0xbf55be48,0xbf22be95,0xbef13f7f,0xbf463f75,0x3f62bdc9
.long 0x3ec4bf6d,0xbf6d3ec4,0x3ec4bf6d,0xbf6d3ec4,0x3f7fbf62,0x3e95bf46,0x3dc93ef1,0x3f75bf22
.long 0x3f0ebe48,0x3f7bbf55,0xbf0e3e48,0xbf7b3f55,0xbef13f22,0xbdc93e95,0x3f62bf46,0x3f7fbf75
.long 0xbf803f80,0xbf803f80,0xbf803f80,0xbf803f80,0xbef13f22,0xbdc93e95,0x3f62bf46,0x3f7fbf75
.long 0x3f0ebe48,0x3f7bbf55,0xbf0e3e48,0xbf7b3f55,0x3f7fbf62,0x3e95bf46,0x3dc93ef1,0x3f75bf22
.long 0x3ec4bf6d,0xbf6d3ec4,0x3ec4bf6d,0xbf6d3ec4,0xbf22be95,0xbef13f7f,0xbf463f75,0x3f62bdc9
.long 0xbf7b3f0e,0x3f553e48,0x3f7bbf0e,0xbf55be48,0xbe953f7f,0x3f22bf62,0xbf75bdc9,0x3f463ef1
.long 0x3f353f35,0xbf35bf35,0x3f353f35,0xbf35bf35,0x3f75bdc9,0xbf463ef1,0xbe95bf7f,0x3f223f62
.long 0x3e48bf55,0x3f0e3f7b,0xbe483f55,0xbf0ebf7b,0xbf46bf75,0x3f623dc9,0x3f22be95,0x3ef13f7f
.long 0xbf6dbec4,0xbec4bf6d,0xbf6dbec4,0xbec4bf6d,0xbdc93ef1,0xbf75bf22,0x3f7f3f62,0x3e953f46
.long 0x3f553f7b,0x3e483f0e,0xbf55bf7b,0xbe48bf0e,0x3f623f46,0x3f7f3f75,0x3ef13f22,0x3dc93e95
.long 0x0,0x0,0x0,0x0,0xbe95bdc9,0xbf22bef1,0xbf75bf7f,0xbf46bf62
.long 0x3f0e3e48,0x3f7b3f55,0xbf0ebe48,0xbf7bbf55,0xbf46be95,0xbf62bf7f,0x3f223f75,0xbef13dc9
.long 0x3f6d3ec4,0x3ec43f6d,0x3f6d3ec4,0x3ec43f6d,0xbf7fbef1,0x3e95bf22,0xbdc9bf62,0x3f753f46
.long 0x3f7b3f0e,0xbf553e48,0xbf7bbf0e,0x3f55be48,0xbf62bf22,0x3f7f3e95,0xbef13f46,0x3dc9bf75
.long 0x3f353f35,0xbf35bf35,0x3f353f35,0xbf35bf35,0xbef1bf46,0x3dc93f75,0x3f62bf22,0xbf7f3e95
.long 0x3e483f55,0x3f0ebf7b,0xbe48bf55,0xbf0e3f7b,0x3dc9bf62,0xbf753f46,0xbf7f3ef1,0x3e953f22
.long 0xbec43f6d,0x3f6dbec4,0xbec43f6d,0x3f6dbec4,0x3f22bf75,0xbef1bdc9,0x3f46be95,0x3f62bf7f
.long 0xbf553f7b,0xbe483f0e,0x3f55bf7b,0x3e48bf0e,0x3f75bf7f,0x3f46bf62,0xbe953dc9,0xbf223ef1
.long 0xbf803f80,0xbf803f80,0xbf803f80,0xbf803f80,0x3f75bf7f,0x3f46bf62,0xbe953dc9,0xbf223ef1
.long 0xbf553f7b,0xbe483f0e,0x3f55bf7b,0x3e48bf0e,0x3f22bf75,0xbef1bdc9,0x3f46be95,0x3f62bf7f
.long 0xbec43f6d,0x3f6dbec4,0xbec43f6d,0x3f6dbec4,0x3dc9bf62,0xbf753f46,0xbf7f3ef1,0x3e953f22
.long 0x3e483f55,0x3f0ebf7b,0xbe48bf55,0xbf0e3f7b,0xbef1bf46,0x3dc93f75,0x3f62bf22,0xbf7f3e95
.long 0x3f353f35,0xbf35bf35,0x3f353f35,0xbf35bf35,0xbf62bf22,0x3f7f3e95,0xbef13f46,0x3dc9bf75
.long 0x3f7b3f0e,0xbf553e48,0xbf7bbf0e,0x3f55be48,0xbf7fbef1,0x3e95bf22,0xbdc9bf62,0x3f753f46
.long 0x3f6d3ec4,0x3ec43f6d,0x3f6d3ec4,0x3ec43f6d,0xbf46be95,0xbf62bf7f,0x3f223f75,0xbef13dc9
.long 0x3f0e3e48,0x3f7b3f55,0xbf0ebe48,0xbf7bbf55,0xbe95bdc9,0xbf22bef1,0xbf75bf7f,0xbf46bf62
.long 0x0,0x0,0x0,0x0,0xbf62bf46,0xbf7fbf75,0xbef1bf22,0xbdc9be95
.long 0x3f553f7b,0x3e483f0e,0xbf55bf7b,0xbe48bf0e,0x3dc9bef1,0x3f753f22,0xbf7fbf62,0xbe95bf46
.long 0xbf6dbec4,0xbec4bf6d,0xbf6dbec4,0xbec4bf6d,0x3f463f75,0xbf62bdc9,0xbf223e95,0xbef1bf7f
.long 0x3e48bf55,0x3f0e3f7b,0xbe483f55,0xbf0ebf7b,0xbf753dc9,0x3f46bef1,0x3e953f7f,0xbf22bf62
.long 0x3f353f35,0xbf35bf35,0x3f353f35,0xbf35bf35,0x3e95bf7f,0xbf223f62,0x3f753dc9,0xbf46bef1
.long 0xbf7b3f0e,0x3f553e48,0x3f7bbf0e,0xbf55be48,0x3f223e95,0x3ef1bf7f,0x3f46bf75,0xbf623dc9
.long 0x3ec4bf6d,0xbf6d3ec4,0x3ec4bf6d,0xbf6d3ec4,0xbf7f3f62,0xbe953f46,0xbdc9bef1,0xbf753f22
.long 0x3f0ebe48,0x3f7bbf55,0xbf0e3e48,0xbf7b3f55,0x3ef1bf22,0x3dc9be95,0xbf623f46,0xbf7f3f75
.long 0xbf803f80,0xbf803f80,0xbf803f80,0xbf803f80,0x3ef1bf22,0x3dc9be95,0xbf623f46,0xbf7f3f75
.long 0x3f0ebe48,0x3f7bbf55,0xbf0e3e48,0xbf7b3f55,0xbf7f3f62,0xbe953f46,0xbdc9bef1,0xbf753f22
.long 0x3ec4bf6d,0xbf6d3ec4,0x3ec4bf6d,0xbf6d3ec4,0x3f223e95,0x3ef1bf7f,0x3f46bf75,0xbf623dc9
.long 0xbf7b3f0e,0x3f553e48,0x3f7bbf0e,0xbf55be48,0x3e95bf7f,0xbf223f62,0x3f753dc9,0xbf46bef1
.long 0x3f353f35,0xbf35bf35,0x3f353f35,0xbf35bf35,0xbf753dc9,0x3f46bef1,0x3e953f7f,0xbf22bf62
.long 0x3e48bf55,0x3f0e3f7b,0xbe483f55,0xbf0ebf7b,0x3f463f75,0xbf62bdc9,0xbf223e95,0xbef1bf7f
.long 0xbf6dbec4,0xbec4bf6d,0xbf6dbec4,0xbec4bf6d,0x3dc9bef1,0x3f753f22,0xbf7fbf62,0xbe95bf46
.long 0x3f553f7b,0x3e483f0e,0xbf55bf7b,0xbe48bf0e,0xbf62bf46,0xbf7fbf75,0xbef1bf22,0xbdc9be95
.long 0x80008000,0x80008000,0x80008000,0x80008000,0xbe95bdc9,0xbf22bef1,0xbf75bf7f,0xbf46bf62
.long 0xbf0ebe48,0xbf7bbf55,0x3f0e3e48,0x3f7b3f55,0xbf46be95,0xbf62bf7f,0x3f223f75,0xbef13dc9
.long 0xbf6dbec4,0xbec4bf6d,0xbf6dbec4,0xbec4bf6d,0xbf7fbef1,0x3e95bf22,0xbdc9bf62,0x3f753f46
.long 0xbf7bbf0e,0x3f55be48,0x3f7b3f0e,0xbf553e48,0xbf62bf22,0x3f7f3e95,0xbef13f46,0x3dc9bf75
.long 0xbf35bf35,0x3f353f35,0xbf35bf35,0x3f353f35,0xbef1bf46,0x3dc93f75,0x3f62bf22,0xbf7f3e95
.long 0xbe48bf55,0xbf0e3f7b,0x3e483f55,0x3f0ebf7b,0x3dc9bf62,0xbf753f46,0xbf7f3ef1,0x3e953f22
.long 0x3ec4bf6d,0xbf6d3ec4,0x3ec4bf6d,0xbf6d3ec4,0x3f22bf75,0xbef1bdc9,0x3f46be95,0x3f62bf7f
.long 0x3f55bf7b,0x3e48bf0e,0xbf553f7b,0xbe483f0e,0x3f75bf7f,0x3f46bf62,0xbe953dc9,0xbf223ef1
.long 0x3f80bf80,0x3f80bf80,0x3f80bf80,0x3f80bf80,0x3f75bf7f,0x3f46bf62,0xbe953dc9,0xbf223ef1
.long 0x3f55bf7b,0x3e48bf0e,0xbf553f7b,0xbe483f0e,0x3f22bf75,0xbef1bdc9,0x3f46be95,0x3f62bf7f
.long 0x3ec4bf6d,0xbf6d3ec4,0x3ec4bf6d,0xbf6d3ec4,0x3dc9bf62,0xbf753f46,0xbf7f3ef1,0x3e953f22
.long 0xbe48bf55,0xbf0e3f7b,0x3e483f55,0x3f0ebf7b,0xbef1bf46,0x3dc93f75,0x3f62bf22,0xbf7f3e95
.long 0xbf35bf35,0x3f353f35,0xbf35bf35,0x3f353f35,0xbf62bf22,0x3f7f3e95,0xbef13f46,0x3dc9bf75
.long 0xbf7bbf0e,0x3f55be48,0x3f7b3f0e,0xbf553e48,0xbf7fbef1,0x3e95bf22,0xbdc9bf62,0x3f753f46
.long 0xbf6dbec4,0xbec4bf6d,0xbf6dbec4,0xbec4bf6d,0xbf46be95,0xbf62bf7f,0x3f223f75,0xbef13dc9
.long 0xbf0ebe48,0xbf7bbf55,0x3f0e3e48,0x3f7b3f55,0xbe95bdc9,0xbf22bef1,0xbf75bf7f,0xbf46bf62
.long 0x80008000,0x80008000,0x80008000,0x80008000,0xbf62bf46,0xbf7fbf75,0xbef1bf22,0xbdc9be95
.long 0xbf55bf7b,0xbe48bf0e,0x3f553f7b,0x3e483f0e,0x3dc9bef1,0x3f753f22,0xbf7fbf62,0xbe95bf46
.long 0x3f6d3ec4,0x3ec43f6d,0x3f6d3ec4,0x3ec43f6d,0x3f463f75,0xbf62bdc9,0xbf223e95,0xbef1bf7f
.long 0xbe483f55,0xbf0ebf7b,0x3e48bf55,0x3f0e3f7b,0xbf753dc9,0x3f46bef1,0x3e953f7f,0xbf22bf62
.long 0xbf35bf35,0x3f353f35,0xbf35bf35,0x3f353f35,0x3e95bf7f,0xbf223f62,0x3f753dc9,0xbf46bef1
.long 0x3f7bbf0e,0xbf55be48,0xbf7b3f0e,0x3f553e48,0x3f223e95,0x3ef1bf7f,0x3f46bf75,0xbf623dc9
.long 0xbec43f6d,0x3f6dbec4,0xbec43f6d,0x3f6dbec4,0xbf7f3f62,0xbe953f46,0xbdc9bef1,0xbf753f22
.long 0xbf0e3e48,0xbf7b3f55,0x3f0ebe48,0x3f7bbf55,0x3ef1bf22,0x3dc9be95,0xbf623f46,0xbf7f3f75
.long 0x3f80bf80,0x3f80bf80,0x3f80bf80,0x3f80bf80,0x3ef1bf22,0x3dc9be95,0xbf623f46,0xbf7f3f75
.long 0xbf0e3e48,0xbf7b3f55,0x3f0ebe48,0x3f7bbf55,0xbf7f3f62,0xbe953f46,0xbdc9bef1,0xbf753f22
.long 0xbec43f6d,0x3f6dbec4,0xbec43f6d,0x3f6dbec4,0x3f223e95,0x3ef1bf7f,0x3f46bf75,0xbf623dc9
.long 0x3f7bbf0e,0xbf55be48,0xbf7b3f0e,0x3f553e48,0x3e95bf7f,0xbf223f62,0x3f753dc9,0xbf46bef1
.long 0xbf35bf35,0x3f353f35,0xbf35bf35,0x3f353f35,0xbf753dc9,0x3f46bef1,0x3e953f7f,0xbf22bf62
.long 0xbe483f55,0xbf0ebf7b,0x3e48bf55,0x3f0e3f7b,0x3f463f75,0xbf62bdc9,0xbf223e95,0xbef1bf7f
.long 0x3f6d3ec4,0x3ec43f6d,0x3f6d3ec4,0x3ec43f6d,0x3dc9bef1,0x3f753f22,0xbf7fbf62,0xbe95bf46
.long 0xbf55bf7b,0xbe48bf0e,0x3f553f7b,0x3e483f0e,0xbf62bf46,0xbf7fbf75,0xbef1bf22,0xbdc9be95
.long 0x80008000,0x80008000,0x80008000,0x80008000,0x3e953dc9,0x3f223ef1,0x3f753f7f,0x3f463f62
.long 0xbf0ebe48,0xbf7bbf55,0x3f0e3e48,0x3f7b3f55,0x3f463e95,0x3f623f7f,0xbf22bf75,0x3ef1bdc9
.long 0xbf6dbec4,0xbec4bf6d,0xbf6dbec4,0xbec4bf6d,0x3f7f3ef1,0xbe953f22,0x3dc93f62,0xbf75bf46
.long 0xbf7bbf0e,0x3f55be48,0x3f7b3f0e,0xbf553e48,0x3f623f22,0xbf7fbe95,0x3ef1bf46,0xbdc93f75
.long 0xbf35bf35,0x3f353f35,0xbf35bf35,0x3f353f35,0x3ef13f46,0xbdc9bf75,0xbf623f22,0x3f7fbe95
.long 0xbe48bf55,0xbf0e3f7b,0x3e483f55,0x3f0ebf7b,0xbdc93f62,0x3f75bf46,0x3f7fbef1,0xbe95bf22
.long 0x3ec4bf6d,0xbf6d3ec4,0x3ec4bf6d,0xbf6d3ec4,0xbf223f75,0x3ef13dc9,0xbf463e95,0xbf623f7f
.long 0x3f55bf7b,0x3e48bf0e,0xbf553f7b,0xbe483f0e,0xbf753f7f,0xbf463f62,0x3e95bdc9,0x3f22bef1
.long 0x3f80bf80,0x3f80bf80,0x3f80bf80,0x3f80bf80,0xbf753f7f,0xbf463f62,0x3e95bdc9,0x3f22bef1
.long 0x3f55bf7b,0x3e48bf0e,0xbf553f7b,0xbe483f0e,0xbf223f75,0x3ef13dc9,0xbf463e95,0xbf623f7f
.long 0x3ec4bf6d,0xbf6d3ec4,0x3ec4bf6d,0xbf6d3ec4,0xbdc93f62,0x3f75bf46,0x3f7fbef1,0xbe95bf22
.long 0xbe48bf55,0xbf0e3f7b,0x3e483f55,0x3f0ebf7b,0x3ef13f46,0xbdc9bf75,0xbf623f22,0x3f7fbe95
.long 0xbf35bf35,0x3f353f35,0xbf35bf35,0x3f353f35,0x3f623f22,0xbf7fbe95,0x3ef1bf46,0xbdc93f75
.long 0xbf7bbf0e,0x3f55be48,0x3f7b3f0e,0xbf553e48,0x3f7f3ef1,0xbe953f22,0x3dc93f62,0xbf75bf46
.long 0xbf6dbec4,0xbec4bf6d,0xbf6dbec4,0xbec4bf6d,0x3f463e95,0x3f623f7f,0xbf22bf75,0x3ef1bdc9
.long 0xbf0ebe48,0xbf7bbf55,0x3f0e3e48,0x3f7b3f55,0x3e953dc9,0x3f223ef1,0x3f753f7f,0x3f463f62
.long 0x80008000,0x80008000,0x80008000,0x80008000,0x3f623f46,0x3f7f3f75,0x3ef13f22,0x3dc93e95
.long 0xbf55bf7b,0xbe48bf0e,0x3f553f7b,0x3e483f0e,0xbdc93ef1,0xbf75bf22,0x3f7f3f62,0x3e953f46
.long 0x3f6d3ec4,0x3ec43f6d,0x3f6d3ec4,0x3ec43f6d,0xbf46bf75,0x3f623dc9,0x3f22be95,0x3ef13f7f
.long 0xbe483f55,0xbf0ebf7b,0x3e48bf55,0x3f0e3f7b,0x3f75bdc9,0xbf463ef1,0xbe95bf7f,0x3f223f62
.long 0xbf35bf35,0x3f353f35,0xbf35bf35,0x3f353f35,0xbe953f7f,0x3f22bf62,0xbf75bdc9,0x3f463ef1
.long 0x3f7bbf0e,0xbf55be48,0xbf7b3f0e,0x3f553e48,0xbf22be95,0xbef13f7f,0xbf463f75,0x3f62bdc9
.long 0xbec43f6d,0x3f6dbec4,0xbec43f6d,0x3f6dbec4,0x3f7fbf62,0x3e95bf46,0x3dc93ef1,0x3f75bf22
.long 0xbf0e3e48,0xbf7b3f55,0x3f0ebe48,0x3f7bbf55,0xbef13f22,0xbdc93e95,0x3f62bf46,0x3f7fbf75
.long 0x3f80bf80,0x3f80bf80,0x3f80bf80,0x3f80bf80,0xbef13f22,0xbdc93e95,0x3f62bf46,0x3f7fbf75
.long 0xbf0e3e48,0xbf7b3f55,0x3f0ebe48,0x3f7bbf55,0x3f7fbf62,0x3e95bf46,0x3dc93ef1,0x3f75bf22
.long 0xbec43f6d,0x3f6dbec4,0xbec43f6d,0x3f6dbec4,0xbf22be95,0xbef13f7f,0xbf463f75,0x3f62bdc9
.long 0x3f7bbf0e,0xbf55be48,0xbf7b3f0e,0x3f553e48,0xbe953f7f,0x3f22bf62,0xbf75bdc9,0x3f463ef1
.long 0xbf35bf35,0x3f353f35,0xbf35bf35,0x3f353f35,0x3f75bdc9,0xbf463ef1,0xbe95bf7f,0x3f223f62
.long 0xbe483f55,0xbf0ebf7b,0x3e48bf55,0x3f0e3f7b,0xbf46bf75,0x3f623dc9,0x3f22be95,0x3ef13f7f
.long 0x3f6d3ec4,0x3ec43f6d,0x3f6d3ec4,0x3ec43f6d,0xbdc93ef1,0xbf75bf22,0x3f7f3f62,0x3e953f46
.long 0xbf55bf7b,0xbe48bf0e,0x3f553f7b,0x3e483f0e,0x3f623f46,0x3f7f3f75,0x3ef13f22,0x3dc93e95
.long 0x3f800000,0x3f800000,0x0,0x0,0x3f800000,0x3f7fffb1,0x0,0x3b490fc6
.long 0x3f800000,0x3f7ffec4,0x0,0x3bc90f88,0x3f800000,0x3f7ffd39,0x0,0x3c16cb58
.long 0x3f800000,0x3f7ffb11,0x0,0x3c490e90,0x3f800000,0x3f7ff84a,0x0,0x3c7b514b
.long 0x3f800000,0x3f7ff4e6,0x0,0x3c96c9b6,0x3f800000,0x3f7ff0e3,0x0,0x3cafea69
.long 0x3f800000,0x3f7fec43,0x0,0x3cc90ab0,0x3f800000,0x3f7fe705,0x0,0x3ce22a7a
.long 0x3f800000,0x3f7fe129,0x0,0x3cfb49ba,0x3f800000,0x3f7fdaaf,0x0,0x3d0a342f
.long 0x3f800000,0x3f7fd397,0x0,0x3d16c32c,0x3f800000,0x3f7fcbe2,0x0,0x3d2351cb
.long 0x3f800000,0x3f7fc38f,0x0,0x3d2fe007,0x3f800000,0x3f7fba9e,0x0,0x3d3c6dd5
.long 0x3f800000,0x3f7fb10f,0x0,0x3d48fb30,0x3f800000,0x3f7fa6e3,0x0,0x3d55880e
.long 0x3f800000,0x3f7f9c18,0x0,0x3d621469,0x3f800000,0x3f7f90b1,0x0,0x3d6ea038
.long 0x3f800000,0x3f7f84ab,0x0,0x3d7b2b74,0x3f800000,0x3f7f7808,0x0,0x3d83db0a
.long 0x3f800000,0x3f7f6ac7,0x0,0x3d8a200a,0x3f800000,0x3f7f5ce9,0x0,0x3d9064b4
.long 0x3f800000,0x3f7f4e6d,0x0,0x3d96a905,0x3f800000,0x3f7f3f54,0x0,0x3d9cecf9
.long 0x3f800000,0x3f7f2f9d,0x0,0x3da3308c,0x3f800000,0x3f7f1f49,0x0,0x3da973ba
.long 0x3f800000,0x3f7f0e58,0x0,0x3dafb680,0x3f800000,0x3f7efcc9,0x0,0x3db5f8da
.long 0x3f800000,0x3f7eea9d,0x0,0x3dbc3ac3,0x3f800000,0x3f7ed7d4,0x0,0x3dc27c39
.long 0x3f800000,0x3f800000,0x0,0x0,0x3f7ffb11,0x3f7ff84a,0x3c490e90,0x3c7b514b
.long 0x3f7fec43,0x3f7fe129,0x3cc90ab0,0x3cfb49ba,0x3f7fd397,0x3f7fba9e,0x3d16c32c,0x3d3c6dd5
.long 0x3f7fb10f,0x3f7f84ab,0x3d48fb30,0x3d7b2b74,0x3f7f84ab,0x3f7f3f54,0x3d7b2b74,0x3d9cecf9
.long 0x3f7f4e6d,0x3f7eea9d,0x3d96a905,0x3dbc3ac3,0x3f7f0e58,0x3f7e868b,0x3dafb680,0x3ddb7d37
.long 0x3f7ec46d,0x3f7e1324,0x3dc8bd36,0x3dfab273,0x3f7e70b0,0x3f7d906e,0x3de1bc2e,0x3e0cec4a
.long 0x3f7e1324,0x3f7cfe73,0x3dfab273,0x3e1c76de,0x3f7dabcc,0x3f7c5d3a,0x3e09cf86,0x3e2bf804
.long 0x3f7d3aac,0x3f7baccd,0x3e164083,0x3e3b6ecf,0x3f7cbfc9,0x3f7aed37,0x3e22abb6,0x3e4ada4f
.long 0x3f7c3b28,0x3f7a1e84,0x3e2f10a2,0x3e5a3997,0x3f7baccd,0x3f7940c0,0x3e3b6ecf,0x3e698bba
.long 0x3f7b14be,0x3f7853f8,0x3e47c5c2,0x3e78cfcc,0x3f7a7302,0x3f77583a,0x3e541501,0x3e840270
.long 0x3f79c79d,0x3f764d97,0x3e605c13,0x3e8b9507,0x3f791298,0x3f75341d,0x3e6c9a7f,0x3e931f35
.long 0x3f7853f8,0x3f740bdd,0x3e78cfcc,0x3e9aa086,0x3f778bc5,0x3f72d4eb,0x3e827dc0,0x3ea21887
.long 0x3f76ba07,0x3f718f57,0x3e888e93,0x3ea986c4,0x3f75dec6,0x3f703b37,0x3e8e9a22,0x3eb0eacb
.long 0x3f74fa0b,0x3f6ed89e,0x3e94a031,0x3eb8442a,0x3f740bdd,0x3f6d67a1,0x3e9aa086,0x3ebf926f
.long 0x3f731447,0x3f6be858,0x3ea09ae5,0x3ec6d529,0x3f721352,0x3f6a5ad9,0x3ea68f12,0x3ece0bea
.long 0x3f710908,0x3f68bf3c,0x3eac7cd4,0x3ed53641,0x3f6ff573,0x3f671599,0x3eb263ef,0x3edc53c1
.long 0x3f6ed89e,0x3f655e0b,0x3eb8442a,0x3ee363fa,0x3f6db293,0x3f6398ac,0x3ebe1d4a,0x3eea6681
.long 0x3f800000,0x3f800000,0x0,0x0,0x3f7ffec4,0x3f7ffd39,0x3bc90f88,0x3c16cb58
.long 0x3f7ffb11,0x3f7ff4e6,0x3c490e90,0x3c96c9b6,0x3f7ff4e6,0x3f7fe705,0x3c96c9b6,0x3ce22a7a
.long 0x3f7fec43,0x3f7fd397,0x3cc90ab0,0x3d16c32c,0x3f7fe129,0x3f7fba9e,0x3cfb49ba,0x3d3c6dd5
.long 0x3f7fd397,0x3f7f9c18,0x3d16c32c,0x3d621469,0x3f7fc38f,0x3f7f7808,0x3d2fe007,0x3d83db0a
.long 0x3f7fb10f,0x3f7f4e6d,0x3d48fb30,0x3d96a905,0x3f7f9c18,0x3f7f1f49,0x3d621469,0x3da973ba
.long 0x3f7f84ab,0x3f7eea9d,0x3d7b2b74,0x3dbc3ac3,0x3f7f6ac7,0x3f7eb069,0x3d8a200a,0x3dcefdb7
.long 0x3f7f4e6d,0x3f7e70b0,0x3d96a905,0x3de1bc2e,0x3f7f2f9d,0x3f7e2b72,0x3da3308c,0x3df475c0
.long 0x3f7f0e58,0x3f7de0b1,0x3dafb680,0x3e039502,0x3f7eea9d,0x3f7d906e,0x3dbc3ac3,0x3e0cec4a
.long 0x3f7ec46d,0x3f7d3aac,0x3dc8bd36,0x3e164083,0x3f7e9bc9,0x3f7cdf6c,0x3dd53db9,0x3e1f917b
.long 0x3f7e70b0,0x3f7c7eb0,0x3de1bc2e,0x3e28defc,0x3f7e4323,0x3f7c187a,0x3dee3876,0x3e3228d4
.long 0x3f7e1324,0x3f7baccd,0x3dfab273,0x3e3b6ecf,0x3f7de0b1,0x3f7b3bab,0x3e039502,0x3e44b0b9
.long 0x3f7dabcc,0x3f7ac516,0x3e09cf86,0x3e4dee60,0x3f7d7474,0x3f7a4910,0x3e1008b7,0x3e57278f
.long 0x3f7d3aac,0x3f79c79d,0x3e164083,0x3e605c13,0x3f7cfe73,0x3f7940c0,0x3e1c76de,0x3e698bba
.long 0x3f7cbfc9,0x3f78b47b,0x3e22abb6,0x3e72b651,0x3f7c7eb0,0x3f7822d1,0x3e28defc,0x3e7bdba4
.long 0x3f7c3b28,0x3f778bc5,0x3e2f10a2,0x3e827dc0,0x3f7bf531,0x3f76ef5b,0x3e354098,0x3e870ada
.long 0x3f7baccd,0x3f764d97,0x3e3b6ecf,0x3e8b9507,0x3f7b61fc,0x3f75a67b,0x3e419b37,0x3e901c2c
.long 0x3f800000,0x3f800000,0x0,0x0,0x3f7ff4e6,0x3f7ff0e3,0x3c96c9b6,0x3cafea69
.long 0x3f7fd397,0x3f7fc38f,0x3d16c32c,0x3d2fe007,0x3f7f9c18,0x3f7f7808,0x3d621469,0x3d83db0a
.long 0x3f7f4e6d,0x3f7f0e58,0x3d96a905,0x3dafb680,0x3f7eea9d,0x3f7e868b,0x3dbc3ac3,0x3ddb7d37
.long 0x3f7e70b0,0x3f7de0b1,0x3de1bc2e,0x3e039502,0x3f7de0b1,0x3f7d1cdd,0x3e039502,0x3e195be0
.long 0x3f7d3aac,0x3f7c3b28,0x3e164083,0x3e2f10a2,0x3f7c7eb0,0x3f7b3bab,0x3e28defc,0x3e44b0b9
.long 0x3f7baccd,0x3f7a1e84,0x3e3b6ecf,0x3e5a3997,0x3f7ac516,0x3f78e3d6,0x3e4dee60,0x3e6fa8b2
.long 0x3f79c79d,0x3f778bc5,0x3e605c13,0x3e827dc0,0x3f78b47b,0x3f76167a,0x3e72b651,0x3e8d17c0
.long 0x3f778bc5,0x3f748422,0x3e827dc0,0x3e97a117,0x3f764d97,0x3f72d4eb,0x3e8b9507,0x3ea21887
.long 0x3f74fa0b,0x3f710908,0x3e94a031,0x3eac7cd4,0x3f73913f,0x3f6f20b0,0x3e9d9e78,0x3eb6ccc3
.long 0x3f721352,0x3f6d1c1d,0x3ea68f12,0x3ec1071e,0x3f708066,0x3f6afb8c,0x3eaf713a,0x3ecb2aae
.long 0x3f6ed89e,0x3f68bf3c,0x3eb8442a,0x3ed53641,0x3f6d1c1d,0x3f666771,0x3ec1071e,0x3edf28a9
.long 0x3f6b4b0c,0x3f63f473,0x3ec9b953,0x3ee900b7,0x3f696591,0x3f61668a,0x3ed25a09,0x3ef2bd43
.long 0x3f676bd8,0x3f5ebe05,0x3edae880,0x3efc5d27,0x3f655e0b,0x3f5bfb34,0x3ee363fa,0x3f02ef9f
.long 0x3f633c5a,0x3f591e6a,0x3eebcbbb,0x3f07a136,0x3f6106f2,0x3f5627fe,0x3ef41f07,0x3f0c42c9
.long 0x3f5ebe05,0x3f531849,0x3efc5d27,0x3f10d3cd,0x3f5c61c7,0x3f4fefa8,0x3f0242b1,0x3f1553b7
.long 0x3f59f26a,0x3f4cae79,0x3f064b82,0x3f19c200,0x3f577026,0x3f495521,0x3f0a48ad,0x3f1e1e22
.long 0x3f800000,0x3f800000,0x0,0x0,0x3f7fec43,0x3f7fe705,0x3cc90ab0,0x3ce22a7a
.long 0x3f7fb10f,0x3f7f9c18,0x3d48fb30,0x3d621469,0x3f7f4e6d,0x3f7f1f49,0x3d96a905,0x3da973ba
.long 0x3f7ec46d,0x3f7e70b0,0x3dc8bd36,0x3de1bc2e,0x3f7e1324,0x3f7d906e,0x3dfab273,0x3e0cec4a
.long 0x3f7d3aac,0x3f7c7eb0,0x3e164083,0x3e28defc,0x3f7c3b28,0x3f7b3bab,0x3e2f10a2,0x3e44b0b9
.long 0x3f7b14be,0x3f79c79d,0x3e47c5c2,0x3e605c13,0x3f79c79d,0x3f7822d1,0x3e605c13,0x3e7bdba4
.long 0x3f7853f8,0x3f764d97,0x3e78cfcc,0x3e8b9507,0x3f76ba07,0x3f74484b,0x3e888e93,0x3e9920fe
.long 0x3f74fa0b,0x3f721352,0x3e94a031,0x3ea68f12,0x3f731447,0x3f6faf1b,0x3ea09ae5,0x3eb3dca5
.long 0x3f710908,0x3f6d1c1d,0x3eac7cd4,0x3ec1071e,0x3f6ed89e,0x3f6a5ad9,0x3eb8442a,0x3ece0bea
.long 0x3f6c835e,0x3f676bd8,0x3ec3ef15,0x3edae880,0x3f6a09a7,0x3f644fac,0x3ecf7bca,0x3ee79a5d
.long 0x3f676bd8,0x3f6106f2,0x3edae880,0x3ef41f07,0x3f64aa59,0x3f5d924d,0x3ee63375,0x3f003a06
.long 0x3f61c598,0x3f59f26a,0x3ef15aea,0x3f064b82,0x3f5ebe05,0x3f5627fe,0x3efc5d27,0x3f0c42c9
.long 0x3f5b941a,0x3f5233c6,0x3f039c3d,0x3f121eb0,0x3f584853,0x3f4e1689,0x3f08f59b,0x3f17de12
.long 0x3f54db31,0x3f49d112,0x3f0e39da,0x3f1d7fd1,0x3f514d3d,0x3f456439,0x3f13682a,0x3f2302d3
.long 0x3f4d9f02,0x3f40d0da,0x3f187fc0,0x3f286605,0x3f49d112,0x3f3c17d9,0x3f1d7fd1,0x3f2da859
.long 0x3f45e403,0x3f373a23,0x3f226799,0x3f32c8c9,0x3f41d870,0x3f3238aa,0x3f273656,0x3f37c655
.long 0x3f3daef9,0x3f2d1469,0x3f2beb4a,0x3f3ca003,0x3f396842,0x3f27ce61,0x3f3085bb,0x3f4154e1
.long 0x3f800000,0x3f800000,0x0,0x0,0x3f7fd397,0x3f7fcbe2,0x3d16c32c,0x3d2351cb
.long 0x3f7f4e6d,0x3f7f2f9d,0x3d96a905,0x3da3308c,0x3f7e70b0,0x3f7e2b72,0x3de1bc2e,0x3df475c0
.long 0x3f7d3aac,0x3f7cbfc9,0x3e164083,0x3e22abb6,0x3f7baccd,0x3f7aed37,0x3e3b6ecf,0x3e4ada4f
.long 0x3f79c79d,0x3f78b47b,0x3e605c13,0x3e72b651,0x3f778bc5,0x3f76167a,0x3e827dc0,0x3e8d17c0
.long 0x3f74fa0b,0x3f731447,0x3e94a031,0x3ea09ae5,0x3f721352,0x3f6faf1b,0x3ea68f12,0x3eb3dca5
.long 0x3f6ed89e,0x3f6be858,0x3eb8442a,0x3ec6d529,0x3f6b4b0c,0x3f67c187,0x3ec9b953,0x3ed97cb9
.long 0x3f676bd8,0x3f633c5a,0x3edae880,0x3eebcbbb,0x3f633c5a,0x3f5e5aa6,0x3eebcbbb,0x3efdbabb
.long 0x3f5ebe05,0x3f591e6a,0x3efc5d27,0x3f07a136,0x3f59f26a,0x3f5389c7,0x3f064b82,0x3f102dd5
.long 0x3f54db31,0x3f4d9f02,0x3f0e39da,0x3f187fc0,0x3f4f7a1f,0x3f476085,0x3f15f6d9,0x3f209393
.long 0x3f49d112,0x3f40d0da,0x3f1d7fd1,0x3f286605,0x3f43e200,0x3f39f2ac,0x3f24d225,0x3f2ff3e6
.long 0x3f3daef9,0x3f32c8c9,0x3f2beb4a,0x3f373a23,0x3f373a23,0x3f2b561b,0x3f32c8c9,0x3f3e35c5
.long 0x3f3085bb,0x3f239da9,0x3f396842,0x3f44e3f5,0x3f299415,0x3f1ba299,0x3f3fc767,0x3f4b41fa
.long 0x3f226799,0x3f13682a,0x3f45e403,0x3f514d3d,0x3f1b02c6,0x3f0af1b7,0x3f4bbbf8,0x3f570348
.long 0x3f13682a,0x3f0242b1,0x3f514d3d,0x3f5c61c7,0x3f0b9a6b,0x3ef2bd43,0x3f5695e5,0x3f61668a
.long 0x3f039c3d,0x3ee0924f,0x3f5b941a,0x3f660f88,0x3ef6e0cb,0x3ece0bea,0x3f604621,0x3f6a5ad9
.long 0x3ee63375,0x3ebb31a0,0x3f64aa59,0x3f6e46be,0x3ed53641,0x3ea80b1f,0x3f68bf3c,0x3f71d19f
.long 0x3f800000,0x3f800000,0x0,0x0,0x3f7fe129,0x3f7fdaaf,0x3cfb49ba,0x3d0a342f
.long 0x3f7f84ab,0x3f7f6ac7,0x3d7b2b74,0x3d8a200a,0x3f7eea9d,0x3f7eb069,0x3dbc3ac3,0x3dcefdb7
.long 0x3f7e1324,0x3f7dabcc,0x3dfab273,0x3e09cf86,0x3f7cfe73,0x3f7c5d3a,0x3e1c76de,0x3e2bf804
.long 0x3f7baccd,0x3f7ac516,0x3e3b6ecf,0x3e4dee60,0x3f7a1e84,0x3f78e3d6,0x3e5a3997,0x3e6fa8b2
.long 0x3f7853f8,0x3f76ba07,0x3e78cfcc,0x3e888e93,0x3f764d97,0x3f74484b,0x3e8b9507,0x3e9920fe
.long 0x3f740bdd,0x3f718f57,0x3e9aa086,0x3ea986c4,0x3f718f57,0x3f6e8ff8,0x3ea986c4,0x3eb9bb1e
.long 0x3f6ed89e,0x3f6b4b0c,0x3eb8442a,0x3ec9b953,0x3f6be858,0x3f67c187,0x3ec6d529,0x3ed97cb9
.long 0x3f68bf3c,0x3f63f473,0x3ed53641,0x3ee900b7,0x3f655e0b,0x3f5fe4e9,0x3ee363fa,0x3ef840c8
.long 0x3f61c598,0x3f5b941a,0x3ef15aea,0x3f039c3d,0x3f5df6be,0x3f570348,0x3eff17b2,0x3f0af1b7
.long 0x3f59f26a,0x3f5233c6,0x3f064b82,0x3f121eb0,0x3f55b993,0x3f4d26fd,0x3f0cead0,0x3f19210f
.long 0x3f514d3d,0x3f47de65,0x3f13682a,0x3f1ff6cb,0x3f4cae79,0x3f425b89,0x3f19c200,0x3f269de3
.long 0x3f47de65,0x3f3ca003,0x3f1ff6cb,0x3f2d1469,0x3f42de29,0x3f36ad7f,0x3f26050a,0x3f33587a
.long 0x3f3daef9,0x3f3085bb,0x3f2beb4a,0x3f396842,0x3f385216,0x3f2a2a80,0x3f31a81d,0x3f3f41fc
.long 0x3f32c8c9,0x3f239da9,0x3f373a23,0x3f44e3f5,0x3f2d1469,0x3f1ce11f,0x3f3ca003,0x3f4a4c87
.long 0x3f273656,0x3f15f6d9,0x3f41d870,0x3f4f7a1f,0x3f212ff9,0x3f0ee0db,0x3f46e22a,0x3f546b3b
.long 0x3f1b02c6,0x3f07a136,0x3f4bbbf8,0x3f591e6a,0x3f14b039,0x3f003a06,0x3f5064af,0x3f5d924d
.long 0x3f800000,0x3f800000,0x0,0x0,0x3f7fc38f,0x3f7fba9e,0x3d2fe007,0x3d3c6dd5
.long 0x3f7f0e58,0x3f7eea9d,0x3dafb680,0x3dbc3ac3,0x3f7de0b1,0x3f7d906e,0x3e039502,0x3e0cec4a
.long 0x3f7c3b28,0x3f7baccd,0x3e2f10a2,0x3e3b6ecf,0x3f7a1e84,0x3f7940c0,0x3e5a3997,0x3e698bba
.long 0x3f778bc5,0x3f764d97,0x3e827dc0,0x3e8b9507,0x3f748422,0x3f72d4eb,0x3e97a117,0x3ea21887
.long 0x3f710908,0x3f6ed89e,0x3eac7cd4,0x3eb8442a,0x3f6d1c1d,0x3f6a5ad9,0x3ec1071e,0x3ece0bea
.long 0x3f68bf3c,0x3f655e0b,0x3ed53641,0x3ee363fa,0x3f63f473,0x3f5fe4e9,0x3ee900b7,0x3ef840c8
.long 0x3f5ebe05,0x3f59f26a,0x3efc5d27,0x3f064b82,0x3f591e6a,0x3f5389c7,0x3f07a136,0x3f102dd5
.long 0x3f531849,0x3f4cae79,0x3f10d3cd,0x3f19c200,0x3f4cae79,0x3f456439,0x3f19c200,0x3f2302d3
.long 0x3f45e403,0x3f3daef9,0x3f226799,0x3f2beb4a,0x3f3ebc1b,0x3f3592e7,0x3f2ac082,0x3f34768f
.long 0x3f373a23,0x3f2d1469,0x3f32c8c9,0x3f3ca003,0x3f2f61a5,0x3f24381a,0x3f3a7ca4,0x3f446337
.long 0x3f273656,0x3f1b02c6,0x3f41d870,0x3f4bbbf8,0x3f1ebc12,0x3f11796b,0x3f48d8b3,0x3f52a649
.long 0x3f15f6d9,0x3f07a136,0x3f4f7a1f,0x3f591e6a,0x3f0cead0,0x3efafef7,0x3f55b993,0x3f5f20db
.long 0x3f039c3d,0x3ee63375,0x3f5b941a,0x3f64aa59,0x3ef41f07,0x3ed0eb2a,0x3f6106f2,0x3f69b7e4
.long 0x3ee0924f,0x3ebb31a0,0x3f660f88,0x3f6e46be,0x3ecc9b8b,0x3ea5129f,0x3f6aab7b,0x3f725470
.long 0x3eb8442a,0x3e8e9a22,0x3f6ed89e,0x3f75dec6,0x3ea395c5,0x3e6fa8b2,0x3f7294f8,0x3f78e3d6
.long 0x3e8e9a22,0x3e419b37,0x3f75dec6,0x3f7b61fc,0x3e72b651,0x3e1324ca,0x3f78b47b,0x3f7d57de
.long 0x3f800000,0x3f800000,0x0,0x0,0x3f7fb10f,0x3f7fa6e3,0x3d48fb30,0x3d55880e
.long 0x3f7ec46d,0x3f7e9bc9,0x3dc8bd36,0x3dd53db9,0x3f7d3aac,0x3f7cdf6c,0x3e164083,0x3e1f917b
.long 0x3f7b14be,0x3f7a7302,0x3e47c5c2,0x3e541501,0x3f7853f8,0x3f77583a,0x3e78cfcc,0x3e840270
.long 0x3f74fa0b,0x3f73913f,0x3e94a031,0x3e9d9e78,0x3f710908,0x3f6f20b0,0x3eac7cd4,0x3eb6ccc3
.long 0x3f6c835e,0x3f6a09a7,0x3ec3ef15,0x3ecf7bca,0x3f676bd8,0x3f644fac,0x3edae880,0x3ee79a5d
.long 0x3f61c598,0x3f5df6be,0x3ef15aea,0x3eff17b2,0x3f5b941a,0x3f570348,0x3f039c3d,0x3f0af1b7
.long 0x3f54db31,0x3f4f7a1f,0x3f0e39da,0x3f15f6d9,0x3f4d9f02,0x3f476085,0x3f187fc0,0x3f209393
.long 0x3f45e403,0x3f3ebc1b,0x3f226799,0x3f2ac082,0x3f3daef9,0x3f3592e7,0x3f2beb4a,0x3f34768f
.long 0x3f3504f3,0x3f2beb4a,0x3f3504f3,0x3f3daef9,0x3f2beb4a,0x3f21cbfb,0x3f3daef9,0x3f466354
.long 0x3f226799,0x3f173c07,0x3f45e403,0x3f4e8d90,0x3f187fc0,0x3f0c42c9,0x3f4d9f02,0x3f5627fe
.long 0x3f0e39da,0x3f00e7e4,0x3f54db31,0x3f5d2d53,0x3f039c3d,0x3eea6681,0x3f5b941a,0x3f6398ac
.long 0x3ef15aea,0x3ed25a09,0x3f61c598,0x3f696591,0x3edae880,0x3eb9bb1e,0x3f676bd8,0x3f6e8ff8
.long 0x3ec3ef15,0x3ea09ae5,0x3f6c835e,0x3f731447,0x3eac7cd4,0x3e870ada,0x3f710908,0x3f76ef5b
.long 0x3e94a031,0x3e5a3997,0x3f74fa0b,0x3f7a1e84,0x3e78cfcc,0x3e25c58c,0x3f7853f8,0x3f7c9f8a
.long 0x3e47c5c2,0x3de1bc2e,0x3f7b14be,0x3f7e70b0,0x3e164083,0x3d6ea038,0x3f7d3aac,0x3f7f90b1
.long 0x3dc8bd36,0x3bc90f88,0x3f7ec46d,0x3f7ffec4,0x3d48fb30,0xbd3c6dd5,0x3f7fb10f,0x3f7fba9e
.long 0x3f800000,0x3f800000,0x0,0x0,0x3f7f84ab,0x3f7f7808,0x3d7b2b74,0x3d83db0a
.long 0x3f7e1324,0x3f7de0b1,0x3dfab273,0x3e039502,0x3f7baccd,0x3f7b3bab,0x3e3b6ecf,0x3e44b0b9
.long 0x3f7853f8,0x3f778bc5,0x3e78cfcc,0x3e827dc0,0x3f740bdd,0x3f72d4eb,0x3e9aa086,0x3ea21887
.long 0x3f6ed89e,0x3f6d1c1d,0x3eb8442a,0x3ec1071e,0x3f68bf3c,0x3f666771,0x3ed53641,0x3edf28a9
.long 0x3f61c598,0x3f5ebe05,0x3ef15aea,0x3efc5d27,0x3f59f26a,0x3f5627fe,0x3f064b82,0x3f0c42c9
.long 0x3f514d3d,0x3f4cae79,0x3f13682a,0x3f19c200,0x3f47de65,0x3f425b89,0x3f1ff6cb,0x3f269de3
.long 0x3f3daef9,0x3f373a23,0x3f2beb4a,0x3f32c8c9,0x3f32c8c9,0x3f2b561b,0x3f373a23,0x3f3e35c5
.long 0x3f273656,0x3f1ebc12,0x3f41d870,0x3f48d8b3,0x3f1b02c6,0x3f11796b,0x3f4bbbf8,0x3f52a649
.long 0x3f0e39da,0x3f039c3d,0x3f54db31,0x3f5b941a,0x3f00e7e4,0x3eea6681,0x3f5d2d53,0x3f6398ac
.long 0x3ee63375,0x3ecc9b8b,0x3f64aa59,0x3f6aab7b,0x3ec9b953,0x3eadf73c,0x3f6b4b0c,0x3f70c501
.long 0x3eac7cd4,0x3e8e9a22,0x3f710908,0x3f75dec6,0x3e8e9a22,0x3e5d4b1a,0x3f75dec6,0x3f79f35e
.long 0x3e605c13,0x3e1c76de,0x3f79c79d,0x3f7cfe73,0x3e22abb6,0x3db5f8da,0x3f7cbfc9,0x3f7efcc9
.long 0x3dc8bd36,0x3cc90ab0,0x3f7ec46d,0x3f7fec43,0x3d16c32c,0xbd2351cb,0x3f7fd397,0x3f7fcbe2
.long 0xbcc90ab0,0xbdd53db9,0x3f7fec43,0x3f7e9bc9,0xbdafb680,0xbe2bf804,0x3f7f0e58,0x3f7c5d3a
.long 0xbe164083,0xbe6c9a7f,0x3f7d3aac,0x3f791298,0xbe541501,0xbe9620d2,0x3f7a7302,0x3f74bf62
.long 0xbe888e93,0xbeb554ec,0x3f76ba07,0x3f6f6830,0xbea68f12,0xbed3c867,0x3f721352,0x3f6912ae
.long 0x3f800000,0x3f800000,0x0,0x0,0x3f7f9c18,0x3f7f90b1,0x3d621469,0x3d6ea038
.long 0x3f7e70b0,0x3f7e4323,0x3de1bc2e,0x3dee3876,0x3f7c7eb0,0x3f7c187a,0x3e28defc,0x3e3228d4
.long 0x3f79c79d,0x3f791298,0x3e605c13,0x3e6c9a7f,0x3f764d97,0x3f75341d,0x3e8b9507,0x3e931f35
.long 0x3f721352,0x3f708066,0x3ea68f12,0x3eaf713a,0x3f6d1c1d,0x3f6afb8c,0x3ec1071e,0x3ecb2aae
.long 0x3f676bd8,0x3f64aa59,0x3edae880,0x3ee63375,0x3f6106f2,0x3f5d924d,0x3ef41f07,0x3f003a06
.long 0x3f59f26a,0x3f55b993,0x3f064b82,0x3f0cead0,0x3f5233c6,0x3f4d26fd,0x3f121eb0,0x3f19210f
.long 0x3f49d112,0x3f43e200,0x3f1d7fd1,0x3f24d225,0x3f40d0da,0x3f39f2ac,0x3f286605,0x3f2ff3e6
.long 0x3f373a23,0x3f2f61a5,0x3f32c8c9,0x3f3a7ca4,0x3f2d1469,0x3f24381a,0x3f3ca003,0x3f446337
.long 0x3f226799,0x3f187fc0,0x3f45e403,0x3f4d9f02,0x3f173c07,0x3f0c42c9,0x3f4e8d90,0x3f5627fe
.long 0x3f0b9a6b,0x3eff17b2,0x3f5695e5,0x3f5df6be,0x3eff17b2,0x3ee4cbfe,0x3f5df6be,0x3f650479
.long 0x3ee63375,0x3ec9b953,0x3f64aa59,0x3f6b4b0c,0x3ecc9b8b,0x3eadf73c,0x3f6aab7b,0x3f70c501
.long 0x3eb263ef,0x3e919ddd,0x3f6ff573,0x3f756d97,0x3e97a117,0x3e698bba,0x3f748422,0x3f7940c0
.long 0x3e78cfcc,0x3e2f10a2,0x3f7853f8,0x3f7c3b28,0x3e419b37,0x3de7fa9a,0x3f7b61fc,0x3f7e5a38
.long 0x3e09cf86,0x3d621469,0x3f7dabcc,0x3f7f9c18,0x3da3308c,0xbb490fc6,0x3f7f2f9d,0x3f7fffb1
.long 0x3cc90ab0,0xbd7b2b74,0x3f7fec43,0x3f7f84ab,0xbcfb49ba,0xbdf475c0,0x3f7fe129,0x3f7e2b72
.long 0xbdafb680,0xbe354098,0x3f7f0e58,0x3f7bf531,0xbe1008b7,0xbe6fa8b2,0x3f7d7474,0x3f78e3d6
.long 0x3f800000,0x3f800000,0x0,0x0,0x3f7f6ac7,0x3f7f5ce9,0x3d8a200a,0x3d9064b4
.long 0x3f7dabcc,0x3f7d7474,0x3e09cf86,0x3e1008b7,0x3f7ac516,0x3f7a4910,0x3e4dee60,0x3e57278f
.long 0x3f76ba07,0x3f75dec6,0x3e888e93,0x3e8e9a22,0x3f718f57,0x3f703b37,0x3ea986c4,0x3eb0eacb
.long 0x3f6b4b0c,0x3f696591,0x3ec9b953,0x3ed25a09,0x3f63f473,0x3f61668a,0x3ee900b7,0x3ef2bd43
.long 0x3f5b941a,0x3f584853,0x3f039c3d,0x3f08f59b,0x3f5233c6,0x3f4e1689,0x3f121eb0,0x3f17de12
.long 0x3f47de65,0x3f42de29,0x3f1ff6cb,0x3f26050a,0x3f3ca003,0x3f36ad7f,0x3f2d1469,0x3f33587a
.long 0x3f3085bb,0x3f299415,0x3f396842,0x3f3fc767,0x3f239da9,0x3f1ba299,0x3f44e3f5,0x3f4b41fa
.long 0x3f15f6d9,0x3f0cead0,0x3f4f7a1f,0x3f55b993,0x3f07a136,0x3efafef7,0x3f591e6a,0x3f5f20db
.long 0x3ef15aea,0x3edae880,0x3f61c598,0x3f676bd8,0x3ed25a09,0x3eb9bb1e,0x3f696591,0x3f6e8ff8
.long 0x3eb263ef,0x3e97a117,0x3f6ff573,0x3f748422,0x3e919ddd,0x3e698bba,0x3f756d97,0x3f7940c0
.long 0x3e605c13,0x3e22abb6,0x3f79c79d,0x3f7cbfc9,0x3e1c76de,0x3db5f8da,0x3f7cfe73,0x3f7efcc9
.long 0x3dafb680,0x3c96c9b6,0x3f7f0e58,0x3f7ff4e6,0x3c96c9b6,0xbd55880e,0x3f7ff4e6,0x3f7fa6e3
.long 0xbd48fb30,0xbdfab273,0x3f7fb10f,0x3f7e1324,0xbdee3876,0xbe44b0b9,0x3f7e4323,0x3f7b3bab
.long 0xbe3b6ecf,0xbe8586ce,0x3f7baccd,0x3f772417,0xbe7ee6e1,0xbea80b1f,0x3f77f110,0x3f71d19f
.long 0xbea09ae5,0xbec9b953,0x3f731447,0x3f6b4b0c,0xbec1071e,0xbeea6681,0x3f6d1c1d,0x3f6398ac
.long 0xbee0924f,0xbf04f484,0x3f660f88,0x3f5ac450,0xbeff17b2,0xbf140c5f,0x3f5df6be,0x3f50d937
.long 0x3f800000,0x3f800000,0x0,0x0,0x3f7f4e6d,0x3f7f3f54,0x3d96a905,0x3d9cecf9
.long 0x3f7d3aac,0x3f7cfe73,0x3e164083,0x3e1c76de,0x3f79c79d,0x3f7940c0,0x3e605c13,0x3e698bba
.long 0x3f74fa0b,0x3f740bdd,0x3e94a031,0x3e9aa086,0x3f6ed89e,0x3f6d67a1,0x3eb8442a,0x3ebf926f
.long 0x3f676bd8,0x3f655e0b,0x3edae880,0x3ee363fa,0x3f5ebe05,0x3f5bfb34,0x3efc5d27,0x3f02ef9f
.long 0x3f54db31,0x3f514d3d,0x3f0e39da,0x3f13682a,0x3f49d112,0x3f456439,0x3f1d7fd1,0x3f2302d3
.long 0x3f3daef9,0x3f385216,0x3f2beb4a,0x3f31a81d,0x3f3085bb,0x3f2a2a80,0x3f396842,0x3f3f41fc
.long 0x3f226799,0x3f1b02c6,0x3f45e403,0x3f4bbbf8,0x3f13682a,0x3f0af1b7,0x3f514d3d,0x3f570348
.long 0x3f039c3d,0x3ef41f07,0x3f5b941a,0x3f6106f2,0x3ee63375,0x3ed0eb2a,0x3f64aa59,0x3f69b7e4
.long 0x3ec3ef15,0x3eac7cd4,0x3f6c835e,0x3f710908,0x3ea09ae5,0x3e870ada,0x3f731447,0x3f76ef5b
.long 0x3e78cfcc,0x3e419b37,0x3f7853f8,0x3f7b61fc,0x3e2f10a2,0x3de7fa9a,0x3f7c3b28,0x3f7e5a38
.long 0x3dc8bd36,0x3d16c32c,0x3f7ec46d,0x3f7fd397,0x3cc90ab0,0xbd2351cb,0x3f7fec43,0x3f7fcbe2
.long 0xbd48fb30,0xbdee3876,0x3f7fb10f,0x3f7e4323,0xbdfab273,0xbe44b0b9,0x3f7e1324,0x3f7b3bab
.long 0xbe47c5c2,0xbe888e93,0x3f7b14be,0x3f76ba07,0xbe888e93,0xbeadf73c,0x3f76ba07,0x3f70c501
.long 0xbeac7cd4,0xbed25a09,0x3f710908,0x3f696591,0xbecf7bca,0xbef58035,0x3f6a09a7,0x3f60a6cf
.long 0xbef15aea,0xbf0b9a6b,0x3f61c598,0x3f5695e5,0xbf08f59b,0xbf1ba299,0x3f584853,0x3f4b41fa
.long 0xbf187fc0,0xbf2ac082,0x3f4d9f02,0x3f3ebc1b,0xbf273656,0xbf38dd65,0x3f41d870,0x3f311722
.long 0x3f800000,0x3f800000,0x0,0x0,0x3f7f0e58,0x3f7efcc9,0x3dafb680,0x3db5f8da
.long 0x3f7c3b28,0x3f7bf531,0x3e2f10a2,0x3e354098,0x3f778bc5,0x3f76ef5b,0x3e827dc0,0x3e870ada
.long 0x3f710908,0x3f6ff573,0x3eac7cd4,0x3eb263ef,0x3f68bf3c,0x3f671599,0x3ed53641,0x3edc53c1
.long 0x3f5ebe05,0x3f5c61c7,0x3efc5d27,0x3f0242b1,0x3f531849,0x3f4fefa8,0x3f10d3cd,0x3f1553b7
.long 0x3f45e403,0x3f41d870,0x3f226799,0x3f273656,0x3f373a23,0x3f3238aa,0x3f32c8c9,0x3f37c655
.long 0x3f273656,0x3f212ff9,0x3f41d870,0x3f46e22a,0x3f15f6d9,0x3f0ee0db,0x3f4f7a1f,0x3f546b3b
.long 0x3f039c3d,0x3ef6e0cb,0x3f5b941a,0x3f604621,0x3ee0924f,0x3ece0bea,0x3f660f88,0x3f6a5ad9
.long 0x3eb8442a,0x3ea395c5,0x3f6ed89e,0x3f7294f8,0x3e8e9a22,0x3e6fa8b2,0x3f75dec6,0x3f78e3d6
.long 0x3e47c5c2,0x3e164083,0x3f7b14be,0x3f7d3aac,0x3de1bc2e,0x3d6ea038,0x3f7e70b0,0x3f7f90b1
.long 0x3cc90ab0,0xbcfb49ba,0x3f7fec43,0x3f7fe129,0xbd7b2b74,0xbdf475c0,0x3f7f84ab,0x3f7e2b72
.long 0xbe164083,0xbe541501,0x3f7d3aac,0x3f7a7302,0xbe6c9a7f,0xbe9620d2,0x3f791298,0x3f74bf62
.long 0xbea09ae5,0xbec1071e,0x3f731447,0x3f6d1c1d,0xbec9b953,0xbeea6681,0x3f6b4b0c,0x3f6398ac
.long 0xbef15aea,0xbf08f59b,0x3f61c598,0x3f584853,0xbf0b9a6b,0xbf1ba299,0x3f5695e5,0x3f4b41fa
.long 0xbf1d7fd1,0xbf2d1469,0x3f49d112,0x3f3ca003,0xbf2e3bde,0xbf3d27b8,0x3f3b8f3b,0x3f2c800f
.long 0xbf3daef9,0xbf4bbbf8,0x3f2beb4a,0x3f1b02c6,0xbf4bbbf8,0xbf58b3a1,0x3f1b02c6,0x3f084b92
.long 0xbf584853,0xbf63f473,0x3f08f59b,0x3ee900b7,0xbf633c5a,0xbf6d67a1,0x3eebcbbb,0x3ebf926f
.long 0x3f800000,0x3f800000,0x0,0x0,0x3f7f2f9d,0x3f7f1f49,0x3da3308c,0x3da973ba
.long 0x3f7cbfc9,0x3f7c7eb0,0x3e22abb6,0x3e28defc,0x3f78b47b,0x3f7822d1,0x3e72b651,0x3e7bdba4
.long 0x3f731447,0x3f721352,0x3ea09ae5,0x3ea68f12,0x3f6be858,0x3f6a5ad9,0x3ec6d529,0x3ece0bea
.long 0x3f633c5a,0x3f6106f2,0x3eebcbbb,0x3ef41f07,0x3f591e6a,0x3f5627fe,0x3f07a136,0x3f0c42c9
.long 0x3f4d9f02,0x3f49d112,0x3f187fc0,0x3f1d7fd1,0x3f40d0da,0x3f3c17d9,0x3f286605,0x3f2da859
.long 0x3f32c8c9,0x3f2d1469,0x3f373a23,0x3f3ca003,0x3f239da9,0x3f1ce11f,0x3f44e3f5,0x3f4a4c87
.long 0x3f13682a,0x3f0b9a6b,0x3f514d3d,0x3f5695e5,0x3f0242b1,0x3ef2bd43,0x3f5c61c7,0x3f61668a
.long 0x3ee0924f,0x3ecc9b8b,0x3f660f88,0x3f6aab7b,0x3ebb31a0,0x3ea5129f,0x3f6e46be,0x3f725470
.long 0x3e94a031,0x3e78cfcc,0x3f74fa0b,0x3f7853f8,0x3e5a3997,0x3e25c58c,0x3f7a1e84,0x3f7c9f8a
.long 0x3e09cf86,0x3da3308c,0x3f7dabcc,0x3f7f2f9d,0x3d621469,0xbb490fc6,0x3f7f9c18,0x3f7fffb1
.long 0xbcc90ab0,0xbdafb680,0x3f7fec43,0x3f7f0e58,0xbdd53db9,0xbe2bf804,0x3f7e9bc9,0x3f7c5d3a
.long 0xbe3b6ecf,0xbe7ee6e1,0x3f7baccd,0x3f77f110,0xbe8586ce,0xbea80b1f,0x3f772417,0x3f71d19f
.long 0xbeac7cd4,0xbecf7bca,0x3f710908,0x3f6a09a7,0xbed25a09,0xbef58035,0x3f696591,0x3f60a6cf
.long 0xbef6e0cb,0xbf0cead0,0x3f604621,0x3f55b993,0xbf0cead0,0xbf1e1e22,0x3f55b993,0x3f495521
.long 0xbf1d7fd1,0xbf2e3bde,0x3f49d112,0x3f3b8f3b,0xbf2d1469,0xbf3d27b8,0x3f3ca003,0x3f2c800f
.long 0xbf3b8f3b,0xbf4ac77f,0x3f2e3bde,0x3f1c420c,0xbf48d8b3,0xbf570348,0x3f1ebc12,0x3f0af1b7
.long 0x3f800000,0x3f800000,0x0,0x0,0x3f7eea9d,0x3f7ed7d4,0x3dbc3ac3,0x3dc27c39
.long 0x3f7baccd,0x3f7b61fc,0x3e3b6ecf,0x3e419b37,0x3f764d97,0x3f75a67b,0x3e8b9507,0x3e901c2c
.long 0x3f6ed89e,0x3f6db293,0x3eb8442a,0x3ebe1d4a,0x3f655e0b,0x3f6398ac,0x3ee363fa,0x3eea6681
.long 0x3f59f26a,0x3f577026,0x3f064b82,0x3f0a48ad,0x3f4cae79,0x3f495521,0x3f19c200,0x3f1e1e22
.long 0x3f3daef9,0x3f396842,0x3f2beb4a,0x3f3085bb,0x3f2d1469,0x3f27ce61,0x3f3ca003,0x3f4154e1
.long 0x3f1b02c6,0x3f14b039,0x3f4bbbf8,0x3f5064af,0x3f07a136,0x3f003a06,0x3f591e6a,0x3f5d924d
.long 0x3ee63375,0x3ed53641,0x3f64aa59,0x3f68bf3c,0x3ebb31a0,0x3ea80b1f,0x3f6e46be,0x3f71d19f
.long 0x3e8e9a22,0x3e72b651,0x3f75dec6,0x3f78b47b,0x3e419b37,0x3e1324ca,0x3f7b61fc,0x3f7d57de
.long 0x3dc8bd36,0x3d48fb30,0x3f7ec46d,0x3f7fb10f,0x3bc90f88,0xbd3c6dd5,0x3f7ffec4,0x3f7fba9e
.long 0xbdafb680,0xbe1008b7,0x3f7f0e58,0x3f7d7474,0xbe354098,0xbe6fa8b2,0x3f7bf531,0x3f78e3d6
.long 0xbe888e93,0xbea68f12,0x3f76ba07,0x3f721352,0xbeb554ec,0xbed3c867,0x3f6f6830,0x3f6912ae
.long 0xbee0924f,0xbeff17b2,0x3f660f88,0x3f5df6be,0xbf04f484,0xbf140c5f,0x3f5ac450,0x3f50d937
.long 0xbf187fc0,0xbf273656,0x3f4d9f02,0x3f41d870,0xbf2ac082,0xbf38dd65,0x3f3ebc1b,0x3f311722
.long 0xbf3b8f3b,0xbf48d8b3,0x3f2e3bde,0x3f1ebc12,0xbf4ac77f,0xbf570348,0x3f1c420c,0x3f0af1b7
.long 0xbf584853,0xbf633c5a,0x3f08f59b,0x3eebcbbb,0xbf63f473,0xbf6d67a1,0x3ee900b7,0x3ebf926f
.long 0xbf6db293,0xbf756d97,0x3ebe1d4a,0x3e919ddd,0xbf756d97,0xbf7b3bab,0x3e919ddd,0x3e44b0b9
.long 0x3f800000,0x3f800000,0x0,0x0,0x3f7ec46d,0x3f7eb069,0x3dc8bd36,0x3dcefdb7
.long 0x3f7b14be,0x3f7ac516,0x3e47c5c2,0x3e4dee60,0x3f74fa0b,0x3f74484b,0x3e94a031,0x3e9920fe
.long 0x3f6c835e,0x3f6b4b0c,0x3ec3ef15,0x3ec9b953,0x3f61c598,0x3f5fe4e9,0x3ef15aea,0x3ef840c8
.long 0x3f54db31,0x3f5233c6,0x3f0e39da,0x3f121eb0,0x3f45e403,0x3f425b89,0x3f226799,0x3f269de3
.long 0x3f3504f3,0x3f3085bb,0x3f3504f3,0x3f396842,0x3f226799,0x3f1ce11f,0x3f45e403,0x3f4a4c87
.long 0x3f0e39da,0x3f07a136,0x3f54db31,0x3f591e6a,0x3ef15aea,0x3ee1fb6a,0x3f61c598,0x3f65b710
.long 0x3ec3ef15,0x3eb263ef,0x3f6c835e,0x3f6ff573,0x3e94a031,0x3e80f8c0,0x3f74fa0b,0x3f77beb7
.long 0x3e47c5c2,0x3e1c76de,0x3f7b14be,0x3f7cfe73,0x3dc8bd36,0x3d55880e,0x3f7ec46d,0x3f7fa6e3
.long 0x248d3132,0xbd48fb30,0x3f800000,0x3f7fb10f,0xbdc8bd36,0xbe195be0,0x3f7ec46d,0x3f7d1cdd
.long 0xbe47c5c2,0xbe7ee6e1,0x3f7b14be,0x3f77f110,0xbe94a031,0xbeb0eacb,0x3f74fa0b,0x3f703b37
.long 0xbec3ef15,0xbee0924f,0x3f6c835e,0x3f660f88,0xbef15aea,0xbf06f686,0x3f61c598,0x3f5988ad
.long 0xbf0e39da,0xbf1c420c,0x3f54db31,0x3f4ac77f,0xbf226799,0xbf2ff3e6,0x3f45e403,0x3f39f2ac
.long 0xbf3504f3,0xbf41d870,0x3f3504f3,0x3f273656,0xbf45e403,0xbf51c0c2,0x3f226799,0x3f12c39a
.long 0xbf54db31,0xbf5f8327,0x3f0e39da,0x3ef9a02d,0xbf61c598,0xbf6afb8c,0x3ef15aea,0x3ecb2aae
.long 0xbf6c835e,0xbf740bdd,0x3ec3ef15,0x3e9aa086,0xbf74fa0b,0xbf7a9c59,0x3e94a031,0x3e5101f1
.long 0xbf7b14be,0xbf7e9bc9,0x3e47c5c2,0x3dd53db9,0xbf7ec46d,0xbf7fffb1,0x3dc8bd36,0x3b490fc6
.long 0x3f800000,0x3f800000,0x0,0x0,0x3f7e70b0,0x3f7e5a38,0x3de1bc2e,0x3de7fa9a
.long 0x3f79c79d,0x3f796e4e,0x3e605c13,0x3e667c66,0x3f721352,0x3f714c7a,0x3ea68f12,0x3eab0201
.long 0x3f676bd8,0x3f660f88,0x3edae880,0x3ee0924f,0x3f59f26a,0x3f57dc7f,0x3f064b82,0x3f099f4e
.long 0x3f49d112,0x3f46e22a,0x3f1d7fd1,0x3f212ff9,0x3f373a23,0x3f33587a,0x3f32c8c9,0x3f36ad7f
.long 0x3f226799,0x3f1d7fd1,0x3f45e403,0x3f49d112,0x3f0b9a6b,0x3f05a02c,0x3f5695e5,0x3f5a5ba0
.long 0x3ee63375,0x3ed8106b,0x3f64aa59,0x3f6816a8,0x3eb263ef,0x3ea21887,0x3f6ff573,0x3f72d4eb
.long 0x3e78cfcc,0x3e541501,0x3f7853f8,0x3f7a7302,0x3e09cf86,0x3dc27c39,0x3f7dabcc,0x3f7ed7d4
.long 0x3cc90ab0,0xbc96c9b6,0x3f7fec43,0x3f7ff4e6,0xbdafb680,0xbe06b26e,0x3f7f0e58,0x3f7dc68c
.long 0xbe47c5c2,0xbe78cfcc,0x3f7b14be,0x3f7853f8,0xbe9aa086,0xbeb3dca5,0x3f740bdd,0x3f6faf1b
.long 0xbecf7bca,0xbee900b7,0x3f6a09a7,0x3f63f473,0xbf00e7e4,0xbf0d9281,0x3f5d2d53,0x3f554aa4
.long 0xbf187fc0,0xbf24d225,0x3f4d9f02,0x3f43e200,0xbf2e3bde,0xbf39f2ac,0x3f3b8f3b,0x3f2ff3e6
.long 0xbf41d870,0xbf4cae79,0x3f273656,0x3f19c200,0xbf531849,0xbf5cc7d1,0x3f10d3cd,0x3f019573
.long 0xbf61c598,0xbf6a09a7,0x3ef15aea,0x3ecf7bca,0xbf6db293,0xbf74484b,0x3ebe1d4a,0x3e9920fe
.long 0xbf76ba07,0xbf7b61fc,0x3e888e93,0x3e419b37,0xbf7cbfc9,0xbf7f3f54,0x3e22abb6,0x3d9cecf9
.long 0xbf7fb10f,0xbf7fd397,0x3d48fb30,0xbd16c32c,0xbf7f84ab,0xbf7d1cdd,0xbd7b2b74,0xbe195be0
.long 0xbf7c3b28,0xbf772417,0xbe2f10a2,0xbe8586ce,0xbf75dec6,0xbf6dfcf2,0xbe8e9a22,0xbebca7af
.long 0x3f800000,0x3f800000,0x0,0x0,0x3f7e9bc9,0x3f7e868b,0x3dd53db9,0x3ddb7d37
.long 0x3f7a7302,0x3f7a1e84,0x3e541501,0x3e5a3997,0x3f73913f,0x3f72d4eb,0x3e9d9e78,0x3ea21887
.long 0x3f6a09a7,0x3f68bf3c,0x3ecf7bca,0x3ed53641,0x3f5df6be,0x3f5bfb34,0x3eff17b2,0x3f02ef9f
.long 0x3f4f7a1f,0x3f4cae79,0x3f15f6d9,0x3f19c200,0x3f3ebc1b,0x3f3b0629,0x3f2ac082,0x3f2ecef7
.long 0x3f2beb4a,0x3f273656,0x3f3daef9,0x3f41d870,0x3f173c07,0x3f11796b,0x3f4e8d90,0x3f52a649
.long 0x3f00e7e4,0x3ef41f07,0x3f5d2d53,0x3f6106f2,0x3ed25a09,0x3ec27b55,0x3f696591,0x3f6cd007
.long 0x3ea09ae5,0x3e8e9a22,0x3f731447,0x3f75dec6,0x3e5a3997,0x3e3228d4,0x3f7a1e84,0x3f7c187a
.long 0x3de1bc2e,0x3d8a200a,0x3f7e70b0,0x3f7f6ac7,0x3bc90f88,0xbd2351cb,0x3f7ffec4,0x3f7fcbe2
.long 0xbdc8bd36,0xbe164083,0x3f7ec46d,0x3f7d3aac,0xbe4dee60,0xbe80f8c0,0x3f7ac516,0x3f77beb7
.long 0xbe9aa086,0xbeb554ec,0x3f740bdd,0x3f6f6830,0xbecc9b8b,0xbee79a5d,0x3f6aab7b,0x3f644fac
.long 0xbefc5d27,0xbf0b9a6b,0x3f5ebe05,0x3f5695e5,0xbf14b039,0xbf21cbfb,0x3f5064af,0x3f466354
.long 0xbf299415,0xbf36206c,0x3f3fc767,0x3f33e7bc,0xbf3ca003,0xbf485bca,0x3f2d1469,0x3f1f599f
.long 0xbf4d9f02,0xbf584853,0x3f187fc0,0x3f08f59b,0xbf5c61c7,0xbf65b710,0x3f0242b1,0x3ee1fb6a
.long 0xbf68bf3c,0xbf708066,0x3ed53641,0x3eaf713a,0xbf7294f8,0xbf788486,0x3ea395c5,0x3e75c35a
.long 0xbf79c79d,0xbf7dabcc,0x3e605c13,0x3e09cf86,0xbf7e4323,0xbf7fe705,0x3dee3876,0x3ce22a7a
.long 0xbf7ffb11,0xbf7f2f9d,0x3c490e90,0xbda3308c,0xbf7eea9d,0xbf7b87b2,0xbdbc3ac3,0xbe3e853e
.long 0x3f800000,0x3f800000,0x0,0x0,0x3f7e4323,0x3f7e2b72,0x3dee3876,0x3df475c0
.long 0x3f791298,0x3f78b47b,0x3e6c9a7f,0x3e72b651,0x3f708066,0x3f6faf1b,0x3eaf713a,0x3eb3dca5
.long 0x3f64aa59,0x3f633c5a,0x3ee63375,0x3eebcbbb,0x3f55b993,0x3f5389c7,0x3f0cead0,0x3f102dd5
.long 0x3f43e200,0x3f40d0da,0x3f24d225,0x3f286605,0x3f2f61a5,0x3f2b561b,0x3f3a7ca4,0x3f3e35c5
.long 0x3f187fc0,0x3f13682a,0x3f4d9f02,0x3f514d3d,0x3eff17b2,0x3ef2bd43,0x3f5df6be,0x3f61668a
.long 0x3ec9b953,0x3ebb31a0,0x3f6b4b0c,0x3f6e46be,0x3e919ddd,0x3e80f8c0,0x3f756d97,0x3f77beb7
.long 0x3e2f10a2,0x3e09cf86,0x3f7c3b28,0x3f7dabcc,0x3d621469,0x3c7b514b,0x3f7f9c18,0x3f7ff84a
.long 0xbd7b2b74,0xbdd53db9,0x3f7f84ab,0x3f7e9bc9,0xbe354098,0xbe636c83,0x3f7bf531,0x3f799b43
.long 0xbe94a031,0xbeac7cd4,0x3f74fa0b,0x3f710908,0xbecc9b8b,0xbee4cbfe,0x3f6aab7b,0x3f650479
.long 0xbf00e7e4,0xbf0cead0,0x3f5d2d53,0x3f55b993,0xbf19c200,0xbf256bcb,0x3f4cae79,0x3f436051
.long 0xbf3085bb,0xbf3b8f3b,0x3f396842,0x3f2e3bde,0xbf44e3f5,0xbf4f0417,0x3f239da9,0x3f16999f
.long 0xbf5695e5,0xbf5f8327,0x3f0b9a6b,0x3ef9a02d,0xbf655e0b,0xbf6cd007,0x3ee363fa,0x3ec27b55
.long 0xbf710908,0xbf76ba07,0x3eac7cd4,0x3e888e93,0xbf796e4e,0xbf7d1cdd,0x3e667c66,0x3e195be0
.long 0xbf7e70b0,0xbf7fe129,0x3de1bc2e,0x3cfb49ba,0xbf7ffec4,0xbf7efcc9,0xbbc90f88,0xbdb5f8da
.long 0xbf7e1324,0xbf7a7302,0xbdfab273,0xbe541501,0xbf78b47b,0xbf725470,0xbe72b651,0xbea5129f
.long 0xbf6ff573,0xbf66becc,0xbeb263ef,0xbeddbe79,0xbf63f473,0xbf57dc7f,0xbee900b7,0xbf099f4e
.long 0x3f800000,0x3f800000,0x0,0x0,0x3f7e1324,0x3f7dfa38,0x3dfab273,0x3e007745
.long 0x3f7853f8,0x3f77f110,0x3e78cfcc,0x3e7ee6e1,0x3f6ed89e,0x3f6dfcf2,0x3eb8442a,0x3ebca7af
.long 0x3f61c598,0x3f604621,0x3ef15aea,0x3ef6e0cb,0x3f514d3d,0x3f4f0417,0x3f13682a,0x3f16999f
.long 0x3f3daef9,0x3f3a7ca4,0x3f2beb4a,0x3f2f61a5,0x3f273656,0x3f2302d3,0x3f41d870,0x3f456439
.long 0x3f0e39da,0x3f08f59b,0x3f54db31,0x3f584853,0x3ee63375,0x3ed97cb9,0x3f64aa59,0x3f67c187
.long 0x3eac7cd4,0x3e9d9e78,0x3f710908,0x3f73913f,0x3e605c13,0x3e3e853e,0x3f79c79d,0x3f7b87b2
.long 0x3dc8bd36,0x3d7b2b74,0x3f7ec46d,0x3f7f84ab,0xbcc90ab0,0xbd83db0a,0x3f7fec43,0x3f7f7808
.long 0xbe164083,0xbe419b37,0x3f7d3aac,0x3f7b61fc,0xbe888e93,0xbe9f1cdf,0x3f76ba07,0x3f73530e
.long 0xbec3ef15,0xbedae880,0x3f6c835e,0x3f676bd8,0xbefc5d27,0xbf099f4e,0x3f5ebe05,0x3f57dc7f
.long 0xbf187fc0,0xbf239da9,0x3f4d9f02,0x3f44e3f5,0xbf3085bb,0xbf3b0629,0x3f396842,0x3f2ecef7
.long 0xbf45e403,0xbf4f7a1f,0x3f226799,0x3f15f6d9,0xbf584853,0xbf60a6cf,0x3f08f59b,0x3ef58035
.long 0xbf676bd8,0xbf6e46be,0x3edae880,0x3ebb31a0,0xbf731447,0xbf7822d1,0x3ea09ae5,0x3e7bdba4
.long 0xbf7b14be,0xbf7e1324,0x3e47c5c2,0x3dfab273,0xbf7f4e6d,0xbf7fffb1,0x3d96a905,0xbb490fc6
.long 0xbf7fb10f,0xbf7de0b1,0xbd48fb30,0xbe039502,0xbf7c3b28,0xbf77beb7,0xbe2f10a2,0xbe80f8c0
.long 0xbf74fa0b,0xbf6db293,0xbe94a031,0xbebe1d4a,0xbf6a09a7,0xbf5fe4e9,0xbecf7bca,0xbef840c8
.long 0xbf5b941a,0xbf4e8d90,0xbf039c3d,0xbf173c07,0xbf49d112,0xbf39f2ac,0xbf1d7fd1,0xbf2ff3e6
.long 0x3f800000,0x3f800000,0x0,0x0,0x3f7dabcc,0x3f7d906e,0x3e09cf86,0x3e0cec4a
.long 0x3f76ba07,0x3f764d97,0x3e888e93,0x3e8b9507,0x3f6b4b0c,0x3f6a5ad9,0x3ec9b953,0x3ece0bea
.long 0x3f5b941a,0x3f59f26a,0x3f039c3d,0x3f064b82,0x3f47de65,0x3f456439,0x3f1ff6cb,0x3f2302d3
.long 0x3f3085bb,0x3f2d1469,0x3f396842,0x3f3ca003,0x3f15f6d9,0x3f11796b,0x3f4f7a1f,0x3f52a649
.long 0x3ef15aea,0x3ee63375,0x3f61c598,0x3f64aa59,0x3eb263ef,0x3ea5129f,0x3f6ff573,0x3f725470
.long 0x3e605c13,0x3e419b37,0x3f79c79d,0x3f7b61fc,0x3dafb680,0x3d55880e,0x3f7f0e58,0x3f7fa6e3
.long 0xbd48fb30,0xbdafb680,0x3f7fb10f,0x3f7f0e58,0xbe3b6ecf,0xbe636c83,0x3f7baccd,0x3f799b43
.long 0xbea09ae5,0xbeb554ec,0x3f731447,0x3f6f6830,0xbee0924f,0xbef58035,0x3f660f88,0x3f60a6cf
.long 0xbf0e39da,0xbf187fc0,0x3f54db31,0x3f4d9f02,0xbf299415,0xbf33587a,0x3f3fc767,0x3f36ad7f
.long 0xbf41d870,0xbf4ac77f,0x3f273656,0x3f1c420c,0xbf5695e5,0xbf5e5aa6,0x3f0b9a6b,0x3efdbabb
.long 0xbf676bd8,0xbf6db293,0x3edae880,0x3ebe1d4a,0xbf740bdd,0xbf788486,0x3e9aa086,0x3e75c35a
.long 0xbf7c3b28,0xbf7e9bc9,0x3e2f10a2,0x3dd53db9,0xbf7fd397,0xbf7fdaaf,0x3d16c32c,0xbd0a342f
.long 0xbf7ec46d,0xbf7c3b28,0xbdc8bd36,0xbe2f10a2,0xbf791298,0xbf73ced9,0xbe6c9a7f,0xbe9c1faf
.long 0xbf6ed89e,0xbf66becc,0xbeb8442a,0xbeddbe79,0xbf604621,0xbf554aa4,0xbef6e0cb,0xbf0d9281
.long 0xbf4d9f02,0xbf3fc767,0xbf187fc0,0xbf299415,0xbf373a23,0xbf269de3,0xbf32c8c9,0xbf425b89
.long 0xbf1d7fd1,0xbf0a48ad,0xbf49d112,0xbf577026,0xbf00e7e4,0xbed6a399,0xbf5d2d53,0xbf686b39
.long 0x3f800000,0x3f800000,0x0,0x0,0x3f7de0b1,0x3f7dc68c,0x3e039502,0x3e06b26e
.long 0x3f778bc5,0x3f772417,0x3e827dc0,0x3e8586ce,0x3f6d1c1d,0x3f6c3624,0x3ec1071e,0x3ec5625c
.long 0x3f5ebe05,0x3f5d2d53,0x3efc5d27,0x3f00e7e4,0x3f4cae79,0x3f4a4c87,0x3f19c200,0x3f1ce11f
.long 0x3f373a23,0x3f33e7bc,0x3f32c8c9,0x3f36206c,0x3f1ebc12,0x3f1a6293,0x3f48d8b3,0x3f4c3578
.long 0x3f039c3d,0x3efc5d27,0x3f5b941a,0x3f5ebe05,0x3ecc9b8b,0x3ebf926f,0x3f6aab7b,0x3f6d67a1
.long 0x3e8e9a22,0x3e7ee6e1,0x3f75dec6,0x3f77f110,0x3e1c76de,0x3df475c0,0x3f7cfe73,0x3f7e2b72
.long 0x3cc90ab0,0xbc490e90,0x3f7fec43,0x3f7ffb11,0xbdd53db9,0xbe1324ca,0x3f7e9bc9,0x3f7d57de
.long 0xbe6c9a7f,0xbe8b9507,0x3f791298,0x3f764d97,0xbeb554ec,0xbecb2aae,0x3f6f6830,0x3f6afb8c
.long 0xbef15aea,0xbf039c3d,0x3f61c598,0x3f5b941a,0xbf14b039,0xbf1f599f,0x3f5064af,0x3f485bca
.long 0xbf2e3bde,0xbf385216,0x3f3b8f3b,0x3f31a81d,0xbf44e3f5,0xbf4e1689,0x3f239da9,0x3f17de12
.long 0xbf584853,0xbf604621,0x3f08f59b,0x3ef6e0cb,0xbf6816a8,0xbf6e8ff8,0x3ed8106b,0x3eb9bb1e
.long 0xbf740bdd,0xbf78b47b,0x3e9aa086,0x3e72b651,0xbf7bf531,0xbf7e868b,0x3e354098,0x3ddb7d37
.long 0xbf7fb10f,0xbf7fec43,0x3d48fb30,0xbcc90ab0,0xbf7f2f9d,0xbf7cdf6c,0xbda3308c,0xbe1f917b
.long 0xbf7a7302,0xbf756d97,0xbe541501,0xbe919ddd,0xbf718f57,0xbf69b7e4,0xbea986c4,0xbed0eb2a
.long 0xbf64aa59,0xbf59f26a,0xbee63375,0xbf064b82,0xbf53fac3,0xbf466354,0xbf0f8784,0xbf21cbfb
.long 0xbf3fc767,0xbf2f61a5,0xbf299415,0xbf3a7ca4,0xbf286605,0xbf1553b7,0xbf40d0da,0xbf4fefa8
.long 0x3f800000,0x3f800000,0x0,0x0,0x3f7d7474,0x3f7d57de,0x3e1008b7,0x3e1324ca
.long 0x3f75dec6,0x3f756d97,0x3e8e9a22,0x3e919ddd,0x3f696591,0x3f686b39,0x3ed25a09,0x3ed6a399
.long 0x3f584853,0x3f5695e5,0x3f08f59b,0x3f0b9a6b,0x3f42de29,0x3f404c5c,0x3f26050a,0x3f28fd41
.long 0x3f299415,0x3f26050a,0x3f3fc767,0x3f42de29,0x3f0cead0,0x3f084b92,0x3f55b993,0x3f58b3a1
.long 0x3edae880,0x3ecf7bca,0x3f676bd8,0x3f6a09a7,0x3e97a117,0x3e8a11f7,0x3f748422,0x3f76841b
.long 0x3e22abb6,0x3e039502,0x3f7cbfc9,0x3f7de0b1,0x3c96c9b6,0xbc7b514b,0x3f7ff4e6,0x3f7ff84a
.long 0xbdfab273,0xbe22abb6,0x3f7e1324,0x3f7cbfc9,0xbe8586ce,0xbe9920fe,0x3f772417,0x3f74484b
.long 0xbec9b953,0xbeddbe79,0x3f6b4b0c,0x3f66becc,0xbf04f484,0xbf0ee0db,0x3f5ac450,0x3f546b3b
.long 0xbf226799,0xbf2beb4a,0x3f45e403,0x3f3daef9,0xbf3ca003,0xbf456439,0x3f2d1469,0x3f2302d3
.long 0xbf531849,0xbf5ac450,0x3f10d3cd,0x3f04f484,0xbf655e0b,0xbf6b99fb,0x3ee363fa,0x3ec8477c
.long 0xbf731447,0xbf778bc5,0x3ea09ae5,0x3e827dc0,0xbf7bf531,0xbf7e5a38,0x3e354098,0x3de7fa9a
.long 0xbf7fd397,0xbf7fe129,0x3d16c32c,0xbcfb49ba,0xbf7e9bc9,0xbf7c187a,0xbdd53db9,0xbe3228d4
.long 0xbf7853f8,0xbf731447,0xbe78cfcc,0xbea09ae5,0xbf6d1c1d,0xbf650479,0xbec1071e,0xbee4cbfe
.long 0xbf5d2d53,0xbf5233c6,0xbf00e7e4,0xbf121eb0,0xbf48d8b3,0xbf3b0629,0xbf1ebc12,0xbf2ecef7
.long 0xbf3085bb,0xbf1ff6cb,0xbf396842,0xbf47de65,0xbf14b039,0xbf019573,0xbf5064af,0xbf5cc7d1
.long 0xbeebcbbb,0xbec1071e,0xbf633c5a,0xbf6d1c1d,0xbea986c4,0xbe75c35a,0xbf718f57,0xbf788486
.long 0x3f800000,0x3f800000,0x0,0x0,0x3f7d3aac,0x3f7d1cdd,0x3e164083,0x3e195be0
.long 0x3f74fa0b,0x3f748422,0x3e94a031,0x3e97a117,0x3f676bd8,0x3f666771,0x3edae880,0x3edf28a9
.long 0x3f54db31,0x3f531849,0x3f0e39da,0x3f10d3cd,0x3f3daef9,0x3f3b0629,0x3f2beb4a,0x3f2ecef7
.long 0x3f226799,0x3f1ebc12,0x3f45e403,0x3f48d8b3,0x3f039c3d,0x3efdbabb,0x3f5b941a,0x3f5e5aa6
.long 0x3ec3ef15,0x3eb8442a,0x3f6c835e,0x3f6ed89e,0x3e78cfcc,0x3e5d4b1a,0x3f7853f8,0x3f79f35e
.long 0x3dc8bd36,0x3d8a200a,0x3f7ec46d,0x3f7f6ac7,0xbd48fb30,0xbda973ba,0x3f7fb10f,0x3f7f1f49
.long 0xbe47c5c2,0xbe6c9a7f,0x3f7b14be,0x3f791298,0xbeac7cd4,0xbebf926f,0x3f710908,0x3f6d67a1
.long 0xbef15aea,0xbf0242b1,0x3f61c598,0x3f5c61c7,0xbf187fc0,0xbf21cbfb,0x3f4d9f02,0x3f466354
.long 0xbf3504f3,0xbf3daef9,0x3f3504f3,0x3f2beb4a,0xbf4d9f02,0xbf554aa4,0x3f187fc0,0x3f0d9281
.long 0xbf61c598,0xbf6816a8,0x3ef15aea,0x3ed8106b,0xbf710908,0xbf75a67b,0x3eac7cd4,0x3e901c2c
.long 0xbf7b14be,0xbf7dabcc,0x3e47c5c2,0x3e09cf86,0xbf7fb10f,0xbf7ff84a,0x3d48fb30,0xbc7b514b
.long 0xbf7ec46d,0xbf7c7eb0,0xbdc8bd36,0xbe28defc,0xbf7853f8,0xbf73530e,0xbe78cfcc,0xbe9f1cdf
.long 0xbf6c835e,0xbf64aa59,0xbec3ef15,0xbee63375,0xbf5b941a,0xbf50d937,0xbf039c3d,0xbf140c5f
.long 0xbf45e403,0xbf385216,0xbf226799,0xbf31a81d,0xbf2beb4a,0xbf1ba299,0xbf3daef9,0xbf4b41fa
.long 0xbf0e39da,0xbef6e0cb,0xbf54db31,0xbf604621,0xbedae880,0xbeb0eacb,0xbf676bd8,0xbf703b37
.long 0xbe94a031,0xbe4dee60,0xbf74fa0b,0xbf7ac516,0xbe164083,0xbd55880e,0xbf7d3aac,0xbf7fa6e3
.long 0x3f800000,0x3f800000,0x0,0x0,0x3f7cbfc9,0x3f7c9f8a,0x3e22abb6,0x3e25c58c
.long 0x3f731447,0x3f7294f8,0x3ea09ae5,0x3ea395c5,0x3f633c5a,0x3f62241a,0x3eebcbbb,0x3eeff7fb
.long 0x3f4d9f02,0x3f4bbbf8,0x3f187fc0,0x3f1b02c6,0x3f32c8c9,0x3f2ff3e6,0x3f373a23,0x3f39f2ac
.long 0x3f13682a,0x3f0f8784,0x3f514d3d,0x3f53fac3,0x3ee0924f,0x3ed6a399,0x3f660f88,0x3f686b39
.long 0x3e94a031,0x3e888e93,0x3f74fa0b,0x3f76ba07,0x3e09cf86,0x3ddb7d37,0x3f7dabcc,0x3f7e868b
.long 0xbcc90ab0,0xbd621469,0x3f7fec43,0x3f7f9c18,0xbe3b6ecf,0xbe5d4b1a,0x3f7baccd,0x3f79f35e
.long 0xbeac7cd4,0xbebe1d4a,0x3f710908,0x3f6db293,0xbef6e0cb,0xbf044889,0x3f604621,0x3f5b2c79
.long 0xbf1d7fd1,0xbf26050a,0x3f49d112,0x3f42de29,0xbf3b8f3b,0xbf436051,0x3f2e3bde,0x3f256bcb
.long 0xbf54db31,0xbf5b941a,0x3f0e39da,0x3f039c3d,0xbf68bf3c,0xbf6dfcf2,0x3ed53641,0x3ebca7af
.long 0xbf76ba07,0xbf7a1e84,0x3e888e93,0x3e5a3997,0xbf7e70b0,0xbf7fa6e3,0x3de1bc2e,0x3d55880e
.long 0xbf7fb10f,0xbf7e70b0,0xbd48fb30,0xbde1bc2e,0xbf7a7302,0xbf76841b,0xbe541501,0xbe8a11f7
.long 0xbf6ed89e,0xbf6816a8,0xbeb8442a,0xbed8106b,0xbf5d2d53,0xbf5389c7,0xbf00e7e4,0xbf102dd5
.long 0xbf45e403,0xbf396842,0xbf226799,0xbf3085bb,0xbf299415,0xbf1a6293,0xbf3fc767,0xbf4c3578
.long 0xbf08f59b,0xbeee9479,0xbf584853,0xbf628210,0xbec9b953,0xbea21887,0xbf6b4b0c,0xbf72d4eb
.long 0xbe78cfcc,0xbe22abb6,0xbf7853f8,0xbf7cbfc9,0xbdafb680,0x3b490fc6,0xbf7f0e58,0xbf7fffb1
.long 0x3d96a905,0x3e28defc,0xbf7f4e6d,0xbf7c7eb0,0x3e6c9a7f,0x3ea5129f,0xbf791298,0xbf725470
.long 0x3f800000,0x3f800000,0x0,0x0,0x3f7cfe73,0x3f7cdf6c,0x3e1c76de,0x3e1f917b
.long 0x3f740bdd,0x3f73913f,0x3e9aa086,0x3e9d9e78,0x3f655e0b,0x3f644fac,0x3ee363fa,0x3ee79a5d
.long 0x3f514d3d,0x3f4f7a1f,0x3f13682a,0x3f15f6d9,0x3f385216,0x3f3592e7,0x3f31a81d,0x3f34768f
.long 0x3f1b02c6,0x3f173c07,0x3f4bbbf8,0x3f4e8d90,0x3ef41f07,0x3eea6681,0x3f6106f2,0x3f6398ac
.long 0x3eac7cd4,0x3ea09ae5,0x3f710908,0x3f731447,0x3e419b37,0x3e25c58c,0x3f7b61fc,0x3f7c9f8a
.long 0x3d16c32c,0x3bc90f88,0x3f7fd397,0x3f7ffec4,0xbdee3876,0xbe195be0,0x3f7e4323,0x3f7d1cdd
.long 0xbe888e93,0xbe9aa086,0x3f76ba07,0x3f740bdd,0xbed25a09,0xbee4cbfe,0x3f696591,0x3f650479
.long 0xbf0b9a6b,0xbf14b039,0x3f5695e5,0x3f5064af,0xbf2ac082,0xbf33587a,0x3f3ebc1b,0x3f36ad7f
.long 0xbf45e403,0xbf4d9f02,0x3f226799,0x3f187fc0,0xbf5c61c7,0xbf62df7b,0x3f0242b1,0x3eed3063
.long 0xbf6db293,0xbf7294f8,0x3ebe1d4a,0x3ea395c5,0xbf796e4e,0xbf7c5d3a,0x3e667c66,0x3e2bf804
.long 0xbf7f4e6d,0xbf7ffb11,0x3d96a905,0x3c490e90,0xbf7f2f9d,0xbf7d57de,0xbda3308c,0xbe1324ca
.long 0xbf791298,0xbf748422,0xbe6c9a7f,0xbe97a117,0xbf6d1c1d,0xbf65b710,0xbec1071e,0xbee1fb6a
.long 0xbf5b941a,0xbf514d3d,0xbf039c3d,0xbf13682a,0xbf44e3f5,0xbf37c655,0xbf239da9,0xbf3238aa
.long 0xbf299415,0xbf19c200,0xbf3fc767,0xbf4cae79,0xbf0a48ad,0xbeeff7fb,0xbf577026,0xbf62241a
.long 0xbecf7bca,0xbea68f12,0xbf6a09a7,0xbf721352,0xbe8586ce,0xbe3228d4,0xbf772417,0xbf7c187a
.long 0xbde1bc2e,0xbc96c9b6,0xbf7e70b0,0xbf7ff4e6,0x3d2fe007,0x3e0cec4a,0xbf7fc38f,0xbf7d906e
.long 0x3f800000,0x3f800000,0x0,0x0,0x3f7c7eb0,0x3f7c5d3a,0x3e28defc,0x3e2bf804
.long 0x3f721352,0x3f718f57,0x3ea68f12,0x3ea986c4,0x3f6106f2,0x3f5fe4e9,0x3ef41f07,0x3ef840c8
.long 0x3f49d112,0x3f47de65,0x3f1d7fd1,0x3f1ff6cb,0x3f2d1469,0x3f2a2a80,0x3f3ca003,0x3f3f41fc
.long 0x3f0b9a6b,0x3f07a136,0x3f5695e5,0x3f591e6a,0x3ecc9b8b,0x3ec27b55,0x3f6aab7b,0x3f6cd007
.long 0x3e78cfcc,0x3e605c13,0x3f7853f8,0x3f79c79d,0x3da3308c,0x3d55880e,0x3f7f2f9d,0x3f7fa6e3
.long 0xbdafb680,0xbdee3876,0x3f7f0e58,0x3f7e4323,0xbe7ee6e1,0xbe901c2c,0x3f77f110,0x3f75a67b
.long 0xbecf7bca,0xbee0924f,0x3f6a09a7,0x3f660f88,0xbf0cead0,0xbf1553b7,0x3f55b993,0x3f4fefa8
.long 0xbf2e3bde,0xbf36206c,0x3f3b8f3b,0x3f33e7bc,0xbf4ac77f,0xbf51c0c2,0x3f1c420c,0x3f12c39a
.long 0xbf61c598,0xbf676bd8,0x3ef15aea,0x3edae880,0xbf7294f8,0xbf76841b,0x3ea395c5,0x3e8a11f7
.long 0xbf7cbfc9,0xbf7e9bc9,0x3e22abb6,0x3dd53db9,0xbf7ffec4,0xbf7f7808,0xbbc90f88,0xbd83db0a
.long 0xbf7c3b28,0xbf791298,0xbe2f10a2,0xbe6c9a7f,0xbf718f57,0xbf6b99fb,0xbea986c4,0xbec8477c
.long 0xbf604621,0xbf577026,0xbef6e0cb,0xbf0a48ad,0xbf48d8b3,0xbf3d27b8,0xbf1ebc12,0xbf2c800f
.long 0xbf2beb4a,0xbf1d7fd1,0xbf3daef9,0xbf49d112,0xbf0a48ad,0xbef2bd43,0xbf577026,0xbf61668a
.long 0xbec9b953,0xbea395c5,0xbf6b4b0c,0xbf7294f8,0xbe72b651,0xbe1f917b,0xbf78b47b,0xbf7cdf6c
.long 0xbd96a905,0x3c490e90,0xbf7f4e6d,0xbf7ffb11,0x3dbc3ac3,0x3e3857ec,0xbf7eea9d,0xbf7bd14d
.long 0x3e827dc0,0x3eaf713a,0xbf778bc5,0xbf708066,0x3ed25a09,0x3efdbabb,0xbf696591,0xbf5e5aa6
.long 0x3f800000,0x3f800000,0x0,0x0,0x3f7c3b28,0x3f7c187a,0x3e2f10a2,0x3e3228d4
.long 0x3f710908,0x3f708066,0x3eac7cd4,0x3eaf713a,0x3f5ebe05,0x3f5d924d,0x3efc5d27,0x3f003a06
.long 0x3f45e403,0x3f43e200,0x3f226799,0x3f24d225,0x3f273656,0x3f24381a,0x3f41d870,0x3f446337
.long 0x3f039c3d,0x3eff17b2,0x3f5b941a,0x3f5df6be,0x3eb8442a,0x3eadf73c,0x3f6ed89e,0x3f70c501
.long 0x3e47c5c2,0x3e2f10a2,0x3f7b14be,0x3f7c3b28,0x3cc90ab0,0xbb490fc6,0x3f7fec43,0x3f7fffb1
.long 0xbe164083,0xbe354098,0x3f7d3aac,0x3f7bf531,0xbea09ae5,0xbeb0eacb,0x3f731447,0x3f703b37
.long 0xbef15aea,0xbf00e7e4,0x3f61c598,0x3f5d2d53,0xbf1d7fd1,0xbf256bcb,0x3f49d112,0x3f436051
.long 0xbf3daef9,0xbf44e3f5,0x3f2beb4a,0x3f239da9,0xbf584853,0xbf5e5aa6,0x3f08f59b,0x3efdbabb
.long 0xbf6c835e,0xbf710908,0x3ec3ef15,0x3eac7cd4,0xbf79c79d,0xbf7c5d3a,0x3e605c13,0x3e2bf804
.long 0xbf7fb10f,0xbf7ffec4,0x3d48fb30,0xbbc90f88,0xbf7e1324,0xbf7bd14d,0xbdfab273,0xbe3857ec
.long 0xbf74fa0b,0xbf6ff573,0xbe94a031,0xbeb263ef,0xbf64aa59,0xbf5cc7d1,0xbee63375,0xbf019573
.long 0xbf4d9f02,0xbf42de29,0xbf187fc0,0xbf26050a,0xbf3085bb,0xbf2302d3,0xbf396842,0xbf456439
.long 0xbf0e39da,0xbefc5d27,0xbf54db31,0xbf5ebe05,0xbecf7bca,0xbeab0201,0xbf6a09a7,0xbf714c7a
.long 0xbe78cfcc,0xbe28defc,0xbf7853f8,0xbf7c7eb0,0xbd96a905,0x3c16cb58,0xbf7f4e6d,0xbf7ffd39
.long 0x3dc8bd36,0x3e3b6ecf,0xbf7ec46d,0xbf7baccd,0x3e888e93,0x3eb3dca5,0xbf76ba07,0xbf6faf1b
.long 0x3edae880,0x3f0242b1,0xbf676bd8,0xbf5c61c7,0x3f13682a,0x3f269de3,0xbf514d3d,0xbf425b89
.long 0x3f800000,0x3f800000,0x0,0x0,0x3f7baccd,0x3f7b87b2,0x3e3b6ecf,0x3e3e853e
.long 0x3f6ed89e,0x3f6e46be,0x3eb8442a,0x3ebb31a0,0x3f59f26a,0x3f58b3a1,0x3f064b82,0x3f084b92
.long 0x3f3daef9,0x3f3b8f3b,0x3f2beb4a,0x3f2e3bde,0x3f1b02c6,0x3f17de12,0x3f4bbbf8,0x3f4e1689
.long 0x3ee63375,0x3eddbe79,0x3f64aa59,0x3f66becc,0x3e8e9a22,0x3e840270,0x3f75dec6,0x3f77583a
.long 0x3dc8bd36,0x3d96a905,0x3f7ec46d,0x3f7f4e6d,0xbdafb680,0xbde7fa9a,0x3f7f0e58,0x3f7e5a38
.long 0xbe888e93,0xbe97a117,0x3f76ba07,0x3f748422,0xbee0924f,0xbeeff7fb,0x3f660f88,0x3f62241a
.long 0xbf187fc0,0xbf1ff6cb,0x3f4d9f02,0x3f47de65,0xbf3b8f3b,0xbf425b89,0x3f2e3bde,0x3f269de3
.long 0xbf584853,0xbf5df6be,0x3f08f59b,0x3eff17b2,0xbf6db293,0xbf71d19f,0x3ebe1d4a,0x3ea80b1f
.long 0xbf7b14be,0xbf7d3aac,0x3e47c5c2,0x3e164083,0xbf7ffb11,0xbf7fcbe2,0x3c490e90,0xbd2351cb
.long 0xbf7c3b28,0xbf796e4e,0xbe2f10a2,0xbe667c66,0xbf6ff573,0xbf6a5ad9,0xbeb263ef,0xbece0bea
.long 0xbf5b941a,0xbf531849,0xbf039c3d,0xbf10d3cd,0xbf3fc767,0xbf34768f,0xbf299415,0xbf3592e7
.long 0xbf1d7fd1,0xbf0f8784,0xbf49d112,0xbf53fac3,0xbeebcbbb,0xbecb2aae,0xbf633c5a,0xbf6afb8c
.long 0xbe94a031,0xbe605c13,0xbf74fa0b,0xbf79c79d,0xbde1bc2e,0xbd0a342f,0xbf7e70b0,0xbf7fdaaf
.long 0x3d96a905,0x3e1c76de,0xbf7f4e6d,0xbf7cfe73,0x3e827dc0,0x3eab0201,0xbf778bc5,0xbf714c7a
.long 0x3edae880,0x3f00e7e4,0xbf676bd8,0xbf5d2d53,0x3f15f6d9,0x3f27ce61,0xbf4f7a1f,0xbf4154e1
.long 0x3f396842,0x3f48d8b3,0xbf3085bb,0xbf1ebc12,0x3f5695e5,0x3f62df7b,0xbf0b9a6b,0xbeed3063
.long 0x3f800000,0x3f800000,0x0,0x0,0x3f7bf531,0x3f7bd14d,0x3e354098,0x3e3857ec
.long 0x3f6ff573,0x3f6f6830,0x3eb263ef,0x3eb554ec,0x3f5c61c7,0x3f5b2c79,0x3f0242b1,0x3f044889
.long 0x3f41d870,0x3f3fc767,0x3f273656,0x3f299415,0x3f212ff9,0x3f1e1e22,0x3f46e22a,0x3f495521
.long 0x3ef6e0cb,0x3eee9479,0x3f604621,0x3f628210,0x3ea395c5,0x3e9920fe,0x3f7294f8,0x3f74484b
.long 0x3e164083,0x3dfab273,0x3f7d3aac,0x3f7e1324,0xbcfb49ba,0xbd6ea038,0x3f7fe129,0x3f7f90b1
.long 0xbe541501,0xbe72b651,0x3f7a7302,0x3f78b47b,0xbec1071e,0xbed0eb2a,0x3f6d1c1d,0x3f69b7e4
.long 0xbf08f59b,0xbf10d3cd,0x3f584853,0x3f531849,0xbf2d1469,0xbf34768f,0x3f3ca003,0x3f3592e7
.long 0xbf4bbbf8,0xbf5233c6,0x3f1b02c6,0x3f121eb0,0xbf63f473,0xbf6912ae,0x3ee900b7,0x3ed3c867
.long 0xbf74fa0b,0xbf7853f8,0x3e94a031,0x3e78cfcc,0xbf7e4323,0xbf7f7808,0x3dee3876,0x3d83db0a
.long 0xbf7f84ab,0xbf7e4323,0xbd7b2b74,0xbdee3876,0xbf78b47b,0xbf74bf62,0xbe72b651,0xbe9620d2
.long 0xbf6a09a7,0xbf633c5a,0xbecf7bca,0xbeebcbbb,0xbf53fac3,0xbf4a4c87,0xbf0f8784,0xbf1ce11f
.long 0xbf373a23,0xbf2ac082,0xbf32c8c9,0xbf3ebc1b,0xbf14b039,0xbf05a02c,0xbf5064af,0xbf5a5ba0
.long 0xbedae880,0xbeb8442a,0xbf676bd8,0xbf6ed89e,0xbe8586ce,0xbe3e853e,0xbf772417,0xbf7b87b2
.long 0xbdafb680,0xbbc90f88,0xbf7f0e58,0xbf7ffec4,0x3dbc3ac3,0x3e3228d4,0xbf7eea9d,0xbf7c187a
.long 0x3e888e93,0x3eb263ef,0xbf76ba07,0xbf6ff573,0x3eddbe79,0x3f02ef9f,0xbf66becc,0xbf5bfb34
.long 0x3f15f6d9,0x3f286605,0xbf4f7a1f,0xbf40d0da,0x3f385216,0x3f485bca,0xbf31a81d,0xbf1f599f
.long 0x3f800000,0x3f800000,0x0,0x0,0x3f7b61fc,0x3f7b3bab,0x3e419b37,0x3e44b0b9
.long 0x3f6db293,0x3f6d1c1d,0x3ebe1d4a,0x3ec1071e,0x3f577026,0x3f5627fe,0x3f0a48ad,0x3f0c42c9
.long 0x3f396842,0x3f373a23,0x3f3085bb,0x3f32c8c9,0x3f14b039,0x3f11796b,0x3f5064af,0x3f52a649
.long 0x3ed53641,0x3ecc9b8b,0x3f68bf3c,0x3f6aab7b,0x3e72b651,0x3e5d4b1a,0x3f78b47b,0x3f79f35e
.long 0x3d48fb30,0x3cc90ab0,0x3f7fb10f,0x3f7fec43,0xbe1008b7,0xbe2bf804,0x3f7d7474,0x3f7c5d3a
.long 0xbea68f12,0xbeb554ec,0x3f721352,0x3f6f6830,0xbeff17b2,0xbf06f686,0x3f5df6be,0x3f5988ad
.long 0xbf273656,0xbf2e3bde,0x3f41d870,0x3f3b8f3b,0xbf48d8b3,0xbf4f0417,0x3f1ebc12,0x3f16999f
.long 0xbf633c5a,0xbf6816a8,0x3eebcbbb,0x3ed8106b,0xbf756d97,0xbf788486,0x3e919ddd,0x3e75c35a
.long 0xbf7ec46d,0xbf7fb10f,0x3dc8bd36,0x3d48fb30,0xbf7eea9d,0xbf7d57de,0xbdbc3ac3,0xbe1324ca
.long 0xbf75dec6,0xbf718f57,0xbe8e9a22,0xbea986c4,0xbf63f473,0xbf5cc7d1,0xbee900b7,0xbf019573
.long 0xbf49d112,0xbf3fc767,0xbf1d7fd1,0xbf299415,0xbf286605,0xbf1ba299,0xbf40d0da,0xbf4b41fa
.long 0xbf00e7e4,0xbee363fa,0xbf5d2d53,0xbf655e0b,0xbea986c4,0xbe870ada,0xbf718f57,0xbf76ef5b
.long 0xbe164083,0xbd96a905,0xbf7d3aac,0xbf7f4e6d,0x3d2fe007,0x3df475c0,0xbf7fc38f,0xbf7e2b72
.long 0x3e6c9a7f,0x3e9d9e78,0xbf791298,0xbf73913f,0x3ed25a09,0x3ef840c8,0xbf696591,0xbf5fe4e9
.long 0x3f13682a,0x3f24d225,0xbf514d3d,0xbf43e200,0x3f385216,0x3f476085,0xbf31a81d,0xbf209393
.long 0x3f5695e5,0x3f628210,0xbf0b9a6b,0xbeee9479,0x3f6d1c1d,0x3f75341d,0xbec1071e,0xbe931f35
.long 0x3f800000,0x3f800000,0x0,0x0,0x3f800000,0x3f7fffb1,0x0,0x3b490fc6
.long 0x3f800000,0x3f7ffec4,0x0,0x3bc90f88,0x3f800000,0x3f7ffd39,0x0,0x3c16cb58
.long 0x3f800000,0x3f7ffb11,0x0,0x3c490e90,0x3f800000,0x3f7ff84a,0x0,0x3c7b514b
.long 0x3f800000,0x3f7ff4e6,0x0,0x3c96c9b6,0x3f800000,0x3f7ff0e3,0x0,0x3cafea69
.long 0x3f800000,0x3f7fec43,0x0,0x3cc90ab0,0x3f800000,0x3f7fe705,0x0,0x3ce22a7a
.long 0x3f800000,0x3f7fe129,0x0,0x3cfb49ba,0x3f800000,0x3f7fdaaf,0x0,0x3d0a342f
.long 0x3f800000,0x3f7fd397,0x0,0x3d16c32c,0x3f800000,0x3f7fcbe2,0x0,0x3d2351cb
.long 0x3f800000,0x3f7fc38f,0x0,0x3d2fe007,0x3f800000,0x3f7fba9e,0x0,0x3d3c6dd5
.long 0x3f800000,0x3f7fb10f,0x0,0x3d48fb30,0x3f800000,0x3f7fa6e3,0x0,0x3d55880e
.long 0x3f800000,0x3f7f9c18,0x0,0x3d621469,0x3f800000,0x3f7f90b1,0x0,0x3d6ea038
.long 0x3f800000,0x3f7f84ab,0x0,0x3d7b2b74,0x3f800000,0x3f7f7808,0x0,0x3d83db0a
.long 0x3f800000,0x3f7f6ac7,0x0,0x3d8a200a,0x3f800000,0x3f7f5ce9,0x0,0x3d9064b4
.long 0x3f800000,0x3f7f4e6d,0x0,0x3d96a905,0x3f800000,0x3f7f3f54,0x0,0x3d9cecf9
.long 0x3f800000,0x3f7f2f9d,0x0,0x3da3308c,0x3f800000,0x3f7f1f49,0x0,0x3da973ba
.long 0x3f800000,0x3f7f0e58,0x0,0x3dafb680,0x3f800000,0x3f7efcc9,0x0,0x3db5f8da
.long 0x3f800000,0x3f7eea9d,0x0,0x3dbc3ac3,0x3f800000,0x3f7ed7d4,0x0,0x3dc27c39
.long 0x3f800000,0x3f800000,0x0,0x0,0x3f7ffb11,0x3f7ff84a,0x3c490e90,0x3c7b514b
.long 0x3f7fec43,0x3f7fe129,0x3cc90ab0,0x3cfb49ba,0x3f7fd397,0x3f7fba9e,0x3d16c32c,0x3d3c6dd5
.long 0x3f7fb10f,0x3f7f84ab,0x3d48fb30,0x3d7b2b74,0x3f7f84ab,0x3f7f3f54,0x3d7b2b74,0x3d9cecf9
.long 0x3f7f4e6d,0x3f7eea9d,0x3d96a905,0x3dbc3ac3,0x3f7f0e58,0x3f7e868b,0x3dafb680,0x3ddb7d37
.long 0x3f7ec46d,0x3f7e1324,0x3dc8bd36,0x3dfab273,0x3f7e70b0,0x3f7d906e,0x3de1bc2e,0x3e0cec4a
.long 0x3f7e1324,0x3f7cfe73,0x3dfab273,0x3e1c76de,0x3f7dabcc,0x3f7c5d3a,0x3e09cf86,0x3e2bf804
.long 0x3f7d3aac,0x3f7baccd,0x3e164083,0x3e3b6ecf,0x3f7cbfc9,0x3f7aed37,0x3e22abb6,0x3e4ada4f
.long 0x3f7c3b28,0x3f7a1e84,0x3e2f10a2,0x3e5a3997,0x3f7baccd,0x3f7940c0,0x3e3b6ecf,0x3e698bba
.long 0x3f7b14be,0x3f7853f8,0x3e47c5c2,0x3e78cfcc,0x3f7a7302,0x3f77583a,0x3e541501,0x3e840270
.long 0x3f79c79d,0x3f764d97,0x3e605c13,0x3e8b9507,0x3f791298,0x3f75341d,0x3e6c9a7f,0x3e931f35
.long 0x3f7853f8,0x3f740bdd,0x3e78cfcc,0x3e9aa086,0x3f778bc5,0x3f72d4eb,0x3e827dc0,0x3ea21887
.long 0x3f76ba07,0x3f718f57,0x3e888e93,0x3ea986c4,0x3f75dec6,0x3f703b37,0x3e8e9a22,0x3eb0eacb
.long 0x3f74fa0b,0x3f6ed89e,0x3e94a031,0x3eb8442a,0x3f740bdd,0x3f6d67a1,0x3e9aa086,0x3ebf926f
.long 0x3f731447,0x3f6be858,0x3ea09ae5,0x3ec6d529,0x3f721352,0x3f6a5ad9,0x3ea68f12,0x3ece0bea
.long 0x3f710908,0x3f68bf3c,0x3eac7cd4,0x3ed53641,0x3f6ff573,0x3f671599,0x3eb263ef,0x3edc53c1
.long 0x3f6ed89e,0x3f655e0b,0x3eb8442a,0x3ee363fa,0x3f6db293,0x3f6398ac,0x3ebe1d4a,0x3eea6681
.long 0x3f800000,0x3f800000,0x0,0x0,0x3f7ffec4,0x3f7ffd39,0x3bc90f88,0x3c16cb58
.long 0x3f7ffb11,0x3f7ff4e6,0x3c490e90,0x3c96c9b6,0x3f7ff4e6,0x3f7fe705,0x3c96c9b6,0x3ce22a7a
.long 0x3f7fec43,0x3f7fd397,0x3cc90ab0,0x3d16c32c,0x3f7fe129,0x3f7fba9e,0x3cfb49ba,0x3d3c6dd5
.long 0x3f7fd397,0x3f7f9c18,0x3d16c32c,0x3d621469,0x3f7fc38f,0x3f7f7808,0x3d2fe007,0x3d83db0a
.long 0x3f7fb10f,0x3f7f4e6d,0x3d48fb30,0x3d96a905,0x3f7f9c18,0x3f7f1f49,0x3d621469,0x3da973ba
.long 0x3f7f84ab,0x3f7eea9d,0x3d7b2b74,0x3dbc3ac3,0x3f7f6ac7,0x3f7eb069,0x3d8a200a,0x3dcefdb7
.long 0x3f7f4e6d,0x3f7e70b0,0x3d96a905,0x3de1bc2e,0x3f7f2f9d,0x3f7e2b72,0x3da3308c,0x3df475c0
.long 0x3f7f0e58,0x3f7de0b1,0x3dafb680,0x3e039502,0x3f7eea9d,0x3f7d906e,0x3dbc3ac3,0x3e0cec4a
.long 0x3f7ec46d,0x3f7d3aac,0x3dc8bd36,0x3e164083,0x3f7e9bc9,0x3f7cdf6c,0x3dd53db9,0x3e1f917b
.long 0x3f7e70b0,0x3f7c7eb0,0x3de1bc2e,0x3e28defc,0x3f7e4323,0x3f7c187a,0x3dee3876,0x3e3228d4
.long 0x3f7e1324,0x3f7baccd,0x3dfab273,0x3e3b6ecf,0x3f7de0b1,0x3f7b3bab,0x3e039502,0x3e44b0b9
.long 0x3f7dabcc,0x3f7ac516,0x3e09cf86,0x3e4dee60,0x3f7d7474,0x3f7a4910,0x3e1008b7,0x3e57278f
.long 0x3f7d3aac,0x3f79c79d,0x3e164083,0x3e605c13,0x3f7cfe73,0x3f7940c0,0x3e1c76de,0x3e698bba
.long 0x3f7cbfc9,0x3f78b47b,0x3e22abb6,0x3e72b651,0x3f7c7eb0,0x3f7822d1,0x3e28defc,0x3e7bdba4
.long 0x3f7c3b28,0x3f778bc5,0x3e2f10a2,0x3e827dc0,0x3f7bf531,0x3f76ef5b,0x3e354098,0x3e870ada
.long 0x3f7baccd,0x3f764d97,0x3e3b6ecf,0x3e8b9507,0x3f7b61fc,0x3f75a67b,0x3e419b37,0x3e901c2c
.long 0x3f800000,0x3f800000,0x0,0x0,0x3f7ff4e6,0x3f7ff0e3,0x3c96c9b6,0x3cafea69
.long 0x3f7fd397,0x3f7fc38f,0x3d16c32c,0x3d2fe007,0x3f7f9c18,0x3f7f7808,0x3d621469,0x3d83db0a
.long 0x3f7f4e6d,0x3f7f0e58,0x3d96a905,0x3dafb680,0x3f7eea9d,0x3f7e868b,0x3dbc3ac3,0x3ddb7d37
.long 0x3f7e70b0,0x3f7de0b1,0x3de1bc2e,0x3e039502,0x3f7de0b1,0x3f7d1cdd,0x3e039502,0x3e195be0
.long 0x3f7d3aac,0x3f7c3b28,0x3e164083,0x3e2f10a2,0x3f7c7eb0,0x3f7b3bab,0x3e28defc,0x3e44b0b9
.long 0x3f7baccd,0x3f7a1e84,0x3e3b6ecf,0x3e5a3997,0x3f7ac516,0x3f78e3d6,0x3e4dee60,0x3e6fa8b2
.long 0x3f79c79d,0x3f778bc5,0x3e605c13,0x3e827dc0,0x3f78b47b,0x3f76167a,0x3e72b651,0x3e8d17c0
.long 0x3f778bc5,0x3f748422,0x3e827dc0,0x3e97a117,0x3f764d97,0x3f72d4eb,0x3e8b9507,0x3ea21887
.long 0x3f74fa0b,0x3f710908,0x3e94a031,0x3eac7cd4,0x3f73913f,0x3f6f20b0,0x3e9d9e78,0x3eb6ccc3
.long 0x3f721352,0x3f6d1c1d,0x3ea68f12,0x3ec1071e,0x3f708066,0x3f6afb8c,0x3eaf713a,0x3ecb2aae
.long 0x3f6ed89e,0x3f68bf3c,0x3eb8442a,0x3ed53641,0x3f6d1c1d,0x3f666771,0x3ec1071e,0x3edf28a9
.long 0x3f6b4b0c,0x3f63f473,0x3ec9b953,0x3ee900b7,0x3f696591,0x3f61668a,0x3ed25a09,0x3ef2bd43
.long 0x3f676bd8,0x3f5ebe05,0x3edae880,0x3efc5d27,0x3f655e0b,0x3f5bfb34,0x3ee363fa,0x3f02ef9f
.long 0x3f633c5a,0x3f591e6a,0x3eebcbbb,0x3f07a136,0x3f6106f2,0x3f5627fe,0x3ef41f07,0x3f0c42c9
.long 0x3f5ebe05,0x3f531849,0x3efc5d27,0x3f10d3cd,0x3f5c61c7,0x3f4fefa8,0x3f0242b1,0x3f1553b7
.long 0x3f59f26a,0x3f4cae79,0x3f064b82,0x3f19c200,0x3f577026,0x3f495521,0x3f0a48ad,0x3f1e1e22
.long 0x3f800000,0x3f800000,0x0,0x0,0x3f7fec43,0x3f7fe705,0x3cc90ab0,0x3ce22a7a
.long 0x3f7fb10f,0x3f7f9c18,0x3d48fb30,0x3d621469,0x3f7f4e6d,0x3f7f1f49,0x3d96a905,0x3da973ba
.long 0x3f7ec46d,0x3f7e70b0,0x3dc8bd36,0x3de1bc2e,0x3f7e1324,0x3f7d906e,0x3dfab273,0x3e0cec4a
.long 0x3f7d3aac,0x3f7c7eb0,0x3e164083,0x3e28defc,0x3f7c3b28,0x3f7b3bab,0x3e2f10a2,0x3e44b0b9
.long 0x3f7b14be,0x3f79c79d,0x3e47c5c2,0x3e605c13,0x3f79c79d,0x3f7822d1,0x3e605c13,0x3e7bdba4
.long 0x3f7853f8,0x3f764d97,0x3e78cfcc,0x3e8b9507,0x3f76ba07,0x3f74484b,0x3e888e93,0x3e9920fe
.long 0x3f74fa0b,0x3f721352,0x3e94a031,0x3ea68f12,0x3f731447,0x3f6faf1b,0x3ea09ae5,0x3eb3dca5
.long 0x3f710908,0x3f6d1c1d,0x3eac7cd4,0x3ec1071e,0x3f6ed89e,0x3f6a5ad9,0x3eb8442a,0x3ece0bea
.long 0x3f6c835e,0x3f676bd8,0x3ec3ef15,0x3edae880,0x3f6a09a7,0x3f644fac,0x3ecf7bca,0x3ee79a5d
.long 0x3f676bd8,0x3f6106f2,0x3edae880,0x3ef41f07,0x3f64aa59,0x3f5d924d,0x3ee63375,0x3f003a06
.long 0x3f61c598,0x3f59f26a,0x3ef15aea,0x3f064b82,0x3f5ebe05,0x3f5627fe,0x3efc5d27,0x3f0c42c9
.long 0x3f5b941a,0x3f5233c6,0x3f039c3d,0x3f121eb0,0x3f584853,0x3f4e1689,0x3f08f59b,0x3f17de12
.long 0x3f54db31,0x3f49d112,0x3f0e39da,0x3f1d7fd1,0x3f514d3d,0x3f456439,0x3f13682a,0x3f2302d3
.long 0x3f4d9f02,0x3f40d0da,0x3f187fc0,0x3f286605,0x3f49d112,0x3f3c17d9,0x3f1d7fd1,0x3f2da859
.long 0x3f45e403,0x3f373a23,0x3f226799,0x3f32c8c9,0x3f41d870,0x3f3238aa,0x3f273656,0x3f37c655
.long 0x3f3daef9,0x3f2d1469,0x3f2beb4a,0x3f3ca003,0x3f396842,0x3f27ce61,0x3f3085bb,0x3f4154e1
.long 0x3f800000,0x3f800000,0x0,0x0,0x3f7fd397,0x3f7fcbe2,0x3d16c32c,0x3d2351cb
.long 0x3f7f4e6d,0x3f7f2f9d,0x3d96a905,0x3da3308c,0x3f7e70b0,0x3f7e2b72,0x3de1bc2e,0x3df475c0
.long 0x3f7d3aac,0x3f7cbfc9,0x3e164083,0x3e22abb6,0x3f7baccd,0x3f7aed37,0x3e3b6ecf,0x3e4ada4f
.long 0x3f79c79d,0x3f78b47b,0x3e605c13,0x3e72b651,0x3f778bc5,0x3f76167a,0x3e827dc0,0x3e8d17c0
.long 0x3f74fa0b,0x3f731447,0x3e94a031,0x3ea09ae5,0x3f721352,0x3f6faf1b,0x3ea68f12,0x3eb3dca5
.long 0x3f6ed89e,0x3f6be858,0x3eb8442a,0x3ec6d529,0x3f6b4b0c,0x3f67c187,0x3ec9b953,0x3ed97cb9
.long 0x3f676bd8,0x3f633c5a,0x3edae880,0x3eebcbbb,0x3f633c5a,0x3f5e5aa6,0x3eebcbbb,0x3efdbabb
.long 0x3f5ebe05,0x3f591e6a,0x3efc5d27,0x3f07a136,0x3f59f26a,0x3f5389c7,0x3f064b82,0x3f102dd5
.long 0x3f54db31,0x3f4d9f02,0x3f0e39da,0x3f187fc0,0x3f4f7a1f,0x3f476085,0x3f15f6d9,0x3f209393
.long 0x3f49d112,0x3f40d0da,0x3f1d7fd1,0x3f286605,0x3f43e200,0x3f39f2ac,0x3f24d225,0x3f2ff3e6
.long 0x3f3daef9,0x3f32c8c9,0x3f2beb4a,0x3f373a23,0x3f373a23,0x3f2b561b,0x3f32c8c9,0x3f3e35c5
.long 0x3f3085bb,0x3f239da9,0x3f396842,0x3f44e3f5,0x3f299415,0x3f1ba299,0x3f3fc767,0x3f4b41fa
.long 0x3f226799,0x3f13682a,0x3f45e403,0x3f514d3d,0x3f1b02c6,0x3f0af1b7,0x3f4bbbf8,0x3f570348
.long 0x3f13682a,0x3f0242b1,0x3f514d3d,0x3f5c61c7,0x3f0b9a6b,0x3ef2bd43,0x3f5695e5,0x3f61668a
.long 0x3f039c3d,0x3ee0924f,0x3f5b941a,0x3f660f88,0x3ef6e0cb,0x3ece0bea,0x3f604621,0x3f6a5ad9
.long 0x3ee63375,0x3ebb31a0,0x3f64aa59,0x3f6e46be,0x3ed53641,0x3ea80b1f,0x3f68bf3c,0x3f71d19f
.long 0x3f800000,0x3f800000,0x0,0x0,0x3f7fe129,0x3f7fdaaf,0x3cfb49ba,0x3d0a342f
.long 0x3f7f84ab,0x3f7f6ac7,0x3d7b2b74,0x3d8a200a,0x3f7eea9d,0x3f7eb069,0x3dbc3ac3,0x3dcefdb7
.long 0x3f7e1324,0x3f7dabcc,0x3dfab273,0x3e09cf86,0x3f7cfe73,0x3f7c5d3a,0x3e1c76de,0x3e2bf804
.long 0x3f7baccd,0x3f7ac516,0x3e3b6ecf,0x3e4dee60,0x3f7a1e84,0x3f78e3d6,0x3e5a3997,0x3e6fa8b2
.long 0x3f7853f8,0x3f76ba07,0x3e78cfcc,0x3e888e93,0x3f764d97,0x3f74484b,0x3e8b9507,0x3e9920fe
.long 0x3f740bdd,0x3f718f57,0x3e9aa086,0x3ea986c4,0x3f718f57,0x3f6e8ff8,0x3ea986c4,0x3eb9bb1e
.long 0x3f6ed89e,0x3f6b4b0c,0x3eb8442a,0x3ec9b953,0x3f6be858,0x3f67c187,0x3ec6d529,0x3ed97cb9
.long 0x3f68bf3c,0x3f63f473,0x3ed53641,0x3ee900b7,0x3f655e0b,0x3f5fe4e9,0x3ee363fa,0x3ef840c8
.long 0x3f61c598,0x3f5b941a,0x3ef15aea,0x3f039c3d,0x3f5df6be,0x3f570348,0x3eff17b2,0x3f0af1b7
.long 0x3f59f26a,0x3f5233c6,0x3f064b82,0x3f121eb0,0x3f55b993,0x3f4d26fd,0x3f0cead0,0x3f19210f
.long 0x3f514d3d,0x3f47de65,0x3f13682a,0x3f1ff6cb,0x3f4cae79,0x3f425b89,0x3f19c200,0x3f269de3
.long 0x3f47de65,0x3f3ca003,0x3f1ff6cb,0x3f2d1469,0x3f42de29,0x3f36ad7f,0x3f26050a,0x3f33587a
.long 0x3f3daef9,0x3f3085bb,0x3f2beb4a,0x3f396842,0x3f385216,0x3f2a2a80,0x3f31a81d,0x3f3f41fc
.long 0x3f32c8c9,0x3f239da9,0x3f373a23,0x3f44e3f5,0x3f2d1469,0x3f1ce11f,0x3f3ca003,0x3f4a4c87
.long 0x3f273656,0x3f15f6d9,0x3f41d870,0x3f4f7a1f,0x3f212ff9,0x3f0ee0db,0x3f46e22a,0x3f546b3b
.long 0x3f1b02c6,0x3f07a136,0x3f4bbbf8,0x3f591e6a,0x3f14b039,0x3f003a06,0x3f5064af,0x3f5d924d
.long 0x3f800000,0x3f800000,0x0,0x0,0x3f7fc38f,0x3f7fba9e,0x3d2fe007,0x3d3c6dd5
.long 0x3f7f0e58,0x3f7eea9d,0x3dafb680,0x3dbc3ac3,0x3f7de0b1,0x3f7d906e,0x3e039502,0x3e0cec4a
.long 0x3f7c3b28,0x3f7baccd,0x3e2f10a2,0x3e3b6ecf,0x3f7a1e84,0x3f7940c0,0x3e5a3997,0x3e698bba
.long 0x3f778bc5,0x3f764d97,0x3e827dc0,0x3e8b9507,0x3f748422,0x3f72d4eb,0x3e97a117,0x3ea21887
.long 0x3f710908,0x3f6ed89e,0x3eac7cd4,0x3eb8442a,0x3f6d1c1d,0x3f6a5ad9,0x3ec1071e,0x3ece0bea
.long 0x3f68bf3c,0x3f655e0b,0x3ed53641,0x3ee363fa,0x3f63f473,0x3f5fe4e9,0x3ee900b7,0x3ef840c8
.long 0x3f5ebe05,0x3f59f26a,0x3efc5d27,0x3f064b82,0x3f591e6a,0x3f5389c7,0x3f07a136,0x3f102dd5
.long 0x3f531849,0x3f4cae79,0x3f10d3cd,0x3f19c200,0x3f4cae79,0x3f456439,0x3f19c200,0x3f2302d3
.long 0x3f45e403,0x3f3daef9,0x3f226799,0x3f2beb4a,0x3f3ebc1b,0x3f3592e7,0x3f2ac082,0x3f34768f
.long 0x3f373a23,0x3f2d1469,0x3f32c8c9,0x3f3ca003,0x3f2f61a5,0x3f24381a,0x3f3a7ca4,0x3f446337
.long 0x3f273656,0x3f1b02c6,0x3f41d870,0x3f4bbbf8,0x3f1ebc12,0x3f11796b,0x3f48d8b3,0x3f52a649
.long 0x3f15f6d9,0x3f07a136,0x3f4f7a1f,0x3f591e6a,0x3f0cead0,0x3efafef7,0x3f55b993,0x3f5f20db
.long 0x3f039c3d,0x3ee63375,0x3f5b941a,0x3f64aa59,0x3ef41f07,0x3ed0eb2a,0x3f6106f2,0x3f69b7e4
.long 0x3ee0924f,0x3ebb31a0,0x3f660f88,0x3f6e46be,0x3ecc9b8b,0x3ea5129f,0x3f6aab7b,0x3f725470
.long 0x3eb8442a,0x3e8e9a22,0x3f6ed89e,0x3f75dec6,0x3ea395c5,0x3e6fa8b2,0x3f7294f8,0x3f78e3d6
.long 0x3e8e9a22,0x3e419b37,0x3f75dec6,0x3f7b61fc,0x3e72b651,0x3e1324ca,0x3f78b47b,0x3f7d57de
.long 0x3f800000,0x3f800000,0x0,0x0,0x3f7fb10f,0x3f7fa6e3,0x3d48fb30,0x3d55880e
.long 0x3f7ec46d,0x3f7e9bc9,0x3dc8bd36,0x3dd53db9,0x3f7d3aac,0x3f7cdf6c,0x3e164083,0x3e1f917b
.long 0x3f7b14be,0x3f7a7302,0x3e47c5c2,0x3e541501,0x3f7853f8,0x3f77583a,0x3e78cfcc,0x3e840270
.long 0x3f74fa0b,0x3f73913f,0x3e94a031,0x3e9d9e78,0x3f710908,0x3f6f20b0,0x3eac7cd4,0x3eb6ccc3
.long 0x3f6c835e,0x3f6a09a7,0x3ec3ef15,0x3ecf7bca,0x3f676bd8,0x3f644fac,0x3edae880,0x3ee79a5d
.long 0x3f61c598,0x3f5df6be,0x3ef15aea,0x3eff17b2,0x3f5b941a,0x3f570348,0x3f039c3d,0x3f0af1b7
.long 0x3f54db31,0x3f4f7a1f,0x3f0e39da,0x3f15f6d9,0x3f4d9f02,0x3f476085,0x3f187fc0,0x3f209393
.long 0x3f45e403,0x3f3ebc1b,0x3f226799,0x3f2ac082,0x3f3daef9,0x3f3592e7,0x3f2beb4a,0x3f34768f
.long 0x3f3504f3,0x3f2beb4a,0x3f3504f3,0x3f3daef9,0x3f2beb4a,0x3f21cbfb,0x3f3daef9,0x3f466354
.long 0x3f226799,0x3f173c07,0x3f45e403,0x3f4e8d90,0x3f187fc0,0x3f0c42c9,0x3f4d9f02,0x3f5627fe
.long 0x3f0e39da,0x3f00e7e4,0x3f54db31,0x3f5d2d53,0x3f039c3d,0x3eea6681,0x3f5b941a,0x3f6398ac
.long 0x3ef15aea,0x3ed25a09,0x3f61c598,0x3f696591,0x3edae880,0x3eb9bb1e,0x3f676bd8,0x3f6e8ff8
.long 0x3ec3ef15,0x3ea09ae5,0x3f6c835e,0x3f731447,0x3eac7cd4,0x3e870ada,0x3f710908,0x3f76ef5b
.long 0x3e94a031,0x3e5a3997,0x3f74fa0b,0x3f7a1e84,0x3e78cfcc,0x3e25c58c,0x3f7853f8,0x3f7c9f8a
.long 0x3e47c5c2,0x3de1bc2e,0x3f7b14be,0x3f7e70b0,0x3e164083,0x3d6ea038,0x3f7d3aac,0x3f7f90b1
.long 0x3dc8bd36,0x3bc90f88,0x3f7ec46d,0x3f7ffec4,0x3d48fb30,0xbd3c6dd5,0x3f7fb10f,0x3f7fba9e
.long 0x3f800000,0x3f800000,0x0,0x0,0x3f7f84ab,0x3f7f7808,0x3d7b2b74,0x3d83db0a
.long 0x3f7e1324,0x3f7de0b1,0x3dfab273,0x3e039502,0x3f7baccd,0x3f7b3bab,0x3e3b6ecf,0x3e44b0b9
.long 0x3f7853f8,0x3f778bc5,0x3e78cfcc,0x3e827dc0,0x3f740bdd,0x3f72d4eb,0x3e9aa086,0x3ea21887
.long 0x3f6ed89e,0x3f6d1c1d,0x3eb8442a,0x3ec1071e,0x3f68bf3c,0x3f666771,0x3ed53641,0x3edf28a9
.long 0x3f61c598,0x3f5ebe05,0x3ef15aea,0x3efc5d27,0x3f59f26a,0x3f5627fe,0x3f064b82,0x3f0c42c9
.long 0x3f514d3d,0x3f4cae79,0x3f13682a,0x3f19c200,0x3f47de65,0x3f425b89,0x3f1ff6cb,0x3f269de3
.long 0x3f3daef9,0x3f373a23,0x3f2beb4a,0x3f32c8c9,0x3f32c8c9,0x3f2b561b,0x3f373a23,0x3f3e35c5
.long 0x3f273656,0x3f1ebc12,0x3f41d870,0x3f48d8b3,0x3f1b02c6,0x3f11796b,0x3f4bbbf8,0x3f52a649
.long 0x3f0e39da,0x3f039c3d,0x3f54db31,0x3f5b941a,0x3f00e7e4,0x3eea6681,0x3f5d2d53,0x3f6398ac
.long 0x3ee63375,0x3ecc9b8b,0x3f64aa59,0x3f6aab7b,0x3ec9b953,0x3eadf73c,0x3f6b4b0c,0x3f70c501
.long 0x3eac7cd4,0x3e8e9a22,0x3f710908,0x3f75dec6,0x3e8e9a22,0x3e5d4b1a,0x3f75dec6,0x3f79f35e
.long 0x3e605c13,0x3e1c76de,0x3f79c79d,0x3f7cfe73,0x3e22abb6,0x3db5f8da,0x3f7cbfc9,0x3f7efcc9
.long 0x3dc8bd36,0x3cc90ab0,0x3f7ec46d,0x3f7fec43,0x3d16c32c,0xbd2351cb,0x3f7fd397,0x3f7fcbe2
.long 0xbcc90ab0,0xbdd53db9,0x3f7fec43,0x3f7e9bc9,0xbdafb680,0xbe2bf804,0x3f7f0e58,0x3f7c5d3a
.long 0xbe164083,0xbe6c9a7f,0x3f7d3aac,0x3f791298,0xbe541501,0xbe9620d2,0x3f7a7302,0x3f74bf62
.long 0xbe888e93,0xbeb554ec,0x3f76ba07,0x3f6f6830,0xbea68f12,0xbed3c867,0x3f721352,0x3f6912ae
.long 0x3f800000,0x3f800000,0x0,0x0,0x3f7f9c18,0x3f7f90b1,0x3d621469,0x3d6ea038
.long 0x3f7e70b0,0x3f7e4323,0x3de1bc2e,0x3dee3876,0x3f7c7eb0,0x3f7c187a,0x3e28defc,0x3e3228d4
.long 0x3f79c79d,0x3f791298,0x3e605c13,0x3e6c9a7f,0x3f764d97,0x3f75341d,0x3e8b9507,0x3e931f35
.long 0x3f721352,0x3f708066,0x3ea68f12,0x3eaf713a,0x3f6d1c1d,0x3f6afb8c,0x3ec1071e,0x3ecb2aae
.long 0x3f676bd8,0x3f64aa59,0x3edae880,0x3ee63375,0x3f6106f2,0x3f5d924d,0x3ef41f07,0x3f003a06
.long 0x3f59f26a,0x3f55b993,0x3f064b82,0x3f0cead0,0x3f5233c6,0x3f4d26fd,0x3f121eb0,0x3f19210f
.long 0x3f49d112,0x3f43e200,0x3f1d7fd1,0x3f24d225,0x3f40d0da,0x3f39f2ac,0x3f286605,0x3f2ff3e6
.long 0x3f373a23,0x3f2f61a5,0x3f32c8c9,0x3f3a7ca4,0x3f2d1469,0x3f24381a,0x3f3ca003,0x3f446337
.long 0x3f226799,0x3f187fc0,0x3f45e403,0x3f4d9f02,0x3f173c07,0x3f0c42c9,0x3f4e8d90,0x3f5627fe
.long 0x3f0b9a6b,0x3eff17b2,0x3f5695e5,0x3f5df6be,0x3eff17b2,0x3ee4cbfe,0x3f5df6be,0x3f650479
.long 0x3ee63375,0x3ec9b953,0x3f64aa59,0x3f6b4b0c,0x3ecc9b8b,0x3eadf73c,0x3f6aab7b,0x3f70c501
.long 0x3eb263ef,0x3e919ddd,0x3f6ff573,0x3f756d97,0x3e97a117,0x3e698bba,0x3f748422,0x3f7940c0
.long 0x3e78cfcc,0x3e2f10a2,0x3f7853f8,0x3f7c3b28,0x3e419b37,0x3de7fa9a,0x3f7b61fc,0x3f7e5a38
.long 0x3e09cf86,0x3d621469,0x3f7dabcc,0x3f7f9c18,0x3da3308c,0xbb490fc6,0x3f7f2f9d,0x3f7fffb1
.long 0x3cc90ab0,0xbd7b2b74,0x3f7fec43,0x3f7f84ab,0xbcfb49ba,0xbdf475c0,0x3f7fe129,0x3f7e2b72
.long 0xbdafb680,0xbe354098,0x3f7f0e58,0x3f7bf531,0xbe1008b7,0xbe6fa8b2,0x3f7d7474,0x3f78e3d6
.long 0x3f800000,0x3f800000,0x0,0x0,0x3f7f6ac7,0x3f7f5ce9,0x3d8a200a,0x3d9064b4
.long 0x3f7dabcc,0x3f7d7474,0x3e09cf86,0x3e1008b7,0x3f7ac516,0x3f7a4910,0x3e4dee60,0x3e57278f
.long 0x3f76ba07,0x3f75dec6,0x3e888e93,0x3e8e9a22,0x3f718f57,0x3f703b37,0x3ea986c4,0x3eb0eacb
.long 0x3f6b4b0c,0x3f696591,0x3ec9b953,0x3ed25a09,0x3f63f473,0x3f61668a,0x3ee900b7,0x3ef2bd43
.long 0x3f5b941a,0x3f584853,0x3f039c3d,0x3f08f59b,0x3f5233c6,0x3f4e1689,0x3f121eb0,0x3f17de12
.long 0x3f47de65,0x3f42de29,0x3f1ff6cb,0x3f26050a,0x3f3ca003,0x3f36ad7f,0x3f2d1469,0x3f33587a
.long 0x3f3085bb,0x3f299415,0x3f396842,0x3f3fc767,0x3f239da9,0x3f1ba299,0x3f44e3f5,0x3f4b41fa
.long 0x3f15f6d9,0x3f0cead0,0x3f4f7a1f,0x3f55b993,0x3f07a136,0x3efafef7,0x3f591e6a,0x3f5f20db
.long 0x3ef15aea,0x3edae880,0x3f61c598,0x3f676bd8,0x3ed25a09,0x3eb9bb1e,0x3f696591,0x3f6e8ff8
.long 0x3eb263ef,0x3e97a117,0x3f6ff573,0x3f748422,0x3e919ddd,0x3e698bba,0x3f756d97,0x3f7940c0
.long 0x3e605c13,0x3e22abb6,0x3f79c79d,0x3f7cbfc9,0x3e1c76de,0x3db5f8da,0x3f7cfe73,0x3f7efcc9
.long 0x3dafb680,0x3c96c9b6,0x3f7f0e58,0x3f7ff4e6,0x3c96c9b6,0xbd55880e,0x3f7ff4e6,0x3f7fa6e3
.long 0xbd48fb30,0xbdfab273,0x3f7fb10f,0x3f7e1324,0xbdee3876,0xbe44b0b9,0x3f7e4323,0x3f7b3bab
.long 0xbe3b6ecf,0xbe8586ce,0x3f7baccd,0x3f772417,0xbe7ee6e1,0xbea80b1f,0x3f77f110,0x3f71d19f
.long 0xbea09ae5,0xbec9b953,0x3f731447,0x3f6b4b0c,0xbec1071e,0xbeea6681,0x3f6d1c1d,0x3f6398ac
.long 0xbee0924f,0xbf04f484,0x3f660f88,0x3f5ac450,0xbeff17b2,0xbf140c5f,0x3f5df6be,0x3f50d937
.long 0x3f800000,0x3f800000,0x0,0x0,0x3f7f4e6d,0x3f7f3f54,0x3d96a905,0x3d9cecf9
.long 0x3f7d3aac,0x3f7cfe73,0x3e164083,0x3e1c76de,0x3f79c79d,0x3f7940c0,0x3e605c13,0x3e698bba
.long 0x3f74fa0b,0x3f740bdd,0x3e94a031,0x3e9aa086,0x3f6ed89e,0x3f6d67a1,0x3eb8442a,0x3ebf926f
.long 0x3f676bd8,0x3f655e0b,0x3edae880,0x3ee363fa,0x3f5ebe05,0x3f5bfb34,0x3efc5d27,0x3f02ef9f
.long 0x3f54db31,0x3f514d3d,0x3f0e39da,0x3f13682a,0x3f49d112,0x3f456439,0x3f1d7fd1,0x3f2302d3
.long 0x3f3daef9,0x3f385216,0x3f2beb4a,0x3f31a81d,0x3f3085bb,0x3f2a2a80,0x3f396842,0x3f3f41fc
.long 0x3f226799,0x3f1b02c6,0x3f45e403,0x3f4bbbf8,0x3f13682a,0x3f0af1b7,0x3f514d3d,0x3f570348
.long 0x3f039c3d,0x3ef41f07,0x3f5b941a,0x3f6106f2,0x3ee63375,0x3ed0eb2a,0x3f64aa59,0x3f69b7e4
.long 0x3ec3ef15,0x3eac7cd4,0x3f6c835e,0x3f710908,0x3ea09ae5,0x3e870ada,0x3f731447,0x3f76ef5b
.long 0x3e78cfcc,0x3e419b37,0x3f7853f8,0x3f7b61fc,0x3e2f10a2,0x3de7fa9a,0x3f7c3b28,0x3f7e5a38
.long 0x3dc8bd36,0x3d16c32c,0x3f7ec46d,0x3f7fd397,0x3cc90ab0,0xbd2351cb,0x3f7fec43,0x3f7fcbe2
.long 0xbd48fb30,0xbdee3876,0x3f7fb10f,0x3f7e4323,0xbdfab273,0xbe44b0b9,0x3f7e1324,0x3f7b3bab
.long 0xbe47c5c2,0xbe888e93,0x3f7b14be,0x3f76ba07,0xbe888e93,0xbeadf73c,0x3f76ba07,0x3f70c501
.long 0xbeac7cd4,0xbed25a09,0x3f710908,0x3f696591,0xbecf7bca,0xbef58035,0x3f6a09a7,0x3f60a6cf
.long 0xbef15aea,0xbf0b9a6b,0x3f61c598,0x3f5695e5,0xbf08f59b,0xbf1ba299,0x3f584853,0x3f4b41fa
.long 0xbf187fc0,0xbf2ac082,0x3f4d9f02,0x3f3ebc1b,0xbf273656,0xbf38dd65,0x3f41d870,0x3f311722
.long 0x3f800000,0x3f800000,0x0,0x0,0x3f7f0e58,0x3f7efcc9,0x3dafb680,0x3db5f8da
.long 0x3f7c3b28,0x3f7bf531,0x3e2f10a2,0x3e354098,0x3f778bc5,0x3f76ef5b,0x3e827dc0,0x3e870ada
.long 0x3f710908,0x3f6ff573,0x3eac7cd4,0x3eb263ef,0x3f68bf3c,0x3f671599,0x3ed53641,0x3edc53c1
.long 0x3f5ebe05,0x3f5c61c7,0x3efc5d27,0x3f0242b1,0x3f531849,0x3f4fefa8,0x3f10d3cd,0x3f1553b7
.long 0x3f45e403,0x3f41d870,0x3f226799,0x3f273656,0x3f373a23,0x3f3238aa,0x3f32c8c9,0x3f37c655
.long 0x3f273656,0x3f212ff9,0x3f41d870,0x3f46e22a,0x3f15f6d9,0x3f0ee0db,0x3f4f7a1f,0x3f546b3b
.long 0x3f039c3d,0x3ef6e0cb,0x3f5b941a,0x3f604621,0x3ee0924f,0x3ece0bea,0x3f660f88,0x3f6a5ad9
.long 0x3eb8442a,0x3ea395c5,0x3f6ed89e,0x3f7294f8,0x3e8e9a22,0x3e6fa8b2,0x3f75dec6,0x3f78e3d6
.long 0x3e47c5c2,0x3e164083,0x3f7b14be,0x3f7d3aac,0x3de1bc2e,0x3d6ea038,0x3f7e70b0,0x3f7f90b1
.long 0x3cc90ab0,0xbcfb49ba,0x3f7fec43,0x3f7fe129,0xbd7b2b74,0xbdf475c0,0x3f7f84ab,0x3f7e2b72
.long 0xbe164083,0xbe541501,0x3f7d3aac,0x3f7a7302,0xbe6c9a7f,0xbe9620d2,0x3f791298,0x3f74bf62
.long 0xbea09ae5,0xbec1071e,0x3f731447,0x3f6d1c1d,0xbec9b953,0xbeea6681,0x3f6b4b0c,0x3f6398ac
.long 0xbef15aea,0xbf08f59b,0x3f61c598,0x3f584853,0xbf0b9a6b,0xbf1ba299,0x3f5695e5,0x3f4b41fa
.long 0xbf1d7fd1,0xbf2d1469,0x3f49d112,0x3f3ca003,0xbf2e3bde,0xbf3d27b8,0x3f3b8f3b,0x3f2c800f
.long 0xbf3daef9,0xbf4bbbf8,0x3f2beb4a,0x3f1b02c6,0xbf4bbbf8,0xbf58b3a1,0x3f1b02c6,0x3f084b92
.long 0xbf584853,0xbf63f473,0x3f08f59b,0x3ee900b7,0xbf633c5a,0xbf6d67a1,0x3eebcbbb,0x3ebf926f
.long 0x3f800000,0x3f800000,0x0,0x0,0x3f7f2f9d,0x3f7f1f49,0x3da3308c,0x3da973ba
.long 0x3f7cbfc9,0x3f7c7eb0,0x3e22abb6,0x3e28defc,0x3f78b47b,0x3f7822d1,0x3e72b651,0x3e7bdba4
.long 0x3f731447,0x3f721352,0x3ea09ae5,0x3ea68f12,0x3f6be858,0x3f6a5ad9,0x3ec6d529,0x3ece0bea
.long 0x3f633c5a,0x3f6106f2,0x3eebcbbb,0x3ef41f07,0x3f591e6a,0x3f5627fe,0x3f07a136,0x3f0c42c9
.long 0x3f4d9f02,0x3f49d112,0x3f187fc0,0x3f1d7fd1,0x3f40d0da,0x3f3c17d9,0x3f286605,0x3f2da859
.long 0x3f32c8c9,0x3f2d1469,0x3f373a23,0x3f3ca003,0x3f239da9,0x3f1ce11f,0x3f44e3f5,0x3f4a4c87
.long 0x3f13682a,0x3f0b9a6b,0x3f514d3d,0x3f5695e5,0x3f0242b1,0x3ef2bd43,0x3f5c61c7,0x3f61668a
.long 0x3ee0924f,0x3ecc9b8b,0x3f660f88,0x3f6aab7b,0x3ebb31a0,0x3ea5129f,0x3f6e46be,0x3f725470
.long 0x3e94a031,0x3e78cfcc,0x3f74fa0b,0x3f7853f8,0x3e5a3997,0x3e25c58c,0x3f7a1e84,0x3f7c9f8a
.long 0x3e09cf86,0x3da3308c,0x3f7dabcc,0x3f7f2f9d,0x3d621469,0xbb490fc6,0x3f7f9c18,0x3f7fffb1
.long 0xbcc90ab0,0xbdafb680,0x3f7fec43,0x3f7f0e58,0xbdd53db9,0xbe2bf804,0x3f7e9bc9,0x3f7c5d3a
.long 0xbe3b6ecf,0xbe7ee6e1,0x3f7baccd,0x3f77f110,0xbe8586ce,0xbea80b1f,0x3f772417,0x3f71d19f
.long 0xbeac7cd4,0xbecf7bca,0x3f710908,0x3f6a09a7,0xbed25a09,0xbef58035,0x3f696591,0x3f60a6cf
.long 0xbef6e0cb,0xbf0cead0,0x3f604621,0x3f55b993,0xbf0cead0,0xbf1e1e22,0x3f55b993,0x3f495521
.long 0xbf1d7fd1,0xbf2e3bde,0x3f49d112,0x3f3b8f3b,0xbf2d1469,0xbf3d27b8,0x3f3ca003,0x3f2c800f
.long 0xbf3b8f3b,0xbf4ac77f,0x3f2e3bde,0x3f1c420c,0xbf48d8b3,0xbf570348,0x3f1ebc12,0x3f0af1b7
.long 0x3f800000,0x3f800000,0x0,0x0,0x3f7eea9d,0x3f7ed7d4,0x3dbc3ac3,0x3dc27c39
.long 0x3f7baccd,0x3f7b61fc,0x3e3b6ecf,0x3e419b37,0x3f764d97,0x3f75a67b,0x3e8b9507,0x3e901c2c
.long 0x3f6ed89e,0x3f6db293,0x3eb8442a,0x3ebe1d4a,0x3f655e0b,0x3f6398ac,0x3ee363fa,0x3eea6681
.long 0x3f59f26a,0x3f577026,0x3f064b82,0x3f0a48ad,0x3f4cae79,0x3f495521,0x3f19c200,0x3f1e1e22
.long 0x3f3daef9,0x3f396842,0x3f2beb4a,0x3f3085bb,0x3f2d1469,0x3f27ce61,0x3f3ca003,0x3f4154e1
.long 0x3f1b02c6,0x3f14b039,0x3f4bbbf8,0x3f5064af,0x3f07a136,0x3f003a06,0x3f591e6a,0x3f5d924d
.long 0x3ee63375,0x3ed53641,0x3f64aa59,0x3f68bf3c,0x3ebb31a0,0x3ea80b1f,0x3f6e46be,0x3f71d19f
.long 0x3e8e9a22,0x3e72b651,0x3f75dec6,0x3f78b47b,0x3e419b37,0x3e1324ca,0x3f7b61fc,0x3f7d57de
.long 0x3dc8bd36,0x3d48fb30,0x3f7ec46d,0x3f7fb10f,0x3bc90f88,0xbd3c6dd5,0x3f7ffec4,0x3f7fba9e
.long 0xbdafb680,0xbe1008b7,0x3f7f0e58,0x3f7d7474,0xbe354098,0xbe6fa8b2,0x3f7bf531,0x3f78e3d6
.long 0xbe888e93,0xbea68f12,0x3f76ba07,0x3f721352,0xbeb554ec,0xbed3c867,0x3f6f6830,0x3f6912ae
.long 0xbee0924f,0xbeff17b2,0x3f660f88,0x3f5df6be,0xbf04f484,0xbf140c5f,0x3f5ac450,0x3f50d937
.long 0xbf187fc0,0xbf273656,0x3f4d9f02,0x3f41d870,0xbf2ac082,0xbf38dd65,0x3f3ebc1b,0x3f311722
.long 0xbf3b8f3b,0xbf48d8b3,0x3f2e3bde,0x3f1ebc12,0xbf4ac77f,0xbf570348,0x3f1c420c,0x3f0af1b7
.long 0xbf584853,0xbf633c5a,0x3f08f59b,0x3eebcbbb,0xbf63f473,0xbf6d67a1,0x3ee900b7,0x3ebf926f
.long 0xbf6db293,0xbf756d97,0x3ebe1d4a,0x3e919ddd,0xbf756d97,0xbf7b3bab,0x3e919ddd,0x3e44b0b9
.long 0x3f803f80,0x3f803f80,0x3f803f80,0x3f803f80,0x3f7b3f80,0x3f553f6d,0x3f0e3f35,0x3e483ec4
.long 0x3f6d3f80,0x3ec43f35,0xbec4248d,0xbf6dbf35,0x3f553f80,0xbe483ec4,0xbf7bbf35,0xbf0ebf6d
.long 0x3f353f80,0xbf35248d,0xbf35bf80,0x3f35a554,0x3f0e3f80,0xbf7bbec4,0x3e48bf35,0x3f553f6d
.long 0x3ec43f80,0xbf6dbf35,0x3f6da554,0xbec43f35,0x3e483f80,0xbf0ebf6d,0x3f553f35,0xbf7bbec4
.long 0x248d3f80,0xa554bf80,0x248d3f80,0xa554bf80,0xbe483f80,0x3f0ebf6d,0xbf553f35,0x3f7bbec4
.long 0xbec43f80,0x3f6dbf35,0xbf6d248d,0x3ec43f35,0xbf0e3f80,0x3f7bbec4,0xbe48bf35,0xbf553f6d
.long 0xbf353f80,0x3f35a554,0x3f35bf80,0xbf35248d,0xbf553f80,0x3e483ec4,0x3f7bbf35,0x3f0ebf6d
.long 0xbf6d3f80,0xbec43f35,0x3ec4a554,0x3f6dbf35,0xbf7b3f80,0xbf553f6d,0xbf0e3f35,0xbe483ec4
.long 0xbf803f80,0xbf803f80,0xbf803f80,0xbf803f80,0xbf7b3f80,0xbf553f6d,0xbf0e3f35,0xbe483ec4
.long 0xbf6d3f80,0xbec43f35,0x3ec4248d,0x3f6dbf35,0xbf553f80,0x3e483ec4,0x3f7bbf35,0x3f0ebf6d
.long 0xbf353f80,0x3f35248d,0x3f35bf80,0xbf35a554,0xbf0e3f80,0x3f7bbec4,0xbe48bf35,0xbf553f6d
.long 0xbec43f80,0x3f6dbf35,0xbf6da554,0x3ec43f35,0xbe483f80,0x3f0ebf6d,0xbf553f35,0x3f7bbec4
.long 0xa5543f80,0x248dbf80,0xa5543f80,0x248dbf80,0x3e483f80,0xbf0ebf6d,0x3f553f35,0xbf7bbec4
.long 0x3ec43f80,0xbf6dbf35,0x3f6d248d,0xbec43f35,0x3f0e3f80,0xbf7bbec4,0x3e48bf35,0x3f553f6d
.long 0x3f353f80,0xbf35a554,0xbf35bf80,0x3f35248d,0x3f553f80,0xbe483ec4,0xbf7bbf35,0xbf0ebf6d
.long 0x3f6d3f80,0x3ec43f35,0xbec4a554,0xbf6dbf35,0x3f7b3f80,0x3f553f6d,0x3f0e3f35,0x3e483ec4
.long 0x0,0x0,0x0,0x0,0x3e480000,0x3f0e3ec4,0x3f553f35,0x3f7b3f6d
.long 0x3ec40000,0x3f6d3f35,0x3f6d3f80,0x3ec43f35,0x3f0e0000,0x3f7b3f6d,0x3e483f35,0xbf55bec4
.long 0x3f350000,0x3f353f80,0xbf35250d,0xbf35bf80,0x3f550000,0x3e483f6d,0xbf7bbf35,0x3f0ebec4
.long 0x3f6d0000,0xbec43f35,0xbec4bf80,0x3f6d3f35,0x3f7b0000,0xbf553ec4,0x3f0ebf35,0xbe483f6d
.long 0x3f800000,0xbf80250d,0x3f800000,0xbf80250d,0x3f7b0000,0xbf55bec4,0x3f0e3f35,0xbe48bf6d
.long 0x3f6d0000,0xbec4bf35,0xbec43f80,0x3f6dbf35,0x3f550000,0x3e48bf6d,0xbf7b3f35,0x3f0e3ec4
.long 0x3f350000,0x3f35bf80,0xbf35250d,0xbf353f80,0x3f0e0000,0x3f7bbf6d,0x3e48bf35,0xbf553ec4
.long 0x3ec40000,0x3f6dbf35,0x3f6dbf80,0x3ec4bf35,0x3e480000,0x3f0ebec4,0x3f55bf35,0x3f7bbf6d
.long 0x250d0000,0x250d0000,0x250d0000,0x250d0000,0xbe480000,0xbf0e3ec4,0xbf553f35,0xbf7b3f6d
.long 0xbec40000,0xbf6d3f35,0xbf6d3f80,0xbec43f35,0xbf0e0000,0xbf7b3f6d,0xbe483f35,0x3f55bec4
.long 0xbf350000,0xbf353f80,0x3f35250d,0x3f35bf80,0xbf550000,0xbe483f6d,0x3f7bbf35,0xbf0ebec4
.long 0xbf6d0000,0x3ec43f35,0x3ec4bf80,0xbf6d3f35,0xbf7b0000,0x3f553ec4,0xbf0ebf35,0x3e483f6d
.long 0xbf800000,0x3f80250d,0xbf800000,0x3f80250d,0xbf7b0000,0x3f55bec4,0xbf0e3f35,0x3e48bf6d
.long 0xbf6d0000,0x3ec4bf35,0x3ec43f80,0xbf6dbf35,0xbf550000,0xbe48bf6d,0x3f7b3f35,0xbf0e3ec4
.long 0xbf350000,0xbf35bf80,0x3f35250d,0x3f353f80,0xbf0e0000,0xbf7bbf6d,0xbe48bf35,0x3f553ec4
.long 0xbec40000,0xbf6dbf35,0xbf6dbf80,0xbec4bf35,0xbe480000,0xbf0ebec4,0xbf55bf35,0xbf7bbf6d
.long 0x3f803f80,0x3f803f80,0x3f803f80,0x3f803f80,0xbe48248d,0xbf0ebec4,0xbf55bf35,0xbf7bbf6d
.long 0xbf6dbf80,0xbec4bf35,0x3ec4a554,0x3f6d3f35,0x3f0ea554,0x3f7b3f6d,0x3e483f35,0xbf55bec4
.long 0x3f353f80,0xbf35248d,0xbf35bf80,0x3f35a554,0xbf55248d,0xbe48bf6d,0x3f7b3f35,0xbf0e3ec4
.long 0xbec4bf80,0x3f6d3f35,0xbf6d248d,0x3ec4bf35,0x3f7ba554,0xbf553ec4,0x3f0ebf35,0xbe483f6d
.long 0x248d3f80,0xa554bf80,0x248d3f80,0xa554bf80,0xbf7b248d,0x3f553ec4,0xbf0ebf35,0x3e483f6d
.long 0x3ec4bf80,0xbf6d3f35,0x3f6da554,0xbec4bf35,0x3f55a554,0x3e48bf6d,0xbf7b3f35,0x3f0e3ec4
.long 0xbf353f80,0x3f35a554,0x3f35bf80,0xbf35248d,0xbf0e248d,0xbf7b3f6d,0xbe483f35,0x3f55bec4
.long 0x3f6dbf80,0x3ec4bf35,0xbec4248d,0xbf6d3f35,0x3e48a554,0x3f0ebec4,0x3f55bf35,0x3f7bbf6d
.long 0xbf803f80,0xbf803f80,0xbf803f80,0xbf803f80,0x3e48248d,0x3f0ebec4,0x3f55bf35,0x3f7bbf6d
.long 0x3f6dbf80,0x3ec4bf35,0xbec4a554,0xbf6d3f35,0xbf0ea554,0xbf7b3f6d,0xbe483f35,0x3f55bec4
.long 0xbf353f80,0x3f35248d,0x3f35bf80,0xbf35a554,0x3f55248d,0x3e48bf6d,0xbf7b3f35,0x3f0e3ec4
.long 0x3ec4bf80,0xbf6d3f35,0x3f6d248d,0xbec4bf35,0xbf7ba554,0x3f553ec4,0xbf0ebf35,0x3e483f6d
.long 0xa5543f80,0x248dbf80,0xa5543f80,0x248dbf80,0x3f7b248d,0xbf553ec4,0x3f0ebf35,0xbe483f6d
.long 0xbec4bf80,0x3f6d3f35,0xbf6da554,0x3ec4bf35,0xbf55a554,0xbe48bf6d,0x3f7b3f35,0xbf0e3ec4
.long 0x3f353f80,0xbf35a554,0xbf35bf80,0x3f35248d,0x3f0e248d,0x3f7b3f6d,0x3e483f35,0xbf55bec4
.long 0xbf6dbf80,0xbec4bf35,0x3ec4248d,0x3f6d3f35,0xbe48a554,0xbf0ebec4,0xbf55bf35,0xbf7bbf6d
.long 0x0,0x0,0x0,0x0,0x3f7b3f80,0x3f553f6d,0x3f0e3f35,0x3e483ec4
.long 0xbec4250d,0xbf6dbf35,0xbf6dbf80,0xbec4bf35,0xbf55bf80,0x3e48bec4,0x3f7b3f35,0x3f0e3f6d
.long 0x3f350000,0x3f353f80,0xbf35250d,0xbf35bf80,0x3f0e3f80,0xbf7bbec4,0x3e48bf35,0x3f553f6d
.long 0xbf6d250d,0x3ec4bf35,0x3ec43f80,0xbf6dbf35,0xbe48bf80,0x3f0e3f6d,0xbf55bf35,0x3f7b3ec4
.long 0x3f800000,0xbf80250d,0x3f800000,0xbf80250d,0xbe483f80,0x3f0ebf6d,0xbf553f35,0x3f7bbec4
.long 0xbf6d250d,0x3ec43f35,0x3ec4bf80,0xbf6d3f35,0x3f0ebf80,0xbf7b3ec4,0x3e483f35,0x3f55bf6d
.long 0x3f350000,0x3f35bf80,0xbf35250d,0xbf353f80,0xbf553f80,0x3e483ec4,0x3f7bbf35,0x3f0ebf6d
.long 0xbec4250d,0xbf6d3f35,0xbf6d3f80,0xbec43f35,0x3f7bbf80,0x3f55bf6d,0x3f0ebf35,0x3e48bec4
.long 0x250d0000,0x250d0000,0x250d0000,0x250d0000,0xbf7b3f80,0xbf553f6d,0xbf0e3f35,0xbe483ec4
.long 0x3ec4250d,0x3f6dbf35,0x3f6dbf80,0x3ec4bf35,0x3f55bf80,0xbe48bec4,0xbf7b3f35,0xbf0e3f6d
.long 0xbf350000,0xbf353f80,0x3f35250d,0x3f35bf80,0xbf0e3f80,0x3f7bbec4,0xbe48bf35,0xbf553f6d
.long 0x3f6d250d,0xbec4bf35,0xbec43f80,0x3f6dbf35,0x3e48bf80,0xbf0e3f6d,0x3f55bf35,0xbf7b3ec4
.long 0xbf800000,0x3f80250d,0xbf800000,0x3f80250d,0x3e483f80,0xbf0ebf6d,0x3f553f35,0xbf7bbec4
.long 0x3f6d250d,0xbec43f35,0xbec4bf80,0x3f6d3f35,0xbf0ebf80,0x3f7b3ec4,0xbe483f35,0xbf55bf6d
.long 0xbf350000,0xbf35bf80,0x3f35250d,0x3f353f80,0x3f553f80,0xbe483ec4,0xbf7bbf35,0xbf0ebf6d
.long 0x3ec4250d,0x3f6d3f35,0x3f6d3f80,0x3ec43f35,0xbf7bbf80,0xbf55bf6d,0xbf0ebf35,0xbe48bec4
.long 0x3f803f80,0x3f803f80,0x3f803f80,0x3f803f80,0xbf7bbf80,0xbf55bf6d,0xbf0ebf35,0xbe48bec4
.long 0x3f6d3f80,0x3ec43f35,0xbec4248d,0xbf6dbf35,0xbf55bf80,0x3e48bec4,0x3f7b3f35,0x3f0e3f6d
.long 0x3f353f80,0xbf35248d,0xbf35bf80,0x3f35a554,0xbf0ebf80,0x3f7b3ec4,0xbe483f35,0xbf55bf6d
.long 0x3ec43f80,0xbf6dbf35,0x3f6da554,0xbec43f35,0xbe48bf80,0x3f0e3f6d,0xbf55bf35,0x3f7b3ec4
.long 0x248d3f80,0xa554bf80,0x248d3f80,0xa554bf80,0x3e48bf80,0xbf0e3f6d,0x3f55bf35,0xbf7b3ec4
.long 0xbec43f80,0x3f6dbf35,0xbf6d248d,0x3ec43f35,0x3f0ebf80,0xbf7b3ec4,0x3e483f35,0x3f55bf6d
.long 0xbf353f80,0x3f35a554,0x3f35bf80,0xbf35248d,0x3f55bf80,0xbe48bec4,0xbf7b3f35,0xbf0e3f6d
.long 0xbf6d3f80,0xbec43f35,0x3ec4a554,0x3f6dbf35,0x3f7bbf80,0x3f55bf6d,0x3f0ebf35,0x3e48bec4
.long 0xbf803f80,0xbf803f80,0xbf803f80,0xbf803f80,0x3f7bbf80,0x3f55bf6d,0x3f0ebf35,0x3e48bec4
.long 0xbf6d3f80,0xbec43f35,0x3ec4248d,0x3f6dbf35,0x3f55bf80,0xbe48bec4,0xbf7b3f35,0xbf0e3f6d
.long 0xbf353f80,0x3f35248d,0x3f35bf80,0xbf35a554,0x3f0ebf80,0xbf7b3ec4,0x3e483f35,0x3f55bf6d
.long 0xbec43f80,0x3f6dbf35,0xbf6da554,0x3ec43f35,0x3e48bf80,0xbf0e3f6d,0x3f55bf35,0xbf7b3ec4
.long 0xa5543f80,0x248dbf80,0xa5543f80,0x248dbf80,0xbe48bf80,0x3f0e3f6d,0xbf55bf35,0x3f7b3ec4
.long 0x3ec43f80,0xbf6dbf35,0x3f6d248d,0xbec43f35,0xbf0ebf80,0x3f7b3ec4,0xbe483f35,0xbf55bf6d
.long 0x3f353f80,0xbf35a554,0xbf35bf80,0x3f35248d,0xbf55bf80,0x3e48bec4,0x3f7b3f35,0x3f0e3f6d
.long 0x3f6d3f80,0x3ec43f35,0xbec4a554,0xbf6dbf35,0xbf7bbf80,0xbf55bf6d,0xbf0ebf35,0xbe48bec4
.long 0x0,0x0,0x0,0x0,0xbe48250d,0xbf0ebec4,0xbf55bf35,0xbf7bbf6d
.long 0x3ec40000,0x3f6d3f35,0x3f6d3f80,0x3ec43f35,0xbf0e250d,0xbf7bbf6d,0xbe48bf35,0x3f553ec4
.long 0x3f350000,0x3f353f80,0xbf35250d,0xbf35bf80,0xbf55250d,0xbe48bf6d,0x3f7b3f35,0xbf0e3ec4
.long 0x3f6d0000,0xbec43f35,0xbec4bf80,0x3f6d3f35,0xbf7b250d,0x3f55bec4,0xbf0e3f35,0x3e48bf6d
.long 0x3f800000,0xbf80250d,0x3f800000,0xbf80250d,0xbf7b250d,0x3f553ec4,0xbf0ebf35,0x3e483f6d
.long 0x3f6d0000,0xbec4bf35,0xbec43f80,0x3f6dbf35,0xbf55250d,0xbe483f6d,0x3f7bbf35,0xbf0ebec4
.long 0x3f350000,0x3f35bf80,0xbf35250d,0xbf353f80,0xbf0e250d,0xbf7b3f6d,0xbe483f35,0x3f55bec4
.long 0x3ec40000,0x3f6dbf35,0x3f6dbf80,0x3ec4bf35,0xbe48250d,0xbf0e3ec4,0xbf553f35,0xbf7b3f6d
.long 0x250d0000,0x250d0000,0x250d0000,0x250d0000,0x3e48250d,0x3f0ebec4,0x3f55bf35,0x3f7bbf6d
.long 0xbec40000,0xbf6d3f35,0xbf6d3f80,0xbec43f35,0x3f0e250d,0x3f7bbf6d,0x3e48bf35,0xbf553ec4
.long 0xbf350000,0xbf353f80,0x3f35250d,0x3f35bf80,0x3f55250d,0x3e48bf6d,0xbf7b3f35,0x3f0e3ec4
.long 0xbf6d0000,0x3ec43f35,0x3ec4bf80,0xbf6d3f35,0x3f7b250d,0xbf55bec4,0x3f0e3f35,0xbe48bf6d
.long 0xbf800000,0x3f80250d,0xbf800000,0x3f80250d,0x3f7b250d,0xbf553ec4,0x3f0ebf35,0xbe483f6d
.long 0xbf6d0000,0x3ec4bf35,0x3ec43f80,0xbf6dbf35,0x3f55250d,0x3e483f6d,0xbf7bbf35,0x3f0ebec4
.long 0xbf350000,0xbf35bf80,0x3f35250d,0x3f353f80,0x3f0e250d,0x3f7b3f6d,0x3e483f35,0xbf55bec4
.long 0xbec40000,0xbf6dbf35,0xbf6dbf80,0xbec4bf35,0x3e48250d,0x3f0e3ec4,0x3f553f35,0x3f7b3f6d
.long 0x3f803f80,0x3f803f80,0x3f803f80,0x3f803f80,0x3e48a554,0x3f0e3ec4,0x3f553f35,0x3f7b3f6d
.long 0xbf6dbf80,0xbec4bf35,0x3ec4a554,0x3f6d3f35,0xbf0e248d,0xbf7bbf6d,0xbe48bf35,0x3f553ec4
.long 0x3f353f80,0xbf35248d,0xbf35bf80,0x3f35a554,0x3f55a554,0x3e483f6d,0xbf7bbf35,0x3f0ebec4
.long 0xbec4bf80,0x3f6d3f35,0xbf6d248d,0x3ec4bf35,0xbf7b248d,0x3f55bec4,0xbf0e3f35,0x3e48bf6d
.long 0x248d3f80,0xa554bf80,0x248d3f80,0xa554bf80,0x3f7ba554,0xbf55bec4,0x3f0e3f35,0xbe48bf6d
.long 0x3ec4bf80,0xbf6d3f35,0x3f6da554,0xbec4bf35,0xbf55248d,0xbe483f6d,0x3f7bbf35,0xbf0ebec4
.long 0xbf353f80,0x3f35a554,0x3f35bf80,0xbf35248d,0x3f0ea554,0x3f7bbf6d,0x3e48bf35,0xbf553ec4
.long 0x3f6dbf80,0x3ec4bf35,0xbec4248d,0xbf6d3f35,0xbe48248d,0xbf0e3ec4,0xbf553f35,0xbf7b3f6d
.long 0xbf803f80,0xbf803f80,0xbf803f80,0xbf803f80,0xbe48a554,0xbf0e3ec4,0xbf553f35,0xbf7b3f6d
.long 0x3f6dbf80,0x3ec4bf35,0xbec4a554,0xbf6d3f35,0x3f0e248d,0x3f7bbf6d,0x3e48bf35,0xbf553ec4
.long 0xbf353f80,0x3f35248d,0x3f35bf80,0xbf35a554,0xbf55a554,0xbe483f6d,0x3f7bbf35,0xbf0ebec4
.long 0x3ec4bf80,0xbf6d3f35,0x3f6d248d,0xbec4bf35,0x3f7b248d,0xbf55bec4,0x3f0e3f35,0xbe48bf6d
.long 0xa5543f80,0x248dbf80,0xa5543f80,0x248dbf80,0xbf7ba554,0x3f55bec4,0xbf0e3f35,0x3e48bf6d
.long 0xbec4bf80,0x3f6d3f35,0xbf6da554,0x3ec4bf35,0x3f55248d,0x3e483f6d,0xbf7bbf35,0x3f0ebec4
.long 0x3f353f80,0xbf35a554,0xbf35bf80,0x3f35248d,0xbf0ea554,0xbf7bbf6d,0xbe48bf35,0x3f553ec4
.long 0xbf6dbf80,0xbec4bf35,0x3ec4248d,0x3f6d3f35,0x3e48248d,0x3f0e3ec4,0x3f553f35,0x3f7b3f6d
.long 0x0,0x0,0x0,0x0,0xbf7bbf80,0xbf55bf6d,0xbf0ebf35,0xbe48bec4
.long 0xbec4250d,0xbf6dbf35,0xbf6dbf80,0xbec4bf35,0x3f553f80,0xbe483ec4,0xbf7bbf35,0xbf0ebf6d
.long 0x3f350000,0x3f353f80,0xbf35250d,0xbf35bf80,0xbf0ebf80,0x3f7b3ec4,0xbe483f35,0xbf55bf6d
.long 0xbf6d250d,0x3ec4bf35,0x3ec43f80,0xbf6dbf35,0x3e483f80,0xbf0ebf6d,0x3f553f35,0xbf7bbec4
.long 0x3f800000,0xbf80250d,0x3f800000,0xbf80250d,0x3e48bf80,0xbf0e3f6d,0x3f55bf35,0xbf7b3ec4
.long 0xbf6d250d,0x3ec43f35,0x3ec4bf80,0xbf6d3f35,0xbf0e3f80,0x3f7bbec4,0xbe48bf35,0xbf553f6d
.long 0x3f350000,0x3f35bf80,0xbf35250d,0xbf353f80,0x3f55bf80,0xbe48bec4,0xbf7b3f35,0xbf0e3f6d
.long 0xbec4250d,0xbf6d3f35,0xbf6d3f80,0xbec43f35,0xbf7b3f80,0xbf553f6d,0xbf0e3f35,0xbe483ec4
.long 0x250d0000,0x250d0000,0x250d0000,0x250d0000,0x3f7bbf80,0x3f55bf6d,0x3f0ebf35,0x3e48bec4
.long 0x3ec4250d,0x3f6dbf35,0x3f6dbf80,0x3ec4bf35,0xbf553f80,0x3e483ec4,0x3f7bbf35,0x3f0ebf6d
.long 0xbf350000,0xbf353f80,0x3f35250d,0x3f35bf80,0x3f0ebf80,0xbf7b3ec4,0x3e483f35,0x3f55bf6d
.long 0x3f6d250d,0xbec4bf35,0xbec43f80,0x3f6dbf35,0xbe483f80,0x3f0ebf6d,0xbf553f35,0x3f7bbec4
.long 0xbf800000,0x3f80250d,0xbf800000,0x3f80250d,0xbe48bf80,0x3f0e3f6d,0xbf55bf35,0x3f7b3ec4
.long 0x3f6d250d,0xbec43f35,0xbec4bf80,0x3f6d3f35,0x3f0e3f80,0xbf7bbec4,0x3e48bf35,0x3f553f6d
.long 0xbf350000,0xbf35bf80,0x3f35250d,0x3f353f80,0xbf55bf80,0x3e48bec4,0x3f7b3f35,0x3f0e3f6d
.long 0x3ec4250d,0x3f6d3f35,0x3f6d3f80,0x3ec43f35,0x3f7b3f80,0x3f553f6d,0x3f0e3f35,0x3e483ec4
.long 0x80008000,0x80008000,0x80008000,0x80008000,0xbe488000,0xbf0ebec4,0xbf55bf35,0xbf7bbf6d
.long 0xbec48000,0xbf6dbf35,0xbf6dbf80,0xbec4bf35,0xbf0e8000,0xbf7bbf6d,0xbe48bf35,0x3f553ec4
.long 0xbf358000,0xbf35bf80,0x3f35a50d,0x3f353f80,0xbf558000,0xbe48bf6d,0x3f7b3f35,0xbf0e3ec4
.long 0xbf6d8000,0x3ec4bf35,0x3ec43f80,0xbf6dbf35,0xbf7b8000,0x3f55bec4,0xbf0e3f35,0x3e48bf6d
.long 0xbf808000,0x3f80a50d,0xbf808000,0x3f80a50d,0xbf7b8000,0x3f553ec4,0xbf0ebf35,0x3e483f6d
.long 0xbf6d8000,0x3ec43f35,0x3ec4bf80,0xbf6d3f35,0xbf558000,0xbe483f6d,0x3f7bbf35,0xbf0ebec4
.long 0xbf358000,0xbf353f80,0x3f35a50d,0x3f35bf80,0xbf0e8000,0xbf7b3f6d,0xbe483f35,0x3f55bec4
.long 0xbec48000,0xbf6d3f35,0xbf6d3f80,0xbec43f35,0xbe488000,0xbf0e3ec4,0xbf553f35,0xbf7b3f6d
.long 0xa50d8000,0xa50d8000,0xa50d8000,0xa50d8000,0x3e488000,0x3f0ebec4,0x3f55bf35,0x3f7bbf6d
.long 0x3ec48000,0x3f6dbf35,0x3f6dbf80,0x3ec4bf35,0x3f0e8000,0x3f7bbf6d,0x3e48bf35,0xbf553ec4
.long 0x3f358000,0x3f35bf80,0xbf35a50d,0xbf353f80,0x3f558000,0x3e48bf6d,0xbf7b3f35,0x3f0e3ec4
.long 0x3f6d8000,0xbec4bf35,0xbec43f80,0x3f6dbf35,0x3f7b8000,0xbf55bec4,0x3f0e3f35,0xbe48bf6d
.long 0x3f808000,0xbf80a50d,0x3f808000,0xbf80a50d,0x3f7b8000,0xbf553ec4,0x3f0ebf35,0xbe483f6d
.long 0x3f6d8000,0xbec43f35,0xbec4bf80,0x3f6d3f35,0x3f558000,0x3e483f6d,0xbf7bbf35,0x3f0ebec4
.long 0x3f358000,0x3f353f80,0xbf35a50d,0xbf35bf80,0x3f0e8000,0x3f7b3f6d,0x3e483f35,0xbf55bec4
.long 0x3ec48000,0x3f6d3f35,0x3f6d3f80,0x3ec43f35,0x3e488000,0x3f0e3ec4,0x3f553f35,0x3f7b3f6d
.long 0x3f803f80,0x3f803f80,0x3f803f80,0x3f803f80,0x3f7b3f80,0x3f553f6d,0x3f0e3f35,0x3e483ec4
.long 0x3f6d3f80,0x3ec43f35,0xbec4248d,0xbf6dbf35,0x3f553f80,0xbe483ec4,0xbf7bbf35,0xbf0ebf6d
.long 0x3f353f80,0xbf35248d,0xbf35bf80,0x3f35a554,0x3f0e3f80,0xbf7bbec4,0x3e48bf35,0x3f553f6d
.long 0x3ec43f80,0xbf6dbf35,0x3f6da554,0xbec43f35,0x3e483f80,0xbf0ebf6d,0x3f553f35,0xbf7bbec4
.long 0x248d3f80,0xa554bf80,0x248d3f80,0xa554bf80,0xbe483f80,0x3f0ebf6d,0xbf553f35,0x3f7bbec4
.long 0xbec43f80,0x3f6dbf35,0xbf6d248d,0x3ec43f35,0xbf0e3f80,0x3f7bbec4,0xbe48bf35,0xbf553f6d
.long 0xbf353f80,0x3f35a554,0x3f35bf80,0xbf35248d,0xbf553f80,0x3e483ec4,0x3f7bbf35,0x3f0ebf6d
.long 0xbf6d3f80,0xbec43f35,0x3ec4a554,0x3f6dbf35,0xbf7b3f80,0xbf553f6d,0xbf0e3f35,0xbe483ec4
.long 0xbf803f80,0xbf803f80,0xbf803f80,0xbf803f80,0xbf7b3f80,0xbf553f6d,0xbf0e3f35,0xbe483ec4
.long 0xbf6d3f80,0xbec43f35,0x3ec4248d,0x3f6dbf35,0xbf553f80,0x3e483ec4,0x3f7bbf35,0x3f0ebf6d
.long 0xbf353f80,0x3f35248d,0x3f35bf80,0xbf35a554,0xbf0e3f80,0x3f7bbec4,0xbe48bf35,0xbf553f6d
.long 0xbec43f80,0x3f6dbf35,0xbf6da554,0x3ec43f35,0xbe483f80,0x3f0ebf6d,0xbf553f35,0x3f7bbec4
.long 0xa5543f80,0x248dbf80,0xa5543f80,0x248dbf80,0x3e483f80,0xbf0ebf6d,0x3f553f35,0xbf7bbec4
.long 0x3ec43f80,0xbf6dbf35,0x3f6d248d,0xbec43f35,0x3f0e3f80,0xbf7bbec4,0x3e48bf35,0x3f553f6d
.long 0x3f353f80,0xbf35a554,0xbf35bf80,0x3f35248d,0x3f553f80,0xbe483ec4,0xbf7bbf35,0xbf0ebf6d
.long 0x3f6d3f80,0x3ec43f35,0xbec4a554,0xbf6dbf35,0x3f7b3f80,0x3f553f6d,0x3f0e3f35,0x3e483ec4
.long 0x80008000,0x80008000,0x80008000,0x80008000,0xbf7bbf80,0xbf55bf6d,0xbf0ebf35,0xbe48bec4
.long 0x3ec4a50d,0x3f6d3f35,0x3f6d3f80,0x3ec43f35,0x3f553f80,0xbe483ec4,0xbf7bbf35,0xbf0ebf6d
.long 0xbf358000,0xbf35bf80,0x3f35a50d,0x3f353f80,0xbf0ebf80,0x3f7b3ec4,0xbe483f35,0xbf55bf6d
.long 0x3f6da50d,0xbec43f35,0xbec4bf80,0x3f6d3f35,0x3e483f80,0xbf0ebf6d,0x3f553f35,0xbf7bbec4
.long 0xbf808000,0x3f80a50d,0xbf808000,0x3f80a50d,0x3e48bf80,0xbf0e3f6d,0x3f55bf35,0xbf7b3ec4
.long 0x3f6da50d,0xbec4bf35,0xbec43f80,0x3f6dbf35,0xbf0e3f80,0x3f7bbec4,0xbe48bf35,0xbf553f6d
.long 0xbf358000,0xbf353f80,0x3f35a50d,0x3f35bf80,0x3f55bf80,0xbe48bec4,0xbf7b3f35,0xbf0e3f6d
.long 0x3ec4a50d,0x3f6dbf35,0x3f6dbf80,0x3ec4bf35,0xbf7b3f80,0xbf553f6d,0xbf0e3f35,0xbe483ec4
.long 0xa50d8000,0xa50d8000,0xa50d8000,0xa50d8000,0x3f7bbf80,0x3f55bf6d,0x3f0ebf35,0x3e48bec4
.long 0xbec4a50d,0xbf6d3f35,0xbf6d3f80,0xbec43f35,0xbf553f80,0x3e483ec4,0x3f7bbf35,0x3f0ebf6d
.long 0x3f358000,0x3f35bf80,0xbf35a50d,0xbf353f80,0x3f0ebf80,0xbf7b3ec4,0x3e483f35,0x3f55bf6d
.long 0xbf6da50d,0x3ec43f35,0x3ec4bf80,0xbf6d3f35,0xbe483f80,0x3f0ebf6d,0xbf553f35,0x3f7bbec4
.long 0x3f808000,0xbf80a50d,0x3f808000,0xbf80a50d,0xbe48bf80,0x3f0e3f6d,0xbf55bf35,0x3f7b3ec4
.long 0xbf6da50d,0x3ec4bf35,0x3ec43f80,0xbf6dbf35,0x3f0e3f80,0xbf7bbec4,0x3e48bf35,0x3f553f6d
.long 0x3f358000,0x3f353f80,0xbf35a50d,0xbf35bf80,0xbf55bf80,0x3e48bec4,0x3f7b3f35,0x3f0e3f6d
.long 0xbec4a50d,0xbf6dbf35,0xbf6dbf80,0xbec4bf35,0x3f7b3f80,0x3f553f6d,0x3f0e3f35,0x3e483ec4
.long 0x3f803f80,0x3f803f80,0x3f803f80,0x3f803f80,0xbe48248d,0xbf0ebec4,0xbf55bf35,0xbf7bbf6d
.long 0xbf6dbf80,0xbec4bf35,0x3ec4a554,0x3f6d3f35,0x3f0ea554,0x3f7b3f6d,0x3e483f35,0xbf55bec4
.long 0x3f353f80,0xbf35248d,0xbf35bf80,0x3f35a554,0xbf55248d,0xbe48bf6d,0x3f7b3f35,0xbf0e3ec4
.long 0xbec4bf80,0x3f6d3f35,0xbf6d248d,0x3ec4bf35,0x3f7ba554,0xbf553ec4,0x3f0ebf35,0xbe483f6d
.long 0x248d3f80,0xa554bf80,0x248d3f80,0xa554bf80,0xbf7b248d,0x3f553ec4,0xbf0ebf35,0x3e483f6d
.long 0x3ec4bf80,0xbf6d3f35,0x3f6da554,0xbec4bf35,0x3f55a554,0x3e48bf6d,0xbf7b3f35,0x3f0e3ec4
.long 0xbf353f80,0x3f35a554,0x3f35bf80,0xbf35248d,0xbf0e248d,0xbf7b3f6d,0xbe483f35,0x3f55bec4
.long 0x3f6dbf80,0x3ec4bf35,0xbec4248d,0xbf6d3f35,0x3e48a554,0x3f0ebec4,0x3f55bf35,0x3f7bbf6d
.long 0xbf803f80,0xbf803f80,0xbf803f80,0xbf803f80,0x3e48248d,0x3f0ebec4,0x3f55bf35,0x3f7bbf6d
.long 0x3f6dbf80,0x3ec4bf35,0xbec4a554,0xbf6d3f35,0xbf0ea554,0xbf7b3f6d,0xbe483f35,0x3f55bec4
.long 0xbf353f80,0x3f35248d,0x3f35bf80,0xbf35a554,0x3f55248d,0x3e48bf6d,0xbf7b3f35,0x3f0e3ec4
.long 0x3ec4bf80,0xbf6d3f35,0x3f6d248d,0xbec4bf35,0xbf7ba554,0x3f553ec4,0xbf0ebf35,0x3e483f6d
.long 0xa5543f80,0x248dbf80,0xa5543f80,0x248dbf80,0x3f7b248d,0xbf553ec4,0x3f0ebf35,0xbe483f6d
.long 0xbec4bf80,0x3f6d3f35,0xbf6da554,0x3ec4bf35,0xbf55a554,0xbe48bf6d,0x3f7b3f35,0xbf0e3ec4
.long 0x3f353f80,0xbf35a554,0xbf35bf80,0x3f35248d,0x3f0e248d,0x3f7b3f6d,0x3e483f35,0xbf55bec4
.long 0xbf6dbf80,0xbec4bf35,0x3ec4248d,0x3f6d3f35,0xbe48a554,0xbf0ebec4,0xbf55bf35,0xbf7bbf6d
.long 0x80008000,0x80008000,0x80008000,0x80008000,0x3e48a50d,0x3f0e3ec4,0x3f553f35,0x3f7b3f6d
.long 0xbec48000,0xbf6dbf35,0xbf6dbf80,0xbec4bf35,0x3f0ea50d,0x3f7b3f6d,0x3e483f35,0xbf55bec4
.long 0xbf358000,0xbf35bf80,0x3f35a50d,0x3f353f80,0x3f55a50d,0x3e483f6d,0xbf7bbf35,0x3f0ebec4
.long 0xbf6d8000,0x3ec4bf35,0x3ec43f80,0xbf6dbf35,0x3f7ba50d,0xbf553ec4,0x3f0ebf35,0xbe483f6d
.long 0xbf808000,0x3f80a50d,0xbf808000,0x3f80a50d,0x3f7ba50d,0xbf55bec4,0x3f0e3f35,0xbe48bf6d
.long 0xbf6d8000,0x3ec43f35,0x3ec4bf80,0xbf6d3f35,0x3f55a50d,0x3e48bf6d,0xbf7b3f35,0x3f0e3ec4
.long 0xbf358000,0xbf353f80,0x3f35a50d,0x3f35bf80,0x3f0ea50d,0x3f7bbf6d,0x3e48bf35,0xbf553ec4
.long 0xbec48000,0xbf6d3f35,0xbf6d3f80,0xbec43f35,0x3e48a50d,0x3f0ebec4,0x3f55bf35,0x3f7bbf6d
.long 0xa50d8000,0xa50d8000,0xa50d8000,0xa50d8000,0xbe48a50d,0xbf0e3ec4,0xbf553f35,0xbf7b3f6d
.long 0x3ec48000,0x3f6dbf35,0x3f6dbf80,0x3ec4bf35,0xbf0ea50d,0xbf7b3f6d,0xbe483f35,0x3f55bec4
.long 0x3f358000,0x3f35bf80,0xbf35a50d,0xbf353f80,0xbf55a50d,0xbe483f6d,0x3f7bbf35,0xbf0ebec4
.long 0x3f6d8000,0xbec4bf35,0xbec43f80,0x3f6dbf35,0xbf7ba50d,0x3f553ec4,0xbf0ebf35,0x3e483f6d
.long 0x3f808000,0xbf80a50d,0x3f808000,0xbf80a50d,0xbf7ba50d,0x3f55bec4,0xbf0e3f35,0x3e48bf6d
.long 0x3f6d8000,0xbec43f35,0xbec4bf80,0x3f6d3f35,0xbf55a50d,0xbe48bf6d,0x3f7b3f35,0xbf0e3ec4
.long 0x3f358000,0x3f353f80,0xbf35a50d,0xbf35bf80,0xbf0ea50d,0xbf7bbf6d,0xbe48bf35,0x3f553ec4
.long 0x3ec48000,0x3f6d3f35,0x3f6d3f80,0x3ec43f35,0xbe48a50d,0xbf0ebec4,0xbf55bf35,0xbf7bbf6d
.long 0x3f803f80,0x3f803f80,0x3f803f80,0x3f803f80,0xbf7bbf80,0xbf55bf6d,0xbf0ebf35,0xbe48bec4
.long 0x3f6d3f80,0x3ec43f35,0xbec4248d,0xbf6dbf35,0xbf55bf80,0x3e48bec4,0x3f7b3f35,0x3f0e3f6d
.long 0x3f353f80,0xbf35248d,0xbf35bf80,0x3f35a554,0xbf0ebf80,0x3f7b3ec4,0xbe483f35,0xbf55bf6d
.long 0x3ec43f80,0xbf6dbf35,0x3f6da554,0xbec43f35,0xbe48bf80,0x3f0e3f6d,0xbf55bf35,0x3f7b3ec4
.long 0x248d3f80,0xa554bf80,0x248d3f80,0xa554bf80,0x3e48bf80,0xbf0e3f6d,0x3f55bf35,0xbf7b3ec4
.long 0xbec43f80,0x3f6dbf35,0xbf6d248d,0x3ec43f35,0x3f0ebf80,0xbf7b3ec4,0x3e483f35,0x3f55bf6d
.long 0xbf353f80,0x3f35a554,0x3f35bf80,0xbf35248d,0x3f55bf80,0xbe48bec4,0xbf7b3f35,0xbf0e3f6d
.long 0xbf6d3f80,0xbec43f35,0x3ec4a554,0x3f6dbf35,0x3f7bbf80,0x3f55bf6d,0x3f0ebf35,0x3e48bec4
.long 0xbf803f80,0xbf803f80,0xbf803f80,0xbf803f80,0x3f7bbf80,0x3f55bf6d,0x3f0ebf35,0x3e48bec4
.long 0xbf6d3f80,0xbec43f35,0x3ec4248d,0x3f6dbf35,0x3f55bf80,0xbe48bec4,0xbf7b3f35,0xbf0e3f6d
.long 0xbf353f80,0x3f35248d,0x3f35bf80,0xbf35a554,0x3f0ebf80,0xbf7b3ec4,0x3e483f35,0x3f55bf6d
.long 0xbec43f80,0x3f6dbf35,0xbf6da554,0x3ec43f35,0x3e48bf80,0xbf0e3f6d,0x3f55bf35,0xbf7b3ec4
.long 0xa5543f80,0x248dbf80,0xa5543f80,0x248dbf80,0xbe48bf80,0x3f0e3f6d,0xbf55bf35,0x3f7b3ec4
.long 0x3ec43f80,0xbf6dbf35,0x3f6d248d,0xbec43f35,0xbf0ebf80,0x3f7b3ec4,0xbe483f35,0xbf55bf6d
.long 0x3f353f80,0xbf35a554,0xbf35bf80,0x3f35248d,0xbf55bf80,0x3e48bec4,0x3f7b3f35,0x3f0e3f6d
.long 0x3f6d3f80,0x3ec43f35,0xbec4a554,0xbf6dbf35,0xbf7bbf80,0xbf55bf6d,0xbf0ebf35,0xbe48bec4
.long 0x80008000,0x80008000,0x80008000,0x80008000,0x3f7b3f80,0x3f553f6d,0x3f0e3f35,0x3e483ec4
.long 0x3ec4a50d,0x3f6d3f35,0x3f6d3f80,0x3ec43f35,0xbf55bf80,0x3e48bec4,0x3f7b3f35,0x3f0e3f6d
.long 0xbf358000,0xbf35bf80,0x3f35a50d,0x3f353f80,0x3f0e3f80,0xbf7bbec4,0x3e48bf35,0x3f553f6d
.long 0x3f6da50d,0xbec43f35,0xbec4bf80,0x3f6d3f35,0xbe48bf80,0x3f0e3f6d,0xbf55bf35,0x3f7b3ec4
.long 0xbf808000,0x3f80a50d,0xbf808000,0x3f80a50d,0xbe483f80,0x3f0ebf6d,0xbf553f35,0x3f7bbec4
.long 0x3f6da50d,0xbec4bf35,0xbec43f80,0x3f6dbf35,0x3f0ebf80,0xbf7b3ec4,0x3e483f35,0x3f55bf6d
.long 0xbf358000,0xbf353f80,0x3f35a50d,0x3f35bf80,0xbf553f80,0x3e483ec4,0x3f7bbf35,0x3f0ebf6d
.long 0x3ec4a50d,0x3f6dbf35,0x3f6dbf80,0x3ec4bf35,0x3f7bbf80,0x3f55bf6d,0x3f0ebf35,0x3e48bec4
.long 0xa50d8000,0xa50d8000,0xa50d8000,0xa50d8000,0xbf7b3f80,0xbf553f6d,0xbf0e3f35,0xbe483ec4
.long 0xbec4a50d,0xbf6d3f35,0xbf6d3f80,0xbec43f35,0x3f55bf80,0xbe48bec4,0xbf7b3f35,0xbf0e3f6d
.long 0x3f358000,0x3f35bf80,0xbf35a50d,0xbf353f80,0xbf0e3f80,0x3f7bbec4,0xbe48bf35,0xbf553f6d
.long 0xbf6da50d,0x3ec43f35,0x3ec4bf80,0xbf6d3f35,0x3e48bf80,0xbf0e3f6d,0x3f55bf35,0xbf7b3ec4
.long 0x3f808000,0xbf80a50d,0x3f808000,0xbf80a50d,0x3e483f80,0xbf0ebf6d,0x3f553f35,0xbf7bbec4
.long 0xbf6da50d,0x3ec4bf35,0x3ec43f80,0xbf6dbf35,0xbf0ebf80,0x3f7b3ec4,0xbe483f35,0xbf55bf6d
.long 0x3f358000,0x3f353f80,0xbf35a50d,0xbf35bf80,0x3f553f80,0xbe483ec4,0xbf7bbf35,0xbf0ebf6d
.long 0xbec4a50d,0xbf6dbf35,0xbf6dbf80,0xbec4bf35,0xbf7bbf80,0xbf55bf6d,0xbf0ebf35,0xbe48bec4
.long 0x3f803f80,0x3f803f80,0x3f803f80,0x3f803f80,0x3e48a554,0x3f0e3ec4,0x3f553f35,0x3f7b3f6d
.long 0xbf6dbf80,0xbec4bf35,0x3ec4a554,0x3f6d3f35,0xbf0e248d,0xbf7bbf6d,0xbe48bf35,0x3f553ec4
.long 0x3f353f80,0xbf35248d,0xbf35bf80,0x3f35a554,0x3f55a554,0x3e483f6d,0xbf7bbf35,0x3f0ebec4
.long 0xbec4bf80,0x3f6d3f35,0xbf6d248d,0x3ec4bf35,0xbf7b248d,0x3f55bec4,0xbf0e3f35,0x3e48bf6d
.long 0x248d3f80,0xa554bf80,0x248d3f80,0xa554bf80,0x3f7ba554,0xbf55bec4,0x3f0e3f35,0xbe48bf6d
.long 0x3ec4bf80,0xbf6d3f35,0x3f6da554,0xbec4bf35,0xbf55248d,0xbe483f6d,0x3f7bbf35,0xbf0ebec4
.long 0xbf353f80,0x3f35a554,0x3f35bf80,0xbf35248d,0x3f0ea554,0x3f7bbf6d,0x3e48bf35,0xbf553ec4
.long 0x3f6dbf80,0x3ec4bf35,0xbec4248d,0xbf6d3f35,0xbe48248d,0xbf0e3ec4,0xbf553f35,0xbf7b3f6d
.long 0xbf803f80,0xbf803f80,0xbf803f80,0xbf803f80,0xbe48a554,0xbf0e3ec4,0xbf553f35,0xbf7b3f6d
.long 0x3f6dbf80,0x3ec4bf35,0xbec4a554,0xbf6d3f35,0x3f0e248d,0x3f7bbf6d,0x3e48bf35,0xbf553ec4
.long 0xbf353f80,0x3f35248d,0x3f35bf80,0xbf35a554,0xbf55a554,0xbe483f6d,0x3f7bbf35,0xbf0ebec4
.long 0x3ec4bf80,0xbf6d3f35,0x3f6d248d,0xbec4bf35,0x3f7b248d,0xbf55bec4,0x3f0e3f35,0xbe48bf6d
.long 0xa5543f80,0x248dbf80,0xa5543f80,0x248dbf80,0xbf7ba554,0x3f55bec4,0xbf0e3f35,0x3e48bf6d
.long 0xbec4bf80,0x3f6d3f35,0xbf6da554,0x3ec4bf35,0x3f55248d,0x3e483f6d,0xbf7bbf35,0x3f0ebec4
.long 0x3f353f80,0xbf35a554,0xbf35bf80,0x3f35248d,0xbf0ea554,0xbf7bbf6d,0xbe48bf35,0x3f553ec4
.long 0xbf6dbf80,0xbec4bf35,0x3ec4248d,0x3f6d3f35,0x3e48248d,0x3f0e3ec4,0x3f553f35,0x3f7b3f6d
.section .rodata,"a"
.p2align 6
.amdhsa_kernel gated_mix__spectral_gfnet__mixer_token_mlp__prompt_kernel
  .amdhsa_next_free_vgpr 256
  .amdhsa_next_free_sgpr 102
  .amdhsa_accum_offset 256
  .amdhsa_group_segment_fixed_size 0
  .amdhsa_kernarg_size 96
  .amdhsa_user_sgpr_count 2
  .amdhsa_user_sgpr_kernarg_segment_ptr 1
  .amdhsa_system_sgpr_workgroup_id_x 1
.end_amdhsa_kernel
```
